```python
import torch

def _softmax(x, axis=-1):
    return torch.softmax(x, dim=axis)

def _gelu(x):
    return torch.nn.functional.gelu(x, approximate='tanh')

def _silu(x):
    return torch.nn.functional.silu(x)

def _sigmoid(x):
    return torch.sigmoid(x)

def _layernorm(x, axis=-1, eps=1e-05):
    m = x.mean(dim=axis, keepdim=True)
    v = x.var(dim=axis, keepdim=True, unbiased=False)
    return (x - m) / torch.sqrt(v + eps)

def _scatter_add(tgt, idx, src, axis=0):
    return tgt.clone().index_add_(axis, idx, src)

def _segment_sum(src, seg, n):
    out = torch.zeros((n,) + src.shape[1:], dtype=src.dtype)
    return out.index_add_(0, seg, src)

def _pad(x, pw):
    flat = tuple((v for pair in reversed(pw) for v in pair))
    return torch.nn.functional.pad(x, flat)
kernel_name = 'parallel_sum__memory_aug_recurrent_mem_tr__mixer_channel_mlp__prompt'

def setup_inputs():

    _w = lambda a: (lambda t: t.to(torch.bfloat16) if t.is_floating_point() else t)(torch.as_tensor(a))

    def _A_setup():
        B, S, Dm = (1, 2048, 512)
        H, Dh = (32, 128)
        M, seg = (8, 32)
        seg = min(seg, S)
        S = S // seg * seg
        return {'x': _w((lambda *s: torch.randn(*s, dtype=torch.bfloat16) * 0.05)(B, S, Dm)), 'mem0': _w((lambda *s: torch.randn(*s, dtype=torch.bfloat16) * 0.2)(B, M, Dm)), 'Wq': _w((lambda *s: torch.randn(*s, dtype=torch.bfloat16) * 1.6)(Dm, H, Dh) * Dm ** (-0.5)), 'Wk': _w((lambda *s: torch.randn(*s, dtype=torch.bfloat16) * 1.6)(Dm, H, Dh) * Dm ** (-0.5)), 'Wv': _w((lambda *s: torch.randn(*s, dtype=torch.bfloat16) * 0.2)(Dm, H, Dh) * Dm ** (-0.5)), 'Wo': _w((lambda *s: torch.randn(*s, dtype=torch.bfloat16) * 0.2)(H, Dh, Dm) * (H * Dh) ** (-0.5)), 'seg_len': seg}
    _A_in = _A_setup()

    def _B_setup():
        B, S, D, F = (1, 2048, 512, 1792)
        return {'x': _w((lambda *s: torch.randn(*s, dtype=torch.bfloat16) * 0.05)(B, S, D)), 'w1': _w((lambda *s: torch.randn(*s, dtype=torch.bfloat16) * 0.8)(D, F) * D ** (-0.5)), 'b1': _w((lambda *s: torch.randn(*s, dtype=torch.bfloat16) * 0.4)(F)), 'w2': _w((lambda *s: torch.randn(*s, dtype=torch.bfloat16) * 0.05)(F, D) * F ** (-0.5)), 'b2': _w((lambda *s: torch.randn(*s, dtype=torch.bfloat16) * 0.05)(D))}
    _B_in = _B_setup()
    return {'A_x': _A_in['x'], 'A_mem0': _A_in['mem0'], 'A_Wq': _A_in['Wq'], 'A_Wk': _A_in['Wk'], 'A_Wv': _A_in['Wv'], 'A_Wo': _A_in['Wo'], 'A_seg_len': _A_in['seg_len'], 'B_x': _B_in['x'], 'B_w1': _B_in['w1'], 'B_b1': _B_in['b1'], 'B_w2': _B_in['w2'], 'B_b2': _B_in['b2']}

def reference(A_x, A_mem0, A_Wq, A_Wk, A_Wv, A_Wo, A_seg_len, B_x, B_w1, B_b1, B_w2, B_b2):

    def _A_ref(x, mem0, Wq, Wk, Wv, Wo, seg_len):
        B, S, Dm = x.shape
        H, Dh = (Wq.shape[1], Wq.shape[2])
        M = mem0.shape[1]
        scale = Dh ** (-0.5)
        n_seg = S // seg_len
        L = M + seg_len
        idx = torch.arange(L)
        mask = (idx[:, None] < M) | (idx[:, None] >= idx[None, :])
        mem = mem0
        outs = []
        for s in range(n_seg):
            xs = x[:, s * seg_len:(s + 1) * seg_len, :].clone()
            h = torch.concatenate([mem, xs], axis=1)
            q = torch.einsum('btd,dhe->bhte', h, Wq)
            k = torch.einsum('btd,dhe->bhte', h, Wk)
            v = torch.einsum('btd,dhe->bhte', h, Wv)
            scores = torch.einsum('bhqe,bhke->bhqk', q, k) * scale
            scores = torch.where(mask[None, None], scores, -1000000000.0)
            p = _softmax(scores, axis=-1)
            o = torch.einsum('bhqk,bhke->bhqe', p, v)
            o = torch.einsum('bhte,hed->btd', o, Wo)
            mem = o[:, :M, :].clone()
            outs.append(o[:, M:, :])
        return torch.concatenate(outs, axis=1)

    def _B_ref(x, w1, b1, w2, b2):
        y = _layernorm(x, axis=-1)
        h = _gelu(torch.einsum('bsd,df->bsf', y, w1) + b1)
        return torch.einsum('bsf,fd->bsd', h, w2) + b2
    x = A_x
    xn = _layernorm(x, axis=-1)
    return x + _A_ref(xn, A_mem0, A_Wq, A_Wk, A_Wv, A_Wo, A_seg_len) + _B_ref(xn, B_w1, B_b1, B_w2, B_b2)
```

```asm
; @launch kernel=parallel_sum__memory_aug_recurrent_mem_tr__mixer_channel_mlp__prompt_kernel grid=(256,1,1) block=(256,1,1) lds=163840
.amdgcn_target "amdgcn-amd-amdhsa--gfx950"
.text
.globl parallel_sum__memory_aug_recurrent_mem_tr__mixer_channel_mlp__prompt_kernel
.p2align 8
.type parallel_sum__memory_aug_recurrent_mem_tr__mixer_channel_mlp__prompt_kernel,@function
parallel_sum__memory_aug_recurrent_mem_tr__mixer_channel_mlp__prompt_kernel:
    s_cmp_ge_u32 s2, 256
    s_cbranch_scc1 L_end
    s_load_dwordx2 s[16:17], s[0:1], 16
    s_load_dwordx2 s[18:19], s[0:1], 24
    s_load_dwordx2 s[20:21], s[0:1], 32
    s_load_dwordx2 s[22:23], s[0:1], 40
    s_load_dwordx2 s[24:25], s[0:1], 8
    s_load_dwordx2 s[52:53], s[0:1], 104
    s_load_dwordx2 s[54:55], s[0:1], 112
    s_load_dwordx2 s[56:57], s[0:1], 0
    s_getreg_b32 s31, hwreg(HW_REG_XCC_ID)
    v_lshrrev_b32 v1, 6, v0
    s_nop 0
    v_readfirstlane_b32 s27, v1
    s_waitcnt lgkmcnt(0)
    s_mov_b32 s4, s54
    s_and_b32 s5, s55, 0xffff
    s_mov_b32 s6, 268435456
    s_mov_b32 s7, 0x20000
    s_mov_b32 s12, s52
    s_and_b32 s13, s53, 0xffff
    s_mov_b32 s14, 256
    s_mov_b32 s15, 0x20000
    s_and_b32 s60, s31, 15
    s_cmp_lg_u32 s2, 0
    s_cbranch_scc1 L_noinit
    v_mov_b32 v60, 0
    v_mov_b32 v61, 0
    v_mov_b32 v62, 0
    v_mov_b32 v63, 0
    v_lshlrev_b32 v64, 4, v0
    s_mov_b32 s61, 91226112
    buffer_store_dwordx4 v[60:63], v64, s[4:7], s61 offen sc1
    s_mov_b32 s61, 91230208
    buffer_store_dwordx4 v[60:63], v64, s[4:7], s61 offen sc1
    s_mov_b32 s61, 91234304
    buffer_store_dwordx4 v[60:63], v64, s[4:7], s61 offen sc1
    s_mov_b32 s61, 91238400
    buffer_store_dwordx4 v[60:63], v64, s[4:7], s61 offen sc1
    s_mov_b32 s61, 91242496
    buffer_store_dwordx4 v[60:63], v64, s[4:7], s61 offen sc1
    s_mov_b32 s61, 91246592
    buffer_store_dwordx4 v[60:63], v64, s[4:7], s61 offen sc1
    s_mov_b32 s61, 91250688
    buffer_store_dwordx4 v[60:63], v64, s[4:7], s61 offen sc1
    s_mov_b32 s61, 91254784
    buffer_store_dwordx4 v[60:63], v64, s[4:7], s61 offen sc1
    s_mov_b32 s61, 91258880
    buffer_store_dwordx4 v[60:63], v64, s[4:7], s61 offen sc1
    s_mov_b32 s61, 91262976
    buffer_store_dwordx4 v[60:63], v64, s[4:7], s61 offen sc1
    s_mov_b32 s61, 91267072
    buffer_store_dwordx4 v[60:63], v64, s[4:7], s61 offen sc1
L_noinit:
    s_cmp_eq_u32 s60, 0
    s_cselect_b32 s29, 0, 64
    s_cmp_lg_u32 s27, 0
    s_cbranch_scc1 L_tk_t
    v_mov_b32 v31, 1
    s_mov_b64 exec, 1
    buffer_atomic_add v31, off, s[12:15], s29 offset:0 sc0
    s_waitcnt vmcnt(0)
    v_mov_b32 v30, 163824
    ds_write_b32 v30, v31
    s_waitcnt lgkmcnt(0)
    s_mov_b64 exec, -1
L_tk_t:
    s_barrier
    v_mov_b32 v30, 163824
    ds_read_b32 v31, v30
    s_waitcnt lgkmcnt(0)
    v_readfirstlane_b32 s26, v31
    s_barrier
    s_cmp_lg_u32 s2, 0
    s_cbranch_scc1 L_noinit2
    s_waitcnt vmcnt(0)
    s_barrier
    s_cmp_lg_u32 s27, 0
    s_cbranch_scc1 L_noinit2
    v_mov_b32 v64, 1
    s_mov_b64 exec, 1
    buffer_store_dword v64, off, s[12:15], 0 offset:128 sc1
    s_mov_b64 exec, -1
L_noinit2:
    s_cmp_lg_u32 s60, 0
    s_cbranch_scc1 L_worker
    s_cmp_ge_u32 s26, 32
    s_cbranch_scc1 L_xs
    v_and_b32 v17, 63, v0
    v_lshrrev_b32 v32, 4, v17
    v_bfe_u32 v33, v17, 1, 3
    v_xor_b32 v34, v33, v32
    v_and_b32 v35, 1, v17
    v_lshl_or_b32 v34, v34, 1, v35
    v_lshlrev_b32 v34, 4, v34
    v_lshl_or_b32 v20, v32, 13, v34
    v_xor_b32 v21, 128, v20
    v_and_b32 v34, 1, v32
    v_xor_b32 v34, v33, v34
    v_lshl_or_b32 v34, v34, 1, v35
    v_lshrrev_b32 v33, 2, v34
    v_lshlrev_b32 v33, 8, v33
    v_and_b32 v34, 3, v34
    v_lshl_or_b32 v33, v34, 5, v33
    v_lshl_or_b32 v22, v32, 10, v33
    v_xor_b32 v23, 256, v22
    v_xor_b32 v24, 512, v22
    v_xor_b32 v25, 768, v22
    v_bfe_u32 v33, v17, 4, 1
    v_bfe_u32 v34, v17, 3, 1
    v_lshl_or_b32 v33, v34, 1, v33
    v_bfe_u32 v34, v17, 2, 1
    v_lshl_or_b32 v33, v34, 2, v33
    v_bfe_u32 v34, v17, 5, 1
    v_lshl_or_b32 v34, v34, 4, v33
    v_lshlrev_b32 v34, 8, v34
    v_and_b32 v35, 3, v17
    v_lshl_or_b32 v34, v35, 3, v34
    s_lshl_b32 s29, s27, 1
    v_xor_b32 v33, s29, v33
    v_lshl_or_b32 v26, v33, 5, v34
    v_xor_b32 v27, 32, v26
    v_bfe_u32 v33, v17, 5, 1
    v_lshlrev_b32 v33, 4, v33
    v_bfe_u32 v34, v17, 4, 1
    v_lshl_or_b32 v33, v34, 2, v33
    v_lshlrev_b32 v18, 1, v34
    v_bfe_u32 v34, v17, 2, 1
    v_or_b32 v33, v33, v34
    v_or_b32 v18, v18, v34
    v_bfe_u32 v34, v17, 3, 1
    v_lshl_or_b32 v33, v34, 3, v33
    v_lshl_or_b32 v18, v34, 2, v18
    v_lshlrev_b32 v33, 8, v33
    v_and_b32 v34, 1, v17
    v_lshl_or_b32 v33, v34, 4, v33
    v_bfe_u32 v34, v17, 1, 1
    v_or_b32 v34, s29, v34
    v_xor_b32 v34, v34, v18
    v_lshl_or_b32 v28, v34, 5, v33
    v_add_u32 v29, 8, v28
    v_bfe_u32 v18, v17, 1, 1
    v_lshlrev_b32 v18, 1, v18
    v_lshrrev_b32 v19, 4, v17
    v_add_u32 v18, v18, v19
    v_lshlrev_b32 v18, 4, v18
    v_and_b32 v19, 1, v17
    v_lshl_or_b32 v18, v19, 3, v18
    s_lshl_b32 s29, s26, 8
    s_lshl_b32 s30, s27, 6
    s_add_u32 s29, s29, s30
    v_bfe_u32 v19, v17, 2, 2
    v_lshl_or_b32 v18, v19, 13, v18
    v_add_u32 v10, s29, v18
    s_mov_b32 s8, s24
    s_and_b32 s9, s25, 0xffff
    s_mov_b32 s10, 8192
    s_mov_b32 s11, 0x20000
    v_lshrrev_b32 v18, 4, v17
    v_and_b32 v18, 1, v18
    v_lshlrev_b32 v18, 10, v18
    v_and_b32 v19, 3, v17
    v_lshl_or_b32 v18, v19, 1, v18
    s_lshl_b32 s29, s27, 11
    s_lshl_b32 s30, s26, 5
    s_add_u32 s29, s29, s30
    buffer_load_ushort v108, v18, s[8:11], s29 offen offset:0
    buffer_load_ushort v109, v18, s[8:11], s29 offen offset:8
    buffer_load_ushort v110, v18, s[8:11], s29 offen offset:16
    buffer_load_ushort v111, v18, s[8:11], s29 offen offset:24
    v_mov_b32 v92, -1
    v_mov_b32 v93, -1
    v_mov_b32 v94, -1
    v_mov_b32 v95, -1
    v_lshlrev_b32 v18, 4, v0
    s_lshl_b32 s29, s26, 13
    s_add_u32 s29, s29, 87031808
    s_add_u32 s30, s29, 0
    buffer_store_dwordx4 v[92:95], v18, s[4:7], s30 offen
    s_add_u32 s30, s29, 4096
    buffer_store_dwordx4 v[92:95], v18, s[4:7], s30 offen
    s_add_u32 s30, s29, 262144
    buffer_store_dwordx4 v[92:95], v18, s[4:7], s30 offen
    s_add_u32 s30, s29, 266240
    buffer_store_dwordx4 v[92:95], v18, s[4:7], s30 offen
    s_add_u32 s30, s29, 524288
    buffer_store_dwordx4 v[92:95], v18, s[4:7], s30 offen
    s_add_u32 s30, s29, 528384
    buffer_store_dwordx4 v[92:95], v18, s[4:7], s30 offen
    v_cmp_gt_u32 vcc, 16, v0
    s_nop 1
    s_and_saveexec_b64 s[50:51], vcc
    s_cbranch_execz L_nomp
    s_lshl_b32 s29, s26, 8
    s_add_u32 s29, s29, 88080384
    s_add_u32 s30, s29, 32768
    buffer_store_dwordx4 v[92:95], v18, s[4:7], s30 offen
    s_add_u32 s30, s29, 40960
    buffer_store_dwordx4 v[92:95], v18, s[4:7], s30 offen
    s_add_u32 s30, s29, 49152
    buffer_store_dwordx4 v[92:95], v18, s[4:7], s30 offen
    s_add_u32 s30, s29, 57344
    buffer_store_dwordx4 v[92:95], v18, s[4:7], s30 offen
    s_add_u32 s30, s29, 65536
    buffer_store_dwordx4 v[92:95], v18, s[4:7], s30 offen
    s_add_u32 s30, s29, 73728
    buffer_store_dwordx4 v[92:95], v18, s[4:7], s30 offen
    s_add_u32 s30, s29, 81920
    buffer_store_dwordx4 v[92:95], v18, s[4:7], s30 offen
    s_add_u32 s30, s29, 90112
    buffer_store_dwordx4 v[92:95], v18, s[4:7], s30 offen
L_nomp:
    s_mov_b64 exec, s[50:51]
    s_mov_b32 s61, s27
    s_lshl_b32 s29, s27, 13
    v_lshlrev_b32 v18, 4, v17
    v_add_u32 v2, s29, v18
    v_add_u32 v3, 0x10000, v2
    s_mov_b32 s8, s16
    s_and_b32 s9, s17, 0xffff
    s_mov_b32 s10, 4194304
    s_mov_b32 s11, 0x20000
    s_lshl_b32 s29, s61, 18
    s_lshl_b32 s30, s26, 8
    s_add_u32 s29, s29, s30
    s_add_u32 s29, s29, 0
    s_lshl_b32 s30, s61, 13
    s_add_u32 s30, s30, 0
    s_mov_b32 m0, s30
    s_nop 0
    buffer_load_dwordx4 v20, s[8:11], s29 offen lds
    s_add_u32 s29, s29, 32768
    s_add_u32 s30, s30, 1024
    s_mov_b32 m0, s30
    s_nop 0
    buffer_load_dwordx4 v21, s[8:11], s29 offen lds
    s_add_u32 s29, s29, 32768
    s_add_u32 s30, s30, 1024
    s_mov_b32 m0, s30
    s_nop 0
    buffer_load_dwordx4 v20, s[8:11], s29 offen lds
    s_add_u32 s29, s29, 32768
    s_add_u32 s30, s30, 1024
    s_mov_b32 m0, s30
    s_nop 0
    buffer_load_dwordx4 v21, s[8:11], s29 offen lds
    s_add_u32 s29, s29, 32768
    s_add_u32 s30, s30, 1024
    s_mov_b32 m0, s30
    s_nop 0
    buffer_load_dwordx4 v20, s[8:11], s29 offen lds
    s_add_u32 s29, s29, 32768
    s_add_u32 s30, s30, 1024
    s_mov_b32 m0, s30
    s_nop 0
    buffer_load_dwordx4 v21, s[8:11], s29 offen lds
    s_add_u32 s29, s29, 32768
    s_add_u32 s30, s30, 1024
    s_mov_b32 m0, s30
    s_nop 0
    buffer_load_dwordx4 v20, s[8:11], s29 offen lds
    s_add_u32 s29, s29, 32768
    s_add_u32 s30, s30, 1024
    s_mov_b32 m0, s30
    s_nop 0
    buffer_load_dwordx4 v21, s[8:11], s29 offen lds
    s_mov_b32 s8, s16
    s_and_b32 s9, s17, 0xffff
    s_mov_b32 s10, 4194304
    s_mov_b32 s11, 0x20000
    s_lshl_b32 s29, s61, 18
    s_lshl_b32 s30, s26, 8
    s_add_u32 s29, s29, s30
    s_add_u32 s29, s29, 1048576
    s_lshl_b32 s30, s61, 13
    s_add_u32 s30, s30, 32768
    s_mov_b32 m0, s30
    s_nop 0
    buffer_load_dwordx4 v20, s[8:11], s29 offen lds
    s_add_u32 s29, s29, 32768
    s_add_u32 s30, s30, 1024
    s_mov_b32 m0, s30
    s_nop 0
    buffer_load_dwordx4 v21, s[8:11], s29 offen lds
    s_add_u32 s29, s29, 32768
    s_add_u32 s30, s30, 1024
    s_mov_b32 m0, s30
    s_nop 0
    buffer_load_dwordx4 v20, s[8:11], s29 offen lds
    s_add_u32 s29, s29, 32768
    s_add_u32 s30, s30, 1024
    s_mov_b32 m0, s30
    s_nop 0
    buffer_load_dwordx4 v21, s[8:11], s29 offen lds
    s_add_u32 s29, s29, 32768
    s_add_u32 s30, s30, 1024
    s_mov_b32 m0, s30
    s_nop 0
    buffer_load_dwordx4 v20, s[8:11], s29 offen lds
    s_add_u32 s29, s29, 32768
    s_add_u32 s30, s30, 1024
    s_mov_b32 m0, s30
    s_nop 0
    buffer_load_dwordx4 v21, s[8:11], s29 offen lds
    s_add_u32 s29, s29, 32768
    s_add_u32 s30, s30, 1024
    s_mov_b32 m0, s30
    s_nop 0
    buffer_load_dwordx4 v20, s[8:11], s29 offen lds
    s_add_u32 s29, s29, 32768
    s_add_u32 s30, s30, 1024
    s_mov_b32 m0, s30
    s_nop 0
    buffer_load_dwordx4 v21, s[8:11], s29 offen lds
    s_mov_b32 s8, s16
    s_and_b32 s9, s17, 0xffff
    s_mov_b32 s10, 4194304
    s_mov_b32 s11, 0x20000
    s_lshl_b32 s29, s61, 18
    s_lshl_b32 s30, s26, 8
    s_add_u32 s29, s29, s30
    s_add_u32 s29, s29, 2097152
    s_lshl_b32 s30, s61, 13
    s_add_u32 s30, s30, 65536
    s_mov_b32 m0, s30
    s_nop 0
    buffer_load_dwordx4 v20, s[8:11], s29 offen lds
    s_add_u32 s29, s29, 32768
    s_add_u32 s30, s30, 1024
    s_mov_b32 m0, s30
    s_nop 0
    buffer_load_dwordx4 v21, s[8:11], s29 offen lds
    s_add_u32 s29, s29, 32768
    s_add_u32 s30, s30, 1024
    s_mov_b32 m0, s30
    s_nop 0
    buffer_load_dwordx4 v20, s[8:11], s29 offen lds
    s_add_u32 s29, s29, 32768
    s_add_u32 s30, s30, 1024
    s_mov_b32 m0, s30
    s_nop 0
    buffer_load_dwordx4 v21, s[8:11], s29 offen lds
    s_add_u32 s29, s29, 32768
    s_add_u32 s30, s30, 1024
    s_mov_b32 m0, s30
    s_nop 0
    buffer_load_dwordx4 v20, s[8:11], s29 offen lds
    s_add_u32 s29, s29, 32768
    s_add_u32 s30, s30, 1024
    s_mov_b32 m0, s30
    s_nop 0
    buffer_load_dwordx4 v21, s[8:11], s29 offen lds
    s_add_u32 s29, s29, 32768
    s_add_u32 s30, s30, 1024
    s_mov_b32 m0, s30
    s_nop 0
    buffer_load_dwordx4 v20, s[8:11], s29 offen lds
    s_add_u32 s29, s29, 32768
    s_add_u32 s30, s30, 1024
    s_mov_b32 m0, s30
    s_nop 0
    buffer_load_dwordx4 v21, s[8:11], s29 offen lds
    s_mov_b32 s8, s18
    s_and_b32 s9, s19, 0xffff
    s_mov_b32 s10, 4194304
    s_mov_b32 s11, 0x20000
    s_lshl_b32 s29, s61, 18
    s_lshl_b32 s30, s26, 8
    s_add_u32 s29, s29, s30
    s_add_u32 s29, s29, 0
    s_lshl_b32 s30, s61, 13
    s_add_u32 s30, s30, 98304
    s_mov_b32 m0, s30
    s_nop 0
    buffer_load_dwordx4 v20, s[8:11], s29 offen lds
    s_add_u32 s29, s29, 32768
    s_add_u32 s30, s30, 1024
    s_mov_b32 m0, s30
    s_nop 0
    buffer_load_dwordx4 v21, s[8:11], s29 offen lds
    s_add_u32 s29, s29, 32768
    s_add_u32 s30, s30, 1024
    s_mov_b32 m0, s30
    s_nop 0
    buffer_load_dwordx4 v20, s[8:11], s29 offen lds
    s_add_u32 s29, s29, 32768
    s_add_u32 s30, s30, 1024
    s_mov_b32 m0, s30
    s_nop 0
    buffer_load_dwordx4 v21, s[8:11], s29 offen lds
    s_add_u32 s29, s29, 32768
    s_add_u32 s30, s30, 1024
    s_mov_b32 m0, s30
    s_nop 0
    buffer_load_dwordx4 v20, s[8:11], s29 offen lds
    s_add_u32 s29, s29, 32768
    s_add_u32 s30, s30, 1024
    s_mov_b32 m0, s30
    s_nop 0
    buffer_load_dwordx4 v21, s[8:11], s29 offen lds
    s_add_u32 s29, s29, 32768
    s_add_u32 s30, s30, 1024
    s_mov_b32 m0, s30
    s_nop 0
    buffer_load_dwordx4 v20, s[8:11], s29 offen lds
    s_add_u32 s29, s29, 32768
    s_add_u32 s30, s30, 1024
    s_mov_b32 m0, s30
    s_nop 0
    buffer_load_dwordx4 v21, s[8:11], s29 offen lds
    s_mov_b32 s8, s18
    s_and_b32 s9, s19, 0xffff
    s_mov_b32 s10, 4194304
    s_mov_b32 s11, 0x20000
    s_lshl_b32 s29, s61, 18
    s_lshl_b32 s30, s26, 8
    s_add_u32 s29, s29, s30
    s_add_u32 s29, s29, 1048576
    s_lshl_b32 s30, s61, 13
    s_add_u32 s30, s30, 131072
    s_mov_b32 m0, s30
    s_nop 0
    buffer_load_dwordx4 v20, s[8:11], s29 offen lds
    s_add_u32 s29, s29, 32768
    s_add_u32 s30, s30, 1024
    s_mov_b32 m0, s30
    s_nop 0
    buffer_load_dwordx4 v21, s[8:11], s29 offen lds
    s_add_u32 s29, s29, 32768
    s_add_u32 s30, s30, 1024
    s_mov_b32 m0, s30
    s_nop 0
    buffer_load_dwordx4 v20, s[8:11], s29 offen lds
    s_add_u32 s29, s29, 32768
    s_add_u32 s30, s30, 1024
    s_mov_b32 m0, s30
    s_nop 0
    buffer_load_dwordx4 v21, s[8:11], s29 offen lds
    s_add_u32 s29, s29, 32768
    s_add_u32 s30, s30, 1024
    s_mov_b32 m0, s30
    s_nop 0
    buffer_load_dwordx4 v20, s[8:11], s29 offen lds
    s_add_u32 s29, s29, 32768
    s_add_u32 s30, s30, 1024
    s_mov_b32 m0, s30
    s_nop 0
    buffer_load_dwordx4 v21, s[8:11], s29 offen lds
    s_add_u32 s29, s29, 32768
    s_add_u32 s30, s30, 1024
    s_mov_b32 m0, s30
    s_nop 0
    buffer_load_dwordx4 v20, s[8:11], s29 offen lds
    s_add_u32 s29, s29, 32768
    s_add_u32 s30, s30, 1024
    s_mov_b32 m0, s30
    s_nop 0
    buffer_load_dwordx4 v21, s[8:11], s29 offen lds
    s_getpc_b64 s[56:57]
L_pc0:
    s_add_u32 s56, s56, L_step-L_pc0
    s_addc_u32 s57, s57, 0
    v_lshlrev_b32 v68, 4, v17
    s_lshl_b32 s29, s27, 11
    v_add_u32 v68, s29, v68
    global_load_dwordx4 v[76:79], v68, s[56:57]
    global_load_dwordx4 v[80:83], v68, s[56:57] offset:1024
    s_waitcnt vmcnt(42)
    v_lshl_or_b32 v112, v109, 16, v108
    v_lshl_or_b32 v113, v111, 16, v110
    s_mov_b32 s29, 88080384
    s_mov_b64 exec, 0xffffffff
    buffer_store_dwordx2 v[112:113], v10, s[4:7], s29 offen
    s_mov_b64 exec, -1
    s_waitcnt vmcnt(32)
    s_barrier
    ds_read_b64_tr_b16 a[0:1], v26 offset:0
    ds_read_b64_tr_b16 a[2:3], v26 offset:2048
    ds_read_b64_tr_b16 a[4:5], v26 offset:8192
    ds_read_b64_tr_b16 a[6:7], v26 offset:10240
    ds_read_b64_tr_b16 a[8:9], v27 offset:0
    ds_read_b64_tr_b16 a[10:11], v27 offset:2048
    ds_read_b64_tr_b16 a[12:13], v27 offset:8192
    ds_read_b64_tr_b16 a[14:15], v27 offset:10240
    ds_read_b64_tr_b16 a[16:17], v26 offset:16384
    ds_read_b64_tr_b16 a[18:19], v26 offset:18432
    ds_read_b64_tr_b16 a[20:21], v26 offset:24576
    ds_read_b64_tr_b16 a[22:23], v26 offset:26624
    ds_read_b64_tr_b16 a[24:25], v27 offset:16384
    ds_read_b64_tr_b16 a[26:27], v27 offset:18432
    ds_read_b64_tr_b16 a[28:29], v27 offset:24576
    s_waitcnt lgkmcnt(14)
    ds_read_b64_tr_b16 a[30:31], v27 offset:26624
    s_waitcnt lgkmcnt(0)
    s_barrier
    s_mov_b32 s8, s18
    s_and_b32 s9, s19, 0xffff
    s_mov_b32 s10, 4194304
    s_mov_b32 s11, 0x20000
    s_lshl_b32 s29, s61, 18
    s_lshl_b32 s30, s26, 8
    s_add_u32 s29, s29, s30
    s_add_u32 s29, s29, 2097152
    s_lshl_b32 s30, s61, 13
    s_add_u32 s30, s30, 0
    s_mov_b32 m0, s30
    s_nop 0
    buffer_load_dwordx4 v20, s[8:11], s29 offen lds
    s_add_u32 s29, s29, 32768
    s_add_u32 s30, s30, 1024
    s_mov_b32 m0, s30
    s_nop 0
    buffer_load_dwordx4 v21, s[8:11], s29 offen lds
    s_add_u32 s29, s29, 32768
    s_add_u32 s30, s30, 1024
    s_mov_b32 m0, s30
    s_nop 0
    buffer_load_dwordx4 v20, s[8:11], s29 offen lds
    s_add_u32 s29, s29, 32768
    s_add_u32 s30, s30, 1024
    s_mov_b32 m0, s30
    s_nop 0
    buffer_load_dwordx4 v21, s[8:11], s29 offen lds
    s_add_u32 s29, s29, 32768
    s_add_u32 s30, s30, 1024
    s_mov_b32 m0, s30
    s_nop 0
    buffer_load_dwordx4 v20, s[8:11], s29 offen lds
    s_add_u32 s29, s29, 32768
    s_add_u32 s30, s30, 1024
    s_mov_b32 m0, s30
    s_nop 0
    buffer_load_dwordx4 v21, s[8:11], s29 offen lds
    s_add_u32 s29, s29, 32768
    s_add_u32 s30, s30, 1024
    s_mov_b32 m0, s30
    s_nop 0
    buffer_load_dwordx4 v20, s[8:11], s29 offen lds
    s_add_u32 s29, s29, 32768
    s_add_u32 s30, s30, 1024
    s_mov_b32 m0, s30
    s_nop 0
    buffer_load_dwordx4 v21, s[8:11], s29 offen lds
    s_waitcnt vmcnt(32)
    s_barrier
    v_add_u32 v19, 32768, v26
    ds_read_b64_tr_b16 a[32:33], v19 offset:0
    ds_read_b64_tr_b16 a[34:35], v19 offset:2048
    ds_read_b64_tr_b16 a[36:37], v19 offset:8192
    ds_read_b64_tr_b16 a[38:39], v19 offset:10240
    v_add_u32 v19, 32768, v27
    ds_read_b64_tr_b16 a[40:41], v19 offset:0
    ds_read_b64_tr_b16 a[42:43], v19 offset:2048
    ds_read_b64_tr_b16 a[44:45], v19 offset:8192
    ds_read_b64_tr_b16 a[46:47], v19 offset:10240
    v_add_u32 v19, 32768, v26
    ds_read_b64_tr_b16 a[48:49], v19 offset:16384
    ds_read_b64_tr_b16 a[50:51], v19 offset:18432
    ds_read_b64_tr_b16 a[52:53], v19 offset:24576
    ds_read_b64_tr_b16 a[54:55], v19 offset:26624
    v_add_u32 v19, 32768, v27
    ds_read_b64_tr_b16 a[56:57], v19 offset:16384
    ds_read_b64_tr_b16 a[58:59], v19 offset:18432
    ds_read_b64_tr_b16 a[60:61], v19 offset:24576
    s_waitcnt lgkmcnt(14)
    ds_read_b64_tr_b16 a[62:63], v19 offset:26624
    s_waitcnt lgkmcnt(0)
    s_barrier
    s_mov_b32 s8, s20
    s_and_b32 s9, s21, 0xffff
    s_mov_b32 s10, 4194304
    s_mov_b32 s11, 0x20000
    s_lshl_b32 s29, s61, 18
    s_lshl_b32 s30, s26, 8
    s_add_u32 s29, s29, s30
    s_add_u32 s29, s29, 0
    s_lshl_b32 s30, s61, 13
    s_add_u32 s30, s30, 32768
    s_mov_b32 m0, s30
    s_nop 0
    buffer_load_dwordx4 v20, s[8:11], s29 offen lds
    s_add_u32 s29, s29, 32768
    s_add_u32 s30, s30, 1024
    s_mov_b32 m0, s30
    s_nop 0
    buffer_load_dwordx4 v21, s[8:11], s29 offen lds
    s_add_u32 s29, s29, 32768
    s_add_u32 s30, s30, 1024
    s_mov_b32 m0, s30
    s_nop 0
    buffer_load_dwordx4 v20, s[8:11], s29 offen lds
    s_add_u32 s29, s29, 32768
    s_add_u32 s30, s30, 1024
    s_mov_b32 m0, s30
    s_nop 0
    buffer_load_dwordx4 v21, s[8:11], s29 offen lds
    s_add_u32 s29, s29, 32768
    s_add_u32 s30, s30, 1024
    s_mov_b32 m0, s30
    s_nop 0
    buffer_load_dwordx4 v20, s[8:11], s29 offen lds
    s_add_u32 s29, s29, 32768
    s_add_u32 s30, s30, 1024
    s_mov_b32 m0, s30
    s_nop 0
    buffer_load_dwordx4 v21, s[8:11], s29 offen lds
    s_add_u32 s29, s29, 32768
    s_add_u32 s30, s30, 1024
    s_mov_b32 m0, s30
    s_nop 0
    buffer_load_dwordx4 v20, s[8:11], s29 offen lds
    s_add_u32 s29, s29, 32768
    s_add_u32 s30, s30, 1024
    s_mov_b32 m0, s30
    s_nop 0
    buffer_load_dwordx4 v21, s[8:11], s29 offen lds
    s_waitcnt vmcnt(32)
    s_barrier
    v_add_u32 v19, 65536, v26
    ds_read_b64_tr_b16 a[64:65], v19 offset:0
    ds_read_b64_tr_b16 a[66:67], v19 offset:2048
    ds_read_b64_tr_b16 a[68:69], v19 offset:8192
    ds_read_b64_tr_b16 a[70:71], v19 offset:10240
    v_add_u32 v19, 65536, v27
    ds_read_b64_tr_b16 a[72:73], v19 offset:0
    ds_read_b64_tr_b16 a[74:75], v19 offset:2048
    ds_read_b64_tr_b16 a[76:77], v19 offset:8192
    ds_read_b64_tr_b16 a[78:79], v19 offset:10240
    v_add_u32 v19, 65536, v26
    ds_read_b64_tr_b16 a[80:81], v19 offset:16384
    ds_read_b64_tr_b16 a[82:83], v19 offset:18432
    ds_read_b64_tr_b16 a[84:85], v19 offset:24576
    ds_read_b64_tr_b16 a[86:87], v19 offset:26624
    v_add_u32 v19, 65536, v27
    ds_read_b64_tr_b16 a[88:89], v19 offset:16384
    ds_read_b64_tr_b16 a[90:91], v19 offset:18432
    ds_read_b64_tr_b16 a[92:93], v19 offset:24576
    s_waitcnt lgkmcnt(14)
    ds_read_b64_tr_b16 a[94:95], v19 offset:26624
    s_waitcnt lgkmcnt(0)
    s_barrier
    s_mov_b32 s8, s20
    s_and_b32 s9, s21, 0xffff
    s_mov_b32 s10, 4194304
    s_mov_b32 s11, 0x20000
    s_lshl_b32 s29, s61, 18
    s_lshl_b32 s30, s26, 8
    s_add_u32 s29, s29, s30
    s_add_u32 s29, s29, 1048576
    s_lshl_b32 s30, s61, 13
    s_add_u32 s30, s30, 65536
    s_mov_b32 m0, s30
    s_nop 0
    buffer_load_dwordx4 v20, s[8:11], s29 offen lds
    s_add_u32 s29, s29, 32768
    s_add_u32 s30, s30, 1024
    s_mov_b32 m0, s30
    s_nop 0
    buffer_load_dwordx4 v21, s[8:11], s29 offen lds
    s_add_u32 s29, s29, 32768
    s_add_u32 s30, s30, 1024
    s_mov_b32 m0, s30
    s_nop 0
    buffer_load_dwordx4 v20, s[8:11], s29 offen lds
    s_add_u32 s29, s29, 32768
    s_add_u32 s30, s30, 1024
    s_mov_b32 m0, s30
    s_nop 0
    buffer_load_dwordx4 v21, s[8:11], s29 offen lds
    s_add_u32 s29, s29, 32768
    s_add_u32 s30, s30, 1024
    s_mov_b32 m0, s30
    s_nop 0
    buffer_load_dwordx4 v20, s[8:11], s29 offen lds
    s_add_u32 s29, s29, 32768
    s_add_u32 s30, s30, 1024
    s_mov_b32 m0, s30
    s_nop 0
    buffer_load_dwordx4 v21, s[8:11], s29 offen lds
    s_add_u32 s29, s29, 32768
    s_add_u32 s30, s30, 1024
    s_mov_b32 m0, s30
    s_nop 0
    buffer_load_dwordx4 v20, s[8:11], s29 offen lds
    s_add_u32 s29, s29, 32768
    s_add_u32 s30, s30, 1024
    s_mov_b32 m0, s30
    s_nop 0
    buffer_load_dwordx4 v21, s[8:11], s29 offen lds
    s_waitcnt vmcnt(32)
    s_barrier
    v_add_u32 v19, 98304, v26
    ds_read_b64_tr_b16 a[96:97], v19 offset:0
    ds_read_b64_tr_b16 a[98:99], v19 offset:2048
    ds_read_b64_tr_b16 a[100:101], v19 offset:8192
    ds_read_b64_tr_b16 a[102:103], v19 offset:10240
    v_add_u32 v19, 98304, v27
    ds_read_b64_tr_b16 a[104:105], v19 offset:0
    ds_read_b64_tr_b16 a[106:107], v19 offset:2048
    ds_read_b64_tr_b16 a[108:109], v19 offset:8192
    ds_read_b64_tr_b16 a[110:111], v19 offset:10240
    v_add_u32 v19, 98304, v26
    ds_read_b64_tr_b16 a[112:113], v19 offset:16384
    ds_read_b64_tr_b16 a[114:115], v19 offset:18432
    ds_read_b64_tr_b16 a[116:117], v19 offset:24576
    ds_read_b64_tr_b16 a[118:119], v19 offset:26624
    v_add_u32 v19, 98304, v27
    ds_read_b64_tr_b16 a[120:121], v19 offset:16384
    ds_read_b64_tr_b16 a[122:123], v19 offset:18432
    ds_read_b64_tr_b16 a[124:125], v19 offset:24576
    s_waitcnt lgkmcnt(14)
    ds_read_b64_tr_b16 a[126:127], v19 offset:26624
    s_waitcnt lgkmcnt(0)
    s_barrier
    s_mov_b32 s8, s20
    s_and_b32 s9, s21, 0xffff
    s_mov_b32 s10, 4194304
    s_mov_b32 s11, 0x20000
    s_lshl_b32 s29, s61, 18
    s_lshl_b32 s30, s26, 8
    s_add_u32 s29, s29, s30
    s_add_u32 s29, s29, 2097152
    s_lshl_b32 s30, s61, 13
    s_add_u32 s30, s30, 98304
    s_mov_b32 m0, s30
    s_nop 0
    buffer_load_dwordx4 v20, s[8:11], s29 offen lds
    s_add_u32 s29, s29, 32768
    s_add_u32 s30, s30, 1024
    s_mov_b32 m0, s30
    s_nop 0
    buffer_load_dwordx4 v21, s[8:11], s29 offen lds
    s_add_u32 s29, s29, 32768
    s_add_u32 s30, s30, 1024
    s_mov_b32 m0, s30
    s_nop 0
    buffer_load_dwordx4 v20, s[8:11], s29 offen lds
    s_add_u32 s29, s29, 32768
    s_add_u32 s30, s30, 1024
    s_mov_b32 m0, s30
    s_nop 0
    buffer_load_dwordx4 v21, s[8:11], s29 offen lds
    s_add_u32 s29, s29, 32768
    s_add_u32 s30, s30, 1024
    s_mov_b32 m0, s30
    s_nop 0
    buffer_load_dwordx4 v20, s[8:11], s29 offen lds
    s_add_u32 s29, s29, 32768
    s_add_u32 s30, s30, 1024
    s_mov_b32 m0, s30
    s_nop 0
    buffer_load_dwordx4 v21, s[8:11], s29 offen lds
    s_add_u32 s29, s29, 32768
    s_add_u32 s30, s30, 1024
    s_mov_b32 m0, s30
    s_nop 0
    buffer_load_dwordx4 v20, s[8:11], s29 offen lds
    s_add_u32 s29, s29, 32768
    s_add_u32 s30, s30, 1024
    s_mov_b32 m0, s30
    s_nop 0
    buffer_load_dwordx4 v21, s[8:11], s29 offen lds
    s_waitcnt vmcnt(32)
    s_barrier
    v_add_u32 v19, 131072, v26
    ds_read_b64_tr_b16 a[128:129], v19 offset:0
    ds_read_b64_tr_b16 a[130:131], v19 offset:2048
    ds_read_b64_tr_b16 a[132:133], v19 offset:8192
    ds_read_b64_tr_b16 a[134:135], v19 offset:10240
    v_add_u32 v19, 131072, v27
    ds_read_b64_tr_b16 a[136:137], v19 offset:0
    ds_read_b64_tr_b16 a[138:139], v19 offset:2048
    ds_read_b64_tr_b16 a[140:141], v19 offset:8192
    ds_read_b64_tr_b16 a[142:143], v19 offset:10240
    v_add_u32 v19, 131072, v26
    ds_read_b64_tr_b16 a[144:145], v19 offset:16384
    ds_read_b64_tr_b16 a[146:147], v19 offset:18432
    ds_read_b64_tr_b16 a[148:149], v19 offset:24576
    ds_read_b64_tr_b16 a[150:151], v19 offset:26624
    v_add_u32 v19, 131072, v27
    ds_read_b64_tr_b16 a[152:153], v19 offset:16384
    ds_read_b64_tr_b16 a[154:155], v19 offset:18432
    ds_read_b64_tr_b16 a[156:157], v19 offset:24576
    s_waitcnt lgkmcnt(14)
    ds_read_b64_tr_b16 a[158:159], v19 offset:26624
    s_waitcnt lgkmcnt(0)
    s_barrier
    s_mov_b32 s8, s22
    s_and_b32 s9, s23, 0xffff
    s_mov_b32 s10, 4194304
    s_mov_b32 s11, 0x20000
    s_lshl_b32 s29, s61, 15
    s_lshl_b32 s30, s26, 17
    s_add_u32 s29, s29, s30
    s_add_u32 s29, s29, 0
    s_lshl_b32 s30, s61, 13
    s_add_u32 s30, s30, 131072
    s_mov_b32 m0, s30
    s_nop 0
    buffer_load_dwordx4 v22, s[8:11], s29 offen lds
    s_add_u32 s29, s29, 4096
    s_add_u32 s30, s30, 1024
    s_mov_b32 m0, s30
    s_nop 0
    buffer_load_dwordx4 v23, s[8:11], s29 offen lds
    s_add_u32 s29, s29, 4096
    s_add_u32 s30, s30, 1024
    s_mov_b32 m0, s30
    s_nop 0
    buffer_load_dwordx4 v24, s[8:11], s29 offen lds
    s_add_u32 s29, s29, 4096
    s_add_u32 s30, s30, 1024
    s_mov_b32 m0, s30
    s_nop 0
    buffer_load_dwordx4 v25, s[8:11], s29 offen lds
    s_add_u32 s29, s29, 4096
    s_add_u32 s30, s30, 1024
    s_mov_b32 m0, s30
    s_nop 0
    buffer_load_dwordx4 v22, s[8:11], s29 offen lds
    s_add_u32 s29, s29, 4096
    s_add_u32 s30, s30, 1024
    s_mov_b32 m0, s30
    s_nop 0
    buffer_load_dwordx4 v23, s[8:11], s29 offen lds
    s_add_u32 s29, s29, 4096
    s_add_u32 s30, s30, 1024
    s_mov_b32 m0, s30
    s_nop 0
    buffer_load_dwordx4 v24, s[8:11], s29 offen lds
    s_add_u32 s29, s29, 4096
    s_add_u32 s30, s30, 1024
    s_mov_b32 m0, s30
    s_nop 0
    buffer_load_dwordx4 v25, s[8:11], s29 offen lds
    s_waitcnt vmcnt(32)
    s_barrier
    s_cmp_lg_u32 s27, 0
    s_cbranch_scc1 L_rdy_skip
    v_mov_b32 v19, 1
    s_mov_b64 exec, 1
    buffer_atomic_add v19, off, s[12:15], 0 offset:36
    s_mov_b64 exec, -1
L_rdy_skip:
    ds_read_b64_tr_b16 a[160:161], v26 offset:0
    ds_read_b64_tr_b16 a[162:163], v26 offset:2048
    ds_read_b64_tr_b16 a[164:165], v26 offset:8192
    ds_read_b64_tr_b16 a[166:167], v26 offset:10240
    ds_read_b64_tr_b16 a[168:169], v27 offset:0
    ds_read_b64_tr_b16 a[170:171], v27 offset:2048
    ds_read_b64_tr_b16 a[172:173], v27 offset:8192
    ds_read_b64_tr_b16 a[174:175], v27 offset:10240
    ds_read_b64_tr_b16 a[176:177], v26 offset:16384
    ds_read_b64_tr_b16 a[178:179], v26 offset:18432
    ds_read_b64_tr_b16 a[180:181], v26 offset:24576
    ds_read_b64_tr_b16 a[182:183], v26 offset:26624
    ds_read_b64_tr_b16 a[184:185], v27 offset:16384
    ds_read_b64_tr_b16 a[186:187], v27 offset:18432
    ds_read_b64_tr_b16 a[188:189], v27 offset:24576
    s_waitcnt lgkmcnt(14)
    ds_read_b64_tr_b16 a[190:191], v27 offset:26624
    s_waitcnt lgkmcnt(0)
    s_barrier
    s_mov_b32 s8, s22
    s_and_b32 s9, s23, 0xffff
    s_mov_b32 s10, 4194304
    s_mov_b32 s11, 0x20000
    s_lshl_b32 s29, s61, 15
    s_lshl_b32 s30, s26, 17
    s_add_u32 s29, s29, s30
    s_add_u32 s29, s29, 16
    s_lshl_b32 s30, s61, 13
    s_add_u32 s30, s30, 0
    s_mov_b32 m0, s30
    s_nop 0
    buffer_load_dwordx4 v22, s[8:11], s29 offen lds
    s_add_u32 s29, s29, 4096
    s_add_u32 s30, s30, 1024
    s_mov_b32 m0, s30
    s_nop 0
    buffer_load_dwordx4 v23, s[8:11], s29 offen lds
    s_add_u32 s29, s29, 4096
    s_add_u32 s30, s30, 1024
    s_mov_b32 m0, s30
    s_nop 0
    buffer_load_dwordx4 v24, s[8:11], s29 offen lds
    s_add_u32 s29, s29, 4096
    s_add_u32 s30, s30, 1024
    s_mov_b32 m0, s30
    s_nop 0
    buffer_load_dwordx4 v25, s[8:11], s29 offen lds
    s_add_u32 s29, s29, 4096
    s_add_u32 s30, s30, 1024
    s_mov_b32 m0, s30
    s_nop 0
    buffer_load_dwordx4 v22, s[8:11], s29 offen lds
    s_add_u32 s29, s29, 4096
    s_add_u32 s30, s30, 1024
    s_mov_b32 m0, s30
    s_nop 0
    buffer_load_dwordx4 v23, s[8:11], s29 offen lds
    s_add_u32 s29, s29, 4096
    s_add_u32 s30, s30, 1024
    s_mov_b32 m0, s30
    s_nop 0
    buffer_load_dwordx4 v24, s[8:11], s29 offen lds
    s_add_u32 s29, s29, 4096
    s_add_u32 s30, s30, 1024
    s_mov_b32 m0, s30
    s_nop 0
    buffer_load_dwordx4 v25, s[8:11], s29 offen lds
    s_waitcnt vmcnt(32)
    s_barrier
    v_add_u32 v19, 32768, v26
    ds_read_b64_tr_b16 a[192:193], v19 offset:0
    ds_read_b64_tr_b16 a[194:195], v19 offset:2048
    ds_read_b64_tr_b16 a[196:197], v19 offset:8192
    ds_read_b64_tr_b16 a[198:199], v19 offset:10240
    v_add_u32 v19, 32768, v27
    ds_read_b64_tr_b16 a[200:201], v19 offset:0
    ds_read_b64_tr_b16 a[202:203], v19 offset:2048
    ds_read_b64_tr_b16 a[204:205], v19 offset:8192
    ds_read_b64_tr_b16 a[206:207], v19 offset:10240
    v_add_u32 v19, 32768, v26
    ds_read_b64_tr_b16 a[208:209], v19 offset:16384
    ds_read_b64_tr_b16 a[210:211], v19 offset:18432
    ds_read_b64_tr_b16 a[212:213], v19 offset:24576
    ds_read_b64_tr_b16 a[214:215], v19 offset:26624
    v_add_u32 v19, 32768, v27
    ds_read_b64_tr_b16 a[216:217], v19 offset:16384
    ds_read_b64_tr_b16 a[218:219], v19 offset:18432
    ds_read_b64_tr_b16 a[220:221], v19 offset:24576
    s_waitcnt lgkmcnt(14)
    ds_read_b64_tr_b16 a[222:223], v19 offset:26624
    s_waitcnt lgkmcnt(0)
    s_barrier
    s_mov_b32 s8, s22
    s_and_b32 s9, s23, 0xffff
    s_mov_b32 s10, 4194304
    s_mov_b32 s11, 0x20000
    s_lshl_b32 s29, s61, 15
    s_lshl_b32 s30, s26, 17
    s_add_u32 s29, s29, s30
    s_add_u32 s29, s29, 128
    s_lshl_b32 s30, s61, 13
    s_add_u32 s30, s30, 32768
    s_mov_b32 m0, s30
    s_nop 0
    buffer_load_dwordx4 v22, s[8:11], s29 offen lds
    s_add_u32 s29, s29, 4096
    s_add_u32 s30, s30, 1024
    s_mov_b32 m0, s30
    s_nop 0
    buffer_load_dwordx4 v23, s[8:11], s29 offen lds
    s_add_u32 s29, s29, 4096
    s_add_u32 s30, s30, 1024
    s_mov_b32 m0, s30
    s_nop 0
    buffer_load_dwordx4 v24, s[8:11], s29 offen lds
    s_add_u32 s29, s29, 4096
    s_add_u32 s30, s30, 1024
    s_mov_b32 m0, s30
    s_nop 0
    buffer_load_dwordx4 v25, s[8:11], s29 offen lds
    s_add_u32 s29, s29, 4096
    s_add_u32 s30, s30, 1024
    s_mov_b32 m0, s30
    s_nop 0
    buffer_load_dwordx4 v22, s[8:11], s29 offen lds
    s_add_u32 s29, s29, 4096
    s_add_u32 s30, s30, 1024
    s_mov_b32 m0, s30
    s_nop 0
    buffer_load_dwordx4 v23, s[8:11], s29 offen lds
    s_add_u32 s29, s29, 4096
    s_add_u32 s30, s30, 1024
    s_mov_b32 m0, s30
    s_nop 0
    buffer_load_dwordx4 v24, s[8:11], s29 offen lds
    s_add_u32 s29, s29, 4096
    s_add_u32 s30, s30, 1024
    s_mov_b32 m0, s30
    s_nop 0
    buffer_load_dwordx4 v25, s[8:11], s29 offen lds
    s_waitcnt vmcnt(32)
    s_barrier
    v_add_u32 v19, 65536, v26
    ds_read_b64_tr_b16 a[224:225], v19 offset:0
    ds_read_b64_tr_b16 a[226:227], v19 offset:2048
    ds_read_b64_tr_b16 a[228:229], v19 offset:8192
    ds_read_b64_tr_b16 a[230:231], v19 offset:10240
    v_add_u32 v19, 65536, v27
    ds_read_b64_tr_b16 a[232:233], v19 offset:0
    ds_read_b64_tr_b16 a[234:235], v19 offset:2048
    ds_read_b64_tr_b16 a[236:237], v19 offset:8192
    ds_read_b64_tr_b16 a[238:239], v19 offset:10240
    v_add_u32 v19, 65536, v26
    ds_read_b64_tr_b16 a[240:241], v19 offset:16384
    ds_read_b64_tr_b16 a[242:243], v19 offset:18432
    ds_read_b64_tr_b16 a[244:245], v19 offset:24576
    ds_read_b64_tr_b16 a[246:247], v19 offset:26624
    v_add_u32 v19, 65536, v27
    ds_read_b64_tr_b16 a[248:249], v19 offset:16384
    ds_read_b64_tr_b16 a[250:251], v19 offset:18432
    ds_read_b64_tr_b16 a[252:253], v19 offset:24576
    s_waitcnt lgkmcnt(14)
    ds_read_b64_tr_b16 a[254:255], v19 offset:26624
    s_waitcnt lgkmcnt(0)
    s_barrier
    s_mov_b32 s8, s20
    s_and_b32 s9, s21, 0xffff
    s_mov_b32 s10, 4194304
    s_mov_b32 s11, 0x20000
    s_lshl_b32 s29, s61, 18
    s_lshl_b32 s30, s26, 8
    s_add_u32 s29, s29, s30
    s_add_u32 s29, s29, 3145728
    s_lshl_b32 s30, s61, 13
    s_add_u32 s30, s30, 65536
    s_mov_b32 m0, s30
    s_nop 0
    buffer_load_dwordx4 v20, s[8:11], s29 offen lds
    s_add_u32 s29, s29, 32768
    s_add_u32 s30, s30, 1024
    s_mov_b32 m0, s30
    s_nop 0
    buffer_load_dwordx4 v21, s[8:11], s29 offen lds
    s_add_u32 s29, s29, 32768
    s_add_u32 s30, s30, 1024
    s_mov_b32 m0, s30
    s_nop 0
    buffer_load_dwordx4 v20, s[8:11], s29 offen lds
    s_add_u32 s29, s29, 32768
    s_add_u32 s30, s30, 1024
    s_mov_b32 m0, s30
    s_nop 0
    buffer_load_dwordx4 v21, s[8:11], s29 offen lds
    s_add_u32 s29, s29, 32768
    s_add_u32 s30, s30, 1024
    s_mov_b32 m0, s30
    s_nop 0
    buffer_load_dwordx4 v20, s[8:11], s29 offen lds
    s_add_u32 s29, s29, 32768
    s_add_u32 s30, s30, 1024
    s_mov_b32 m0, s30
    s_nop 0
    buffer_load_dwordx4 v21, s[8:11], s29 offen lds
    s_add_u32 s29, s29, 32768
    s_add_u32 s30, s30, 1024
    s_mov_b32 m0, s30
    s_nop 0
    buffer_load_dwordx4 v20, s[8:11], s29 offen lds
    s_add_u32 s29, s29, 32768
    s_add_u32 s30, s30, 1024
    s_mov_b32 m0, s30
    s_nop 0
    buffer_load_dwordx4 v21, s[8:11], s29 offen lds
    s_waitcnt vmcnt(32)
    s_barrier
    v_add_u32 v19, 98304, v26
    ds_read_b64_tr_b16 v[128:129], v19 offset:0
    ds_read_b64_tr_b16 v[130:131], v19 offset:2048
    ds_read_b64_tr_b16 v[132:133], v19 offset:8192
    ds_read_b64_tr_b16 v[134:135], v19 offset:10240
    v_add_u32 v19, 98304, v27
    ds_read_b64_tr_b16 v[136:137], v19 offset:0
    ds_read_b64_tr_b16 v[138:139], v19 offset:2048
    ds_read_b64_tr_b16 v[140:141], v19 offset:8192
    ds_read_b64_tr_b16 v[142:143], v19 offset:10240
    v_add_u32 v19, 98304, v26
    ds_read_b64_tr_b16 v[144:145], v19 offset:16384
    ds_read_b64_tr_b16 v[146:147], v19 offset:18432
    ds_read_b64_tr_b16 v[148:149], v19 offset:24576
    ds_read_b64_tr_b16 v[150:151], v19 offset:26624
    v_add_u32 v19, 98304, v27
    ds_read_b64_tr_b16 v[152:153], v19 offset:16384
    ds_read_b64_tr_b16 v[154:155], v19 offset:18432
    ds_read_b64_tr_b16 v[156:157], v19 offset:24576
    s_waitcnt lgkmcnt(14)
    ds_read_b64_tr_b16 v[158:159], v19 offset:26624
    s_waitcnt lgkmcnt(0)
    s_barrier
    s_mov_b32 s8, s22
    s_and_b32 s9, s23, 0xffff
    s_mov_b32 s10, 4194304
    s_mov_b32 s11, 0x20000
    s_lshl_b32 s29, s61, 15
    s_lshl_b32 s30, s26, 17
    s_add_u32 s29, s29, s30
    s_add_u32 s29, s29, 144
    s_lshl_b32 s30, s61, 13
    s_add_u32 s30, s30, 98304
    s_mov_b32 m0, s30
    s_nop 0
    buffer_load_dwordx4 v22, s[8:11], s29 offen lds
    s_add_u32 s29, s29, 4096
    s_add_u32 s30, s30, 1024
    s_mov_b32 m0, s30
    s_nop 0
    buffer_load_dwordx4 v23, s[8:11], s29 offen lds
    s_add_u32 s29, s29, 4096
    s_add_u32 s30, s30, 1024
    s_mov_b32 m0, s30
    s_nop 0
    buffer_load_dwordx4 v24, s[8:11], s29 offen lds
    s_add_u32 s29, s29, 4096
    s_add_u32 s30, s30, 1024
    s_mov_b32 m0, s30
    s_nop 0
    buffer_load_dwordx4 v25, s[8:11], s29 offen lds
    s_add_u32 s29, s29, 4096
    s_add_u32 s30, s30, 1024
    s_mov_b32 m0, s30
    s_nop 0
    buffer_load_dwordx4 v22, s[8:11], s29 offen lds
    s_add_u32 s29, s29, 4096
    s_add_u32 s30, s30, 1024
    s_mov_b32 m0, s30
    s_nop 0
    buffer_load_dwordx4 v23, s[8:11], s29 offen lds
    s_add_u32 s29, s29, 4096
    s_add_u32 s30, s30, 1024
    s_mov_b32 m0, s30
    s_nop 0
    buffer_load_dwordx4 v24, s[8:11], s29 offen lds
    s_add_u32 s29, s29, 4096
    s_add_u32 s30, s30, 1024
    s_mov_b32 m0, s30
    s_nop 0
    buffer_load_dwordx4 v25, s[8:11], s29 offen lds
    s_waitcnt vmcnt(32)
    s_barrier
    v_add_u32 v19, 131072, v28
    ds_read_b64_tr_b16 v[160:161], v19 offset:0
    ds_read_b64_tr_b16 v[162:163], v19 offset:512
    ds_read_b64_tr_b16 v[164:165], v19 offset:8192
    ds_read_b64_tr_b16 v[166:167], v19 offset:8704
    v_add_u32 v19, 131072, v29
    ds_read_b64_tr_b16 v[168:169], v19 offset:0
    ds_read_b64_tr_b16 v[170:171], v19 offset:512
    ds_read_b64_tr_b16 v[172:173], v19 offset:8192
    ds_read_b64_tr_b16 v[174:175], v19 offset:8704
    v_add_u32 v19, 131072, v28
    ds_read_b64_tr_b16 v[176:177], v19 offset:16384
    ds_read_b64_tr_b16 v[178:179], v19 offset:16896
    ds_read_b64_tr_b16 v[180:181], v19 offset:24576
    ds_read_b64_tr_b16 v[182:183], v19 offset:25088
    v_add_u32 v19, 131072, v29
    ds_read_b64_tr_b16 v[184:185], v19 offset:16384
    ds_read_b64_tr_b16 v[186:187], v19 offset:16896
    ds_read_b64_tr_b16 v[188:189], v19 offset:24576
    s_waitcnt lgkmcnt(14)
    ds_read_b64_tr_b16 v[190:191], v19 offset:25088
    s_waitcnt lgkmcnt(0)
    s_barrier
    s_waitcnt vmcnt(24)
    s_barrier
    ds_read_b64_tr_b16 v[192:193], v28 offset:0
    ds_read_b64_tr_b16 v[194:195], v28 offset:512
    ds_read_b64_tr_b16 v[196:197], v28 offset:8192
    ds_read_b64_tr_b16 v[198:199], v28 offset:8704
    ds_read_b64_tr_b16 v[200:201], v29 offset:0
    ds_read_b64_tr_b16 v[202:203], v29 offset:512
    ds_read_b64_tr_b16 v[204:205], v29 offset:8192
    ds_read_b64_tr_b16 v[206:207], v29 offset:8704
    ds_read_b64_tr_b16 v[208:209], v28 offset:16384
    ds_read_b64_tr_b16 v[210:211], v28 offset:16896
    ds_read_b64_tr_b16 v[212:213], v28 offset:24576
    ds_read_b64_tr_b16 v[214:215], v28 offset:25088
    ds_read_b64_tr_b16 v[216:217], v29 offset:16384
    ds_read_b64_tr_b16 v[218:219], v29 offset:16896
    ds_read_b64_tr_b16 v[220:221], v29 offset:24576
    s_waitcnt lgkmcnt(14)
    ds_read_b64_tr_b16 v[222:223], v29 offset:25088
    s_waitcnt lgkmcnt(0)
    s_barrier
    s_mov_b32 s8, s16
    s_and_b32 s9, s17, 0xffff
    s_mov_b32 s10, 4194304
    s_mov_b32 s11, 0x20000
    s_lshl_b32 s29, s61, 18
    s_lshl_b32 s30, s26, 8
    s_add_u32 s29, s29, s30
    s_add_u32 s29, s29, 3145728
    s_lshl_b32 s30, s61, 13
    s_add_u32 s30, s30, 0
    s_mov_b32 m0, s30
    s_nop 0
    buffer_load_dwordx4 v20, s[8:11], s29 offen lds
    s_add_u32 s29, s29, 32768
    s_add_u32 s30, s30, 1024
    s_mov_b32 m0, s30
    s_nop 0
    buffer_load_dwordx4 v21, s[8:11], s29 offen lds
    s_add_u32 s29, s29, 32768
    s_add_u32 s30, s30, 1024
    s_mov_b32 m0, s30
    s_nop 0
    buffer_load_dwordx4 v20, s[8:11], s29 offen lds
    s_add_u32 s29, s29, 32768
    s_add_u32 s30, s30, 1024
    s_mov_b32 m0, s30
    s_nop 0
    buffer_load_dwordx4 v21, s[8:11], s29 offen lds
    s_add_u32 s29, s29, 32768
    s_add_u32 s30, s30, 1024
    s_mov_b32 m0, s30
    s_nop 0
    buffer_load_dwordx4 v20, s[8:11], s29 offen lds
    s_add_u32 s29, s29, 32768
    s_add_u32 s30, s30, 1024
    s_mov_b32 m0, s30
    s_nop 0
    buffer_load_dwordx4 v21, s[8:11], s29 offen lds
    s_add_u32 s29, s29, 32768
    s_add_u32 s30, s30, 1024
    s_mov_b32 m0, s30
    s_nop 0
    buffer_load_dwordx4 v20, s[8:11], s29 offen lds
    s_add_u32 s29, s29, 32768
    s_add_u32 s30, s30, 1024
    s_mov_b32 m0, s30
    s_nop 0
    buffer_load_dwordx4 v21, s[8:11], s29 offen lds
    buffer_load_dword v84, off, s[12:15], 0 offset:36 sc1
    buffer_load_dword v85, off, s[12:15], 0 offset:128 sc1
    s_waitcnt vmcnt(24)
    s_barrier
    v_add_u32 v19, 32768, v28
    ds_read_b64_tr_b16 v[224:225], v19 offset:0
    ds_read_b64_tr_b16 v[226:227], v19 offset:512
    ds_read_b64_tr_b16 v[228:229], v19 offset:8192
    ds_read_b64_tr_b16 v[230:231], v19 offset:8704
    v_add_u32 v19, 32768, v29
    ds_read_b64_tr_b16 v[232:233], v19 offset:0
    ds_read_b64_tr_b16 v[234:235], v19 offset:512
    ds_read_b64_tr_b16 v[236:237], v19 offset:8192
    ds_read_b64_tr_b16 v[238:239], v19 offset:8704
    v_add_u32 v19, 32768, v28
    ds_read_b64_tr_b16 v[240:241], v19 offset:16384
    ds_read_b64_tr_b16 v[242:243], v19 offset:16896
    ds_read_b64_tr_b16 v[244:245], v19 offset:24576
    ds_read_b64_tr_b16 v[246:247], v19 offset:25088
    v_add_u32 v19, 32768, v29
    ds_read_b64_tr_b16 v[248:249], v19 offset:16384
    ds_read_b64_tr_b16 v[250:251], v19 offset:16896
    ds_read_b64_tr_b16 v[252:253], v19 offset:24576
    s_waitcnt lgkmcnt(14)
    ds_read_b64_tr_b16 v[254:255], v19 offset:25088
    s_waitcnt lgkmcnt(0)
    s_barrier
    s_mov_b32 s8, s18
    s_and_b32 s9, s19, 0xffff
    s_mov_b32 s10, 4194304
    s_mov_b32 s11, 0x20000
    s_lshl_b32 s29, s61, 18
    s_lshl_b32 s30, s26, 8
    s_add_u32 s29, s29, s30
    s_add_u32 s29, s29, 3145728
    s_lshl_b32 s30, s61, 13
    s_add_u32 s30, s30, 32768
    s_mov_b32 m0, s30
    s_nop 0
    buffer_load_dwordx4 v20, s[8:11], s29 offen lds
    s_add_u32 s29, s29, 32768
    s_add_u32 s30, s30, 1024
    s_mov_b32 m0, s30
    s_nop 0
    buffer_load_dwordx4 v21, s[8:11], s29 offen lds
    s_add_u32 s29, s29, 32768
    s_add_u32 s30, s30, 1024
    s_mov_b32 m0, s30
    s_nop 0
    buffer_load_dwordx4 v20, s[8:11], s29 offen lds
    s_add_u32 s29, s29, 32768
    s_add_u32 s30, s30, 1024
    s_mov_b32 m0, s30
    s_nop 0
    buffer_load_dwordx4 v21, s[8:11], s29 offen lds
    s_add_u32 s29, s29, 32768
    s_add_u32 s30, s30, 1024
    s_mov_b32 m0, s30
    s_nop 0
    buffer_load_dwordx4 v20, s[8:11], s29 offen lds
    s_add_u32 s29, s29, 32768
    s_add_u32 s30, s30, 1024
    s_mov_b32 m0, s30
    s_nop 0
    buffer_load_dwordx4 v21, s[8:11], s29 offen lds
    s_add_u32 s29, s29, 32768
    s_add_u32 s30, s30, 1024
    s_mov_b32 m0, s30
    s_nop 0
    buffer_load_dwordx4 v20, s[8:11], s29 offen lds
    s_add_u32 s29, s29, 32768
    s_add_u32 s30, s30, 1024
    s_mov_b32 m0, s30
    s_nop 0
    buffer_load_dwordx4 v21, s[8:11], s29 offen lds
    s_waitcnt vmcnt(24)
    s_barrier
    v_add_u32 v19, 65536, v26
    ds_read_b64_tr_b16 v[52:53], v19 offset:0
    ds_read_b64_tr_b16 v[54:55], v19 offset:2048
    ds_read_b64_tr_b16 v[56:57], v19 offset:8192
    ds_read_b64_tr_b16 v[58:59], v19 offset:10240
    v_add_u32 v19, 65536, v27
    ds_read_b64_tr_b16 v[60:61], v19 offset:0
    ds_read_b64_tr_b16 v[62:63], v19 offset:2048
    ds_read_b64_tr_b16 v[64:65], v19 offset:8192
    ds_read_b64_tr_b16 v[66:67], v19 offset:10240
    v_add_u32 v19, 65536, v26
    ds_read_b64_tr_b16 v[68:69], v19 offset:16384
    ds_read_b64_tr_b16 v[70:71], v19 offset:18432
    ds_read_b64_tr_b16 v[72:73], v19 offset:24576
    ds_read_b64_tr_b16 v[74:75], v19 offset:26624
    v_add_u32 v19, 65536, v27
    ds_read_b64_tr_b16 v[76:77], v19 offset:16384
    ds_read_b64_tr_b16 v[78:79], v19 offset:18432
    ds_read_b64_tr_b16 v[80:81], v19 offset:24576
    s_waitcnt lgkmcnt(14)
    ds_read_b64_tr_b16 v[82:83], v19 offset:26624
    s_waitcnt lgkmcnt(0)
    s_barrier
    ds_write_b128 v3, v[52:55] offset:0
    ds_write_b128 v3, v[56:59] offset:1024
    ds_write_b128 v3, v[60:63] offset:2048
    ds_write_b128 v3, v[64:67] offset:3072
    ds_write_b128 v3, v[68:71] offset:4096
    ds_write_b128 v3, v[72:75] offset:5120
    ds_write_b128 v3, v[76:79] offset:6144
    ds_write_b128 v3, v[80:83] offset:7168
    s_waitcnt lgkmcnt(0)
    s_waitcnt vmcnt(16)
    s_barrier
    v_add_u32 v19, 98304, v28
    ds_read_b64_tr_b16 v[52:53], v19 offset:0
    ds_read_b64_tr_b16 v[54:55], v19 offset:512
    ds_read_b64_tr_b16 v[56:57], v19 offset:8192
    ds_read_b64_tr_b16 v[58:59], v19 offset:8704
    v_add_u32 v19, 98304, v29
    ds_read_b64_tr_b16 v[60:61], v19 offset:0
    ds_read_b64_tr_b16 v[62:63], v19 offset:512
    ds_read_b64_tr_b16 v[64:65], v19 offset:8192
    ds_read_b64_tr_b16 v[66:67], v19 offset:8704
    v_add_u32 v19, 98304, v28
    ds_read_b64_tr_b16 v[68:69], v19 offset:16384
    ds_read_b64_tr_b16 v[70:71], v19 offset:16896
    ds_read_b64_tr_b16 v[72:73], v19 offset:24576
    ds_read_b64_tr_b16 v[74:75], v19 offset:25088
    v_add_u32 v19, 98304, v29
    ds_read_b64_tr_b16 v[76:77], v19 offset:16384
    ds_read_b64_tr_b16 v[78:79], v19 offset:16896
    ds_read_b64_tr_b16 v[80:81], v19 offset:24576
    s_waitcnt lgkmcnt(14)
    ds_read_b64_tr_b16 v[82:83], v19 offset:25088
    s_waitcnt lgkmcnt(0)
    s_barrier
    ds_write_b128 v3, v[52:55] offset:32768
    ds_write_b128 v3, v[56:59] offset:33792
    ds_write_b128 v3, v[60:63] offset:34816
    ds_write_b128 v3, v[64:67] offset:35840
    ds_write_b128 v3, v[68:71] offset:36864
    ds_write_b128 v3, v[72:75] offset:37888
    ds_write_b128 v3, v[76:79] offset:38912
    ds_write_b128 v3, v[80:83] offset:39936
    s_waitcnt lgkmcnt(0)
    v_bfe_u32 v18, v17, 1, 1
    v_mov_b32 v1, 0x4444
    v_mov_b32 v19, 0xeeee
    v_cmp_ne_u32 vcc, 0, v18
    s_nop 1
    v_cndmask_b32 v1, v1, v19, vcc
    s_lshl_b32 s29, s27, 13
    v_lshlrev_b32 v18, 4, v17
    v_add_u32 v2, s29, v18
    v_add_u32 v3, 0x10000, v2
    v_add_u32 v4, 131072, v18
    s_lshl_b32 s29, s27, 11
    v_add_u32 v11, s29, v4
    s_lshl_b32 s30, s26, 13
    s_add_u32 s29, s29, s30
    v_add_u32 v9, s29, v18
    v_and_b32 v18, 15, v17
    v_lshlrev_b32 v18, 5, v18
    v_lshrrev_b32 v19, 4, v17
    v_lshl_or_b32 v18, v19, 3, v18
    v_bfe_u32 v19, v17, 3, 1
    v_lshlrev_b32 v19, 7, v19
    v_xor_b32 v18, v18, v19
    s_lshl_b32 s29, s27, 10
    s_add_u32 s29, s29, 155648
    v_add_u32 v5, s29, v18
    v_lshrrev_b32 v18, 4, v17
    v_lshlrev_b32 v18, 3, v18
    v_bfe_u32 v19, v17, 2, 2
    v_or_b32 v18, v18, v19
    v_lshlrev_b32 v18, 5, v18
    v_and_b32 v19, 3, v17
    v_lshl_or_b32 v18, v19, 3, v18
    v_bfe_u32 v19, v17, 4, 1
    v_lshlrev_b32 v19, 7, v19
    v_xor_b32 v18, v18, v19
    v_add_u32 v6, 155648, v18
    v_xor_b32 v14, 128, v18
    v_add_u32 v14, 155648, v14
    v_and_b32 v18, 13, v17
    v_bfe_u32 v19, v17, 5, 1
    v_lshl_or_b32 v18, v19, 1, v18
    v_lshlrev_b32 v18, 4, v18
    v_bfe_u32 v19, v17, 4, 1
    v_lshl_or_b32 v18, v19, 3, v18
    s_lshl_b32 s29, s27, 9
    s_add_u32 s29, s29, 159744
    v_add_u32 v7, s29, v18
    v_mov_b32 v18, 162816
    v_and_b32 v19, 2, v17
    v_cmp_ne_u32 vcc, 0, v19
    s_nop 1
    v_cndmask_b32 v7, v7, v18, vcc
    v_bfe_u32 v18, v17, 2, 2
    v_lshlrev_b32 v18, 13, v18
    v_lshrrev_b32 v19, 4, v17
    v_lshl_or_b32 v18, v19, 11, v18
    v_and_b32 v19, 3, v17
    v_lshl_or_b32 v18, v19, 4, v18
    s_lshl_b32 s29, s26, 6
    v_add_u32 v8, s29, v18
    v_and_b32 v18, 15, v17
    v_lshlrev_b32 v18, 13, v18
    v_lshrrev_b32 v19, 4, v17
    v_lshl_or_b32 v18, v19, 4, v18
    s_lshl_b32 s29, s26, 8
    s_lshr_b32 s30, s27, 1
    s_lshl_b32 s30, s30, 17
    s_add_u32 s29, s29, s30
    s_and_b32 s30, s27, 1
    s_lshl_b32 s30, s30, 7
    s_add_u32 s29, s29, s30
    v_add_u32 v12, s29, v18
    v_and_b32 v18, 15, v17
    v_lshlrev_b32 v18, 6, v18
    v_lshrrev_b32 v19, 4, v17
    v_lshl_or_b32 v18, v19, 4, v18
    s_lshl_b32 s29, s26, 13
    s_lshl_b32 s30, s27, 11
    s_add_u32 s29, s29, s30
    v_add_u32 v13, s29, v18
    v_lshlrev_b32 v18, 4, v17
    s_lshl_b32 s29, s26, 12
    s_lshl_b32 s30, s27, 10
    s_add_u32 s29, s29, s30
    v_add_u32 v15, s29, v18
    s_mov_b32 s32, 0x3e0293ee
    s_mov_b32 s33, 0x3e0293ee
    v_and_b32 v32, 15, v17
    v_mov_b32 v33, 0x3f80
    v_mov_b32 v34, 0x3f800000
    v_cmp_gt_u32 vcc, 4, v32
    s_nop 1
    v_cndmask_b32 v33, v34, v33, vcc
    v_cmp_gt_u32 vcc, 8, v32
    s_nop 1
    v_cndmask_b32 v33, 0, v33, vcc
    v_and_b32 v32, 3, v32
    v_cmp_eq_u32 vcc, 0, v32
    s_nop 1
    v_cndmask_b32 v76, 0, v33, vcc
    v_cmp_eq_u32 vcc, 1, v32
    s_nop 1
    v_cndmask_b32 v77, 0, v33, vcc
    v_cmp_eq_u32 vcc, 2, v32
    s_nop 1
    v_cndmask_b32 v78, 0, v33, vcc
    v_cmp_eq_u32 vcc, 3, v32
    s_nop 1
    v_cndmask_b32 v79, 0, v33, vcc
    s_lshl_b32 s43, s27, 11
    s_add_u32 s43, s43, 139264
    s_mov_b32 s41, 2097152
    s_waitcnt vmcnt(0)
    ds_write_b128 v4, v[76:79] offset:30720
    s_waitcnt lgkmcnt(0)
    s_barrier
    v_cmp_gt_u32 vcc, 32, v84
    s_cbranch_vccz L_rdy_done
    s_mov_b32 s48, 0
    v_mov_b32 v18, 36
L_rdy_poll:
    buffer_load_dword v19, v18, s[12:15], 0 offen sc1
    s_add_u32 s48, s48, 1
    s_cmp_gt_u32 s48, 0x40000
    s_cbranch_scc1 L_bail
    s_waitcnt vmcnt(0)
    v_cmp_gt_u32 vcc, 32, v19
    s_cbranch_vccnz L_rdy_poll
L_rdy_done:
    v_cmp_ne_u32 vcc, 0, v85
    s_cbranch_vccnz L_ci_done
    s_mov_b32 s48, 0
L_ci_poll:
    buffer_load_dword v19, off, s[12:15], 0 offset:128 sc1
    s_add_u32 s48, s48, 1
    s_cmp_gt_u32 s48, 0x100000
    s_cbranch_scc1 L_bail
    s_waitcnt vmcnt(0)
    v_cmp_eq_u32 vcc, 0, v19
    s_cbranch_vccnz L_ci_poll
L_ci_done:
    ds_read_b64_tr_b16 v[52:53], v26 offset:0
    ds_read_b64_tr_b16 v[54:55], v26 offset:2048
    ds_read_b64_tr_b16 v[56:57], v26 offset:8192
    ds_read_b64_tr_b16 v[58:59], v26 offset:10240
    ds_read_b64_tr_b16 v[60:61], v27 offset:0
    ds_read_b64_tr_b16 v[62:63], v27 offset:2048
    ds_read_b64_tr_b16 v[64:65], v27 offset:8192
    ds_read_b64_tr_b16 v[66:67], v27 offset:10240
    ds_read_b64_tr_b16 v[68:69], v26 offset:16384
    ds_read_b64_tr_b16 v[70:71], v26 offset:18432
    ds_read_b64_tr_b16 v[72:73], v26 offset:24576
    ds_read_b64_tr_b16 v[74:75], v26 offset:26624
    ds_read_b64_tr_b16 v[76:77], v27 offset:16384
    ds_read_b64_tr_b16 v[78:79], v27 offset:18432
    ds_read_b64_tr_b16 v[80:81], v27 offset:24576
    s_waitcnt lgkmcnt(14)
    ds_read_b64_tr_b16 v[82:83], v27 offset:26624
    s_waitcnt lgkmcnt(0)
    s_barrier
    ds_write_b128 v2, v[52:55] offset:0
    ds_write_b128 v2, v[56:59] offset:1024
    ds_write_b128 v2, v[60:63] offset:2048
    ds_write_b128 v2, v[64:67] offset:3072
    ds_write_b128 v2, v[68:71] offset:4096
    ds_write_b128 v2, v[72:75] offset:5120
    ds_write_b128 v2, v[76:79] offset:6144
    ds_write_b128 v2, v[80:83] offset:7168
    s_waitcnt lgkmcnt(0)
    v_add_u32 v19, 32768, v26
    ds_read_b64_tr_b16 v[52:53], v19 offset:0
    ds_read_b64_tr_b16 v[54:55], v19 offset:2048
    ds_read_b64_tr_b16 v[56:57], v19 offset:8192
    ds_read_b64_tr_b16 v[58:59], v19 offset:10240
    v_add_u32 v19, 32768, v27
    ds_read_b64_tr_b16 v[60:61], v19 offset:0
    ds_read_b64_tr_b16 v[62:63], v19 offset:2048
    ds_read_b64_tr_b16 v[64:65], v19 offset:8192
    ds_read_b64_tr_b16 v[66:67], v19 offset:10240
    v_add_u32 v19, 32768, v26
    ds_read_b64_tr_b16 v[68:69], v19 offset:16384
    ds_read_b64_tr_b16 v[70:71], v19 offset:18432
    ds_read_b64_tr_b16 v[72:73], v19 offset:24576
    ds_read_b64_tr_b16 v[74:75], v19 offset:26624
    v_add_u32 v19, 32768, v27
    ds_read_b64_tr_b16 v[76:77], v19 offset:16384
    ds_read_b64_tr_b16 v[78:79], v19 offset:18432
    ds_read_b64_tr_b16 v[80:81], v19 offset:24576
    s_waitcnt lgkmcnt(14)
    ds_read_b64_tr_b16 v[82:83], v19 offset:26624
    s_waitcnt lgkmcnt(0)
    s_barrier
    ds_write_b128 v2, v[52:55] offset:32768
    ds_write_b128 v2, v[56:59] offset:33792
    ds_write_b128 v2, v[60:63] offset:34816
    ds_write_b128 v2, v[64:67] offset:35840
    ds_write_b128 v2, v[68:71] offset:36864
    ds_write_b128 v2, v[72:75] offset:37888
    ds_write_b128 v2, v[76:79] offset:38912
    ds_write_b128 v2, v[80:83] offset:39936
    s_waitcnt lgkmcnt(0)
    s_mov_b32 s29, 91226112
    s_mov_b32 s48, 0
L_ck_poll:
    buffer_load_dword v19, off, s[4:7], s29 sc1
    s_add_u32 s48, s48, 1
    s_cmp_gt_u32 s48, 0x100000
    s_cbranch_scc1 L_bail
    s_waitcnt vmcnt(0)
    v_cmp_gt_u32 vcc, 128, v19
    s_cbranch_vccnz L_ck_poll
    s_mov_b32 m0, s43
    s_nop 0
    buffer_load_dwordx4 v12, s[4:7], s41 offen sc1 lds
    s_add_u32 s29, s43, 1024
    s_add_u32 s30, s41, 64
    s_mov_b32 m0, s29
    s_nop 0
    buffer_load_dwordx4 v12, s[4:7], s30 offen sc1 lds
    s_waitcnt vmcnt(0)
    s_barrier
    s_mov_b32 s28, 0
    s_mov_b32 s34, 0
    s_mov_b32 s45, 18612224
    s_and_b32 s46, s26, 3
    s_lshl_b32 s46, s46, 13
    s_sub_u32 s46, s46, 131072
    s_mov_b32 s11, 88080384
    s_mov_b32 s25, 88113152
    s_mov_b32 s49, 88145920
    s_mov_b32 s47, 77594624
    s_mov_b32 s52, 91226112
    s_lshl_b32 s54, s26, 7
    s_add_u32 s54, s54, 91230208
    s_mov_b32 s51, 85983232
    s_mov_b32 s8, 87031808
    s_mov_b32 s9, 87293952
    s_mov_b32 s10, 87556096
    v_mov_b64 v[68:69], 0
    v_mov_b64 v[70:71], 0
    v_mov_b64 v[72:73], 0
    v_mov_b64 v[74:75], 0
    v_mov_b64 v[76:77], 0
    v_mov_b64 v[78:79], 0
    v_mov_b64 v[80:81], 0
    v_mov_b64 v[82:83], 0
    v_mov_b64 v[84:85], 0
    v_mov_b64 v[86:87], 0
    v_mov_b64 v[88:89], 0
    v_mov_b64 v[90:91], 0
    s_mov_b32 s37, s8
    s_mov_b32 s38, s10
    s_lshl_b32 s30, s27, 16
    s_add_u32 s35, s37, s30
    s_add_u32 s36, s35, 32768
    s_add_u32 s39, s11, s46
    s_add_u32 s40, s39, 1024
    s_add_u32 s45, s45, 262144
    s_add_u32 s41, s41, 262144
    s_add_u32 s42, s41, 64
    s_xor_b32 s43, s43, 24576
    s_add_u32 s44, s43, 1024
    v_add_u32 v0, s34, v4
    buffer_load_dwordx4 v[112:115], v11, s[4:7], s39 offen sc1
    buffer_load_dwordx4 v[116:119], v11, s[4:7], s40 offen sc1
    s_waitcnt vmcnt(1)
    ds_write_b128 v11, v[112:115]
    s_waitcnt vmcnt(0)
    ds_write_b128 v11, v[116:119] offset:1024
    s_waitcnt lgkmcnt(0)
    s_barrier
    ds_read_b128 v[52:55], v2 offset:0
    ds_read_b128 v[56:59], v2 offset:1024
    ds_read_b128 v[60:63], v2 offset:2048
    ds_read_b128 v[64:67], v2 offset:3072
    s_waitcnt lgkmcnt(0)
L_step:
    ds_read_b128 v[44:47], v4 offset:6144
    ds_read_b128 v[20:23], v4 offset:0
    ds_read_b128 v[24:27], v4 offset:1024
    ds_read_b128 v[28:31], v4 offset:2048
    ds_read_b128 v[48:51], v4 offset:7168
    ds_read_b128 v[32:35], v4 offset:3072
    ds_read_b128 v[36:39], v4 offset:4096
    ds_read_b128 v[40:43], v4 offset:5120
    s_add_u32 s29, s28, 2
    s_and_b32 s55, s29, 7
    s_cmp_lg_u32 s55, 0
    s_cbranch_scc1 L_noflag
    buffer_load_dword v108, off, s[4:7], s52 sc1
L_noflag:
    s_and_b32 s29, s28, 3
    s_or_b32 s29, s29, s27
    s_cmp_lg_u32 s29, 0
    s_cbranch_scc1 L_noprog
    s_sub_u32 s29, s28, 1
    s_max_i32 s29, s29, 0
    v_mov_b32 v17, s29
    s_mov_b64 exec, 1
    buffer_store_dword v17, off, s[4:7], s54 sc1
    s_mov_b64 exec, -1
L_noprog:
    s_waitcnt lgkmcnt(7)
    v_smfmac_f32_16x16x64_bf16 v[68:71], v[44:47], v[52:59], v1
    ds_read_b128 v[52:55], v2 offset:32768
    ds_read_b128 v[56:59], v2 offset:33792
    s_waitcnt lgkmcnt(8)
    v_smfmac_f32_16x16x64_bf16 v[68:71], v[20:23], a[0:7], v1
    v_smfmac_f32_16x16x64_bf16 v[72:75], v[20:23], a[8:15], v1
    v_smfmac_f32_16x16x64_bf16 v[76:79], v[20:23], a[96:103], v1
    v_smfmac_f32_16x16x64_bf16 v[72:75], v[44:47], v[60:67], v1
    ds_read_b128 v[60:63], v2 offset:34816
    ds_read_b128 v[64:67], v2 offset:35840
    v_smfmac_f32_16x16x64_bf16 v[80:83], v[20:23], a[104:111], v1
    buffer_store_dwordx4 v[84:87], v15, s[4:7], s51 offen sc1
    s_waitcnt lgkmcnt(9)
    v_smfmac_f32_16x16x64_bf16 v[68:71], v[24:27], a[16:23], v1
    v_smfmac_f32_16x16x64_bf16 v[72:75], v[24:27], a[24:31], v1
    s_waitcnt lgkmcnt(2)
    v_smfmac_f32_16x16x64_bf16 v[76:79], v[44:47], v[52:59], v1
    ds_read_b128 v[52:55], v2 offset:4096
    ds_read_b128 v[56:59], v2 offset:5120
    v_smfmac_f32_16x16x64_bf16 v[76:79], v[24:27], a[112:119], v1
    v_mov_b64 v[84:85], 0
    v_smfmac_f32_16x16x64_bf16 v[80:83], v[24:27], a[120:127], v1
    buffer_load_dwordx4 v[120:123], v13, s[4:7], s45 offen sc1
    v_smfmac_f32_16x16x64_bf16 v[68:71], v[28:31], a[32:39], v1
    s_waitcnt lgkmcnt(2)
    v_smfmac_f32_16x16x64_bf16 v[80:83], v[44:47], v[60:67], v1
    ds_read_b128 v[60:63], v2 offset:6144
    ds_read_b128 v[64:67], v2 offset:7168
    v_smfmac_f32_16x16x64_bf16 v[72:75], v[28:31], a[40:47], v1
    v_mov_b64 v[86:87], 0
    v_smfmac_f32_16x16x64_bf16 v[76:79], v[28:31], a[128:135], v1
    v_smfmac_f32_16x16x64_bf16 v[80:83], v[28:31], a[136:143], v1
    buffer_load_dwordx4 v[124:127], v13, s[4:7], s45 offen offset:1024 sc1
    s_waitcnt lgkmcnt(2)
    v_smfmac_f32_16x16x64_bf16 v[68:71], v[48:51], v[52:59], v1
    ds_read_b128 v[52:55], v2 offset:36864
    ds_read_b128 v[56:59], v2 offset:37888
    v_smfmac_f32_16x16x64_bf16 v[68:71], v[32:35], a[48:55], v1
    v_mov_b64 v[88:89], 0
    v_smfmac_f32_16x16x64_bf16 v[72:75], v[32:35], a[56:63], v1
    v_smfmac_f32_16x16x64_bf16 v[76:79], v[32:35], a[144:151], v1
    s_waitcnt lgkmcnt(2)
    v_smfmac_f32_16x16x64_bf16 v[72:75], v[48:51], v[60:67], v1
    ds_read_b128 v[60:63], v2 offset:38912
    ds_read_b128 v[64:67], v2 offset:39936
    v_smfmac_f32_16x16x64_bf16 v[80:83], v[32:35], a[152:159], v1
    v_mov_b64 v[90:91], 0
    s_mov_b32 m0, s43
    v_smfmac_f32_16x16x64_bf16 v[68:71], v[36:39], a[64:71], v1
    buffer_load_dwordx4 v12, s[4:7], s41 offen sc1 lds
    v_smfmac_f32_16x16x64_bf16 v[72:75], v[36:39], a[72:79], v1
    s_waitcnt lgkmcnt(2)
    v_smfmac_f32_16x16x64_bf16 v[76:79], v[48:51], v[52:59], v1
    ds_read_b128 v[52:55], v3 offset:0
    ds_read_b128 v[56:59], v3 offset:1024
    v_smfmac_f32_16x16x64_bf16 v[68:71], v[40:43], a[80:87], v1
    v_smfmac_f32_16x16x64_bf16 v[72:75], v[40:43], a[88:95], v1
    s_mov_b32 m0, s44
    v_smfmac_f32_16x16x64_bf16 v[76:79], v[36:39], a[160:167], v1
    buffer_load_dwordx4 v12, s[4:7], s42 offen sc1 lds
    s_waitcnt lgkmcnt(2)
    v_smfmac_f32_16x16x64_bf16 v[80:83], v[48:51], v[60:67], v1
    ds_read_b128 v[60:63], v3 offset:2048
    ds_read_b128 v[64:67], v3 offset:3072
    v_smfmac_f32_16x16x64_bf16 v[80:83], v[36:39], a[168:175], v1
    v_pk_add_f32 v[68:69], v[68:69], v[70:71]
    v_pk_add_f32 v[72:73], v[72:73], v[74:75]
    v_smfmac_f32_16x16x64_bf16 v[76:79], v[40:43], a[176:183], v1
    v_cvt_pk_bf16_f32 v70, v68, v69
    v_cvt_pk_bf16_f32 v74, v72, v73
    v_smfmac_f32_16x16x64_bf16 v[80:83], v[40:43], a[184:191], v1
    ds_write2_b32 v5, v70, v74 offset0:0 offset1:128
L_v:
    s_waitcnt lgkmcnt(3)
    v_smfmac_f32_16x16x64_bf16 v[84:87], v[44:47], v[52:59], v1
    ds_read_b128 v[52:55], v3 offset:4096
    ds_read_b128 v[56:59], v3 offset:5120
    v_smfmac_f32_16x16x64_bf16 v[84:87], v[20:23], a[192:199], v1
    v_smfmac_f32_16x16x64_bf16 v[88:91], v[20:23], a[200:207], v1
    v_pk_add_f32 v[76:77], v[76:77], v[78:79]
    v_pk_add_f32 v[80:81], v[80:81], v[82:83]
    v_smfmac_f32_16x16x64_bf16 v[84:87], v[24:27], a[208:215], v1
    v_cvt_pk_bf16_f32 v16, v76, v77
    v_cvt_pk_bf16_f32 v17, v80, v81
    ds_write2_b32 v5, v16, v17 offset0:1 offset1:129
    s_waitcnt lgkmcnt(4)
    v_smfmac_f32_16x16x64_bf16 v[88:91], v[44:47], v[60:67], v1
    ds_read_b128 v[60:63], v3 offset:6144
    ds_read_b128 v[64:67], v3 offset:7168
    v_smfmac_f32_16x16x64_bf16 v[88:91], v[24:27], a[216:223], v1
    v_smfmac_f32_16x16x64_bf16 v[84:87], v[28:31], a[224:231], v1
    v_smfmac_f32_16x16x64_bf16 v[88:91], v[28:31], a[232:239], v1
    s_waitcnt lgkmcnt(2)
    s_barrier
    ds_read_b64_tr_b16 v[92:93], v6 offset:0
    ds_read_b64_tr_b16 v[94:95], v14 offset:0
    v_smfmac_f32_16x16x64_bf16 v[84:87], v[48:51], v[52:59], v1
    ds_read_b64_tr_b16 v[96:97], v6 offset:1024
    ds_read_b64_tr_b16 v[98:99], v14 offset:1024
    v_smfmac_f32_16x16x64_bf16 v[84:87], v[32:35], a[240:247], v1
    ds_read_b64_tr_b16 v[100:101], v6 offset:2048
    ds_read_b64_tr_b16 v[102:103], v14 offset:2048
    v_smfmac_f32_16x16x64_bf16 v[88:91], v[32:35], a[248:255], v1
    ds_read_b64_tr_b16 v[104:105], v6 offset:3072
    ds_read_b64_tr_b16 v[106:107], v14 offset:3072
    v_smfmac_f32_16x16x64_bf16 v[84:87], v[36:39], v[128:135], v1
    ds_read_b128 v[68:71], v0 offset:8192
    ds_read_b128 v[72:75], v0 offset:9216
    s_waitcnt lgkmcnt(10)
    v_smfmac_f32_16x16x64_bf16 v[88:91], v[48:51], v[60:67], v1
    v_mov_b32 v32, 0x3f803f80
    v_mov_b32 v33, 0x3f803f80
    v_smfmac_f32_16x16x64_bf16 v[88:91], v[36:39], v[136:143], v1
    ds_read_b128 v[76:79], v0 offset:10240
    v_smfmac_f32_16x16x64_bf16 v[84:87], v[40:43], v[144:151], v1
    ds_read_b128 v[80:83], v0 offset:11264
    v_smfmac_f32_16x16x64_bf16 v[88:91], v[40:43], v[152:159], v1
    v_mov_b32 v34, 0x3f803f80
    v_mov_b32 v35, 0x3f803f80
    s_waitcnt vmcnt(5)
    s_mov_b32 s53, 128
    s_cmp_lg_u32 s55, 0
    s_cbranch_scc1 L_norfl
    v_readfirstlane_b32 s53, v108
L_norfl:
    s_waitcnt lgkmcnt(10)
    v_mfma_f32_16x16x32_bf16 v[108:111], v[92:95], v[92:95], 0
    ds_read_b128 v[20:23], v0 offset:12288
    ds_read_b128 v[44:47], v0 offset:13312
    s_waitcnt lgkmcnt(10)
    v_mfma_f32_16x16x32_bf16 v[108:111], v[96:99], v[96:99], v[108:111]
    ds_read_b128 v[24:27], v0 offset:14336
    ds_read_b128 v[28:31], v0 offset:15360
    s_waitcnt lgkmcnt(10)
    v_mfma_f32_16x16x32_bf16 v[108:111], v[100:103], v[100:103], v[108:111]
    v_pk_add_f32 v[84:85], v[84:85], v[86:87]
    v_pk_add_f32 v[88:89], v[88:89], v[90:91]
    s_waitcnt lgkmcnt(8)
    v_mfma_f32_16x16x32_bf16 v[108:111], v[104:107], v[104:107], v[108:111]
    v_cvt_pk_bf16_f32 v86, v84, v85
    v_cvt_pk_bf16_f32 v90, v88, v89
    s_waitcnt lgkmcnt(7)
    v_mfma_f32_16x16x32_bf16 v[112:115], v[68:71], v[92:95], 0
    v_mov_b32 v87, 0
    v_mov_b32 v91, 0
    s_waitcnt lgkmcnt(6)
    v_mfma_f32_16x16x32_bf16 v[112:115], v[72:75], v[96:99], v[112:115]
    v_min_u32 v84, -2, v16
    v_min_u32 v85, -2, v17
    s_waitcnt lgkmcnt(5)
    v_mfma_f32_16x16x32_bf16 v[112:115], v[76:79], v[100:103], v[112:115]
    s_waitcnt lgkmcnt(4)
    v_mfma_f32_16x16x32_bf16 v[112:115], v[80:83], v[104:107], v[112:115]
    s_waitcnt lgkmcnt(3)
    v_mfma_f32_16x16x32_bf16 v[116:119], v[20:23], v[92:95], 0
    s_waitcnt lgkmcnt(2)
    v_mfma_f32_16x16x32_bf16 v[116:119], v[44:47], v[96:99], v[116:119]
    s_nop 3
    v_max3_f32 v19, v110, v111, v112
    s_waitcnt lgkmcnt(1)
    v_mfma_f32_16x16x32_bf16 v[116:119], v[24:27], v[100:103], v[116:119]
    v_max3_f32 v19, v19, v113, v114
    s_waitcnt lgkmcnt(0)
    v_mfma_f32_16x16x32_bf16 v[116:119], v[28:31], v[104:107], v[116:119]
    v_max_f32 v19, v19, v115
    s_cmp_eq_u32 s28, 63
    s_cbranch_scc1 L_last
    s_nop 4
    v_max3_f32 v19, v19, v116, v117
    v_max3_f32 v17, v19, v118, v119
    v_max3_f32 v19, v19, v118, v119
    ds_read_b128 v[52:55], v3 offset:32768
    s_nop 0
    v_permlane16_swap_b32 v19, v17
    ds_read_b128 v[56:59], v3 offset:33792
    v_max_f32 v18, v19, v17
    v_max_f32 v19, v19, v17
    ds_read_b128 v[60:63], v3 offset:34816
    ds_read_b128 v[64:67], v3 offset:35840
    v_permlane32_swap_b32 v19, v18
    v_max_f32 v19, v19, v18
    v_mul_f32 v19, s32, v19
    v_pk_fma_f32 v[112:113], v[112:113], s[32:33], v[18:19] op_sel:[0,0,1] op_sel_hi:[1,1,1] neg_lo:[0,0,1] neg_hi:[0,0,1]
    v_pk_fma_f32 v[114:115], v[114:115], s[32:33], v[18:19] op_sel:[0,0,1] op_sel_hi:[1,1,1] neg_lo:[0,0,1] neg_hi:[0,0,1]
    v_pk_fma_f32 v[116:117], v[116:117], s[32:33], v[18:19] op_sel:[0,0,1] op_sel_hi:[1,1,1] neg_lo:[0,0,1] neg_hi:[0,0,1]
    v_pk_fma_f32 v[118:119], v[118:119], s[32:33], v[18:19] op_sel:[0,0,1] op_sel_hi:[1,1,1] neg_lo:[0,0,1] neg_hi:[0,0,1]
    v_pk_fma_f32 v[110:111], v[110:111], s[32:33], v[18:19] op_sel:[0,0,1] op_sel_hi:[1,1,1] neg_lo:[0,0,1] neg_hi:[0,0,1]
    v_exp_f32 v112, v112
    v_exp_f32 v113, v113
    v_exp_f32 v114, v114
    v_exp_f32 v115, v115
    v_exp_f32 v116, v116
    v_exp_f32 v117, v117
    v_cvt_pk_bf16_f32 v68, v112, v113
    v_exp_f32 v118, v118
    v_cvt_pk_bf16_f32 v69, v114, v115
    v_exp_f32 v119, v119
    v_cvt_pk_bf16_f32 v70, v116, v117
    v_exp_f32 v110, v110
    v_cvt_pk_bf16_f32 v71, v118, v119
    v_exp_f32 v111, v111
    v_mov_b32 v73, 0
    v_mfma_f32_16x16x32_bf16 v[48:51], v[32:35], v[68:71], 0
    v_cvt_pk_bf16_f32 v72, v110, v111
    s_waitcnt vmcnt(3)
    v_mfma_f32_16x16x32_bf16 v[76:79], v[120:123], v[68:71], 0
    s_waitcnt vmcnt(2)
    v_mfma_f32_16x16x32_bf16 v[80:83], v[124:127], v[68:71], 0
    v_mov_b64 v[112:113], -1
    v_mov_b64 v[114:115], -1
    v_mfma_f32_16x16x16_bf16 v[48:51], v[32:33], v[72:73], v[48:51]
    s_nop 0
    v_mfma_f32_16x16x16_bf16 v[76:79], v[86:87], v[72:73], v[76:79]
    s_nop 0
    v_mfma_f32_16x16x16_bf16 v[80:83], v[90:91], v[72:73], v[80:83]
    v_min_u32 v87, -2, v90
    v_min_u32 v86, -2, v86
    s_nop 1
    v_rcp_f32 v18, v48
    s_nop 0
    v_pk_mul_f32 v[76:77], v[76:77], v[18:19] op_sel_hi:[1,0]
    v_pk_mul_f32 v[78:79], v[78:79], v[18:19] op_sel_hi:[1,0]
    v_pk_mul_f32 v[80:81], v[80:81], v[18:19] op_sel_hi:[1,0]
    v_pk_mul_f32 v[82:83], v[82:83], v[18:19] op_sel_hi:[1,0]
    v_cvt_pk_bf16_f32 v76, v76, v77
    v_cvt_pk_bf16_f32 v77, v78, v79
    ds_write_b64 v7, v[76:77] offset:0
    v_cvt_pk_bf16_f32 v80, v80, v81
    v_cvt_pk_bf16_f32 v81, v82, v83
    ds_write_b64 v7, v[80:81] offset:256
    s_waitcnt lgkmcnt(0)
    s_barrier
    ds_read_b128 v[120:123], v4 offset:28672
    ds_read_b128 v[124:127], v4 offset:29696
    buffer_store_dwordx4 v[112:115], v9, s[4:7], s38 offen
    buffer_store_dwordx4 v[112:115], v9, s[4:7], s38 offen offset:1024
    v_mov_b64 v[20:21], 0
    v_mov_b64 v[22:23], 0
    v_mov_b64 v[24:25], 0
    v_mov_b64 v[26:27], 0
    v_mov_b64 v[28:29], 0
    v_mov_b64 v[30:31], 0
    v_mov_b64 v[32:33], 0
    v_mov_b64 v[34:35], 0
    v_mov_b64 v[36:37], 0
    v_mov_b64 v[38:39], 0
    v_mov_b64 v[40:41], 0
    v_mov_b64 v[42:43], 0
    v_mov_b64 v[44:45], 0
    v_mov_b64 v[46:47], 0
    v_mov_b64 v[48:49], 0
    v_mov_b64 v[50:51], 0
    s_waitcnt lgkmcnt(1)
    v_smfmac_f32_16x16x64_bf16 v[44:47], v[120:123], v[52:59], v1
    ds_read_b128 v[52:55], v3 offset:36864
    ds_read_b128 v[56:59], v3 offset:37888
    v_smfmac_f32_16x16x64_bf16 v[20:23], v[120:123], v[160:167], v1
    ds_read_b128 v[108:111], v4 offset:30720
    s_waitcnt lgkmcnt(3)
    v_smfmac_f32_16x16x64_bf16 v[20:23], v[124:127], v[176:183], v1
    v_smfmac_f32_16x16x64_bf16 v[24:27], v[120:123], v[168:175], v1
    v_smfmac_f32_16x16x64_bf16 v[48:51], v[120:123], v[60:67], v1
    ds_read_b128 v[60:63], v3 offset:38912
    ds_read_b128 v[64:67], v3 offset:39936
    v_smfmac_f32_16x16x64_bf16 v[24:27], v[124:127], v[184:191], v1
    s_nop 2
    v_pk_add_f32 v[20:21], v[20:21], v[22:23]
    v_cvt_pk_bf16_f32 v68, v20, v21
    v_smfmac_f32_16x16x64_bf16 v[28:31], v[120:123], v[192:199], v1
    v_smfmac_f32_16x16x64_bf16 v[28:31], v[124:127], v[208:215], v1
    s_waitcnt lgkmcnt(3)
    v_smfmac_f32_16x16x64_bf16 v[44:47], v[124:127], v[52:59], v1
    ds_read_b128 v[52:55], v2 offset:0
    ds_read_b128 v[56:59], v2 offset:1024
    v_pk_add_f32 v[24:25], v[24:25], v[26:27]
    v_cvt_pk_bf16_f32 v69, v24, v25
    v_smfmac_f32_16x16x64_bf16 v[32:35], v[120:123], v[200:207], v1
    v_smfmac_f32_16x16x64_bf16 v[32:35], v[124:127], v[216:223], v1
    v_pk_add_f32 v[28:29], v[28:29], v[30:31]
    v_cvt_pk_bf16_f32 v70, v28, v29
    v_smfmac_f32_16x16x64_bf16 v[36:39], v[120:123], v[224:231], v1
    s_waitcnt lgkmcnt(2)
    v_smfmac_f32_16x16x64_bf16 v[48:51], v[124:127], v[60:67], v1
    ds_read_b128 v[60:63], v2 offset:2048
    ds_read_b128 v[64:67], v2 offset:3072
    s_nop 0
    v_pk_add_f32 v[32:33], v[32:33], v[34:35]
    v_cvt_pk_bf16_f32 v71, v32, v33
    v_smfmac_f32_16x16x64_bf16 v[36:39], v[124:127], v[240:247], v1
    buffer_store_dwordx4 v[68:71], v8, s[4:7], s35 offen
    v_smfmac_f32_16x16x64_bf16 v[40:43], v[120:123], v[232:239], v1
    v_smfmac_f32_16x16x64_bf16 v[40:43], v[124:127], v[248:255], v1
    v_pk_add_f32 v[44:45], v[44:45], v[46:47]
    v_cvt_pk_bf16_f32 v74, v44, v45
    v_pk_add_f32 v[48:49], v[48:49], v[50:51]
    v_cvt_pk_bf16_f32 v75, v48, v49
    s_nop 0
    v_pk_add_f32 v[36:37], v[36:37], v[38:39]
    v_cvt_pk_bf16_f32 v72, v36, v37
    s_nop 0
    v_pk_add_f32 v[40:41], v[40:41], v[42:43]
    v_cvt_pk_bf16_f32 v73, v40, v41
    buffer_store_dwordx4 v[72:75], v8, s[4:7], s36 offen
    s_mov_b32 s24, s37
    s_mov_b32 s50, s38
    s_mov_b32 s51, s47
    s_mov_b32 s22, s25
    s_mov_b32 s23, s49
    s_mov_b32 s49, s11
    s_mov_b32 s11, s22
    s_mov_b32 s25, s23
    s_xor_b32 s34, s34, 8192
    s_add_u32 s28, s28, 1
    s_add_u32 s47, s47, 131072
    s_mov_b32 s29, s8
    s_mov_b32 s8, s9
    s_mov_b32 s9, s10
    s_mov_b32 s10, s29
    s_mov_b32 s37, s8
    s_mov_b32 s38, s10
    s_lshl_b32 s30, s27, 16
    s_add_u32 s35, s37, s30
    s_add_u32 s36, s35, 32768
    s_add_u32 s39, s11, s46
    s_add_u32 s40, s39, 1024
    s_add_u32 s45, s45, 262144
    s_add_u32 s41, s41, 262144
    s_add_u32 s42, s41, 64
    s_xor_b32 s43, s43, 24576
    s_add_u32 s44, s43, 1024
    v_add_u32 v0, s34, v4
    s_cmp_ge_u32 s53, 128
    s_cbranch_scc0 L_kvslow
L_kvok:
    s_add_u32 s29, s28, 2
    s_lshr_b32 s29, s29, 3
    s_min_u32 s29, s29, 7
    s_lshl_b32 s29, s29, 7
    s_add_u32 s52, s29, 91226112
    v_mov_b64 v[68:69], 0
    v_mov_b64 v[70:71], 0
    v_mov_b64 v[72:73], 0
    v_mov_b64 v[74:75], 0
    s_waitcnt vmcnt(0)
    buffer_load_dwordx4 v[76:79], v9, s[4:7], s24 offen offset:0 sc1
    buffer_load_dwordx4 v[80:83], v9, s[4:7], s24 offen offset:1024 sc1
    s_mov_b32 s48, 0
    s_waitcnt vmcnt(0)
    v_max3_u32 v17, v76, v77, v78
    v_max3_u32 v18, v80, v81, v82
    v_max_u32 v17, v17, v79
    v_mfma_f32_16x16x32_bf16 v[120:123], v[108:111], v[76:79], 0
    v_max_u32 v18, v18, v83
    v_mfma_f32_16x16x32_bf16 v[120:123], v[108:111], v[80:83], v[120:123]
    v_cmp_eq_u32 s[16:17], -1, v17
    v_cmp_eq_u32 s[18:19], -1, v18
    s_nop 1
    s_or_b64 s[20:21], s[16:17], s[18:19]
    s_cbranch_scc0 L_h1ok
    s_or_b32 s16, s16, 1
    s_or_b32 s18, s18, 1
    s_mov_b64 exec, s[16:17]
    buffer_load_dwordx4 v[76:79], v9, s[4:7], s24 offen offset:0 sc1
    s_mov_b64 exec, s[18:19]
    buffer_load_dwordx4 v[80:83], v9, s[4:7], s24 offen offset:1024 sc1
    s_mov_b64 exec, -1
L_h1loop:
    s_or_b32 s16, s16, 1
    s_or_b32 s18, s18, 1
    s_mov_b64 exec, s[16:17]
    buffer_load_dwordx4 v[76:79], v9, s[4:7], s24 offen offset:0 sc1
    s_mov_b64 exec, s[18:19]
    buffer_load_dwordx4 v[80:83], v9, s[4:7], s24 offen offset:1024 sc1
    s_mov_b64 exec, -1
    s_add_u32 s48, s48, 1
    s_cmp_gt_u32 s48, 0x40000
    s_cbranch_scc1 L_bail
    s_waitcnt vmcnt(2)
    v_max3_u32 v17, v76, v77, v78
    v_max3_u32 v18, v80, v81, v82
    v_max_u32 v17, v17, v79
    v_mfma_f32_16x16x32_bf16 v[120:123], v[108:111], v[76:79], 0
    v_max_u32 v18, v18, v83
    v_mfma_f32_16x16x32_bf16 v[120:123], v[108:111], v[80:83], v[120:123]
    v_cmp_eq_u32 s[16:17], -1, v17
    v_cmp_eq_u32 s[18:19], -1, v18
    s_nop 1
    s_or_b64 s[20:21], s[16:17], s[18:19]
    s_cbranch_scc0 L_h1ok
    s_branch L_h1loop
L_h1ok:
    s_nop 2
    v_add_f32_dpp v120, v120, v120 row_ror:4 row_mask:0xf bank_mask:0xf
    v_add_f32_dpp v121, v121, v121 row_ror:4 row_mask:0xf bank_mask:0xf
    v_add_f32_dpp v122, v122, v122 row_ror:4 row_mask:0xf bank_mask:0xf
    v_add_f32_dpp v123, v123, v123 row_ror:4 row_mask:0xf bank_mask:0xf
    v_add_f32_dpp v120, v120, v120 row_ror:8 row_mask:0xf bank_mask:0xf
    v_add_f32_dpp v121, v121, v121 row_ror:8 row_mask:0xf bank_mask:0xf
    v_add_f32_dpp v122, v122, v122 row_ror:8 row_mask:0xf bank_mask:0xf
    v_add_f32_dpp v123, v123, v123 row_ror:8 row_mask:0xf bank_mask:0xf
    v_cvt_pk_bf16_f32 v120, v120, v121
    v_cvt_pk_bf16_f32 v121, v122, v123
    v_min_u32 v120, -2, v120
    v_min_u32 v121, -2, v121
    s_mov_b64 exec, 0xffffffff
    buffer_store_dwordx2 v[120:121], v10, s[4:7], s22 offen
    v_mov_b64 v[122:123], -1
    buffer_store_dwordx2 v[122:123], v10, s[4:7], s23 offen
    s_mov_b64 exec, -1
    s_waitcnt vmcnt(0)
    buffer_load_dwordx4 v[112:115], v11, s[4:7], s39 offen sc1
    buffer_load_dwordx4 v[116:119], v11, s[4:7], s40 offen sc1
    s_mov_b32 s48, 0
    s_waitcnt vmcnt(0)
    v_max3_u32 v17, v112, v113, v114
    v_max3_u32 v18, v116, v117, v118
    v_max_u32 v17, v17, v115
    v_max_u32 v18, v18, v119
    v_cmp_eq_u32 s[16:17], -1, v17
    v_cmp_eq_u32 s[18:19], -1, v18
    s_nop 1
    s_or_b64 s[20:21], s[16:17], s[18:19]
    s_cbranch_scc0 L_h2ok
    s_or_b32 s16, s16, 1
    s_or_b32 s18, s18, 1
    s_mov_b64 exec, s[16:17]
    buffer_load_dwordx4 v[112:115], v11, s[4:7], s39 offen sc1
    s_mov_b64 exec, s[18:19]
    buffer_load_dwordx4 v[116:119], v11, s[4:7], s40 offen sc1
    s_mov_b64 exec, -1
L_h2loop:
    s_or_b32 s16, s16, 1
    s_or_b32 s18, s18, 1
    s_mov_b64 exec, s[16:17]
    buffer_load_dwordx4 v[112:115], v11, s[4:7], s39 offen sc1
    s_mov_b64 exec, s[18:19]
    buffer_load_dwordx4 v[116:119], v11, s[4:7], s40 offen sc1
    s_mov_b64 exec, -1
    s_add_u32 s48, s48, 1
    s_cmp_gt_u32 s48, 0x40000
    s_cbranch_scc1 L_bail
    s_waitcnt vmcnt(2)
    v_max3_u32 v17, v112, v113, v114
    v_max3_u32 v18, v116, v117, v118
    v_max_u32 v17, v17, v115
    v_max_u32 v18, v18, v119
    v_cmp_eq_u32 s[16:17], -1, v17
    v_cmp_eq_u32 s[18:19], -1, v18
    s_nop 1
    s_or_b64 s[20:21], s[16:17], s[18:19]
    s_cbranch_scc0 L_h2ok
    s_branch L_h2loop
L_h2ok:
    ds_write_b128 v11, v[112:115]
    ds_write_b128 v11, v[116:119] offset:1024
    v_mov_b64 v[76:77], 0
    v_mov_b64 v[78:79], 0
    v_mov_b64 v[80:81], 0
    v_mov_b64 v[82:83], 0
    s_waitcnt lgkmcnt(0)
    s_barrier
    s_branch L_step
L_kvslow:
    s_mov_b32 s48, 0
L_kvslow2:
    buffer_load_dword v17, off, s[4:7], s52 sc1
    s_add_u32 s48, s48, 1
    s_cmp_gt_u32 s48, 0x100000
    s_cbranch_scc1 L_bail
    s_waitcnt vmcnt(0)
    v_cmp_gt_u32 vcc, 128, v17
    s_cbranch_vccnz L_kvslow2
    s_branch L_kvok
L_last:
    s_nop 2
    v_min_u32 v87, -2, v90
    v_min_u32 v86, -2, v86
    buffer_store_dwordx4 v[84:87], v15, s[4:7], s47 offen sc1
    s_waitcnt vmcnt(0)
    s_barrier
    s_cmp_lg_u32 s27, 0
    s_cbranch_scc1 L_end
    v_mov_b32 v17, 64
    s_mov_b64 exec, 1
    buffer_store_dword v17, off, s[4:7], s54 sc1
    s_waitcnt vmcnt(0)
    s_branch L_end
L_bail:
    s_mov_b64 exec, 1
    v_mov_b32 v16, 60
    v_mov_b32 v17, 0xdead
    buffer_store_dword v17, v16, s[12:15], 0 offen
    s_waitcnt vmcnt(0)
L_end:
    s_endpgm
L_xs:
    s_cmp_lg_u32 s27, 0
    s_cbranch_scc1 L_xtk_t
    v_mov_b32 v31, 1
    s_mov_b64 exec, 1
    buffer_atomic_add v31, off, s[12:15], 0 offset:64 sc0
    s_waitcnt vmcnt(0)
    v_mov_b32 v30, 163824
    ds_write_b32 v30, v31
    s_waitcnt lgkmcnt(0)
    s_mov_b64 exec, -1
L_xtk_t:
    s_barrier
    v_mov_b32 v30, 163824
    ds_read_b32 v31, v30
    s_waitcnt lgkmcnt(0)
    v_readfirstlane_b32 s26, v31
    s_barrier
L_worker:
    s_nop 0
    s_mov_b32 s28, s26
    s_mov_b32 s80, s22
    s_mov_b32 s81, s23
    s_mov_b32 s72, s56
    s_mov_b32 s73, s57
    s_load_dwordx2 s[22:23], s[0:1], 64
    s_load_dwordx2 s[24:25], s[0:1], 72
    s_load_dwordx2 s[74:75], s[0:1], 88
    s_load_dwordx2 s[76:77], s[0:1], 96
    s_load_dwordx2 s[78:79], s[0:1], 80
    s_waitcnt lgkmcnt(0)
    s_mov_b32 s68, s24
    s_and_b32 s69, s25, 0xffff
    s_mov_b32 s70, 3584
    s_mov_b32 s71, 0x20000
    v_and_b32 v1, 63, v0
    s_lshr_b32 s58, s27, 1
    s_and_b32 s59, s27, 1
    s_mov_b32 s93, 1
    s_cmp_lt_u32 s28, 128
    s_cbranch_scc1 L_nopref
    s_cmp_ge_u32 s28, 224
    s_cbranch_scc1 L_nopref
    s_sub_u32 s30, s28, 128
    s_lshl_b32 s30, s30, 13
    s_lshl_b32 s31, s27, 11
    s_add_u32 s30, s30, s31
    v_lshlrev_b32 v32, 4, v1
    s_mov_b32 s8, s18
    s_and_b32 s9, s19, 0xffff
    s_mov_b32 s10, 4194304
    s_mov_b32 s11, 0x20000
    s_add_u32 s31, s30, 0
    buffer_load_dwordx4 v[36:39], v32, s[8:11], s31 offen offset:0
    buffer_load_dwordx4 v[40:43], v32, s[8:11], s31 offen offset:1024
    s_add_u32 s31, s30, 786432
    buffer_load_dwordx4 v[44:47], v32, s[8:11], s31 offen offset:0
    buffer_load_dwordx4 v[48:51], v32, s[8:11], s31 offen offset:1024
    s_add_u32 s31, s30, 1572864
    buffer_load_dwordx4 v[52:55], v32, s[8:11], s31 offen offset:0
    buffer_load_dwordx4 v[56:59], v32, s[8:11], s31 offen offset:1024
    s_add_u32 s31, s30, 2359296
    buffer_load_dwordx4 v[60:63], v32, s[8:11], s31 offen offset:0
    buffer_load_dwordx4 v[64:67], v32, s[8:11], s31 offen offset:1024
    s_add_u32 s31, s30, 3145728
    buffer_load_dwordx4 v[68:71], v32, s[8:11], s31 offen offset:0
    buffer_load_dwordx4 v[72:75], v32, s[8:11], s31 offen offset:1024
    s_add_u32 s31, s30, 3932160
    buffer_load_dwordx4 v[76:79], v32, s[8:11], s31 offen offset:0
    buffer_load_dwordx4 v[80:83], v32, s[8:11], s31 offen offset:1024
    s_mov_b32 s8, s20
    s_and_b32 s9, s21, 0xffff
    s_mov_b32 s10, 4194304
    s_mov_b32 s11, 0x20000
    s_add_u32 s31, s30, 0
    buffer_load_dwordx4 v[84:87], v32, s[8:11], s31 offen offset:0
    buffer_load_dwordx4 v[88:91], v32, s[8:11], s31 offen offset:1024
    s_add_u32 s31, s30, 786432
    buffer_load_dwordx4 v[92:95], v32, s[8:11], s31 offen offset:0
    buffer_load_dwordx4 v[96:99], v32, s[8:11], s31 offen offset:1024
    s_add_u32 s31, s30, 1572864
    buffer_load_dwordx4 v[36:39], v32, s[8:11], s31 offen offset:0
    buffer_load_dwordx4 v[40:43], v32, s[8:11], s31 offen offset:1024
    s_add_u32 s31, s30, 2359296
    buffer_load_dwordx4 v[44:47], v32, s[8:11], s31 offen offset:0
    buffer_load_dwordx4 v[48:51], v32, s[8:11], s31 offen offset:1024
    s_add_u32 s31, s30, 3145728
    buffer_load_dwordx4 v[52:55], v32, s[8:11], s31 offen offset:0
    buffer_load_dwordx4 v[56:59], v32, s[8:11], s31 offen offset:1024
    s_add_u32 s31, s30, 3932160
    buffer_load_dwordx4 v[60:63], v32, s[8:11], s31 offen offset:0
    buffer_load_dwordx4 v[64:67], v32, s[8:11], s31 offen offset:1024
    s_mov_b32 s8, s80
    s_and_b32 s9, s81, 0xffff
    s_mov_b32 s10, 4194304
    s_mov_b32 s11, 0x20000
    s_add_u32 s31, s30, 0
    buffer_load_dwordx4 v[68:71], v32, s[8:11], s31 offen offset:0
    buffer_load_dwordx4 v[72:75], v32, s[8:11], s31 offen offset:1024
    s_add_u32 s31, s30, 786432
    buffer_load_dwordx4 v[76:79], v32, s[8:11], s31 offen offset:0
    buffer_load_dwordx4 v[80:83], v32, s[8:11], s31 offen offset:1024
    s_add_u32 s31, s30, 1572864
    buffer_load_dwordx4 v[84:87], v32, s[8:11], s31 offen offset:0
    buffer_load_dwordx4 v[88:91], v32, s[8:11], s31 offen offset:1024
    s_add_u32 s31, s30, 2359296
    buffer_load_dwordx4 v[92:95], v32, s[8:11], s31 offen offset:0
    buffer_load_dwordx4 v[96:99], v32, s[8:11], s31 offen offset:1024
    s_add_u32 s31, s30, 3145728
    buffer_load_dwordx4 v[36:39], v32, s[8:11], s31 offen offset:0
    buffer_load_dwordx4 v[40:43], v32, s[8:11], s31 offen offset:1024
    s_add_u32 s31, s30, 3932160
    buffer_load_dwordx4 v[44:47], v32, s[8:11], s31 offen offset:0
    buffer_load_dwordx4 v[48:51], v32, s[8:11], s31 offen offset:1024
    s_waitcnt vmcnt(0)
L_nopref:
    s_cmp_lt_u32 s28, 128
    s_cbranch_scc1 L_nokvp
    s_cmp_ge_u32 s28, 224
    s_cbranch_scc1 L_nokvp
    v_mov_b32 v32, -1
    v_mov_b32 v33, -1
    v_mov_b32 v34, -1
    v_mov_b32 v35, -1
    v_lshlrev_b32 v36, 4, v0
    s_sub_u32 s30, s28, 128
    s_lshl_b32 s30, s30, 13
    s_add_u32 s30, s30, 85196800
    buffer_store_dwordx4 v[32:35], v36, s[4:7], s30 offen sc1
    s_add_u32 s30, s30, 4096
    buffer_store_dwordx4 v[32:35], v36, s[4:7], s30 offen sc1
L_nokvp:
    s_cmp_ge_u32 s28, 128
    s_cbranch_scc1 L_noln
    s_mov_b32 s8, s72
    s_and_b32 s9, s73, 0xffff
    s_mov_b32 s10, 2097152
    s_mov_b32 s11, 0x20000
    s_lshl_b32 s30, s28, 4
    s_lshl_b32 s31, s27, 2
    s_add_u32 s30, s30, s31
    v_lshlrev_b32 v32, 4, v1
    s_lshl_b32 s94, s30, 10
    buffer_load_dwordx4 v[34:37], v32, s[8:11], s94 offen offset:0
    buffer_load_dwordx4 v[38:41], v32, s[8:11], s94 offen offset:1024
    buffer_load_dwordx4 v[42:45], v32, s[8:11], s94 offen offset:2048
    buffer_load_dwordx4 v[46:49], v32, s[8:11], s94 offen offset:3072
    s_add_u32 s95, s94, 0
    s_waitcnt vmcnt(3)
    v_lshlrev_b32 v50, 16, v34
    v_and_b32 v51, 0xffff0000, v34
    v_lshlrev_b32 v52, 16, v35
    v_and_b32 v53, 0xffff0000, v35
    v_lshlrev_b32 v54, 16, v36
    v_and_b32 v55, 0xffff0000, v36
    v_lshlrev_b32 v56, 16, v37
    v_and_b32 v57, 0xffff0000, v37
    v_add_f32 v58, v50, v51
    v_add_f32 v58, v58, v52
    v_add_f32 v58, v58, v53
    v_add_f32 v58, v58, v54
    v_add_f32 v58, v58, v55
    v_add_f32 v58, v58, v56
    v_add_f32 v58, v58, v57
    s_nop 1
    v_add_f32_dpp v58, v58, v58 row_ror:1 row_mask:0xf bank_mask:0xf
    s_nop 1
    v_add_f32_dpp v58, v58, v58 row_ror:2 row_mask:0xf bank_mask:0xf
    s_nop 1
    v_add_f32_dpp v58, v58, v58 row_ror:4 row_mask:0xf bank_mask:0xf
    s_nop 1
    v_add_f32_dpp v58, v58, v58 row_ror:8 row_mask:0xf bank_mask:0xf
    v_mov_b32 v59, v58
    s_nop 1
    v_permlane16_swap_b32 v58, v59
    v_add_f32 v58, v58, v59
    v_mov_b32 v59, v58
    s_nop 1
    v_permlane32_swap_b32 v58, v59
    v_add_f32 v58, v58, v59
    v_mul_f32 v58, 0x3b000000, v58
    v_sub_f32 v59, v50, v58
    v_mul_f32 v60, v59, v59
    v_sub_f32 v59, v51, v58
    v_fmac_f32 v60, v59, v59
    v_sub_f32 v59, v52, v58
    v_fmac_f32 v60, v59, v59
    v_sub_f32 v59, v53, v58
    v_fmac_f32 v60, v59, v59
    v_sub_f32 v59, v54, v58
    v_fmac_f32 v60, v59, v59
    v_sub_f32 v59, v55, v58
    v_fmac_f32 v60, v59, v59
    v_sub_f32 v59, v56, v58
    v_fmac_f32 v60, v59, v59
    v_sub_f32 v59, v57, v58
    v_fmac_f32 v60, v59, v59
    s_nop 1
    v_add_f32_dpp v60, v60, v60 row_ror:1 row_mask:0xf bank_mask:0xf
    s_nop 1
    v_add_f32_dpp v60, v60, v60 row_ror:2 row_mask:0xf bank_mask:0xf
    s_nop 1
    v_add_f32_dpp v60, v60, v60 row_ror:4 row_mask:0xf bank_mask:0xf
    s_nop 1
    v_add_f32_dpp v60, v60, v60 row_ror:8 row_mask:0xf bank_mask:0xf
    v_mov_b32 v59, v60
    s_nop 1
    v_permlane16_swap_b32 v60, v59
    v_add_f32 v60, v60, v59
    v_mov_b32 v59, v60
    s_nop 1
    v_permlane32_swap_b32 v60, v59
    v_add_f32 v60, v60, v59
    v_mul_f32 v60, 0x3b000000, v60
    v_cvt_pk_bf16_f32 v60, v60, v60
    v_lshlrev_b32 v60, 16, v60
    v_add_f32 v60, 0x3727c5ac, v60
    v_cvt_pk_bf16_f32 v60, v60, v60
    v_lshlrev_b32 v60, 16, v60
    v_sqrt_f32 v60, v60
    s_nop 0
    v_cvt_pk_bf16_f32 v60, v60, v60
    v_lshlrev_b32 v60, 16, v60
    v_rcp_f32 v60, v60
    v_mov_b32 v61, v58
    v_cvt_pk_bf16_f32 v61, v61, v61
    v_lshlrev_b32 v61, 16, v61
    v_sub_f32 v50, v50, v61
    v_sub_f32 v51, v51, v61
    v_sub_f32 v52, v52, v61
    v_sub_f32 v53, v53, v61
    v_sub_f32 v54, v54, v61
    v_sub_f32 v55, v55, v61
    v_sub_f32 v56, v56, v61
    v_sub_f32 v57, v57, v61
    v_cvt_pk_bf16_f32 v34, v50, v51
    v_cvt_pk_bf16_f32 v35, v52, v53
    v_cvt_pk_bf16_f32 v36, v54, v55
    v_cvt_pk_bf16_f32 v37, v56, v57
    v_lshlrev_b32 v50, 16, v34
    v_and_b32 v51, 0xffff0000, v34
    v_lshlrev_b32 v52, 16, v35
    v_and_b32 v53, 0xffff0000, v35
    v_lshlrev_b32 v54, 16, v36
    v_and_b32 v55, 0xffff0000, v36
    v_lshlrev_b32 v56, 16, v37
    v_and_b32 v57, 0xffff0000, v37
    v_mul_f32 v50, v50, v60
    v_mul_f32 v51, v51, v60
    v_mul_f32 v52, v52, v60
    v_mul_f32 v53, v53, v60
    v_mul_f32 v54, v54, v60
    v_mul_f32 v55, v55, v60
    v_mul_f32 v56, v56, v60
    v_mul_f32 v57, v57, v60
    v_cvt_pk_bf16_f32 v34, v50, v51
    v_cvt_pk_bf16_f32 v35, v52, v53
    v_cvt_pk_bf16_f32 v36, v54, v55
    v_cvt_pk_bf16_f32 v37, v56, v57
    buffer_store_dwordx4 v[34:37], v32, s[4:7], s95 offen offset:0 sc1
    s_waitcnt vmcnt(3)
    v_lshlrev_b32 v50, 16, v38
    v_and_b32 v51, 0xffff0000, v38
    v_lshlrev_b32 v52, 16, v39
    v_and_b32 v53, 0xffff0000, v39
    v_lshlrev_b32 v54, 16, v40
    v_and_b32 v55, 0xffff0000, v40
    v_lshlrev_b32 v56, 16, v41
    v_and_b32 v57, 0xffff0000, v41
    v_add_f32 v58, v50, v51
    v_add_f32 v58, v58, v52
    v_add_f32 v58, v58, v53
    v_add_f32 v58, v58, v54
    v_add_f32 v58, v58, v55
    v_add_f32 v58, v58, v56
    v_add_f32 v58, v58, v57
    s_nop 1
    v_add_f32_dpp v58, v58, v58 row_ror:1 row_mask:0xf bank_mask:0xf
    s_nop 1
    v_add_f32_dpp v58, v58, v58 row_ror:2 row_mask:0xf bank_mask:0xf
    s_nop 1
    v_add_f32_dpp v58, v58, v58 row_ror:4 row_mask:0xf bank_mask:0xf
    s_nop 1
    v_add_f32_dpp v58, v58, v58 row_ror:8 row_mask:0xf bank_mask:0xf
    v_mov_b32 v59, v58
    s_nop 1
    v_permlane16_swap_b32 v58, v59
    v_add_f32 v58, v58, v59
    v_mov_b32 v59, v58
    s_nop 1
    v_permlane32_swap_b32 v58, v59
    v_add_f32 v58, v58, v59
    v_mul_f32 v58, 0x3b000000, v58
    v_sub_f32 v59, v50, v58
    v_mul_f32 v60, v59, v59
    v_sub_f32 v59, v51, v58
    v_fmac_f32 v60, v59, v59
    v_sub_f32 v59, v52, v58
    v_fmac_f32 v60, v59, v59
    v_sub_f32 v59, v53, v58
    v_fmac_f32 v60, v59, v59
    v_sub_f32 v59, v54, v58
    v_fmac_f32 v60, v59, v59
    v_sub_f32 v59, v55, v58
    v_fmac_f32 v60, v59, v59
    v_sub_f32 v59, v56, v58
    v_fmac_f32 v60, v59, v59
    v_sub_f32 v59, v57, v58
    v_fmac_f32 v60, v59, v59
    s_nop 1
    v_add_f32_dpp v60, v60, v60 row_ror:1 row_mask:0xf bank_mask:0xf
    s_nop 1
    v_add_f32_dpp v60, v60, v60 row_ror:2 row_mask:0xf bank_mask:0xf
    s_nop 1
    v_add_f32_dpp v60, v60, v60 row_ror:4 row_mask:0xf bank_mask:0xf
    s_nop 1
    v_add_f32_dpp v60, v60, v60 row_ror:8 row_mask:0xf bank_mask:0xf
    v_mov_b32 v59, v60
    s_nop 1
    v_permlane16_swap_b32 v60, v59
    v_add_f32 v60, v60, v59
    v_mov_b32 v59, v60
    s_nop 1
    v_permlane32_swap_b32 v60, v59
    v_add_f32 v60, v60, v59
    v_mul_f32 v60, 0x3b000000, v60
    v_cvt_pk_bf16_f32 v60, v60, v60
    v_lshlrev_b32 v60, 16, v60
    v_add_f32 v60, 0x3727c5ac, v60
    v_cvt_pk_bf16_f32 v60, v60, v60
    v_lshlrev_b32 v60, 16, v60
    v_sqrt_f32 v60, v60
    s_nop 0
    v_cvt_pk_bf16_f32 v60, v60, v60
    v_lshlrev_b32 v60, 16, v60
    v_rcp_f32 v60, v60
    v_mov_b32 v61, v58
    v_cvt_pk_bf16_f32 v61, v61, v61
    v_lshlrev_b32 v61, 16, v61
    v_sub_f32 v50, v50, v61
    v_sub_f32 v51, v51, v61
    v_sub_f32 v52, v52, v61
    v_sub_f32 v53, v53, v61
    v_sub_f32 v54, v54, v61
    v_sub_f32 v55, v55, v61
    v_sub_f32 v56, v56, v61
    v_sub_f32 v57, v57, v61
    v_cvt_pk_bf16_f32 v38, v50, v51
    v_cvt_pk_bf16_f32 v39, v52, v53
    v_cvt_pk_bf16_f32 v40, v54, v55
    v_cvt_pk_bf16_f32 v41, v56, v57
    v_lshlrev_b32 v50, 16, v38
    v_and_b32 v51, 0xffff0000, v38
    v_lshlrev_b32 v52, 16, v39
    v_and_b32 v53, 0xffff0000, v39
    v_lshlrev_b32 v54, 16, v40
    v_and_b32 v55, 0xffff0000, v40
    v_lshlrev_b32 v56, 16, v41
    v_and_b32 v57, 0xffff0000, v41
    v_mul_f32 v50, v50, v60
    v_mul_f32 v51, v51, v60
    v_mul_f32 v52, v52, v60
    v_mul_f32 v53, v53, v60
    v_mul_f32 v54, v54, v60
    v_mul_f32 v55, v55, v60
    v_mul_f32 v56, v56, v60
    v_mul_f32 v57, v57, v60
    v_cvt_pk_bf16_f32 v38, v50, v51
    v_cvt_pk_bf16_f32 v39, v52, v53
    v_cvt_pk_bf16_f32 v40, v54, v55
    v_cvt_pk_bf16_f32 v41, v56, v57
    buffer_store_dwordx4 v[38:41], v32, s[4:7], s95 offen offset:1024 sc1
    s_waitcnt vmcnt(3)
    v_lshlrev_b32 v50, 16, v42
    v_and_b32 v51, 0xffff0000, v42
    v_lshlrev_b32 v52, 16, v43
    v_and_b32 v53, 0xffff0000, v43
    v_lshlrev_b32 v54, 16, v44
    v_and_b32 v55, 0xffff0000, v44
    v_lshlrev_b32 v56, 16, v45
    v_and_b32 v57, 0xffff0000, v45
    v_add_f32 v58, v50, v51
    v_add_f32 v58, v58, v52
    v_add_f32 v58, v58, v53
    v_add_f32 v58, v58, v54
    v_add_f32 v58, v58, v55
    v_add_f32 v58, v58, v56
    v_add_f32 v58, v58, v57
    s_nop 1
    v_add_f32_dpp v58, v58, v58 row_ror:1 row_mask:0xf bank_mask:0xf
    s_nop 1
    v_add_f32_dpp v58, v58, v58 row_ror:2 row_mask:0xf bank_mask:0xf
    s_nop 1
    v_add_f32_dpp v58, v58, v58 row_ror:4 row_mask:0xf bank_mask:0xf
    s_nop 1
    v_add_f32_dpp v58, v58, v58 row_ror:8 row_mask:0xf bank_mask:0xf
    v_mov_b32 v59, v58
    s_nop 1
    v_permlane16_swap_b32 v58, v59
    v_add_f32 v58, v58, v59
    v_mov_b32 v59, v58
    s_nop 1
    v_permlane32_swap_b32 v58, v59
    v_add_f32 v58, v58, v59
    v_mul_f32 v58, 0x3b000000, v58
    v_sub_f32 v59, v50, v58
    v_mul_f32 v60, v59, v59
    v_sub_f32 v59, v51, v58
    v_fmac_f32 v60, v59, v59
    v_sub_f32 v59, v52, v58
    v_fmac_f32 v60, v59, v59
    v_sub_f32 v59, v53, v58
    v_fmac_f32 v60, v59, v59
    v_sub_f32 v59, v54, v58
    v_fmac_f32 v60, v59, v59
    v_sub_f32 v59, v55, v58
    v_fmac_f32 v60, v59, v59
    v_sub_f32 v59, v56, v58
    v_fmac_f32 v60, v59, v59
    v_sub_f32 v59, v57, v58
    v_fmac_f32 v60, v59, v59
    s_nop 1
    v_add_f32_dpp v60, v60, v60 row_ror:1 row_mask:0xf bank_mask:0xf
    s_nop 1
    v_add_f32_dpp v60, v60, v60 row_ror:2 row_mask:0xf bank_mask:0xf
    s_nop 1
    v_add_f32_dpp v60, v60, v60 row_ror:4 row_mask:0xf bank_mask:0xf
    s_nop 1
    v_add_f32_dpp v60, v60, v60 row_ror:8 row_mask:0xf bank_mask:0xf
    v_mov_b32 v59, v60
    s_nop 1
    v_permlane16_swap_b32 v60, v59
    v_add_f32 v60, v60, v59
    v_mov_b32 v59, v60
    s_nop 1
    v_permlane32_swap_b32 v60, v59
    v_add_f32 v60, v60, v59
    v_mul_f32 v60, 0x3b000000, v60
    v_cvt_pk_bf16_f32 v60, v60, v60
    v_lshlrev_b32 v60, 16, v60
    v_add_f32 v60, 0x3727c5ac, v60
    v_cvt_pk_bf16_f32 v60, v60, v60
    v_lshlrev_b32 v60, 16, v60
    v_sqrt_f32 v60, v60
    s_nop 0
    v_cvt_pk_bf16_f32 v60, v60, v60
    v_lshlrev_b32 v60, 16, v60
    v_rcp_f32 v60, v60
    v_mov_b32 v61, v58
    v_cvt_pk_bf16_f32 v61, v61, v61
    v_lshlrev_b32 v61, 16, v61
    v_sub_f32 v50, v50, v61
    v_sub_f32 v51, v51, v61
    v_sub_f32 v52, v52, v61
    v_sub_f32 v53, v53, v61
    v_sub_f32 v54, v54, v61
    v_sub_f32 v55, v55, v61
    v_sub_f32 v56, v56, v61
    v_sub_f32 v57, v57, v61
    v_cvt_pk_bf16_f32 v42, v50, v51
    v_cvt_pk_bf16_f32 v43, v52, v53
    v_cvt_pk_bf16_f32 v44, v54, v55
    v_cvt_pk_bf16_f32 v45, v56, v57
    v_lshlrev_b32 v50, 16, v42
    v_and_b32 v51, 0xffff0000, v42
    v_lshlrev_b32 v52, 16, v43
    v_and_b32 v53, 0xffff0000, v43
    v_lshlrev_b32 v54, 16, v44
    v_and_b32 v55, 0xffff0000, v44
    v_lshlrev_b32 v56, 16, v45
    v_and_b32 v57, 0xffff0000, v45
    v_mul_f32 v50, v50, v60
    v_mul_f32 v51, v51, v60
    v_mul_f32 v52, v52, v60
    v_mul_f32 v53, v53, v60
    v_mul_f32 v54, v54, v60
    v_mul_f32 v55, v55, v60
    v_mul_f32 v56, v56, v60
    v_mul_f32 v57, v57, v60
    v_cvt_pk_bf16_f32 v42, v50, v51
    v_cvt_pk_bf16_f32 v43, v52, v53
    v_cvt_pk_bf16_f32 v44, v54, v55
    v_cvt_pk_bf16_f32 v45, v56, v57
    buffer_store_dwordx4 v[42:45], v32, s[4:7], s95 offen offset:2048 sc1
    s_waitcnt vmcnt(3)
    v_lshlrev_b32 v50, 16, v46
    v_and_b32 v51, 0xffff0000, v46
    v_lshlrev_b32 v52, 16, v47
    v_and_b32 v53, 0xffff0000, v47
    v_lshlrev_b32 v54, 16, v48
    v_and_b32 v55, 0xffff0000, v48
    v_lshlrev_b32 v56, 16, v49
    v_and_b32 v57, 0xffff0000, v49
    v_add_f32 v58, v50, v51
    v_add_f32 v58, v58, v52
    v_add_f32 v58, v58, v53
    v_add_f32 v58, v58, v54
    v_add_f32 v58, v58, v55
    v_add_f32 v58, v58, v56
    v_add_f32 v58, v58, v57
    s_nop 1
    v_add_f32_dpp v58, v58, v58 row_ror:1 row_mask:0xf bank_mask:0xf
    s_nop 1
    v_add_f32_dpp v58, v58, v58 row_ror:2 row_mask:0xf bank_mask:0xf
    s_nop 1
    v_add_f32_dpp v58, v58, v58 row_ror:4 row_mask:0xf bank_mask:0xf
    s_nop 1
    v_add_f32_dpp v58, v58, v58 row_ror:8 row_mask:0xf bank_mask:0xf
    v_mov_b32 v59, v58
    s_nop 1
    v_permlane16_swap_b32 v58, v59
    v_add_f32 v58, v58, v59
    v_mov_b32 v59, v58
    s_nop 1
    v_permlane32_swap_b32 v58, v59
    v_add_f32 v58, v58, v59
    v_mul_f32 v58, 0x3b000000, v58
    v_sub_f32 v59, v50, v58
    v_mul_f32 v60, v59, v59
    v_sub_f32 v59, v51, v58
    v_fmac_f32 v60, v59, v59
    v_sub_f32 v59, v52, v58
    v_fmac_f32 v60, v59, v59
    v_sub_f32 v59, v53, v58
    v_fmac_f32 v60, v59, v59
    v_sub_f32 v59, v54, v58
    v_fmac_f32 v60, v59, v59
    v_sub_f32 v59, v55, v58
    v_fmac_f32 v60, v59, v59
    v_sub_f32 v59, v56, v58
    v_fmac_f32 v60, v59, v59
    v_sub_f32 v59, v57, v58
    v_fmac_f32 v60, v59, v59
    s_nop 1
    v_add_f32_dpp v60, v60, v60 row_ror:1 row_mask:0xf bank_mask:0xf
    s_nop 1
    v_add_f32_dpp v60, v60, v60 row_ror:2 row_mask:0xf bank_mask:0xf
    s_nop 1
    v_add_f32_dpp v60, v60, v60 row_ror:4 row_mask:0xf bank_mask:0xf
    s_nop 1
    v_add_f32_dpp v60, v60, v60 row_ror:8 row_mask:0xf bank_mask:0xf
    v_mov_b32 v59, v60
    s_nop 1
    v_permlane16_swap_b32 v60, v59
    v_add_f32 v60, v60, v59
    v_mov_b32 v59, v60
    s_nop 1
    v_permlane32_swap_b32 v60, v59
    v_add_f32 v60, v60, v59
    v_mul_f32 v60, 0x3b000000, v60
    v_cvt_pk_bf16_f32 v60, v60, v60
    v_lshlrev_b32 v60, 16, v60
    v_add_f32 v60, 0x3727c5ac, v60
    v_cvt_pk_bf16_f32 v60, v60, v60
    v_lshlrev_b32 v60, 16, v60
    v_sqrt_f32 v60, v60
    s_nop 0
    v_cvt_pk_bf16_f32 v60, v60, v60
    v_lshlrev_b32 v60, 16, v60
    v_rcp_f32 v60, v60
    v_mov_b32 v61, v58
    v_cvt_pk_bf16_f32 v61, v61, v61
    v_lshlrev_b32 v61, 16, v61
    v_sub_f32 v50, v50, v61
    v_sub_f32 v51, v51, v61
    v_sub_f32 v52, v52, v61
    v_sub_f32 v53, v53, v61
    v_sub_f32 v54, v54, v61
    v_sub_f32 v55, v55, v61
    v_sub_f32 v56, v56, v61
    v_sub_f32 v57, v57, v61
    v_cvt_pk_bf16_f32 v46, v50, v51
    v_cvt_pk_bf16_f32 v47, v52, v53
    v_cvt_pk_bf16_f32 v48, v54, v55
    v_cvt_pk_bf16_f32 v49, v56, v57
    v_lshlrev_b32 v50, 16, v46
    v_and_b32 v51, 0xffff0000, v46
    v_lshlrev_b32 v52, 16, v47
    v_and_b32 v53, 0xffff0000, v47
    v_lshlrev_b32 v54, 16, v48
    v_and_b32 v55, 0xffff0000, v48
    v_lshlrev_b32 v56, 16, v49
    v_and_b32 v57, 0xffff0000, v49
    v_mul_f32 v50, v50, v60
    v_mul_f32 v51, v51, v60
    v_mul_f32 v52, v52, v60
    v_mul_f32 v53, v53, v60
    v_mul_f32 v54, v54, v60
    v_mul_f32 v55, v55, v60
    v_mul_f32 v56, v56, v60
    v_mul_f32 v57, v57, v60
    v_cvt_pk_bf16_f32 v46, v50, v51
    v_cvt_pk_bf16_f32 v47, v52, v53
    v_cvt_pk_bf16_f32 v48, v54, v55
    v_cvt_pk_bf16_f32 v49, v56, v57
    buffer_store_dwordx4 v[46:49], v32, s[4:7], s95 offen offset:3072 sc1
    s_waitcnt vmcnt(0)
    s_barrier
L_noln:
    s_cmp_lg_u32 s27, 0
    s_cbranch_scc1 L_lnsig
    s_mov_b32 s62, 0
L_ln_ip:
    buffer_load_dword v31, off, s[12:15], 0 offset:128 sc1
    s_add_u32 s62, s62, 1
    s_cmp_gt_u32 s62, 0x200000
    s_cbranch_scc1 L_wbail
    s_waitcnt vmcnt(0)
    v_cmp_eq_u32 vcc, 0, v31
    s_cbranch_vccnz L_ln_ip
    s_cmp_ge_u32 s28, 128
    s_cbranch_scc1 L_lnsig
    s_lshr_b32 s30, s28, 4
    s_lshl_b32 s30, s30, 7
    s_add_u32 s30, s30, 91267072
    v_mov_b32 v31, 1
    s_mov_b64 exec, 1
    buffer_atomic_add v31, off, s[4:7], s30
    s_mov_b64 exec, -1
L_lnsig:
    s_mov_b32 s89, 0
L_g1_next:
    s_cmp_ge_u32 s28, 600
    s_cbranch_scc1 L_ao_role
    s_cmp_ge_u32 s28, 536
    s_cbranch_scc1 L_m2
    s_mov_b32 s44, 1024
    s_mov_b32 s50, 8
    s_mov_b32 s66, 268435456
    s_mov_b32 s8, s4
    s_mov_b32 s9, s5
    s_mov_b32 s11, 0x20000
    s_mov_b32 s40, s4
    s_mov_b32 s41, s5
    s_mov_b32 s42, 268435456
    s_mov_b32 s43, 0x20000
    s_mov_b32 s39, 0x20000
    s_mov_b32 s90, 1
    s_cmp_ge_u32 s28, 408
    s_cbranch_scc1 L_dec_q
    s_cmp_ge_u32 s28, 352
    s_cbranch_scc1 L_dec_h
    s_mov_b32 s45, 8192
    s_mov_b32 s67, 4194304
    s_mov_b32 s46, 8192
    s_cmp_lt_u32 s28, 128
    s_cbranch_scc1 L_kv_small
    s_sub_u32 s83, s28, 96
    s_and_b32 s56, s83, 15
    s_lshl_b32 s48, s56, 9
    s_lshl_b32 s57, s56, 14
    s_bfe_u32 s91, s83, 0x10004
    s_lshr_b32 s84, s83, 5
    s_lshl_b32 s83, s84, 1
    s_mov_b32 s90, 4
    s_branch L_kv_common
L_kv_small:
    s_and_b32 s56, s28, 31
    s_lshl_b32 s48, s56, 8
    s_lshl_b32 s57, s56, 13
    s_bfe_u32 s91, s28, 0x10005
    s_lshr_b32 s83, s28, 6
    s_mov_b32 s84, 0
L_kv_common:
    s_lshl_b32 s47, s83, 17
    s_add_u32 s47, s47, 0
    s_lshl_b32 s85, s84, 7
    s_add_u32 s85, s85, 91226112
    s_lshl_b32 s49, s83, 20
    s_cmp_eq_u32 s91, 1
    s_cbranch_scc1 L_dec_v
    s_mov_b32 s36, s18
    s_and_b32 s37, s19, 0xffff
    s_add_u32 s49, s49, s48
    s_add_u32 s49, s49, 2097152
    s_branch L_lnwait
L_dec_v:
    s_mov_b32 s36, s20
    s_and_b32 s37, s21, 0xffff
    s_add_u32 s49, s49, s57
    s_add_u32 s49, s49, 18874368
    s_branch L_lnwait
L_dec_q:
    s_sub_u32 s83, s28, 408
    s_and_b32 s56, s83, 15
    s_lshr_b32 s84, s83, 4
    s_mov_b32 s45, 8192
    s_mov_b32 s67, 4194304
    s_lshl_b32 s48, s56, 9
    s_mov_b32 s46, 8192
    s_lshl_b32 s47, s84, 18
    s_add_u32 s47, s47, 0
    s_mov_b32 s36, s16
    s_and_b32 s37, s17, 0xffff
    s_lshl_b32 s49, s84, 21
    s_add_u32 s49, s49, s48
    s_add_u32 s49, s49, 35651584
    s_lshl_b32 s85, s84, 7
    s_add_u32 s85, s85, 91227136
    s_mov_b32 s91, 0
    s_branch L_lnwait
L_dec_h:
    s_sub_u32 s56, s28, 352
    s_mul_i32 s84, s56, 37
    s_lshr_b32 s84, s84, 8
    s_mul_i32 s57, s84, 7
    s_sub_u32 s56, s56, s57
    s_lshl_b32 s47, s84, 18
    s_add_u32 s47, s47, 0
    s_mov_b32 s45, 3584
    s_mov_b32 s67, 1835008
    s_lshl_b32 s48, s56, 9
    s_mov_b32 s60, s48
    s_mov_b32 s36, s22
    s_and_b32 s37, s23, 0xffff
    s_mov_b32 s46, 3584
    s_mul_i32 s49, s84, 917504
    s_add_u32 s49, s49, s48
    s_add_u32 s49, s49, 69206016
    s_lshl_b32 s85, s84, 7
    s_add_u32 s85, s85, 91228160
    s_mov_b32 s91, 2
L_lnwait:
    s_cmp_lt_u32 s28, 600
    s_cbranch_scc1 L_nohold
    s_mov_b32 s30, 91226112
    s_cmp_lg_u32 s27, 0
    s_cbranch_scc1 L_hold_j
    s_mov_b32 s82, 0
L_hold_p:
    buffer_load_dword v31, off, s[4:7], s30 sc1
    s_add_u32 s82, s82, 1
    s_cmp_gt_u32 s82, 2097152
    s_cbranch_scc1 L_wbail
    s_waitcnt vmcnt(0)
    v_cmp_gt_u32 vcc, 128, v31
    s_cbranch_vccz L_hold_j
    s_sleep 2
    s_branch L_hold_p
L_hold_j:
    s_barrier
L_nohold:
    s_lshl_b32 s30, s84, 7
    s_add_u32 s30, s30, 91267072
    s_cmp_lg_u32 s27, 0
    s_cbranch_scc1 L_lnw_j
    s_mov_b32 s82, 0
L_lnw_p:
    buffer_load_dword v31, off, s[4:7], s30 sc1
    s_add_u32 s82, s82, 1
    s_cmp_gt_u32 s82, 2097152
    s_cbranch_scc1 L_wbail
    s_waitcnt vmcnt(0)
    v_cmp_gt_u32 vcc, 16, v31
    s_cbranch_vccz L_lnw_j
    s_sleep 2
    s_branch L_lnw_p
L_lnw_j:
    s_barrier
    s_cmp_eq_u32 s91, 2
    s_cbranch_scc1 L_task_h
    s_cmp_lt_u32 s28, 128
    s_cbranch_scc1 L_small
    s_cmp_eq_u32 s91, 1
    s_cbranch_scc1 L_task_v
    s_branch L_task_k
L_small:
    s_cmp_eq_u32 s91, 1
    s_cbranch_scc1 L_task_vs
    s_branch L_task_ks
L_task_ks:
    v_and_b32 v14, 31, v1
    v_bfe_u32 v15, v1, 1, 3
    v_lshrrev_b32 v16, 5, v1
    v_xor_b32 v15, v15, v16
    v_lshlrev_b32 v14, 7, v14
    s_mul_i32 s55, s58, 8192
    v_add_u32 v14, s55, v14
    v_xor_b32 v16, 0, v15
    v_lshl_add_u32 v2, v16, 4, v14
    v_xor_b32 v16, 2, v15
    v_lshl_add_u32 v3, v16, 4, v14
    v_xor_b32 v16, 4, v15
    v_lshl_add_u32 v4, v16, 4, v14
    v_xor_b32 v16, 6, v15
    v_lshl_add_u32 v5, v16, 4, v14
    v_lshrrev_b32 v14, 5, v1
    v_lshlrev_b32 v14, 3, v14
    v_bfe_u32 v15, v1, 2, 2
    v_add_u32 v14, v14, v15
    v_lshlrev_b32 v14, 8, v14
    v_bfe_u32 v16, v1, 4, 1
    v_lshl_or_b32 v14, v16, 5, v14
    v_bfe_u32 v16, v1, 1, 1
    v_lshl_or_b32 v14, v16, 4, v14
    v_and_b32 v16, 1, v1
    v_lshl_or_b32 v14, v16, 3, v14
    s_mov_b32 s55, 0
    s_add_u32 s55, s55, 16384
    v_add_u32 v14, s55, v14
    v_xor_b32 v16, 0, v15
    v_lshl_add_u32 v6, v16, 6, v14
    v_xor_b32 v16, 1, v15
    v_lshl_add_u32 v7, v16, 6, v14
    v_xor_b32 v16, 2, v15
    v_lshl_add_u32 v8, v16, 6, v14
    v_xor_b32 v16, 3, v15
    v_lshl_add_u32 v9, v16, 6, v14
    v_mov_b32 v22, v2
    v_mov_b32 v23, v3
    v_mov_b32 v24, v4
    v_mov_b32 v25, v5
    v_mov_b32 v26, v6
    v_mov_b32 v27, v7
    v_mov_b32 v28, v8
    v_mov_b32 v29, v9
    v_lshrrev_b32 v14, 3, v1
    v_mul_lo_u32 v14, v14, s44
    v_and_b32 v15, 7, v1
    v_bfe_u32 v16, v1, 4, 2
    v_xor_b32 v15, v15, v16
    v_lshl_add_u32 v10, v15, 4, v14
    v_xor_b32 v15, 4, v15
    v_lshl_add_u32 v11, v15, 4, v14
    v_lshrrev_b32 v16, 5, v1
    v_mul_lo_u32 v14, v16, s45
    v_and_b32 v15, 31, v1
    v_lshlrev_b32 v16, 2, v16
    v_xor_b32 v15, v15, v16
    v_lshl_add_u32 v12, v15, 4, v14
    v_xor_b32 v15, 8, v15
    v_lshl_add_u32 v13, v15, 4, v14
    v_lshrrev_b32 v16, 4, v1
    v_mul_lo_u32 v14, v16, s45
    v_and_b32 v15, 15, v1
    v_lshlrev_b32 v16, 2, v16
    v_xor_b32 v15, v15, v16
    v_lshl_add_u32 v12, v15, 4, v14
    v_mov_b32 v13, v12
    s_mov_b32 s10, s66
    s_mov_b32 s38, s67
    s_lshl_b32 s57, s44, 3
    s_lshl_b32 s61, s45, 2
    s_mul_i32 s52, s44, s27
    s_mul_i32 s52, s52, 32
    s_add_u32 s52, s52, s47
    s_mul_i32 s53, s45, s27
    s_lshl_b32 s53, s53, 4
    s_add_u32 s53, s53, s48
    s_lshl_b32 s54, s27, 12
    s_mul_i32 s65, s27, 4096
    s_mov_b32 s55, s52
    s_add_u32 m0, s65, 0
    s_nop 0
    buffer_load_dwordx4 v10, s[8:11], s55 offen sc1 lds
    s_add_u32 s55, s55, s57
    s_add_u32 m0, s65, 1024
    s_nop 0
    buffer_load_dwordx4 v11, s[8:11], s55 offen sc1 lds
    s_add_u32 s55, s55, s57
    s_add_u32 m0, s65, 2048
    s_nop 0
    buffer_load_dwordx4 v10, s[8:11], s55 offen sc1 lds
    s_add_u32 s55, s55, s57
    s_add_u32 m0, s65, 3072
    s_nop 0
    buffer_load_dwordx4 v11, s[8:11], s55 offen sc1 lds
    s_mov_b32 s56, s53
    s_add_u32 m0, s54, 16384
    s_nop 0
    buffer_load_dwordx4 v12, s[36:39], s56 offen lds
    s_add_u32 s56, s56, s61
    s_add_u32 m0, s54, 17408
    s_nop 0
    buffer_load_dwordx4 v13, s[36:39], s56 offen lds
    s_add_u32 s56, s56, s61
    s_add_u32 m0, s54, 18432
    s_nop 0
    buffer_load_dwordx4 v12, s[36:39], s56 offen lds
    s_add_u32 s56, s56, s61
    s_add_u32 m0, s54, 19456
    s_nop 0
    buffer_load_dwordx4 v13, s[36:39], s56 offen lds
    s_add_u32 s52, s52, 128
    s_lshl_b32 s62, s45, 6
    s_add_u32 s53, s53, s62
    s_add_u32 s54, s54, 49152
    s_sub_u32 s62, s54, 147456
    s_cmp_ge_u32 s54, 147456
    s_cselect_b32 s54, s62, s54
    s_add_u32 s65, s65, 49152
    s_sub_u32 s62, s65, 147456
    s_cmp_ge_u32 s65, 147456
    s_cselect_b32 s65, s62, s65
    s_mov_b32 s55, s52
    s_add_u32 m0, s65, 0
    s_nop 0
    buffer_load_dwordx4 v10, s[8:11], s55 offen sc1 lds
    s_add_u32 s55, s55, s57
    s_add_u32 m0, s65, 1024
    s_nop 0
    buffer_load_dwordx4 v11, s[8:11], s55 offen sc1 lds
    s_add_u32 s55, s55, s57
    s_add_u32 m0, s65, 2048
    s_nop 0
    buffer_load_dwordx4 v10, s[8:11], s55 offen sc1 lds
    s_add_u32 s55, s55, s57
    s_add_u32 m0, s65, 3072
    s_nop 0
    buffer_load_dwordx4 v11, s[8:11], s55 offen sc1 lds
    s_mov_b32 s56, s53
    s_add_u32 m0, s54, 16384
    s_nop 0
    buffer_load_dwordx4 v12, s[36:39], s56 offen lds
    s_add_u32 s56, s56, s61
    s_add_u32 m0, s54, 17408
    s_nop 0
    buffer_load_dwordx4 v13, s[36:39], s56 offen lds
    s_add_u32 s56, s56, s61
    s_add_u32 m0, s54, 18432
    s_nop 0
    buffer_load_dwordx4 v12, s[36:39], s56 offen lds
    s_add_u32 s56, s56, s61
    s_add_u32 m0, s54, 19456
    s_nop 0
    buffer_load_dwordx4 v13, s[36:39], s56 offen lds
    s_add_u32 s52, s52, 128
    s_lshl_b32 s62, s45, 6
    s_add_u32 s53, s53, s62
    s_add_u32 s54, s54, 49152
    s_sub_u32 s62, s54, 147456
    s_cmp_ge_u32 s54, 147456
    s_cselect_b32 s54, s62, s54
    s_add_u32 s65, s65, 49152
    s_sub_u32 s62, s65, 147456
    s_cmp_ge_u32 s65, 147456
    s_cselect_b32 s65, s62, s65
    s_mov_b32 s63, 0
    v_accvgpr_write_b32 a0, 0
    v_accvgpr_write_b32 a1, 0
    v_accvgpr_write_b32 a2, 0
    v_accvgpr_write_b32 a3, 0
    v_accvgpr_write_b32 a4, 0
    v_accvgpr_write_b32 a5, 0
    v_accvgpr_write_b32 a6, 0
    v_accvgpr_write_b32 a7, 0
    v_accvgpr_write_b32 a8, 0
    v_accvgpr_write_b32 a9, 0
    v_accvgpr_write_b32 a10, 0
    v_accvgpr_write_b32 a11, 0
    v_accvgpr_write_b32 a12, 0
    v_accvgpr_write_b32 a13, 0
    v_accvgpr_write_b32 a14, 0
    v_accvgpr_write_b32 a15, 0
    v_accvgpr_write_b32 a16, 0
    v_accvgpr_write_b32 a17, 0
    v_accvgpr_write_b32 a18, 0
    v_accvgpr_write_b32 a19, 0
    v_accvgpr_write_b32 a20, 0
    v_accvgpr_write_b32 a21, 0
    v_accvgpr_write_b32 a22, 0
    v_accvgpr_write_b32 a23, 0
    v_accvgpr_write_b32 a24, 0
    v_accvgpr_write_b32 a25, 0
    v_accvgpr_write_b32 a26, 0
    v_accvgpr_write_b32 a27, 0
    v_accvgpr_write_b32 a28, 0
    v_accvgpr_write_b32 a29, 0
    v_accvgpr_write_b32 a30, 0
    v_accvgpr_write_b32 a31, 0
    v_accvgpr_write_b32 a32, 0
    v_accvgpr_write_b32 a33, 0
    v_accvgpr_write_b32 a34, 0
    v_accvgpr_write_b32 a35, 0
    v_accvgpr_write_b32 a36, 0
    v_accvgpr_write_b32 a37, 0
    v_accvgpr_write_b32 a38, 0
    v_accvgpr_write_b32 a39, 0
    v_accvgpr_write_b32 a40, 0
    v_accvgpr_write_b32 a41, 0
    v_accvgpr_write_b32 a42, 0
    v_accvgpr_write_b32 a43, 0
    v_accvgpr_write_b32 a44, 0
    v_accvgpr_write_b32 a45, 0
    v_accvgpr_write_b32 a46, 0
    v_accvgpr_write_b32 a47, 0
    v_accvgpr_write_b32 a48, 0
    v_accvgpr_write_b32 a49, 0
    v_accvgpr_write_b32 a50, 0
    v_accvgpr_write_b32 a51, 0
    v_accvgpr_write_b32 a52, 0
    v_accvgpr_write_b32 a53, 0
    v_accvgpr_write_b32 a54, 0
    v_accvgpr_write_b32 a55, 0
    v_accvgpr_write_b32 a56, 0
    v_accvgpr_write_b32 a57, 0
    v_accvgpr_write_b32 a58, 0
    v_accvgpr_write_b32 a59, 0
    v_accvgpr_write_b32 a60, 0
    v_accvgpr_write_b32 a61, 0
    v_accvgpr_write_b32 a62, 0
    v_accvgpr_write_b32 a63, 0
    v_accvgpr_write_b32 a64, 0
    v_accvgpr_write_b32 a65, 0
    v_accvgpr_write_b32 a66, 0
    v_accvgpr_write_b32 a67, 0
    v_accvgpr_write_b32 a68, 0
    v_accvgpr_write_b32 a69, 0
    v_accvgpr_write_b32 a70, 0
    v_accvgpr_write_b32 a71, 0
    v_accvgpr_write_b32 a72, 0
    v_accvgpr_write_b32 a73, 0
    v_accvgpr_write_b32 a74, 0
    v_accvgpr_write_b32 a75, 0
    v_accvgpr_write_b32 a76, 0
    v_accvgpr_write_b32 a77, 0
    v_accvgpr_write_b32 a78, 0
    v_accvgpr_write_b32 a79, 0
    v_accvgpr_write_b32 a80, 0
    v_accvgpr_write_b32 a81, 0
    v_accvgpr_write_b32 a82, 0
    v_accvgpr_write_b32 a83, 0
    v_accvgpr_write_b32 a84, 0
    v_accvgpr_write_b32 a85, 0
    v_accvgpr_write_b32 a86, 0
    v_accvgpr_write_b32 a87, 0
    v_accvgpr_write_b32 a88, 0
    v_accvgpr_write_b32 a89, 0
    v_accvgpr_write_b32 a90, 0
    v_accvgpr_write_b32 a91, 0
    v_accvgpr_write_b32 a92, 0
    v_accvgpr_write_b32 a93, 0
    v_accvgpr_write_b32 a94, 0
    v_accvgpr_write_b32 a95, 0
    v_accvgpr_write_b32 a96, 0
    v_accvgpr_write_b32 a97, 0
    v_accvgpr_write_b32 a98, 0
    v_accvgpr_write_b32 a99, 0
    v_accvgpr_write_b32 a100, 0
    v_accvgpr_write_b32 a101, 0
    v_accvgpr_write_b32 a102, 0
    v_accvgpr_write_b32 a103, 0
    v_accvgpr_write_b32 a104, 0
    v_accvgpr_write_b32 a105, 0
    v_accvgpr_write_b32 a106, 0
    v_accvgpr_write_b32 a107, 0
    v_accvgpr_write_b32 a108, 0
    v_accvgpr_write_b32 a109, 0
    v_accvgpr_write_b32 a110, 0
    v_accvgpr_write_b32 a111, 0
    v_accvgpr_write_b32 a112, 0
    v_accvgpr_write_b32 a113, 0
    v_accvgpr_write_b32 a114, 0
    v_accvgpr_write_b32 a115, 0
    v_accvgpr_write_b32 a116, 0
    v_accvgpr_write_b32 a117, 0
    v_accvgpr_write_b32 a118, 0
    v_accvgpr_write_b32 a119, 0
    v_accvgpr_write_b32 a120, 0
    v_accvgpr_write_b32 a121, 0
    v_accvgpr_write_b32 a122, 0
    v_accvgpr_write_b32 a123, 0
    v_accvgpr_write_b32 a124, 0
    v_accvgpr_write_b32 a125, 0
    v_accvgpr_write_b32 a126, 0
    v_accvgpr_write_b32 a127, 0
    s_mov_b32 s51, 0
    s_nop 0
L_gks:
    s_waitcnt vmcnt(8)
    s_barrier
    ds_read_b128 v[64:67], v2 offset:0
    ds_read_b64_tr_b16 v[96:97], v6 offset:0
    ds_read_b64_tr_b16 v[98:99], v6 offset:1024
    ds_read_b64_tr_b16 v[100:101], v7 offset:0
    ds_read_b64_tr_b16 v[102:103], v7 offset:1024
    ds_read_b128 v[68:71], v2 offset:4096
    ds_read_b64_tr_b16 v[104:105], v8 offset:0
    ds_read_b64_tr_b16 v[106:107], v8 offset:1024
    ds_read_b64_tr_b16 v[108:109], v9 offset:0
    ds_read_b64_tr_b16 v[110:111], v9 offset:1024
    s_add_u32 s55, s51, 2
    s_cmp_ge_u32 s55, s50
    s_cselect_b32 s10, 0, s66
    s_cselect_b32 s38, 0, s67
    s_waitcnt lgkmcnt(7)
    v_mfma_f32_32x32x16_bf16 a[0:15], v[96:99], v[64:67], a[0:15]
    ds_read_b128 v[80:83], v3 offset:0
    ds_read_b64_tr_b16 v[112:113], v6 offset:4096
    s_mov_b32 s55, s52
    s_add_u32 m0, s65, 0
    s_nop 0
    buffer_load_dwordx4 v10, s[8:11], s55 offen sc1 lds
    s_waitcnt lgkmcnt(7)
    v_mfma_f32_32x32x16_bf16 a[16:31], v[100:103], v[64:67], a[16:31]
    ds_read_b64_tr_b16 v[114:115], v6 offset:5120
    ds_read_b64_tr_b16 v[116:117], v7 offset:4096
    s_add_u32 s55, s55, s57
    s_add_u32 m0, s65, 1024
    s_nop 0
    buffer_load_dwordx4 v11, s[8:11], s55 offen sc1 lds
    s_waitcnt lgkmcnt(8)
    v_mfma_f32_32x32x16_bf16 a[64:79], v[96:99], v[68:71], a[64:79]
    ds_read_b64_tr_b16 v[118:119], v7 offset:5120
    ds_read_b128 v[84:87], v3 offset:4096
    s_add_u32 s55, s55, s57
    s_add_u32 m0, s65, 2048
    s_nop 0
    buffer_load_dwordx4 v10, s[8:11], s55 offen sc1 lds
    v_mfma_f32_32x32x16_bf16 a[80:95], v[100:103], v[68:71], a[80:95]
    ds_read_b64_tr_b16 v[120:121], v8 offset:4096
    ds_read_b64_tr_b16 v[122:123], v8 offset:5120
    s_add_u32 s55, s55, s57
    s_add_u32 m0, s65, 3072
    s_nop 0
    buffer_load_dwordx4 v11, s[8:11], s55 offen sc1 lds
    s_waitcnt lgkmcnt(10)
    v_mfma_f32_32x32x16_bf16 a[32:47], v[104:107], v[64:67], a[32:47]
    ds_read_b64_tr_b16 v[124:125], v9 offset:4096
    ds_read_b64_tr_b16 v[126:127], v9 offset:5120
    s_mov_b32 s56, s53
    s_add_u32 m0, s54, 16384
    s_nop 0
    buffer_load_dwordx4 v12, s[36:39], s56 offen lds
    s_waitcnt lgkmcnt(10)
    v_mfma_f32_32x32x16_bf16 a[48:63], v[108:111], v[64:67], a[48:63]
    s_add_u32 s56, s56, s61
    s_add_u32 m0, s54, 17408
    s_nop 0
    buffer_load_dwordx4 v13, s[36:39], s56 offen lds
    v_mfma_f32_32x32x16_bf16 a[96:111], v[104:107], v[68:71], a[96:111]
    s_add_u32 s56, s56, s61
    s_add_u32 m0, s54, 18432
    s_nop 0
    buffer_load_dwordx4 v12, s[36:39], s56 offen lds
    v_mfma_f32_32x32x16_bf16 a[112:127], v[108:111], v[68:71], a[112:127]
    s_add_u32 s56, s56, s61
    s_add_u32 m0, s54, 19456
    s_nop 0
    buffer_load_dwordx4 v13, s[36:39], s56 offen lds
    s_waitcnt lgkmcnt(7)
    v_mfma_f32_32x32x16_bf16 a[0:15], v[112:115], v[80:83], a[0:15]
    ds_read_b128 v[64:67], v4 offset:0
    ds_read_b64_tr_b16 v[96:97], v6 offset:8192
    s_waitcnt lgkmcnt(7)
    v_mfma_f32_32x32x16_bf16 a[16:31], v[116:119], v[80:83], a[16:31]
    ds_read_b64_tr_b16 v[98:99], v6 offset:9216
    ds_read_b64_tr_b16 v[100:101], v7 offset:8192
    s_waitcnt lgkmcnt(8)
    v_mfma_f32_32x32x16_bf16 a[64:79], v[112:115], v[84:87], a[64:79]
    ds_read_b64_tr_b16 v[102:103], v7 offset:9216
    ds_read_b128 v[68:71], v4 offset:4096
    v_mfma_f32_32x32x16_bf16 a[80:95], v[116:119], v[84:87], a[80:95]
    ds_read_b64_tr_b16 v[104:105], v8 offset:8192
    ds_read_b64_tr_b16 v[106:107], v8 offset:9216
    s_waitcnt lgkmcnt(10)
    v_mfma_f32_32x32x16_bf16 a[32:47], v[120:123], v[80:83], a[32:47]
    ds_read_b64_tr_b16 v[108:109], v9 offset:8192
    ds_read_b64_tr_b16 v[110:111], v9 offset:9216
    s_waitcnt lgkmcnt(10)
    v_mfma_f32_32x32x16_bf16 a[48:63], v[124:127], v[80:83], a[48:63]
    v_mfma_f32_32x32x16_bf16 a[96:111], v[120:123], v[84:87], a[96:111]
    v_mfma_f32_32x32x16_bf16 a[112:127], v[124:127], v[84:87], a[112:127]
    s_waitcnt lgkmcnt(7)
    v_mfma_f32_32x32x16_bf16 a[0:15], v[96:99], v[64:67], a[0:15]
    ds_read_b128 v[80:83], v5 offset:0
    ds_read_b64_tr_b16 v[112:113], v6 offset:12288
    s_waitcnt lgkmcnt(7)
    v_mfma_f32_32x32x16_bf16 a[16:31], v[100:103], v[64:67], a[16:31]
    ds_read_b64_tr_b16 v[114:115], v6 offset:13312
    ds_read_b64_tr_b16 v[116:117], v7 offset:12288
    s_waitcnt lgkmcnt(8)
    v_mfma_f32_32x32x16_bf16 a[64:79], v[96:99], v[68:71], a[64:79]
    ds_read_b64_tr_b16 v[118:119], v7 offset:13312
    ds_read_b128 v[84:87], v5 offset:4096
    v_mfma_f32_32x32x16_bf16 a[80:95], v[100:103], v[68:71], a[80:95]
    ds_read_b64_tr_b16 v[120:121], v8 offset:12288
    ds_read_b64_tr_b16 v[122:123], v8 offset:13312
    s_waitcnt lgkmcnt(10)
    v_mfma_f32_32x32x16_bf16 a[32:47], v[104:107], v[64:67], a[32:47]
    ds_read_b64_tr_b16 v[124:125], v9 offset:12288
    ds_read_b64_tr_b16 v[126:127], v9 offset:13312
    s_waitcnt lgkmcnt(10)
    v_mfma_f32_32x32x16_bf16 a[48:63], v[108:111], v[64:67], a[48:63]
    v_mfma_f32_32x32x16_bf16 a[96:111], v[104:107], v[68:71], a[96:111]
    v_mfma_f32_32x32x16_bf16 a[112:127], v[108:111], v[68:71], a[112:127]
    s_waitcnt lgkmcnt(7)
    v_mfma_f32_32x32x16_bf16 a[0:15], v[112:115], v[80:83], a[0:15]
    s_waitcnt lgkmcnt(5)
    v_mfma_f32_32x32x16_bf16 a[16:31], v[116:119], v[80:83], a[16:31]
    s_waitcnt lgkmcnt(4)
    v_mfma_f32_32x32x16_bf16 a[64:79], v[112:115], v[84:87], a[64:79]
    v_mfma_f32_32x32x16_bf16 a[80:95], v[116:119], v[84:87], a[80:95]
    s_waitcnt lgkmcnt(2)
    v_mfma_f32_32x32x16_bf16 a[32:47], v[120:123], v[80:83], a[32:47]
    s_waitcnt lgkmcnt(0)
    v_mfma_f32_32x32x16_bf16 a[48:63], v[124:127], v[80:83], a[48:63]
    v_mfma_f32_32x32x16_bf16 a[96:111], v[120:123], v[84:87], a[96:111]
    v_mfma_f32_32x32x16_bf16 a[112:127], v[124:127], v[84:87], a[112:127]
    s_add_u32 s52, s52, 128
    s_lshl_b32 s62, s45, 6
    s_add_u32 s53, s53, s62
    s_add_u32 s54, s54, 49152
    s_sub_u32 s62, s54, 147456
    s_cmp_ge_u32 s54, 147456
    s_cselect_b32 s54, s62, s54
    s_add_u32 s65, s65, 49152
    s_sub_u32 s62, s65, 147456
    s_cmp_ge_u32 s65, 147456
    s_cselect_b32 s65, s62, s65
    s_add_u32 s63, s63, 49152
    s_cmp_ge_u32 s63, 147456
    s_cselect_b32 s63, 0, s63
    s_waitcnt lgkmcnt(0)
    v_add_u32 v2, s63, v22
    v_add_u32 v3, s63, v23
    v_add_u32 v4, s63, v24
    v_add_u32 v5, s63, v25
    v_add_u32 v6, s63, v26
    v_add_u32 v7, s63, v27
    v_add_u32 v8, s63, v28
    v_add_u32 v9, s63, v29
    s_add_u32 s51, s51, 1
    s_cmp_lt_u32 s51, s50
    s_waitcnt lgkmcnt(0)
    s_cbranch_scc1 L_gks
    s_waitcnt vmcnt(0)
    s_barrier
    s_cmp_lg_u32 s59, 0
    s_cbranch_scc1 L_eskip_ks
    s_mul_i32 s55, s27, 24576
    s_add_u32 s55, s55, 65536
    v_and_b32 v14, 31, v1
    v_lshlrev_b32 v16, 8, v14
    v_lshrrev_b32 v15, 5, v1
    v_lshl_or_b32 v16, v15, 3, v16
    v_add_u32 v16, s55, v16
    v_and_b32 v14, 15, v1
    v_lshlrev_b32 v21, 4, v14
    v_lshrrev_b32 v15, 4, v1
    v_xor_b32 v14, v14, v15
    v_lshlrev_b32 v14, 4, v14
    v_lshl_or_b32 v17, v15, 8, v14
    v_add_u32 v17, s55, v17
    s_mul_i32 s56, s58, 64
    v_add_u32 v15, s56, v15
    v_mul_lo_u32 v15, v15, s46
    v_and_b32 v14, 15, v1
    v_lshlrev_b32 v14, 4, v14
    s_lshl_b32 s56, s59, 8
    v_add3_u32 v20, v14, v15, s56
    s_lshl_b32 s57, s46, 2
    s_mov_b32 s56, s49
    v_accvgpr_read_b32 v32, a0
    v_accvgpr_read_b32 v33, a1
    v_accvgpr_read_b32 v34, a2
    v_accvgpr_read_b32 v35, a3
    v_accvgpr_read_b32 v36, a4
    v_accvgpr_read_b32 v37, a5
    v_accvgpr_read_b32 v38, a6
    v_accvgpr_read_b32 v39, a7
    v_accvgpr_read_b32 v40, a8
    v_accvgpr_read_b32 v41, a9
    v_accvgpr_read_b32 v42, a10
    v_accvgpr_read_b32 v43, a11
    v_accvgpr_read_b32 v44, a12
    v_accvgpr_read_b32 v45, a13
    v_accvgpr_read_b32 v46, a14
    v_accvgpr_read_b32 v47, a15
    v_cvt_pk_bf16_f32 v56, v32, v33
    v_cvt_pk_bf16_f32 v57, v34, v35
    v_xor_b32 v60, 0, v21
    v_add_u32 v60, v60, v16
    ds_write_b64 v60, v[56:57] offset:0
    v_cvt_pk_bf16_f32 v58, v36, v37
    v_cvt_pk_bf16_f32 v59, v38, v39
    v_xor_b32 v61, 16, v21
    v_add_u32 v61, v61, v16
    ds_write_b64 v61, v[58:59] offset:0
    v_cvt_pk_bf16_f32 v56, v40, v41
    v_cvt_pk_bf16_f32 v57, v42, v43
    v_xor_b32 v60, 32, v21
    v_add_u32 v60, v60, v16
    ds_write_b64 v60, v[56:57] offset:0
    v_cvt_pk_bf16_f32 v58, v44, v45
    v_cvt_pk_bf16_f32 v59, v46, v47
    v_xor_b32 v61, 48, v21
    v_add_u32 v61, v61, v16
    ds_write_b64 v61, v[58:59] offset:0
    v_accvgpr_read_b32 v32, a16
    v_accvgpr_read_b32 v33, a17
    v_accvgpr_read_b32 v34, a18
    v_accvgpr_read_b32 v35, a19
    v_accvgpr_read_b32 v36, a20
    v_accvgpr_read_b32 v37, a21
    v_accvgpr_read_b32 v38, a22
    v_accvgpr_read_b32 v39, a23
    v_accvgpr_read_b32 v40, a24
    v_accvgpr_read_b32 v41, a25
    v_accvgpr_read_b32 v42, a26
    v_accvgpr_read_b32 v43, a27
    v_accvgpr_read_b32 v44, a28
    v_accvgpr_read_b32 v45, a29
    v_accvgpr_read_b32 v46, a30
    v_accvgpr_read_b32 v47, a31
    v_cvt_pk_bf16_f32 v56, v32, v33
    v_cvt_pk_bf16_f32 v57, v34, v35
    v_xor_b32 v60, 64, v21
    v_add_u32 v60, v60, v16
    ds_write_b64 v60, v[56:57] offset:0
    v_cvt_pk_bf16_f32 v58, v36, v37
    v_cvt_pk_bf16_f32 v59, v38, v39
    v_xor_b32 v61, 80, v21
    v_add_u32 v61, v61, v16
    ds_write_b64 v61, v[58:59] offset:0
    v_cvt_pk_bf16_f32 v56, v40, v41
    v_cvt_pk_bf16_f32 v57, v42, v43
    v_xor_b32 v60, 96, v21
    v_add_u32 v60, v60, v16
    ds_write_b64 v60, v[56:57] offset:0
    v_cvt_pk_bf16_f32 v58, v44, v45
    v_cvt_pk_bf16_f32 v59, v46, v47
    v_xor_b32 v61, 112, v21
    v_add_u32 v61, v61, v16
    ds_write_b64 v61, v[58:59] offset:0
    v_accvgpr_read_b32 v32, a32
    v_accvgpr_read_b32 v33, a33
    v_accvgpr_read_b32 v34, a34
    v_accvgpr_read_b32 v35, a35
    v_accvgpr_read_b32 v36, a36
    v_accvgpr_read_b32 v37, a37
    v_accvgpr_read_b32 v38, a38
    v_accvgpr_read_b32 v39, a39
    v_accvgpr_read_b32 v40, a40
    v_accvgpr_read_b32 v41, a41
    v_accvgpr_read_b32 v42, a42
    v_accvgpr_read_b32 v43, a43
    v_accvgpr_read_b32 v44, a44
    v_accvgpr_read_b32 v45, a45
    v_accvgpr_read_b32 v46, a46
    v_accvgpr_read_b32 v47, a47
    v_cvt_pk_bf16_f32 v56, v32, v33
    v_cvt_pk_bf16_f32 v57, v34, v35
    v_xor_b32 v60, 128, v21
    v_add_u32 v60, v60, v16
    ds_write_b64 v60, v[56:57] offset:0
    v_cvt_pk_bf16_f32 v58, v36, v37
    v_cvt_pk_bf16_f32 v59, v38, v39
    v_xor_b32 v61, 144, v21
    v_add_u32 v61, v61, v16
    ds_write_b64 v61, v[58:59] offset:0
    v_cvt_pk_bf16_f32 v56, v40, v41
    v_cvt_pk_bf16_f32 v57, v42, v43
    v_xor_b32 v60, 160, v21
    v_add_u32 v60, v60, v16
    ds_write_b64 v60, v[56:57] offset:0
    v_cvt_pk_bf16_f32 v58, v44, v45
    v_cvt_pk_bf16_f32 v59, v46, v47
    v_xor_b32 v61, 176, v21
    v_add_u32 v61, v61, v16
    ds_write_b64 v61, v[58:59] offset:0
    v_accvgpr_read_b32 v32, a48
    v_accvgpr_read_b32 v33, a49
    v_accvgpr_read_b32 v34, a50
    v_accvgpr_read_b32 v35, a51
    v_accvgpr_read_b32 v36, a52
    v_accvgpr_read_b32 v37, a53
    v_accvgpr_read_b32 v38, a54
    v_accvgpr_read_b32 v39, a55
    v_accvgpr_read_b32 v40, a56
    v_accvgpr_read_b32 v41, a57
    v_accvgpr_read_b32 v42, a58
    v_accvgpr_read_b32 v43, a59
    v_accvgpr_read_b32 v44, a60
    v_accvgpr_read_b32 v45, a61
    v_accvgpr_read_b32 v46, a62
    v_accvgpr_read_b32 v47, a63
    v_cvt_pk_bf16_f32 v56, v32, v33
    v_cvt_pk_bf16_f32 v57, v34, v35
    v_xor_b32 v60, 192, v21
    v_add_u32 v60, v60, v16
    ds_write_b64 v60, v[56:57] offset:0
    v_cvt_pk_bf16_f32 v58, v36, v37
    v_cvt_pk_bf16_f32 v59, v38, v39
    v_xor_b32 v61, 208, v21
    v_add_u32 v61, v61, v16
    ds_write_b64 v61, v[58:59] offset:0
    v_cvt_pk_bf16_f32 v56, v40, v41
    v_cvt_pk_bf16_f32 v57, v42, v43
    v_xor_b32 v60, 224, v21
    v_add_u32 v60, v60, v16
    ds_write_b64 v60, v[56:57] offset:0
    v_cvt_pk_bf16_f32 v58, v44, v45
    v_cvt_pk_bf16_f32 v59, v46, v47
    v_xor_b32 v61, 240, v21
    v_add_u32 v61, v61, v16
    s_waitcnt lgkmcnt(14)
    ds_write_b64 v61, v[58:59] offset:0
    v_accvgpr_read_b32 v32, a64
    v_accvgpr_read_b32 v33, a65
    v_accvgpr_read_b32 v34, a66
    v_accvgpr_read_b32 v35, a67
    v_accvgpr_read_b32 v36, a68
    v_accvgpr_read_b32 v37, a69
    v_accvgpr_read_b32 v38, a70
    v_accvgpr_read_b32 v39, a71
    v_accvgpr_read_b32 v40, a72
    v_accvgpr_read_b32 v41, a73
    v_accvgpr_read_b32 v42, a74
    v_accvgpr_read_b32 v43, a75
    v_accvgpr_read_b32 v44, a76
    v_accvgpr_read_b32 v45, a77
    v_accvgpr_read_b32 v46, a78
    v_accvgpr_read_b32 v47, a79
    v_cvt_pk_bf16_f32 v56, v32, v33
    v_cvt_pk_bf16_f32 v57, v34, v35
    v_xor_b32 v60, 0, v21
    v_add_u32 v60, v60, v16
    s_waitcnt lgkmcnt(14)
    ds_write_b64 v60, v[56:57] offset:8192
    v_cvt_pk_bf16_f32 v58, v36, v37
    v_cvt_pk_bf16_f32 v59, v38, v39
    v_xor_b32 v61, 16, v21
    v_add_u32 v61, v61, v16
    s_waitcnt lgkmcnt(14)
    ds_write_b64 v61, v[58:59] offset:8192
    v_cvt_pk_bf16_f32 v56, v40, v41
    v_cvt_pk_bf16_f32 v57, v42, v43
    v_xor_b32 v60, 32, v21
    v_add_u32 v60, v60, v16
    s_waitcnt lgkmcnt(14)
    ds_write_b64 v60, v[56:57] offset:8192
    v_cvt_pk_bf16_f32 v58, v44, v45
    v_cvt_pk_bf16_f32 v59, v46, v47
    v_xor_b32 v61, 48, v21
    v_add_u32 v61, v61, v16
    s_waitcnt lgkmcnt(14)
    ds_write_b64 v61, v[58:59] offset:8192
    v_accvgpr_read_b32 v32, a80
    v_accvgpr_read_b32 v33, a81
    v_accvgpr_read_b32 v34, a82
    v_accvgpr_read_b32 v35, a83
    v_accvgpr_read_b32 v36, a84
    v_accvgpr_read_b32 v37, a85
    v_accvgpr_read_b32 v38, a86
    v_accvgpr_read_b32 v39, a87
    v_accvgpr_read_b32 v40, a88
    v_accvgpr_read_b32 v41, a89
    v_accvgpr_read_b32 v42, a90
    v_accvgpr_read_b32 v43, a91
    v_accvgpr_read_b32 v44, a92
    v_accvgpr_read_b32 v45, a93
    v_accvgpr_read_b32 v46, a94
    v_accvgpr_read_b32 v47, a95
    v_cvt_pk_bf16_f32 v56, v32, v33
    v_cvt_pk_bf16_f32 v57, v34, v35
    v_xor_b32 v60, 64, v21
    v_add_u32 v60, v60, v16
    s_waitcnt lgkmcnt(14)
    ds_write_b64 v60, v[56:57] offset:8192
    v_cvt_pk_bf16_f32 v58, v36, v37
    v_cvt_pk_bf16_f32 v59, v38, v39
    v_xor_b32 v61, 80, v21
    v_add_u32 v61, v61, v16
    s_waitcnt lgkmcnt(14)
    ds_write_b64 v61, v[58:59] offset:8192
    v_cvt_pk_bf16_f32 v56, v40, v41
    v_cvt_pk_bf16_f32 v57, v42, v43
    v_xor_b32 v60, 96, v21
    v_add_u32 v60, v60, v16
    s_waitcnt lgkmcnt(14)
    ds_write_b64 v60, v[56:57] offset:8192
    v_cvt_pk_bf16_f32 v58, v44, v45
    v_cvt_pk_bf16_f32 v59, v46, v47
    v_xor_b32 v61, 112, v21
    v_add_u32 v61, v61, v16
    s_waitcnt lgkmcnt(14)
    ds_write_b64 v61, v[58:59] offset:8192
    v_accvgpr_read_b32 v32, a96
    v_accvgpr_read_b32 v33, a97
    v_accvgpr_read_b32 v34, a98
    v_accvgpr_read_b32 v35, a99
    v_accvgpr_read_b32 v36, a100
    v_accvgpr_read_b32 v37, a101
    v_accvgpr_read_b32 v38, a102
    v_accvgpr_read_b32 v39, a103
    v_accvgpr_read_b32 v40, a104
    v_accvgpr_read_b32 v41, a105
    v_accvgpr_read_b32 v42, a106
    v_accvgpr_read_b32 v43, a107
    v_accvgpr_read_b32 v44, a108
    v_accvgpr_read_b32 v45, a109
    v_accvgpr_read_b32 v46, a110
    v_accvgpr_read_b32 v47, a111
    v_cvt_pk_bf16_f32 v56, v32, v33
    v_cvt_pk_bf16_f32 v57, v34, v35
    v_xor_b32 v60, 128, v21
    v_add_u32 v60, v60, v16
    s_waitcnt lgkmcnt(14)
    ds_write_b64 v60, v[56:57] offset:8192
    v_cvt_pk_bf16_f32 v58, v36, v37
    v_cvt_pk_bf16_f32 v59, v38, v39
    v_xor_b32 v61, 144, v21
    v_add_u32 v61, v61, v16
    s_waitcnt lgkmcnt(14)
    ds_write_b64 v61, v[58:59] offset:8192
    v_cvt_pk_bf16_f32 v56, v40, v41
    v_cvt_pk_bf16_f32 v57, v42, v43
    v_xor_b32 v60, 160, v21
    v_add_u32 v60, v60, v16
    s_waitcnt lgkmcnt(14)
    ds_write_b64 v60, v[56:57] offset:8192
    v_cvt_pk_bf16_f32 v58, v44, v45
    v_cvt_pk_bf16_f32 v59, v46, v47
    v_xor_b32 v61, 176, v21
    v_add_u32 v61, v61, v16
    s_waitcnt lgkmcnt(14)
    ds_write_b64 v61, v[58:59] offset:8192
    v_accvgpr_read_b32 v32, a112
    v_accvgpr_read_b32 v33, a113
    v_accvgpr_read_b32 v34, a114
    v_accvgpr_read_b32 v35, a115
    v_accvgpr_read_b32 v36, a116
    v_accvgpr_read_b32 v37, a117
    v_accvgpr_read_b32 v38, a118
    v_accvgpr_read_b32 v39, a119
    v_accvgpr_read_b32 v40, a120
    v_accvgpr_read_b32 v41, a121
    v_accvgpr_read_b32 v42, a122
    v_accvgpr_read_b32 v43, a123
    v_accvgpr_read_b32 v44, a124
    v_accvgpr_read_b32 v45, a125
    v_accvgpr_read_b32 v46, a126
    v_accvgpr_read_b32 v47, a127
    v_cvt_pk_bf16_f32 v56, v32, v33
    v_cvt_pk_bf16_f32 v57, v34, v35
    v_xor_b32 v60, 192, v21
    v_add_u32 v60, v60, v16
    s_waitcnt lgkmcnt(14)
    ds_write_b64 v60, v[56:57] offset:8192
    v_cvt_pk_bf16_f32 v58, v36, v37
    v_cvt_pk_bf16_f32 v59, v38, v39
    v_xor_b32 v61, 208, v21
    v_add_u32 v61, v61, v16
    s_waitcnt lgkmcnt(14)
    ds_write_b64 v61, v[58:59] offset:8192
    v_cvt_pk_bf16_f32 v56, v40, v41
    v_cvt_pk_bf16_f32 v57, v42, v43
    v_xor_b32 v60, 224, v21
    v_add_u32 v60, v60, v16
    s_waitcnt lgkmcnt(14)
    ds_write_b64 v60, v[56:57] offset:8192
    v_cvt_pk_bf16_f32 v58, v44, v45
    v_cvt_pk_bf16_f32 v59, v46, v47
    v_xor_b32 v61, 240, v21
    v_add_u32 v61, v61, v16
    s_waitcnt lgkmcnt(14)
    ds_write_b64 v61, v[58:59] offset:8192
    s_waitcnt lgkmcnt(0)
    v_xor_b32 v62, 0, v17
    ds_read_b128 v[96:99], v62 offset:0
    v_xor_b32 v63, 64, v17
    ds_read_b128 v[100:103], v63 offset:1024
    v_xor_b32 v62, 128, v17
    ds_read_b128 v[104:107], v62 offset:2048
    v_xor_b32 v63, 192, v17
    ds_read_b128 v[108:111], v63 offset:3072
    v_xor_b32 v62, 0, v17
    ds_read_b128 v[112:115], v62 offset:4096
    v_xor_b32 v63, 64, v17
    ds_read_b128 v[116:119], v63 offset:5120
    v_xor_b32 v62, 128, v17
    ds_read_b128 v[120:123], v62 offset:6144
    v_xor_b32 v63, 192, v17
    ds_read_b128 v[124:127], v63 offset:7168
    s_waitcnt lgkmcnt(7)
    buffer_store_dwordx4 v[96:99], v20, s[40:43], s56 offen sc1
    s_add_u32 s56, s56, s57
    s_waitcnt lgkmcnt(6)
    buffer_store_dwordx4 v[100:103], v20, s[40:43], s56 offen sc1
    s_add_u32 s56, s56, s57
    s_waitcnt lgkmcnt(5)
    buffer_store_dwordx4 v[104:107], v20, s[40:43], s56 offen sc1
    s_add_u32 s56, s56, s57
    s_waitcnt lgkmcnt(4)
    buffer_store_dwordx4 v[108:111], v20, s[40:43], s56 offen sc1
    s_add_u32 s56, s56, s57
    s_waitcnt lgkmcnt(3)
    buffer_store_dwordx4 v[112:115], v20, s[40:43], s56 offen sc1
    s_add_u32 s56, s56, s57
    s_waitcnt lgkmcnt(2)
    buffer_store_dwordx4 v[116:119], v20, s[40:43], s56 offen sc1
    s_add_u32 s56, s56, s57
    s_waitcnt lgkmcnt(1)
    buffer_store_dwordx4 v[120:123], v20, s[40:43], s56 offen sc1
    s_add_u32 s56, s56, s57
    s_waitcnt lgkmcnt(0)
    buffer_store_dwordx4 v[124:127], v20, s[40:43], s56 offen sc1
    s_add_u32 s56, s56, s57
    v_xor_b32 v62, 0, v17
    ds_read_b128 v[96:99], v62 offset:8192
    v_xor_b32 v63, 64, v17
    ds_read_b128 v[100:103], v63 offset:9216
    v_xor_b32 v62, 128, v17
    ds_read_b128 v[104:107], v62 offset:10240
    v_xor_b32 v63, 192, v17
    ds_read_b128 v[108:111], v63 offset:11264
    v_xor_b32 v62, 0, v17
    ds_read_b128 v[112:115], v62 offset:12288
    v_xor_b32 v63, 64, v17
    ds_read_b128 v[116:119], v63 offset:13312
    v_xor_b32 v62, 128, v17
    ds_read_b128 v[120:123], v62 offset:14336
    v_xor_b32 v63, 192, v17
    ds_read_b128 v[124:127], v63 offset:15360
    s_waitcnt lgkmcnt(7)
    buffer_store_dwordx4 v[96:99], v20, s[40:43], s56 offen sc1
    s_add_u32 s56, s56, s57
    s_waitcnt lgkmcnt(6)
    buffer_store_dwordx4 v[100:103], v20, s[40:43], s56 offen sc1
    s_add_u32 s56, s56, s57
    s_waitcnt lgkmcnt(5)
    buffer_store_dwordx4 v[104:107], v20, s[40:43], s56 offen sc1
    s_add_u32 s56, s56, s57
    s_waitcnt lgkmcnt(4)
    buffer_store_dwordx4 v[108:111], v20, s[40:43], s56 offen sc1
    s_add_u32 s56, s56, s57
    s_waitcnt lgkmcnt(3)
    buffer_store_dwordx4 v[112:115], v20, s[40:43], s56 offen sc1
    s_add_u32 s56, s56, s57
    s_waitcnt lgkmcnt(2)
    buffer_store_dwordx4 v[116:119], v20, s[40:43], s56 offen sc1
    s_add_u32 s56, s56, s57
    s_waitcnt lgkmcnt(1)
    buffer_store_dwordx4 v[120:123], v20, s[40:43], s56 offen sc1
    s_add_u32 s56, s56, s57
    s_waitcnt lgkmcnt(0)
    buffer_store_dwordx4 v[124:127], v20, s[40:43], s56 offen sc1
    s_add_u32 s56, s56, s57
    s_waitcnt lgkmcnt(0)
L_eskip_ks:
    s_waitcnt vmcnt(0)
    s_barrier
    s_cmp_lg_u32 s27, 0
    s_cbranch_scc1 L_sgks_s
    s_cmp_lg_u32 s93, 0
    s_cbranch_scc1 L_sgks_i
    s_mov_b32 s82, 0
L_sgks_ip:
    buffer_load_dword v31, off, s[12:15], 0 offset:128 sc1
    s_add_u32 s82, s82, 1
    s_cmp_gt_u32 s82, 0x200000
    s_cbranch_scc1 L_wbail
    s_waitcnt vmcnt(0)
    v_cmp_eq_u32 vcc, 0, v31
    s_cbranch_vccnz L_sgks_ip
    s_mov_b32 s93, 1
L_sgks_i:
    v_mov_b32 v31, s90
    s_mov_b64 exec, 1
    buffer_atomic_add v31, off, s[4:7], s85
    s_mov_b64 exec, -1
L_sgks_s:
    s_add_u32 s89, s89, 1
    s_branch L_fetch
L_task_vs:
    v_and_b32 v14, 31, v1
    v_bfe_u32 v15, v1, 1, 3
    v_lshrrev_b32 v16, 5, v1
    v_xor_b32 v15, v15, v16
    v_lshlrev_b32 v14, 7, v14
    s_mul_i32 s55, s58, 8192
    v_add_u32 v14, s55, v14
    v_xor_b32 v16, 0, v15
    v_lshl_add_u32 v2, v16, 4, v14
    v_xor_b32 v16, 2, v15
    v_lshl_add_u32 v3, v16, 4, v14
    v_xor_b32 v16, 4, v15
    v_lshl_add_u32 v4, v16, 4, v14
    v_xor_b32 v16, 6, v15
    v_lshl_add_u32 v5, v16, 4, v14
    v_lshrrev_b32 v14, 5, v1
    v_lshlrev_b32 v14, 3, v14
    v_bfe_u32 v15, v1, 2, 2
    v_add_u32 v14, v14, v15
    v_lshlrev_b32 v14, 8, v14
    v_bfe_u32 v16, v1, 4, 1
    v_lshl_or_b32 v14, v16, 5, v14
    v_bfe_u32 v16, v1, 1, 1
    v_lshl_or_b32 v14, v16, 4, v14
    v_and_b32 v16, 1, v1
    v_lshl_or_b32 v14, v16, 3, v14
    s_mov_b32 s55, 0
    s_add_u32 s55, s55, 16384
    v_add_u32 v14, s55, v14
    v_xor_b32 v16, 0, v15
    v_lshl_add_u32 v6, v16, 6, v14
    v_xor_b32 v16, 1, v15
    v_lshl_add_u32 v7, v16, 6, v14
    v_xor_b32 v16, 2, v15
    v_lshl_add_u32 v8, v16, 6, v14
    v_xor_b32 v16, 3, v15
    v_lshl_add_u32 v9, v16, 6, v14
    v_mov_b32 v22, v2
    v_mov_b32 v23, v3
    v_mov_b32 v24, v4
    v_mov_b32 v25, v5
    v_mov_b32 v26, v6
    v_mov_b32 v27, v7
    v_mov_b32 v28, v8
    v_mov_b32 v29, v9
    v_lshrrev_b32 v14, 3, v1
    v_mul_lo_u32 v14, v14, s44
    v_and_b32 v15, 7, v1
    v_bfe_u32 v16, v1, 4, 2
    v_xor_b32 v15, v15, v16
    v_lshl_add_u32 v10, v15, 4, v14
    v_xor_b32 v15, 4, v15
    v_lshl_add_u32 v11, v15, 4, v14
    v_lshrrev_b32 v16, 5, v1
    v_mul_lo_u32 v14, v16, s45
    v_and_b32 v15, 31, v1
    v_lshlrev_b32 v16, 2, v16
    v_xor_b32 v15, v15, v16
    v_lshl_add_u32 v12, v15, 4, v14
    v_xor_b32 v15, 8, v15
    v_lshl_add_u32 v13, v15, 4, v14
    v_lshrrev_b32 v16, 4, v1
    v_mul_lo_u32 v14, v16, s45
    v_and_b32 v15, 15, v1
    v_lshlrev_b32 v16, 2, v16
    v_xor_b32 v15, v15, v16
    v_lshl_add_u32 v12, v15, 4, v14
    v_mov_b32 v13, v12
    s_mov_b32 s10, s66
    s_mov_b32 s38, s67
    s_lshl_b32 s57, s44, 3
    s_lshl_b32 s61, s45, 2
    s_mul_i32 s52, s44, s27
    s_mul_i32 s52, s52, 32
    s_add_u32 s52, s52, s47
    s_mul_i32 s53, s45, s27
    s_lshl_b32 s53, s53, 4
    s_add_u32 s53, s53, s48
    s_lshl_b32 s54, s27, 12
    s_mul_i32 s65, s27, 4096
    s_mov_b32 s55, s52
    s_add_u32 m0, s65, 0
    s_nop 0
    buffer_load_dwordx4 v10, s[8:11], s55 offen sc1 lds
    s_add_u32 s55, s55, s57
    s_add_u32 m0, s65, 1024
    s_nop 0
    buffer_load_dwordx4 v11, s[8:11], s55 offen sc1 lds
    s_add_u32 s55, s55, s57
    s_add_u32 m0, s65, 2048
    s_nop 0
    buffer_load_dwordx4 v10, s[8:11], s55 offen sc1 lds
    s_add_u32 s55, s55, s57
    s_add_u32 m0, s65, 3072
    s_nop 0
    buffer_load_dwordx4 v11, s[8:11], s55 offen sc1 lds
    s_mov_b32 s56, s53
    s_add_u32 m0, s54, 16384
    s_nop 0
    buffer_load_dwordx4 v12, s[36:39], s56 offen lds
    s_add_u32 s56, s56, s61
    s_add_u32 m0, s54, 17408
    s_nop 0
    buffer_load_dwordx4 v13, s[36:39], s56 offen lds
    s_add_u32 s56, s56, s61
    s_add_u32 m0, s54, 18432
    s_nop 0
    buffer_load_dwordx4 v12, s[36:39], s56 offen lds
    s_add_u32 s56, s56, s61
    s_add_u32 m0, s54, 19456
    s_nop 0
    buffer_load_dwordx4 v13, s[36:39], s56 offen lds
    s_add_u32 s52, s52, 128
    s_lshl_b32 s62, s45, 6
    s_add_u32 s53, s53, s62
    s_add_u32 s54, s54, 49152
    s_sub_u32 s62, s54, 147456
    s_cmp_ge_u32 s54, 147456
    s_cselect_b32 s54, s62, s54
    s_add_u32 s65, s65, 49152
    s_sub_u32 s62, s65, 147456
    s_cmp_ge_u32 s65, 147456
    s_cselect_b32 s65, s62, s65
    s_mov_b32 s55, s52
    s_add_u32 m0, s65, 0
    s_nop 0
    buffer_load_dwordx4 v10, s[8:11], s55 offen sc1 lds
    s_add_u32 s55, s55, s57
    s_add_u32 m0, s65, 1024
    s_nop 0
    buffer_load_dwordx4 v11, s[8:11], s55 offen sc1 lds
    s_add_u32 s55, s55, s57
    s_add_u32 m0, s65, 2048
    s_nop 0
    buffer_load_dwordx4 v10, s[8:11], s55 offen sc1 lds
    s_add_u32 s55, s55, s57
    s_add_u32 m0, s65, 3072
    s_nop 0
    buffer_load_dwordx4 v11, s[8:11], s55 offen sc1 lds
    s_mov_b32 s56, s53
    s_add_u32 m0, s54, 16384
    s_nop 0
    buffer_load_dwordx4 v12, s[36:39], s56 offen lds
    s_add_u32 s56, s56, s61
    s_add_u32 m0, s54, 17408
    s_nop 0
    buffer_load_dwordx4 v13, s[36:39], s56 offen lds
    s_add_u32 s56, s56, s61
    s_add_u32 m0, s54, 18432
    s_nop 0
    buffer_load_dwordx4 v12, s[36:39], s56 offen lds
    s_add_u32 s56, s56, s61
    s_add_u32 m0, s54, 19456
    s_nop 0
    buffer_load_dwordx4 v13, s[36:39], s56 offen lds
    s_add_u32 s52, s52, 128
    s_lshl_b32 s62, s45, 6
    s_add_u32 s53, s53, s62
    s_add_u32 s54, s54, 49152
    s_sub_u32 s62, s54, 147456
    s_cmp_ge_u32 s54, 147456
    s_cselect_b32 s54, s62, s54
    s_add_u32 s65, s65, 49152
    s_sub_u32 s62, s65, 147456
    s_cmp_ge_u32 s65, 147456
    s_cselect_b32 s65, s62, s65
    s_mov_b32 s63, 0
    v_accvgpr_write_b32 a0, 0
    v_accvgpr_write_b32 a1, 0
    v_accvgpr_write_b32 a2, 0
    v_accvgpr_write_b32 a3, 0
    v_accvgpr_write_b32 a4, 0
    v_accvgpr_write_b32 a5, 0
    v_accvgpr_write_b32 a6, 0
    v_accvgpr_write_b32 a7, 0
    v_accvgpr_write_b32 a8, 0
    v_accvgpr_write_b32 a9, 0
    v_accvgpr_write_b32 a10, 0
    v_accvgpr_write_b32 a11, 0
    v_accvgpr_write_b32 a12, 0
    v_accvgpr_write_b32 a13, 0
    v_accvgpr_write_b32 a14, 0
    v_accvgpr_write_b32 a15, 0
    v_accvgpr_write_b32 a16, 0
    v_accvgpr_write_b32 a17, 0
    v_accvgpr_write_b32 a18, 0
    v_accvgpr_write_b32 a19, 0
    v_accvgpr_write_b32 a20, 0
    v_accvgpr_write_b32 a21, 0
    v_accvgpr_write_b32 a22, 0
    v_accvgpr_write_b32 a23, 0
    v_accvgpr_write_b32 a24, 0
    v_accvgpr_write_b32 a25, 0
    v_accvgpr_write_b32 a26, 0
    v_accvgpr_write_b32 a27, 0
    v_accvgpr_write_b32 a28, 0
    v_accvgpr_write_b32 a29, 0
    v_accvgpr_write_b32 a30, 0
    v_accvgpr_write_b32 a31, 0
    v_accvgpr_write_b32 a32, 0
    v_accvgpr_write_b32 a33, 0
    v_accvgpr_write_b32 a34, 0
    v_accvgpr_write_b32 a35, 0
    v_accvgpr_write_b32 a36, 0
    v_accvgpr_write_b32 a37, 0
    v_accvgpr_write_b32 a38, 0
    v_accvgpr_write_b32 a39, 0
    v_accvgpr_write_b32 a40, 0
    v_accvgpr_write_b32 a41, 0
    v_accvgpr_write_b32 a42, 0
    v_accvgpr_write_b32 a43, 0
    v_accvgpr_write_b32 a44, 0
    v_accvgpr_write_b32 a45, 0
    v_accvgpr_write_b32 a46, 0
    v_accvgpr_write_b32 a47, 0
    v_accvgpr_write_b32 a48, 0
    v_accvgpr_write_b32 a49, 0
    v_accvgpr_write_b32 a50, 0
    v_accvgpr_write_b32 a51, 0
    v_accvgpr_write_b32 a52, 0
    v_accvgpr_write_b32 a53, 0
    v_accvgpr_write_b32 a54, 0
    v_accvgpr_write_b32 a55, 0
    v_accvgpr_write_b32 a56, 0
    v_accvgpr_write_b32 a57, 0
    v_accvgpr_write_b32 a58, 0
    v_accvgpr_write_b32 a59, 0
    v_accvgpr_write_b32 a60, 0
    v_accvgpr_write_b32 a61, 0
    v_accvgpr_write_b32 a62, 0
    v_accvgpr_write_b32 a63, 0
    v_accvgpr_write_b32 a64, 0
    v_accvgpr_write_b32 a65, 0
    v_accvgpr_write_b32 a66, 0
    v_accvgpr_write_b32 a67, 0
    v_accvgpr_write_b32 a68, 0
    v_accvgpr_write_b32 a69, 0
    v_accvgpr_write_b32 a70, 0
    v_accvgpr_write_b32 a71, 0
    v_accvgpr_write_b32 a72, 0
    v_accvgpr_write_b32 a73, 0
    v_accvgpr_write_b32 a74, 0
    v_accvgpr_write_b32 a75, 0
    v_accvgpr_write_b32 a76, 0
    v_accvgpr_write_b32 a77, 0
    v_accvgpr_write_b32 a78, 0
    v_accvgpr_write_b32 a79, 0
    v_accvgpr_write_b32 a80, 0
    v_accvgpr_write_b32 a81, 0
    v_accvgpr_write_b32 a82, 0
    v_accvgpr_write_b32 a83, 0
    v_accvgpr_write_b32 a84, 0
    v_accvgpr_write_b32 a85, 0
    v_accvgpr_write_b32 a86, 0
    v_accvgpr_write_b32 a87, 0
    v_accvgpr_write_b32 a88, 0
    v_accvgpr_write_b32 a89, 0
    v_accvgpr_write_b32 a90, 0
    v_accvgpr_write_b32 a91, 0
    v_accvgpr_write_b32 a92, 0
    v_accvgpr_write_b32 a93, 0
    v_accvgpr_write_b32 a94, 0
    v_accvgpr_write_b32 a95, 0
    v_accvgpr_write_b32 a96, 0
    v_accvgpr_write_b32 a97, 0
    v_accvgpr_write_b32 a98, 0
    v_accvgpr_write_b32 a99, 0
    v_accvgpr_write_b32 a100, 0
    v_accvgpr_write_b32 a101, 0
    v_accvgpr_write_b32 a102, 0
    v_accvgpr_write_b32 a103, 0
    v_accvgpr_write_b32 a104, 0
    v_accvgpr_write_b32 a105, 0
    v_accvgpr_write_b32 a106, 0
    v_accvgpr_write_b32 a107, 0
    v_accvgpr_write_b32 a108, 0
    v_accvgpr_write_b32 a109, 0
    v_accvgpr_write_b32 a110, 0
    v_accvgpr_write_b32 a111, 0
    v_accvgpr_write_b32 a112, 0
    v_accvgpr_write_b32 a113, 0
    v_accvgpr_write_b32 a114, 0
    v_accvgpr_write_b32 a115, 0
    v_accvgpr_write_b32 a116, 0
    v_accvgpr_write_b32 a117, 0
    v_accvgpr_write_b32 a118, 0
    v_accvgpr_write_b32 a119, 0
    v_accvgpr_write_b32 a120, 0
    v_accvgpr_write_b32 a121, 0
    v_accvgpr_write_b32 a122, 0
    v_accvgpr_write_b32 a123, 0
    v_accvgpr_write_b32 a124, 0
    v_accvgpr_write_b32 a125, 0
    v_accvgpr_write_b32 a126, 0
    v_accvgpr_write_b32 a127, 0
    s_mov_b32 s51, 0
    s_nop 0
L_gvs:
    s_waitcnt vmcnt(8)
    s_barrier
    ds_read_b128 v[64:67], v2 offset:0
    ds_read_b64_tr_b16 v[96:97], v6 offset:0
    ds_read_b64_tr_b16 v[98:99], v6 offset:1024
    ds_read_b64_tr_b16 v[100:101], v7 offset:0
    ds_read_b64_tr_b16 v[102:103], v7 offset:1024
    ds_read_b128 v[68:71], v2 offset:4096
    ds_read_b64_tr_b16 v[104:105], v8 offset:0
    ds_read_b64_tr_b16 v[106:107], v8 offset:1024
    ds_read_b64_tr_b16 v[108:109], v9 offset:0
    ds_read_b64_tr_b16 v[110:111], v9 offset:1024
    s_add_u32 s55, s51, 2
    s_cmp_ge_u32 s55, s50
    s_cselect_b32 s10, 0, s66
    s_cselect_b32 s38, 0, s67
    s_waitcnt lgkmcnt(7)
    v_mfma_f32_32x32x16_bf16 a[0:15], v[64:67], v[96:99], a[0:15]
    ds_read_b128 v[80:83], v3 offset:0
    ds_read_b64_tr_b16 v[112:113], v6 offset:4096
    s_mov_b32 s55, s52
    s_add_u32 m0, s65, 0
    s_nop 0
    buffer_load_dwordx4 v10, s[8:11], s55 offen sc1 lds
    s_waitcnt lgkmcnt(7)
    v_mfma_f32_32x32x16_bf16 a[16:31], v[64:67], v[100:103], a[16:31]
    ds_read_b64_tr_b16 v[114:115], v6 offset:5120
    ds_read_b64_tr_b16 v[116:117], v7 offset:4096
    s_add_u32 s55, s55, s57
    s_add_u32 m0, s65, 1024
    s_nop 0
    buffer_load_dwordx4 v11, s[8:11], s55 offen sc1 lds
    s_waitcnt lgkmcnt(8)
    v_mfma_f32_32x32x16_bf16 a[64:79], v[68:71], v[96:99], a[64:79]
    ds_read_b64_tr_b16 v[118:119], v7 offset:5120
    ds_read_b128 v[84:87], v3 offset:4096
    s_add_u32 s55, s55, s57
    s_add_u32 m0, s65, 2048
    s_nop 0
    buffer_load_dwordx4 v10, s[8:11], s55 offen sc1 lds
    v_mfma_f32_32x32x16_bf16 a[80:95], v[68:71], v[100:103], a[80:95]
    ds_read_b64_tr_b16 v[120:121], v8 offset:4096
    ds_read_b64_tr_b16 v[122:123], v8 offset:5120
    s_add_u32 s55, s55, s57
    s_add_u32 m0, s65, 3072
    s_nop 0
    buffer_load_dwordx4 v11, s[8:11], s55 offen sc1 lds
    s_waitcnt lgkmcnt(10)
    v_mfma_f32_32x32x16_bf16 a[32:47], v[64:67], v[104:107], a[32:47]
    ds_read_b64_tr_b16 v[124:125], v9 offset:4096
    ds_read_b64_tr_b16 v[126:127], v9 offset:5120
    s_mov_b32 s56, s53
    s_add_u32 m0, s54, 16384
    s_nop 0
    buffer_load_dwordx4 v12, s[36:39], s56 offen lds
    s_waitcnt lgkmcnt(10)
    v_mfma_f32_32x32x16_bf16 a[48:63], v[64:67], v[108:111], a[48:63]
    s_add_u32 s56, s56, s61
    s_add_u32 m0, s54, 17408
    s_nop 0
    buffer_load_dwordx4 v13, s[36:39], s56 offen lds
    v_mfma_f32_32x32x16_bf16 a[96:111], v[68:71], v[104:107], a[96:111]
    s_add_u32 s56, s56, s61
    s_add_u32 m0, s54, 18432
    s_nop 0
    buffer_load_dwordx4 v12, s[36:39], s56 offen lds
    v_mfma_f32_32x32x16_bf16 a[112:127], v[68:71], v[108:111], a[112:127]
    s_add_u32 s56, s56, s61
    s_add_u32 m0, s54, 19456
    s_nop 0
    buffer_load_dwordx4 v13, s[36:39], s56 offen lds
    s_waitcnt lgkmcnt(7)
    v_mfma_f32_32x32x16_bf16 a[0:15], v[80:83], v[112:115], a[0:15]
    ds_read_b128 v[64:67], v4 offset:0
    ds_read_b64_tr_b16 v[96:97], v6 offset:8192
    s_waitcnt lgkmcnt(7)
    v_mfma_f32_32x32x16_bf16 a[16:31], v[80:83], v[116:119], a[16:31]
    ds_read_b64_tr_b16 v[98:99], v6 offset:9216
    ds_read_b64_tr_b16 v[100:101], v7 offset:8192
    s_waitcnt lgkmcnt(8)
    v_mfma_f32_32x32x16_bf16 a[64:79], v[84:87], v[112:115], a[64:79]
    ds_read_b64_tr_b16 v[102:103], v7 offset:9216
    ds_read_b128 v[68:71], v4 offset:4096
    v_mfma_f32_32x32x16_bf16 a[80:95], v[84:87], v[116:119], a[80:95]
    ds_read_b64_tr_b16 v[104:105], v8 offset:8192
    ds_read_b64_tr_b16 v[106:107], v8 offset:9216
    s_waitcnt lgkmcnt(10)
    v_mfma_f32_32x32x16_bf16 a[32:47], v[80:83], v[120:123], a[32:47]
    ds_read_b64_tr_b16 v[108:109], v9 offset:8192
    ds_read_b64_tr_b16 v[110:111], v9 offset:9216
    s_waitcnt lgkmcnt(10)
    v_mfma_f32_32x32x16_bf16 a[48:63], v[80:83], v[124:127], a[48:63]
    v_mfma_f32_32x32x16_bf16 a[96:111], v[84:87], v[120:123], a[96:111]
    v_mfma_f32_32x32x16_bf16 a[112:127], v[84:87], v[124:127], a[112:127]
    s_waitcnt lgkmcnt(7)
    v_mfma_f32_32x32x16_bf16 a[0:15], v[64:67], v[96:99], a[0:15]
    ds_read_b128 v[80:83], v5 offset:0
    ds_read_b64_tr_b16 v[112:113], v6 offset:12288
    s_waitcnt lgkmcnt(7)
    v_mfma_f32_32x32x16_bf16 a[16:31], v[64:67], v[100:103], a[16:31]
    ds_read_b64_tr_b16 v[114:115], v6 offset:13312
    ds_read_b64_tr_b16 v[116:117], v7 offset:12288
    s_waitcnt lgkmcnt(8)
    v_mfma_f32_32x32x16_bf16 a[64:79], v[68:71], v[96:99], a[64:79]
    ds_read_b64_tr_b16 v[118:119], v7 offset:13312
    ds_read_b128 v[84:87], v5 offset:4096
    v_mfma_f32_32x32x16_bf16 a[80:95], v[68:71], v[100:103], a[80:95]
    ds_read_b64_tr_b16 v[120:121], v8 offset:12288
    ds_read_b64_tr_b16 v[122:123], v8 offset:13312
    s_waitcnt lgkmcnt(10)
    v_mfma_f32_32x32x16_bf16 a[32:47], v[64:67], v[104:107], a[32:47]
    ds_read_b64_tr_b16 v[124:125], v9 offset:12288
    ds_read_b64_tr_b16 v[126:127], v9 offset:13312
    s_waitcnt lgkmcnt(10)
    v_mfma_f32_32x32x16_bf16 a[48:63], v[64:67], v[108:111], a[48:63]
    v_mfma_f32_32x32x16_bf16 a[96:111], v[68:71], v[104:107], a[96:111]
    v_mfma_f32_32x32x16_bf16 a[112:127], v[68:71], v[108:111], a[112:127]
    s_waitcnt lgkmcnt(7)
    v_mfma_f32_32x32x16_bf16 a[0:15], v[80:83], v[112:115], a[0:15]
    s_waitcnt lgkmcnt(5)
    v_mfma_f32_32x32x16_bf16 a[16:31], v[80:83], v[116:119], a[16:31]
    s_waitcnt lgkmcnt(4)
    v_mfma_f32_32x32x16_bf16 a[64:79], v[84:87], v[112:115], a[64:79]
    v_mfma_f32_32x32x16_bf16 a[80:95], v[84:87], v[116:119], a[80:95]
    s_waitcnt lgkmcnt(2)
    v_mfma_f32_32x32x16_bf16 a[32:47], v[80:83], v[120:123], a[32:47]
    s_waitcnt lgkmcnt(0)
    v_mfma_f32_32x32x16_bf16 a[48:63], v[80:83], v[124:127], a[48:63]
    v_mfma_f32_32x32x16_bf16 a[96:111], v[84:87], v[120:123], a[96:111]
    v_mfma_f32_32x32x16_bf16 a[112:127], v[84:87], v[124:127], a[112:127]
    s_add_u32 s52, s52, 128
    s_lshl_b32 s62, s45, 6
    s_add_u32 s53, s53, s62
    s_add_u32 s54, s54, 49152
    s_sub_u32 s62, s54, 147456
    s_cmp_ge_u32 s54, 147456
    s_cselect_b32 s54, s62, s54
    s_add_u32 s65, s65, 49152
    s_sub_u32 s62, s65, 147456
    s_cmp_ge_u32 s65, 147456
    s_cselect_b32 s65, s62, s65
    s_add_u32 s63, s63, 49152
    s_cmp_ge_u32 s63, 147456
    s_cselect_b32 s63, 0, s63
    s_waitcnt lgkmcnt(0)
    v_add_u32 v2, s63, v22
    v_add_u32 v3, s63, v23
    v_add_u32 v4, s63, v24
    v_add_u32 v5, s63, v25
    v_add_u32 v6, s63, v26
    v_add_u32 v7, s63, v27
    v_add_u32 v8, s63, v28
    v_add_u32 v9, s63, v29
    s_add_u32 s51, s51, 1
    s_cmp_lt_u32 s51, s50
    s_waitcnt lgkmcnt(0)
    s_cbranch_scc1 L_gvs
    s_waitcnt vmcnt(0)
    s_barrier
    s_cmp_lg_u32 s59, 0
    s_cbranch_scc1 L_eskip_vs
    s_mul_i32 s55, s27, 24576
    s_add_u32 s55, s55, 65536
    v_and_b32 v14, 31, v1
    v_lshlrev_b32 v16, 6, v14
    v_add_u32 v16, s55, v16
    v_bfe_u32 v14, v1, 1, 2
    v_lshrrev_b32 v15, 5, v1
    v_xor_b32 v14, v14, v15
    v_lshlrev_b32 v21, 4, v14
    v_add_u32 v22, v21, v16
    v_xor_b32 v21, 32, v21
    v_add_u32 v21, v21, v16
    v_lshlrev_b32 v17, 4, v1
    v_add_u32 v17, s55, v17
    v_lshrrev_b32 v14, 2, v1
    v_lshlrev_b32 v14, 6, v14
    v_and_b32 v15, 3, v1
    v_bfe_u32 v20, v1, 3, 2
    v_xor_b32 v15, v15, v20
    v_lshl_or_b32 v14, v15, 4, v14
    s_mul_i32 s55, s58, 524288
    s_lshl_b32 s56, s59, 13
    s_add_u32 s55, s55, s56
    v_add_u32 v20, s55, v14
    s_mov_b32 s56, s49
    v_accvgpr_read_b32 v32, a0
    v_accvgpr_read_b32 v33, a1
    v_accvgpr_read_b32 v34, a2
    v_accvgpr_read_b32 v35, a3
    v_accvgpr_read_b32 v36, a4
    v_accvgpr_read_b32 v37, a5
    v_accvgpr_read_b32 v38, a6
    v_accvgpr_read_b32 v39, a7
    v_accvgpr_read_b32 v40, a8
    v_accvgpr_read_b32 v41, a9
    v_accvgpr_read_b32 v42, a10
    v_accvgpr_read_b32 v43, a11
    v_accvgpr_read_b32 v44, a12
    v_accvgpr_read_b32 v45, a13
    v_accvgpr_read_b32 v46, a14
    v_accvgpr_read_b32 v47, a15
    v_cvt_pk_bf16_f32 v48, v32, v33
    v_cvt_pk_bf16_f32 v49, v34, v35
    v_cvt_pk_bf16_f32 v50, v40, v41
    v_cvt_pk_bf16_f32 v51, v42, v43
    ds_write_b128 v22, v[48:51] offset:0
    v_cvt_pk_bf16_f32 v52, v36, v37
    v_cvt_pk_bf16_f32 v53, v38, v39
    v_cvt_pk_bf16_f32 v54, v44, v45
    v_cvt_pk_bf16_f32 v55, v46, v47
    ds_write_b128 v21, v[52:55] offset:0
    v_accvgpr_read_b32 v32, a16
    v_accvgpr_read_b32 v33, a17
    v_accvgpr_read_b32 v34, a18
    v_accvgpr_read_b32 v35, a19
    v_accvgpr_read_b32 v36, a20
    v_accvgpr_read_b32 v37, a21
    v_accvgpr_read_b32 v38, a22
    v_accvgpr_read_b32 v39, a23
    v_accvgpr_read_b32 v40, a24
    v_accvgpr_read_b32 v41, a25
    v_accvgpr_read_b32 v42, a26
    v_accvgpr_read_b32 v43, a27
    v_accvgpr_read_b32 v44, a28
    v_accvgpr_read_b32 v45, a29
    v_accvgpr_read_b32 v46, a30
    v_accvgpr_read_b32 v47, a31
    v_cvt_pk_bf16_f32 v48, v32, v33
    v_cvt_pk_bf16_f32 v49, v34, v35
    v_cvt_pk_bf16_f32 v50, v40, v41
    v_cvt_pk_bf16_f32 v51, v42, v43
    ds_write_b128 v22, v[48:51] offset:2048
    v_cvt_pk_bf16_f32 v52, v36, v37
    v_cvt_pk_bf16_f32 v53, v38, v39
    v_cvt_pk_bf16_f32 v54, v44, v45
    v_cvt_pk_bf16_f32 v55, v46, v47
    ds_write_b128 v21, v[52:55] offset:2048
    v_accvgpr_read_b32 v32, a32
    v_accvgpr_read_b32 v33, a33
    v_accvgpr_read_b32 v34, a34
    v_accvgpr_read_b32 v35, a35
    v_accvgpr_read_b32 v36, a36
    v_accvgpr_read_b32 v37, a37
    v_accvgpr_read_b32 v38, a38
    v_accvgpr_read_b32 v39, a39
    v_accvgpr_read_b32 v40, a40
    v_accvgpr_read_b32 v41, a41
    v_accvgpr_read_b32 v42, a42
    v_accvgpr_read_b32 v43, a43
    v_accvgpr_read_b32 v44, a44
    v_accvgpr_read_b32 v45, a45
    v_accvgpr_read_b32 v46, a46
    v_accvgpr_read_b32 v47, a47
    v_cvt_pk_bf16_f32 v48, v32, v33
    v_cvt_pk_bf16_f32 v49, v34, v35
    v_cvt_pk_bf16_f32 v50, v40, v41
    v_cvt_pk_bf16_f32 v51, v42, v43
    ds_write_b128 v22, v[48:51] offset:4096
    v_cvt_pk_bf16_f32 v52, v36, v37
    v_cvt_pk_bf16_f32 v53, v38, v39
    v_cvt_pk_bf16_f32 v54, v44, v45
    v_cvt_pk_bf16_f32 v55, v46, v47
    ds_write_b128 v21, v[52:55] offset:4096
    v_accvgpr_read_b32 v32, a48
    v_accvgpr_read_b32 v33, a49
    v_accvgpr_read_b32 v34, a50
    v_accvgpr_read_b32 v35, a51
    v_accvgpr_read_b32 v36, a52
    v_accvgpr_read_b32 v37, a53
    v_accvgpr_read_b32 v38, a54
    v_accvgpr_read_b32 v39, a55
    v_accvgpr_read_b32 v40, a56
    v_accvgpr_read_b32 v41, a57
    v_accvgpr_read_b32 v42, a58
    v_accvgpr_read_b32 v43, a59
    v_accvgpr_read_b32 v44, a60
    v_accvgpr_read_b32 v45, a61
    v_accvgpr_read_b32 v46, a62
    v_accvgpr_read_b32 v47, a63
    v_cvt_pk_bf16_f32 v48, v32, v33
    v_cvt_pk_bf16_f32 v49, v34, v35
    v_cvt_pk_bf16_f32 v50, v40, v41
    v_cvt_pk_bf16_f32 v51, v42, v43
    ds_write_b128 v22, v[48:51] offset:6144
    v_cvt_pk_bf16_f32 v52, v36, v37
    v_cvt_pk_bf16_f32 v53, v38, v39
    v_cvt_pk_bf16_f32 v54, v44, v45
    v_cvt_pk_bf16_f32 v55, v46, v47
    ds_write_b128 v21, v[52:55] offset:6144
    v_accvgpr_read_b32 v32, a64
    v_accvgpr_read_b32 v33, a65
    v_accvgpr_read_b32 v34, a66
    v_accvgpr_read_b32 v35, a67
    v_accvgpr_read_b32 v36, a68
    v_accvgpr_read_b32 v37, a69
    v_accvgpr_read_b32 v38, a70
    v_accvgpr_read_b32 v39, a71
    v_accvgpr_read_b32 v40, a72
    v_accvgpr_read_b32 v41, a73
    v_accvgpr_read_b32 v42, a74
    v_accvgpr_read_b32 v43, a75
    v_accvgpr_read_b32 v44, a76
    v_accvgpr_read_b32 v45, a77
    v_accvgpr_read_b32 v46, a78
    v_accvgpr_read_b32 v47, a79
    v_cvt_pk_bf16_f32 v48, v32, v33
    v_cvt_pk_bf16_f32 v49, v34, v35
    v_cvt_pk_bf16_f32 v50, v40, v41
    v_cvt_pk_bf16_f32 v51, v42, v43
    ds_write_b128 v22, v[48:51] offset:8192
    v_cvt_pk_bf16_f32 v52, v36, v37
    v_cvt_pk_bf16_f32 v53, v38, v39
    v_cvt_pk_bf16_f32 v54, v44, v45
    v_cvt_pk_bf16_f32 v55, v46, v47
    ds_write_b128 v21, v[52:55] offset:8192
    v_accvgpr_read_b32 v32, a80
    v_accvgpr_read_b32 v33, a81
    v_accvgpr_read_b32 v34, a82
    v_accvgpr_read_b32 v35, a83
    v_accvgpr_read_b32 v36, a84
    v_accvgpr_read_b32 v37, a85
    v_accvgpr_read_b32 v38, a86
    v_accvgpr_read_b32 v39, a87
    v_accvgpr_read_b32 v40, a88
    v_accvgpr_read_b32 v41, a89
    v_accvgpr_read_b32 v42, a90
    v_accvgpr_read_b32 v43, a91
    v_accvgpr_read_b32 v44, a92
    v_accvgpr_read_b32 v45, a93
    v_accvgpr_read_b32 v46, a94
    v_accvgpr_read_b32 v47, a95
    v_cvt_pk_bf16_f32 v48, v32, v33
    v_cvt_pk_bf16_f32 v49, v34, v35
    v_cvt_pk_bf16_f32 v50, v40, v41
    v_cvt_pk_bf16_f32 v51, v42, v43
    ds_write_b128 v22, v[48:51] offset:10240
    v_cvt_pk_bf16_f32 v52, v36, v37
    v_cvt_pk_bf16_f32 v53, v38, v39
    v_cvt_pk_bf16_f32 v54, v44, v45
    v_cvt_pk_bf16_f32 v55, v46, v47
    ds_write_b128 v21, v[52:55] offset:10240
    v_accvgpr_read_b32 v32, a96
    v_accvgpr_read_b32 v33, a97
    v_accvgpr_read_b32 v34, a98
    v_accvgpr_read_b32 v35, a99
    v_accvgpr_read_b32 v36, a100
    v_accvgpr_read_b32 v37, a101
    v_accvgpr_read_b32 v38, a102
    v_accvgpr_read_b32 v39, a103
    v_accvgpr_read_b32 v40, a104
    v_accvgpr_read_b32 v41, a105
    v_accvgpr_read_b32 v42, a106
    v_accvgpr_read_b32 v43, a107
    v_accvgpr_read_b32 v44, a108
    v_accvgpr_read_b32 v45, a109
    v_accvgpr_read_b32 v46, a110
    v_accvgpr_read_b32 v47, a111
    v_cvt_pk_bf16_f32 v48, v32, v33
    v_cvt_pk_bf16_f32 v49, v34, v35
    v_cvt_pk_bf16_f32 v50, v40, v41
    v_cvt_pk_bf16_f32 v51, v42, v43
    ds_write_b128 v22, v[48:51] offset:12288
    v_cvt_pk_bf16_f32 v52, v36, v37
    v_cvt_pk_bf16_f32 v53, v38, v39
    v_cvt_pk_bf16_f32 v54, v44, v45
    v_cvt_pk_bf16_f32 v55, v46, v47
    ds_write_b128 v21, v[52:55] offset:12288
    v_accvgpr_read_b32 v32, a112
    v_accvgpr_read_b32 v33, a113
    v_accvgpr_read_b32 v34, a114
    v_accvgpr_read_b32 v35, a115
    v_accvgpr_read_b32 v36, a116
    v_accvgpr_read_b32 v37, a117
    v_accvgpr_read_b32 v38, a118
    v_accvgpr_read_b32 v39, a119
    v_accvgpr_read_b32 v40, a120
    v_accvgpr_read_b32 v41, a121
    v_accvgpr_read_b32 v42, a122
    v_accvgpr_read_b32 v43, a123
    v_accvgpr_read_b32 v44, a124
    v_accvgpr_read_b32 v45, a125
    v_accvgpr_read_b32 v46, a126
    v_accvgpr_read_b32 v47, a127
    v_cvt_pk_bf16_f32 v48, v32, v33
    v_cvt_pk_bf16_f32 v49, v34, v35
    v_cvt_pk_bf16_f32 v50, v40, v41
    v_cvt_pk_bf16_f32 v51, v42, v43
    ds_write_b128 v22, v[48:51] offset:14336
    v_cvt_pk_bf16_f32 v52, v36, v37
    v_cvt_pk_bf16_f32 v53, v38, v39
    v_cvt_pk_bf16_f32 v54, v44, v45
    v_cvt_pk_bf16_f32 v55, v46, v47
    s_waitcnt lgkmcnt(14)
    ds_write_b128 v21, v[52:55] offset:14336
    s_waitcnt lgkmcnt(0)
    ds_read_b128 v[96:99], v17 offset:0
    ds_read_b128 v[100:103], v17 offset:1024
    ds_read_b128 v[104:107], v17 offset:2048
    ds_read_b128 v[108:111], v17 offset:3072
    ds_read_b128 v[112:115], v17 offset:4096
    ds_read_b128 v[116:119], v17 offset:5120
    ds_read_b128 v[120:123], v17 offset:6144
    ds_read_b128 v[124:127], v17 offset:7168
    s_add_u32 s55, s56, 0
    s_waitcnt lgkmcnt(7)
    buffer_store_dwordx4 v[96:99], v20, s[40:43], s55 offen offset:0 sc1
    s_waitcnt lgkmcnt(6)
    buffer_store_dwordx4 v[100:103], v20, s[40:43], s55 offen offset:1024 sc1
    s_waitcnt lgkmcnt(5)
    buffer_store_dwordx4 v[104:107], v20, s[40:43], s55 offen offset:2048 sc1
    s_waitcnt lgkmcnt(4)
    buffer_store_dwordx4 v[108:111], v20, s[40:43], s55 offen offset:3072 sc1
    s_add_u32 s55, s56, 4096
    s_waitcnt lgkmcnt(3)
    buffer_store_dwordx4 v[112:115], v20, s[40:43], s55 offen offset:0 sc1
    s_waitcnt lgkmcnt(2)
    buffer_store_dwordx4 v[116:119], v20, s[40:43], s55 offen offset:1024 sc1
    s_waitcnt lgkmcnt(1)
    buffer_store_dwordx4 v[120:123], v20, s[40:43], s55 offen offset:2048 sc1
    s_waitcnt lgkmcnt(0)
    buffer_store_dwordx4 v[124:127], v20, s[40:43], s55 offen offset:3072 sc1
    s_add_u32 s56, s56, 262144
    ds_read_b128 v[96:99], v17 offset:8192
    ds_read_b128 v[100:103], v17 offset:9216
    ds_read_b128 v[104:107], v17 offset:10240
    ds_read_b128 v[108:111], v17 offset:11264
    ds_read_b128 v[112:115], v17 offset:12288
    ds_read_b128 v[116:119], v17 offset:13312
    ds_read_b128 v[120:123], v17 offset:14336
    ds_read_b128 v[124:127], v17 offset:15360
    s_add_u32 s55, s56, 0
    s_waitcnt lgkmcnt(7)
    buffer_store_dwordx4 v[96:99], v20, s[40:43], s55 offen offset:0 sc1
    s_waitcnt lgkmcnt(6)
    buffer_store_dwordx4 v[100:103], v20, s[40:43], s55 offen offset:1024 sc1
    s_waitcnt lgkmcnt(5)
    buffer_store_dwordx4 v[104:107], v20, s[40:43], s55 offen offset:2048 sc1
    s_waitcnt lgkmcnt(4)
    buffer_store_dwordx4 v[108:111], v20, s[40:43], s55 offen offset:3072 sc1
    s_add_u32 s55, s56, 4096
    s_waitcnt lgkmcnt(3)
    buffer_store_dwordx4 v[112:115], v20, s[40:43], s55 offen offset:0 sc1
    s_waitcnt lgkmcnt(2)
    buffer_store_dwordx4 v[116:119], v20, s[40:43], s55 offen offset:1024 sc1
    s_waitcnt lgkmcnt(1)
    buffer_store_dwordx4 v[120:123], v20, s[40:43], s55 offen offset:2048 sc1
    s_waitcnt lgkmcnt(0)
    buffer_store_dwordx4 v[124:127], v20, s[40:43], s55 offen offset:3072 sc1
    s_add_u32 s56, s56, 262144
    s_waitcnt lgkmcnt(0)
L_eskip_vs:
    s_waitcnt vmcnt(0)
    s_barrier
    s_cmp_lg_u32 s27, 0
    s_cbranch_scc1 L_sgvs_s
    s_cmp_lg_u32 s93, 0
    s_cbranch_scc1 L_sgvs_i
    s_mov_b32 s82, 0
L_sgvs_ip:
    buffer_load_dword v31, off, s[12:15], 0 offset:128 sc1
    s_add_u32 s82, s82, 1
    s_cmp_gt_u32 s82, 0x200000
    s_cbranch_scc1 L_wbail
    s_waitcnt vmcnt(0)
    v_cmp_eq_u32 vcc, 0, v31
    s_cbranch_vccnz L_sgvs_ip
    s_mov_b32 s93, 1
L_sgvs_i:
    v_mov_b32 v31, s90
    s_mov_b64 exec, 1
    buffer_atomic_add v31, off, s[4:7], s85
    s_mov_b64 exec, -1
L_sgvs_s:
    s_add_u32 s89, s89, 1
    s_branch L_fetch
L_task_k:
    v_and_b32 v14, 31, v1
    v_bfe_u32 v15, v1, 1, 3
    v_lshrrev_b32 v16, 5, v1
    v_xor_b32 v15, v15, v16
    v_lshlrev_b32 v14, 7, v14
    s_mul_i32 s55, s58, 16384
    v_add_u32 v14, s55, v14
    v_xor_b32 v16, 0, v15
    v_lshl_add_u32 v2, v16, 4, v14
    v_xor_b32 v16, 2, v15
    v_lshl_add_u32 v3, v16, 4, v14
    v_xor_b32 v16, 4, v15
    v_lshl_add_u32 v4, v16, 4, v14
    v_xor_b32 v16, 6, v15
    v_lshl_add_u32 v5, v16, 4, v14
    v_lshrrev_b32 v14, 5, v1
    v_lshlrev_b32 v14, 3, v14
    v_bfe_u32 v15, v1, 2, 2
    v_add_u32 v14, v14, v15
    v_lshlrev_b32 v14, 9, v14
    v_bfe_u32 v16, v1, 4, 1
    v_lshl_or_b32 v14, v16, 5, v14
    v_bfe_u32 v16, v1, 1, 1
    v_lshl_or_b32 v14, v16, 4, v14
    v_and_b32 v16, 1, v1
    v_lshl_or_b32 v14, v16, 3, v14
    s_lshl_b32 s55, s59, 8
    s_add_u32 s55, s55, 32768
    v_add_u32 v14, s55, v14
    v_xor_b32 v16, 0, v15
    v_lshl_add_u32 v6, v16, 6, v14
    v_xor_b32 v16, 1, v15
    v_lshl_add_u32 v7, v16, 6, v14
    v_xor_b32 v16, 2, v15
    v_lshl_add_u32 v8, v16, 6, v14
    v_xor_b32 v16, 3, v15
    v_lshl_add_u32 v9, v16, 6, v14
    v_lshrrev_b32 v14, 3, v1
    v_mul_lo_u32 v14, v14, s44
    v_and_b32 v15, 7, v1
    v_bfe_u32 v16, v1, 4, 2
    v_xor_b32 v15, v15, v16
    v_lshl_add_u32 v10, v15, 4, v14
    v_xor_b32 v15, 4, v15
    v_lshl_add_u32 v11, v15, 4, v14
    v_lshrrev_b32 v16, 5, v1
    v_mul_lo_u32 v14, v16, s45
    v_and_b32 v15, 31, v1
    v_lshlrev_b32 v16, 2, v16
    v_xor_b32 v15, v15, v16
    v_lshl_add_u32 v12, v15, 4, v14
    v_xor_b32 v15, 8, v15
    v_lshl_add_u32 v13, v15, 4, v14
    s_mov_b32 s10, s66
    s_mov_b32 s38, s67
    s_lshl_b32 s57, s44, 3
    s_lshl_b32 s61, s45, 1
    s_mul_i32 s52, s44, s27
    s_mul_i32 s52, s52, 64
    s_add_u32 s52, s52, s47
    s_mul_i32 s53, s45, s27
    s_lshl_b32 s53, s53, 4
    s_add_u32 s53, s53, s48
    s_lshl_b32 s54, s27, 13
    s_mul_i32 s65, s27, 8192
    s_mov_b32 s55, s52
    s_add_u32 m0, s65, 0
    s_nop 0
    buffer_load_dwordx4 v10, s[8:11], s55 offen sc1 lds
    s_add_u32 s55, s55, s57
    s_add_u32 m0, s65, 1024
    s_nop 0
    buffer_load_dwordx4 v11, s[8:11], s55 offen sc1 lds
    s_add_u32 s55, s55, s57
    s_add_u32 m0, s65, 2048
    s_nop 0
    buffer_load_dwordx4 v10, s[8:11], s55 offen sc1 lds
    s_add_u32 s55, s55, s57
    s_add_u32 m0, s65, 3072
    s_nop 0
    buffer_load_dwordx4 v11, s[8:11], s55 offen sc1 lds
    s_add_u32 s55, s55, s57
    s_add_u32 m0, s65, 4096
    s_nop 0
    buffer_load_dwordx4 v10, s[8:11], s55 offen sc1 lds
    s_add_u32 s55, s55, s57
    s_add_u32 m0, s65, 5120
    s_nop 0
    buffer_load_dwordx4 v11, s[8:11], s55 offen sc1 lds
    s_add_u32 s55, s55, s57
    s_add_u32 m0, s65, 6144
    s_nop 0
    buffer_load_dwordx4 v10, s[8:11], s55 offen sc1 lds
    s_add_u32 s55, s55, s57
    s_add_u32 m0, s65, 7168
    s_nop 0
    buffer_load_dwordx4 v11, s[8:11], s55 offen sc1 lds
    s_mov_b32 s56, s53
    s_add_u32 m0, s54, 32768
    s_nop 0
    buffer_load_dwordx4 v12, s[36:39], s56 offen lds
    s_add_u32 s56, s56, s61
    s_add_u32 m0, s54, 33792
    s_nop 0
    buffer_load_dwordx4 v13, s[36:39], s56 offen lds
    s_add_u32 s56, s56, s61
    s_add_u32 m0, s54, 34816
    s_nop 0
    buffer_load_dwordx4 v12, s[36:39], s56 offen lds
    s_add_u32 s56, s56, s61
    s_add_u32 m0, s54, 35840
    s_nop 0
    buffer_load_dwordx4 v13, s[36:39], s56 offen lds
    s_add_u32 s56, s56, s61
    s_add_u32 m0, s54, 36864
    s_nop 0
    buffer_load_dwordx4 v12, s[36:39], s56 offen lds
    s_add_u32 s56, s56, s61
    s_add_u32 m0, s54, 37888
    s_nop 0
    buffer_load_dwordx4 v13, s[36:39], s56 offen lds
    s_add_u32 s56, s56, s61
    s_add_u32 m0, s54, 38912
    s_nop 0
    buffer_load_dwordx4 v12, s[36:39], s56 offen lds
    s_add_u32 s56, s56, s61
    s_add_u32 m0, s54, 39936
    s_nop 0
    buffer_load_dwordx4 v13, s[36:39], s56 offen lds
    s_add_u32 s52, s52, 128
    s_lshl_b32 s62, s45, 6
    s_add_u32 s53, s53, s62
    s_xor_b32 s54, s54, 0x10000
    s_xor_b32 s65, s65, 0x10000
    s_mov_b32 s63, 0
    v_accvgpr_write_b32 a0, 0
    v_accvgpr_write_b32 a1, 0
    v_accvgpr_write_b32 a2, 0
    v_accvgpr_write_b32 a3, 0
    v_accvgpr_write_b32 a4, 0
    v_accvgpr_write_b32 a5, 0
    v_accvgpr_write_b32 a6, 0
    v_accvgpr_write_b32 a7, 0
    v_accvgpr_write_b32 a8, 0
    v_accvgpr_write_b32 a9, 0
    v_accvgpr_write_b32 a10, 0
    v_accvgpr_write_b32 a11, 0
    v_accvgpr_write_b32 a12, 0
    v_accvgpr_write_b32 a13, 0
    v_accvgpr_write_b32 a14, 0
    v_accvgpr_write_b32 a15, 0
    v_accvgpr_write_b32 a16, 0
    v_accvgpr_write_b32 a17, 0
    v_accvgpr_write_b32 a18, 0
    v_accvgpr_write_b32 a19, 0
    v_accvgpr_write_b32 a20, 0
    v_accvgpr_write_b32 a21, 0
    v_accvgpr_write_b32 a22, 0
    v_accvgpr_write_b32 a23, 0
    v_accvgpr_write_b32 a24, 0
    v_accvgpr_write_b32 a25, 0
    v_accvgpr_write_b32 a26, 0
    v_accvgpr_write_b32 a27, 0
    v_accvgpr_write_b32 a28, 0
    v_accvgpr_write_b32 a29, 0
    v_accvgpr_write_b32 a30, 0
    v_accvgpr_write_b32 a31, 0
    v_accvgpr_write_b32 a32, 0
    v_accvgpr_write_b32 a33, 0
    v_accvgpr_write_b32 a34, 0
    v_accvgpr_write_b32 a35, 0
    v_accvgpr_write_b32 a36, 0
    v_accvgpr_write_b32 a37, 0
    v_accvgpr_write_b32 a38, 0
    v_accvgpr_write_b32 a39, 0
    v_accvgpr_write_b32 a40, 0
    v_accvgpr_write_b32 a41, 0
    v_accvgpr_write_b32 a42, 0
    v_accvgpr_write_b32 a43, 0
    v_accvgpr_write_b32 a44, 0
    v_accvgpr_write_b32 a45, 0
    v_accvgpr_write_b32 a46, 0
    v_accvgpr_write_b32 a47, 0
    v_accvgpr_write_b32 a48, 0
    v_accvgpr_write_b32 a49, 0
    v_accvgpr_write_b32 a50, 0
    v_accvgpr_write_b32 a51, 0
    v_accvgpr_write_b32 a52, 0
    v_accvgpr_write_b32 a53, 0
    v_accvgpr_write_b32 a54, 0
    v_accvgpr_write_b32 a55, 0
    v_accvgpr_write_b32 a56, 0
    v_accvgpr_write_b32 a57, 0
    v_accvgpr_write_b32 a58, 0
    v_accvgpr_write_b32 a59, 0
    v_accvgpr_write_b32 a60, 0
    v_accvgpr_write_b32 a61, 0
    v_accvgpr_write_b32 a62, 0
    v_accvgpr_write_b32 a63, 0
    v_accvgpr_write_b32 a64, 0
    v_accvgpr_write_b32 a65, 0
    v_accvgpr_write_b32 a66, 0
    v_accvgpr_write_b32 a67, 0
    v_accvgpr_write_b32 a68, 0
    v_accvgpr_write_b32 a69, 0
    v_accvgpr_write_b32 a70, 0
    v_accvgpr_write_b32 a71, 0
    v_accvgpr_write_b32 a72, 0
    v_accvgpr_write_b32 a73, 0
    v_accvgpr_write_b32 a74, 0
    v_accvgpr_write_b32 a75, 0
    v_accvgpr_write_b32 a76, 0
    v_accvgpr_write_b32 a77, 0
    v_accvgpr_write_b32 a78, 0
    v_accvgpr_write_b32 a79, 0
    v_accvgpr_write_b32 a80, 0
    v_accvgpr_write_b32 a81, 0
    v_accvgpr_write_b32 a82, 0
    v_accvgpr_write_b32 a83, 0
    v_accvgpr_write_b32 a84, 0
    v_accvgpr_write_b32 a85, 0
    v_accvgpr_write_b32 a86, 0
    v_accvgpr_write_b32 a87, 0
    v_accvgpr_write_b32 a88, 0
    v_accvgpr_write_b32 a89, 0
    v_accvgpr_write_b32 a90, 0
    v_accvgpr_write_b32 a91, 0
    v_accvgpr_write_b32 a92, 0
    v_accvgpr_write_b32 a93, 0
    v_accvgpr_write_b32 a94, 0
    v_accvgpr_write_b32 a95, 0
    v_accvgpr_write_b32 a96, 0
    v_accvgpr_write_b32 a97, 0
    v_accvgpr_write_b32 a98, 0
    v_accvgpr_write_b32 a99, 0
    v_accvgpr_write_b32 a100, 0
    v_accvgpr_write_b32 a101, 0
    v_accvgpr_write_b32 a102, 0
    v_accvgpr_write_b32 a103, 0
    v_accvgpr_write_b32 a104, 0
    v_accvgpr_write_b32 a105, 0
    v_accvgpr_write_b32 a106, 0
    v_accvgpr_write_b32 a107, 0
    v_accvgpr_write_b32 a108, 0
    v_accvgpr_write_b32 a109, 0
    v_accvgpr_write_b32 a110, 0
    v_accvgpr_write_b32 a111, 0
    v_accvgpr_write_b32 a112, 0
    v_accvgpr_write_b32 a113, 0
    v_accvgpr_write_b32 a114, 0
    v_accvgpr_write_b32 a115, 0
    v_accvgpr_write_b32 a116, 0
    v_accvgpr_write_b32 a117, 0
    v_accvgpr_write_b32 a118, 0
    v_accvgpr_write_b32 a119, 0
    v_accvgpr_write_b32 a120, 0
    v_accvgpr_write_b32 a121, 0
    v_accvgpr_write_b32 a122, 0
    v_accvgpr_write_b32 a123, 0
    v_accvgpr_write_b32 a124, 0
    v_accvgpr_write_b32 a125, 0
    v_accvgpr_write_b32 a126, 0
    v_accvgpr_write_b32 a127, 0
    v_accvgpr_write_b32 a128, 0
    v_accvgpr_write_b32 a129, 0
    v_accvgpr_write_b32 a130, 0
    v_accvgpr_write_b32 a131, 0
    v_accvgpr_write_b32 a132, 0
    v_accvgpr_write_b32 a133, 0
    v_accvgpr_write_b32 a134, 0
    v_accvgpr_write_b32 a135, 0
    v_accvgpr_write_b32 a136, 0
    v_accvgpr_write_b32 a137, 0
    v_accvgpr_write_b32 a138, 0
    v_accvgpr_write_b32 a139, 0
    v_accvgpr_write_b32 a140, 0
    v_accvgpr_write_b32 a141, 0
    v_accvgpr_write_b32 a142, 0
    v_accvgpr_write_b32 a143, 0
    v_accvgpr_write_b32 a144, 0
    v_accvgpr_write_b32 a145, 0
    v_accvgpr_write_b32 a146, 0
    v_accvgpr_write_b32 a147, 0
    v_accvgpr_write_b32 a148, 0
    v_accvgpr_write_b32 a149, 0
    v_accvgpr_write_b32 a150, 0
    v_accvgpr_write_b32 a151, 0
    v_accvgpr_write_b32 a152, 0
    v_accvgpr_write_b32 a153, 0
    v_accvgpr_write_b32 a154, 0
    v_accvgpr_write_b32 a155, 0
    v_accvgpr_write_b32 a156, 0
    v_accvgpr_write_b32 a157, 0
    v_accvgpr_write_b32 a158, 0
    v_accvgpr_write_b32 a159, 0
    v_accvgpr_write_b32 a160, 0
    v_accvgpr_write_b32 a161, 0
    v_accvgpr_write_b32 a162, 0
    v_accvgpr_write_b32 a163, 0
    v_accvgpr_write_b32 a164, 0
    v_accvgpr_write_b32 a165, 0
    v_accvgpr_write_b32 a166, 0
    v_accvgpr_write_b32 a167, 0
    v_accvgpr_write_b32 a168, 0
    v_accvgpr_write_b32 a169, 0
    v_accvgpr_write_b32 a170, 0
    v_accvgpr_write_b32 a171, 0
    v_accvgpr_write_b32 a172, 0
    v_accvgpr_write_b32 a173, 0
    v_accvgpr_write_b32 a174, 0
    v_accvgpr_write_b32 a175, 0
    v_accvgpr_write_b32 a176, 0
    v_accvgpr_write_b32 a177, 0
    v_accvgpr_write_b32 a178, 0
    v_accvgpr_write_b32 a179, 0
    v_accvgpr_write_b32 a180, 0
    v_accvgpr_write_b32 a181, 0
    v_accvgpr_write_b32 a182, 0
    v_accvgpr_write_b32 a183, 0
    v_accvgpr_write_b32 a184, 0
    v_accvgpr_write_b32 a185, 0
    v_accvgpr_write_b32 a186, 0
    v_accvgpr_write_b32 a187, 0
    v_accvgpr_write_b32 a188, 0
    v_accvgpr_write_b32 a189, 0
    v_accvgpr_write_b32 a190, 0
    v_accvgpr_write_b32 a191, 0
    v_accvgpr_write_b32 a192, 0
    v_accvgpr_write_b32 a193, 0
    v_accvgpr_write_b32 a194, 0
    v_accvgpr_write_b32 a195, 0
    v_accvgpr_write_b32 a196, 0
    v_accvgpr_write_b32 a197, 0
    v_accvgpr_write_b32 a198, 0
    v_accvgpr_write_b32 a199, 0
    v_accvgpr_write_b32 a200, 0
    v_accvgpr_write_b32 a201, 0
    v_accvgpr_write_b32 a202, 0
    v_accvgpr_write_b32 a203, 0
    v_accvgpr_write_b32 a204, 0
    v_accvgpr_write_b32 a205, 0
    v_accvgpr_write_b32 a206, 0
    v_accvgpr_write_b32 a207, 0
    v_accvgpr_write_b32 a208, 0
    v_accvgpr_write_b32 a209, 0
    v_accvgpr_write_b32 a210, 0
    v_accvgpr_write_b32 a211, 0
    v_accvgpr_write_b32 a212, 0
    v_accvgpr_write_b32 a213, 0
    v_accvgpr_write_b32 a214, 0
    v_accvgpr_write_b32 a215, 0
    v_accvgpr_write_b32 a216, 0
    v_accvgpr_write_b32 a217, 0
    v_accvgpr_write_b32 a218, 0
    v_accvgpr_write_b32 a219, 0
    v_accvgpr_write_b32 a220, 0
    v_accvgpr_write_b32 a221, 0
    v_accvgpr_write_b32 a222, 0
    v_accvgpr_write_b32 a223, 0
    v_accvgpr_write_b32 a224, 0
    v_accvgpr_write_b32 a225, 0
    v_accvgpr_write_b32 a226, 0
    v_accvgpr_write_b32 a227, 0
    v_accvgpr_write_b32 a228, 0
    v_accvgpr_write_b32 a229, 0
    v_accvgpr_write_b32 a230, 0
    v_accvgpr_write_b32 a231, 0
    v_accvgpr_write_b32 a232, 0
    v_accvgpr_write_b32 a233, 0
    v_accvgpr_write_b32 a234, 0
    v_accvgpr_write_b32 a235, 0
    v_accvgpr_write_b32 a236, 0
    v_accvgpr_write_b32 a237, 0
    v_accvgpr_write_b32 a238, 0
    v_accvgpr_write_b32 a239, 0
    v_accvgpr_write_b32 a240, 0
    v_accvgpr_write_b32 a241, 0
    v_accvgpr_write_b32 a242, 0
    v_accvgpr_write_b32 a243, 0
    v_accvgpr_write_b32 a244, 0
    v_accvgpr_write_b32 a245, 0
    v_accvgpr_write_b32 a246, 0
    v_accvgpr_write_b32 a247, 0
    v_accvgpr_write_b32 a248, 0
    v_accvgpr_write_b32 a249, 0
    v_accvgpr_write_b32 a250, 0
    v_accvgpr_write_b32 a251, 0
    v_accvgpr_write_b32 a252, 0
    v_accvgpr_write_b32 a253, 0
    v_accvgpr_write_b32 a254, 0
    v_accvgpr_write_b32 a255, 0
    s_mov_b32 s51, 0
    s_nop 0
L_gk:
    s_waitcnt vmcnt(0)
    s_barrier
    ds_read_b128 v[64:67], v2 offset:0
    ds_read_b64_tr_b16 v[96:97], v6 offset:0
    ds_read_b64_tr_b16 v[98:99], v6 offset:2048
    ds_read_b64_tr_b16 v[100:101], v7 offset:0
    ds_read_b64_tr_b16 v[102:103], v7 offset:2048
    ds_read_b128 v[68:71], v2 offset:4096
    ds_read_b64_tr_b16 v[104:105], v8 offset:0
    ds_read_b64_tr_b16 v[106:107], v8 offset:2048
    ds_read_b64_tr_b16 v[108:109], v9 offset:0
    ds_read_b64_tr_b16 v[110:111], v9 offset:2048
    ds_read_b128 v[72:75], v2 offset:8192
    ds_read_b128 v[76:79], v2 offset:12288
    s_add_u32 s55, s51, 1
    s_cmp_ge_u32 s55, s50
    s_cselect_b32 s10, 0, s66
    s_cselect_b32 s38, 0, s67
    s_waitcnt lgkmcnt(9)
    v_mfma_f32_32x32x16_bf16 a[0:15], v[96:99], v[64:67], a[0:15]
    ds_read_b128 v[80:83], v3 offset:0
    s_mov_b32 s55, s52
    s_add_u32 m0, s65, 0
    s_nop 0
    buffer_load_dwordx4 v10, s[8:11], s55 offen sc1 lds
    s_waitcnt lgkmcnt(8)
    v_mfma_f32_32x32x16_bf16 a[16:31], v[100:103], v[64:67], a[16:31]
    ds_read_b64_tr_b16 v[112:113], v6 offset:8192
    s_add_u32 s55, s55, s57
    s_add_u32 m0, s65, 1024
    s_nop 0
    buffer_load_dwordx4 v11, s[8:11], s55 offen sc1 lds
    s_waitcnt lgkmcnt(8)
    v_mfma_f32_32x32x16_bf16 a[64:79], v[96:99], v[68:71], a[64:79]
    ds_read_b64_tr_b16 v[114:115], v6 offset:10240
    s_add_u32 s55, s55, s57
    s_add_u32 m0, s65, 2048
    s_nop 0
    buffer_load_dwordx4 v10, s[8:11], s55 offen sc1 lds
    v_mfma_f32_32x32x16_bf16 a[80:95], v[100:103], v[68:71], a[80:95]
    ds_read_b64_tr_b16 v[116:117], v7 offset:8192
    s_add_u32 s55, s55, s57
    s_add_u32 m0, s65, 3072
    s_nop 0
    buffer_load_dwordx4 v11, s[8:11], s55 offen sc1 lds
    s_waitcnt lgkmcnt(8)
    v_mfma_f32_32x32x16_bf16 a[32:47], v[104:107], v[64:67], a[32:47]
    ds_read_b64_tr_b16 v[118:119], v7 offset:10240
    s_add_u32 s55, s55, s57
    s_add_u32 m0, s65, 4096
    s_nop 0
    buffer_load_dwordx4 v10, s[8:11], s55 offen sc1 lds
    s_waitcnt lgkmcnt(7)
    v_mfma_f32_32x32x16_bf16 a[48:63], v[108:111], v[64:67], a[48:63]
    ds_read_b128 v[84:87], v3 offset:4096
    s_add_u32 s55, s55, s57
    s_add_u32 m0, s65, 5120
    s_nop 0
    buffer_load_dwordx4 v11, s[8:11], s55 offen sc1 lds
    v_mfma_f32_32x32x16_bf16 a[96:111], v[104:107], v[68:71], a[96:111]
    ds_read_b64_tr_b16 v[120:121], v8 offset:8192
    s_add_u32 s55, s55, s57
    s_add_u32 m0, s65, 6144
    s_nop 0
    buffer_load_dwordx4 v10, s[8:11], s55 offen sc1 lds
    v_mfma_f32_32x32x16_bf16 a[112:127], v[108:111], v[68:71], a[112:127]
    ds_read_b64_tr_b16 v[122:123], v8 offset:10240
    s_add_u32 s55, s55, s57
    s_add_u32 m0, s65, 7168
    s_nop 0
    buffer_load_dwordx4 v11, s[8:11], s55 offen sc1 lds
    s_waitcnt lgkmcnt(9)
    v_mfma_f32_32x32x16_bf16 a[128:143], v[96:99], v[72:75], a[128:143]
    ds_read_b64_tr_b16 v[124:125], v9 offset:8192
    s_mov_b32 s56, s53
    s_add_u32 m0, s54, 32768
    s_nop 0
    buffer_load_dwordx4 v12, s[36:39], s56 offen lds
    v_mfma_f32_32x32x16_bf16 a[144:159], v[100:103], v[72:75], a[144:159]
    ds_read_b64_tr_b16 v[126:127], v9 offset:10240
    s_add_u32 s56, s56, s61
    s_add_u32 m0, s54, 33792
    s_nop 0
    buffer_load_dwordx4 v13, s[36:39], s56 offen lds
    v_mfma_f32_32x32x16_bf16 a[160:175], v[104:107], v[72:75], a[160:175]
    ds_read_b128 v[88:91], v3 offset:8192
    s_add_u32 s56, s56, s61
    s_add_u32 m0, s54, 34816
    s_nop 0
    buffer_load_dwordx4 v12, s[36:39], s56 offen lds
    v_mfma_f32_32x32x16_bf16 a[176:191], v[108:111], v[72:75], a[176:191]
    ds_read_b128 v[92:95], v3 offset:12288
    s_add_u32 s56, s56, s61
    s_add_u32 m0, s54, 35840
    s_nop 0
    buffer_load_dwordx4 v13, s[36:39], s56 offen lds
    s_waitcnt lgkmcnt(12)
    v_mfma_f32_32x32x16_bf16 a[192:207], v[96:99], v[76:79], a[192:207]
    s_add_u32 s56, s56, s61
    s_add_u32 m0, s54, 36864
    s_nop 0
    buffer_load_dwordx4 v12, s[36:39], s56 offen lds
    v_mfma_f32_32x32x16_bf16 a[208:223], v[100:103], v[76:79], a[208:223]
    s_add_u32 s56, s56, s61
    s_add_u32 m0, s54, 37888
    s_nop 0
    buffer_load_dwordx4 v13, s[36:39], s56 offen lds
    v_mfma_f32_32x32x16_bf16 a[224:239], v[104:107], v[76:79], a[224:239]
    s_add_u32 s56, s56, s61
    s_add_u32 m0, s54, 38912
    s_nop 0
    buffer_load_dwordx4 v12, s[36:39], s56 offen lds
    v_mfma_f32_32x32x16_bf16 a[240:255], v[108:111], v[76:79], a[240:255]
    s_add_u32 s56, s56, s61
    s_add_u32 m0, s54, 39936
    s_nop 0
    buffer_load_dwordx4 v13, s[36:39], s56 offen lds
    s_waitcnt lgkmcnt(9)
    v_mfma_f32_32x32x16_bf16 a[0:15], v[112:115], v[80:83], a[0:15]
    ds_read_b128 v[64:67], v4 offset:0
    s_waitcnt lgkmcnt(8)
    v_mfma_f32_32x32x16_bf16 a[16:31], v[116:119], v[80:83], a[16:31]
    ds_read_b64_tr_b16 v[96:97], v6 offset:16384
    s_waitcnt lgkmcnt(8)
    v_mfma_f32_32x32x16_bf16 a[64:79], v[112:115], v[84:87], a[64:79]
    ds_read_b64_tr_b16 v[98:99], v6 offset:18432
    v_mfma_f32_32x32x16_bf16 a[80:95], v[116:119], v[84:87], a[80:95]
    ds_read_b64_tr_b16 v[100:101], v7 offset:16384
    s_waitcnt lgkmcnt(8)
    v_mfma_f32_32x32x16_bf16 a[32:47], v[120:123], v[80:83], a[32:47]
    ds_read_b64_tr_b16 v[102:103], v7 offset:18432
    s_waitcnt lgkmcnt(7)
    v_mfma_f32_32x32x16_bf16 a[48:63], v[124:127], v[80:83], a[48:63]
    ds_read_b128 v[68:71], v4 offset:4096
    v_mfma_f32_32x32x16_bf16 a[96:111], v[120:123], v[84:87], a[96:111]
    ds_read_b64_tr_b16 v[104:105], v8 offset:16384
    v_mfma_f32_32x32x16_bf16 a[112:127], v[124:127], v[84:87], a[112:127]
    ds_read_b64_tr_b16 v[106:107], v8 offset:18432
    s_waitcnt lgkmcnt(9)
    v_mfma_f32_32x32x16_bf16 a[128:143], v[112:115], v[88:91], a[128:143]
    ds_read_b64_tr_b16 v[108:109], v9 offset:16384
    v_mfma_f32_32x32x16_bf16 a[144:159], v[116:119], v[88:91], a[144:159]
    ds_read_b64_tr_b16 v[110:111], v9 offset:18432
    v_mfma_f32_32x32x16_bf16 a[160:175], v[120:123], v[88:91], a[160:175]
    ds_read_b128 v[72:75], v4 offset:8192
    v_mfma_f32_32x32x16_bf16 a[176:191], v[124:127], v[88:91], a[176:191]
    ds_read_b128 v[76:79], v4 offset:12288
    s_waitcnt lgkmcnt(12)
    v_mfma_f32_32x32x16_bf16 a[192:207], v[112:115], v[92:95], a[192:207]
    v_mfma_f32_32x32x16_bf16 a[208:223], v[116:119], v[92:95], a[208:223]
    v_mfma_f32_32x32x16_bf16 a[224:239], v[120:123], v[92:95], a[224:239]
    v_mfma_f32_32x32x16_bf16 a[240:255], v[124:127], v[92:95], a[240:255]
    s_waitcnt lgkmcnt(9)
    v_mfma_f32_32x32x16_bf16 a[0:15], v[96:99], v[64:67], a[0:15]
    ds_read_b128 v[80:83], v5 offset:0
    s_waitcnt lgkmcnt(8)
    v_mfma_f32_32x32x16_bf16 a[16:31], v[100:103], v[64:67], a[16:31]
    ds_read_b64_tr_b16 v[112:113], v6 offset:24576
    s_waitcnt lgkmcnt(8)
    v_mfma_f32_32x32x16_bf16 a[64:79], v[96:99], v[68:71], a[64:79]
    ds_read_b64_tr_b16 v[114:115], v6 offset:26624
    v_mfma_f32_32x32x16_bf16 a[80:95], v[100:103], v[68:71], a[80:95]
    ds_read_b64_tr_b16 v[116:117], v7 offset:24576
    s_waitcnt lgkmcnt(8)
    v_mfma_f32_32x32x16_bf16 a[32:47], v[104:107], v[64:67], a[32:47]
    ds_read_b64_tr_b16 v[118:119], v7 offset:26624
    s_waitcnt lgkmcnt(7)
    v_mfma_f32_32x32x16_bf16 a[48:63], v[108:111], v[64:67], a[48:63]
    ds_read_b128 v[84:87], v5 offset:4096
    v_mfma_f32_32x32x16_bf16 a[96:111], v[104:107], v[68:71], a[96:111]
    ds_read_b64_tr_b16 v[120:121], v8 offset:24576
    v_mfma_f32_32x32x16_bf16 a[112:127], v[108:111], v[68:71], a[112:127]
    ds_read_b64_tr_b16 v[122:123], v8 offset:26624
    s_waitcnt lgkmcnt(9)
    v_mfma_f32_32x32x16_bf16 a[128:143], v[96:99], v[72:75], a[128:143]
    ds_read_b64_tr_b16 v[124:125], v9 offset:24576
    v_mfma_f32_32x32x16_bf16 a[144:159], v[100:103], v[72:75], a[144:159]
    ds_read_b64_tr_b16 v[126:127], v9 offset:26624
    v_mfma_f32_32x32x16_bf16 a[160:175], v[104:107], v[72:75], a[160:175]
    ds_read_b128 v[88:91], v5 offset:8192
    v_mfma_f32_32x32x16_bf16 a[176:191], v[108:111], v[72:75], a[176:191]
    ds_read_b128 v[92:95], v5 offset:12288
    s_waitcnt lgkmcnt(12)
    v_mfma_f32_32x32x16_bf16 a[192:207], v[96:99], v[76:79], a[192:207]
    v_mfma_f32_32x32x16_bf16 a[208:223], v[100:103], v[76:79], a[208:223]
    v_mfma_f32_32x32x16_bf16 a[224:239], v[104:107], v[76:79], a[224:239]
    v_mfma_f32_32x32x16_bf16 a[240:255], v[108:111], v[76:79], a[240:255]
    s_waitcnt lgkmcnt(9)
    v_mfma_f32_32x32x16_bf16 a[0:15], v[112:115], v[80:83], a[0:15]
    s_waitcnt lgkmcnt(7)
    v_mfma_f32_32x32x16_bf16 a[16:31], v[116:119], v[80:83], a[16:31]
    s_waitcnt lgkmcnt(6)
    v_mfma_f32_32x32x16_bf16 a[64:79], v[112:115], v[84:87], a[64:79]
    v_mfma_f32_32x32x16_bf16 a[80:95], v[116:119], v[84:87], a[80:95]
    s_waitcnt lgkmcnt(4)
    v_mfma_f32_32x32x16_bf16 a[32:47], v[120:123], v[80:83], a[32:47]
    s_waitcnt lgkmcnt(2)
    v_mfma_f32_32x32x16_bf16 a[48:63], v[124:127], v[80:83], a[48:63]
    v_mfma_f32_32x32x16_bf16 a[96:111], v[120:123], v[84:87], a[96:111]
    v_mfma_f32_32x32x16_bf16 a[112:127], v[124:127], v[84:87], a[112:127]
    s_waitcnt lgkmcnt(1)
    v_mfma_f32_32x32x16_bf16 a[128:143], v[112:115], v[88:91], a[128:143]
    v_mfma_f32_32x32x16_bf16 a[144:159], v[116:119], v[88:91], a[144:159]
    v_mfma_f32_32x32x16_bf16 a[160:175], v[120:123], v[88:91], a[160:175]
    v_mfma_f32_32x32x16_bf16 a[176:191], v[124:127], v[88:91], a[176:191]
    s_waitcnt lgkmcnt(0)
    v_mfma_f32_32x32x16_bf16 a[192:207], v[112:115], v[92:95], a[192:207]
    v_mfma_f32_32x32x16_bf16 a[208:223], v[116:119], v[92:95], a[208:223]
    v_mfma_f32_32x32x16_bf16 a[224:239], v[120:123], v[92:95], a[224:239]
    v_mfma_f32_32x32x16_bf16 a[240:255], v[124:127], v[92:95], a[240:255]
    s_add_u32 s52, s52, 128
    s_lshl_b32 s62, s45, 6
    s_add_u32 s53, s53, s62
    s_xor_b32 s54, s54, 0x10000
    s_xor_b32 s65, s65, 0x10000
    v_xor_b32 v2, 0x10000, v2
    v_xor_b32 v3, 0x10000, v3
    v_xor_b32 v4, 0x10000, v4
    v_xor_b32 v5, 0x10000, v5
    v_xor_b32 v6, 0x10000, v6
    v_xor_b32 v7, 0x10000, v7
    v_xor_b32 v8, 0x10000, v8
    v_xor_b32 v9, 0x10000, v9
    s_add_u32 s51, s51, 1
    s_cmp_lt_u32 s51, s50
    s_waitcnt lgkmcnt(0)
    s_cbranch_scc1 L_gk
    s_waitcnt vmcnt(0)
    s_barrier
    s_mul_i32 s55, s27, 24576
    s_add_u32 s55, s55, 65536
    v_and_b32 v14, 31, v1
    v_lshlrev_b32 v16, 8, v14
    v_lshrrev_b32 v15, 5, v1
    v_lshl_or_b32 v16, v15, 3, v16
    v_add_u32 v16, s55, v16
    v_and_b32 v14, 15, v1
    v_lshlrev_b32 v21, 4, v14
    v_lshrrev_b32 v15, 4, v1
    v_xor_b32 v14, v14, v15
    v_lshlrev_b32 v14, 4, v14
    v_lshl_or_b32 v17, v15, 8, v14
    v_add_u32 v17, s55, v17
    s_mul_i32 s56, s58, 128
    v_add_u32 v15, s56, v15
    v_mul_lo_u32 v15, v15, s46
    v_and_b32 v14, 15, v1
    v_lshlrev_b32 v14, 4, v14
    s_lshl_b32 s56, s59, 8
    v_add3_u32 v20, v14, v15, s56
    s_lshl_b32 s57, s46, 2
    s_mov_b32 s56, s49
    v_accvgpr_read_b32 v32, a0
    v_accvgpr_read_b32 v33, a1
    v_accvgpr_read_b32 v34, a2
    v_accvgpr_read_b32 v35, a3
    v_accvgpr_read_b32 v36, a4
    v_accvgpr_read_b32 v37, a5
    v_accvgpr_read_b32 v38, a6
    v_accvgpr_read_b32 v39, a7
    v_accvgpr_read_b32 v40, a8
    v_accvgpr_read_b32 v41, a9
    v_accvgpr_read_b32 v42, a10
    v_accvgpr_read_b32 v43, a11
    v_accvgpr_read_b32 v44, a12
    v_accvgpr_read_b32 v45, a13
    v_accvgpr_read_b32 v46, a14
    v_accvgpr_read_b32 v47, a15
    v_cvt_pk_bf16_f32 v56, v32, v33
    v_cvt_pk_bf16_f32 v57, v34, v35
    v_xor_b32 v60, 0, v21
    v_add_u32 v60, v60, v16
    ds_write_b64 v60, v[56:57] offset:0
    v_cvt_pk_bf16_f32 v58, v36, v37
    v_cvt_pk_bf16_f32 v59, v38, v39
    v_xor_b32 v61, 16, v21
    v_add_u32 v61, v61, v16
    ds_write_b64 v61, v[58:59] offset:0
    v_cvt_pk_bf16_f32 v56, v40, v41
    v_cvt_pk_bf16_f32 v57, v42, v43
    v_xor_b32 v60, 32, v21
    v_add_u32 v60, v60, v16
    ds_write_b64 v60, v[56:57] offset:0
    v_cvt_pk_bf16_f32 v58, v44, v45
    v_cvt_pk_bf16_f32 v59, v46, v47
    v_xor_b32 v61, 48, v21
    v_add_u32 v61, v61, v16
    ds_write_b64 v61, v[58:59] offset:0
    v_accvgpr_read_b32 v32, a16
    v_accvgpr_read_b32 v33, a17
    v_accvgpr_read_b32 v34, a18
    v_accvgpr_read_b32 v35, a19
    v_accvgpr_read_b32 v36, a20
    v_accvgpr_read_b32 v37, a21
    v_accvgpr_read_b32 v38, a22
    v_accvgpr_read_b32 v39, a23
    v_accvgpr_read_b32 v40, a24
    v_accvgpr_read_b32 v41, a25
    v_accvgpr_read_b32 v42, a26
    v_accvgpr_read_b32 v43, a27
    v_accvgpr_read_b32 v44, a28
    v_accvgpr_read_b32 v45, a29
    v_accvgpr_read_b32 v46, a30
    v_accvgpr_read_b32 v47, a31
    v_cvt_pk_bf16_f32 v56, v32, v33
    v_cvt_pk_bf16_f32 v57, v34, v35
    v_xor_b32 v60, 64, v21
    v_add_u32 v60, v60, v16
    ds_write_b64 v60, v[56:57] offset:0
    v_cvt_pk_bf16_f32 v58, v36, v37
    v_cvt_pk_bf16_f32 v59, v38, v39
    v_xor_b32 v61, 80, v21
    v_add_u32 v61, v61, v16
    ds_write_b64 v61, v[58:59] offset:0
    v_cvt_pk_bf16_f32 v56, v40, v41
    v_cvt_pk_bf16_f32 v57, v42, v43
    v_xor_b32 v60, 96, v21
    v_add_u32 v60, v60, v16
    ds_write_b64 v60, v[56:57] offset:0
    v_cvt_pk_bf16_f32 v58, v44, v45
    v_cvt_pk_bf16_f32 v59, v46, v47
    v_xor_b32 v61, 112, v21
    v_add_u32 v61, v61, v16
    ds_write_b64 v61, v[58:59] offset:0
    v_accvgpr_read_b32 v32, a32
    v_accvgpr_read_b32 v33, a33
    v_accvgpr_read_b32 v34, a34
    v_accvgpr_read_b32 v35, a35
    v_accvgpr_read_b32 v36, a36
    v_accvgpr_read_b32 v37, a37
    v_accvgpr_read_b32 v38, a38
    v_accvgpr_read_b32 v39, a39
    v_accvgpr_read_b32 v40, a40
    v_accvgpr_read_b32 v41, a41
    v_accvgpr_read_b32 v42, a42
    v_accvgpr_read_b32 v43, a43
    v_accvgpr_read_b32 v44, a44
    v_accvgpr_read_b32 v45, a45
    v_accvgpr_read_b32 v46, a46
    v_accvgpr_read_b32 v47, a47
    v_cvt_pk_bf16_f32 v56, v32, v33
    v_cvt_pk_bf16_f32 v57, v34, v35
    v_xor_b32 v60, 128, v21
    v_add_u32 v60, v60, v16
    ds_write_b64 v60, v[56:57] offset:0
    v_cvt_pk_bf16_f32 v58, v36, v37
    v_cvt_pk_bf16_f32 v59, v38, v39
    v_xor_b32 v61, 144, v21
    v_add_u32 v61, v61, v16
    ds_write_b64 v61, v[58:59] offset:0
    v_cvt_pk_bf16_f32 v56, v40, v41
    v_cvt_pk_bf16_f32 v57, v42, v43
    v_xor_b32 v60, 160, v21
    v_add_u32 v60, v60, v16
    ds_write_b64 v60, v[56:57] offset:0
    v_cvt_pk_bf16_f32 v58, v44, v45
    v_cvt_pk_bf16_f32 v59, v46, v47
    v_xor_b32 v61, 176, v21
    v_add_u32 v61, v61, v16
    ds_write_b64 v61, v[58:59] offset:0
    v_accvgpr_read_b32 v32, a48
    v_accvgpr_read_b32 v33, a49
    v_accvgpr_read_b32 v34, a50
    v_accvgpr_read_b32 v35, a51
    v_accvgpr_read_b32 v36, a52
    v_accvgpr_read_b32 v37, a53
    v_accvgpr_read_b32 v38, a54
    v_accvgpr_read_b32 v39, a55
    v_accvgpr_read_b32 v40, a56
    v_accvgpr_read_b32 v41, a57
    v_accvgpr_read_b32 v42, a58
    v_accvgpr_read_b32 v43, a59
    v_accvgpr_read_b32 v44, a60
    v_accvgpr_read_b32 v45, a61
    v_accvgpr_read_b32 v46, a62
    v_accvgpr_read_b32 v47, a63
    v_cvt_pk_bf16_f32 v56, v32, v33
    v_cvt_pk_bf16_f32 v57, v34, v35
    v_xor_b32 v60, 192, v21
    v_add_u32 v60, v60, v16
    ds_write_b64 v60, v[56:57] offset:0
    v_cvt_pk_bf16_f32 v58, v36, v37
    v_cvt_pk_bf16_f32 v59, v38, v39
    v_xor_b32 v61, 208, v21
    v_add_u32 v61, v61, v16
    ds_write_b64 v61, v[58:59] offset:0
    v_cvt_pk_bf16_f32 v56, v40, v41
    v_cvt_pk_bf16_f32 v57, v42, v43
    v_xor_b32 v60, 224, v21
    v_add_u32 v60, v60, v16
    ds_write_b64 v60, v[56:57] offset:0
    v_cvt_pk_bf16_f32 v58, v44, v45
    v_cvt_pk_bf16_f32 v59, v46, v47
    v_xor_b32 v61, 240, v21
    v_add_u32 v61, v61, v16
    s_waitcnt lgkmcnt(14)
    ds_write_b64 v61, v[58:59] offset:0
    v_accvgpr_read_b32 v32, a64
    v_accvgpr_read_b32 v33, a65
    v_accvgpr_read_b32 v34, a66
    v_accvgpr_read_b32 v35, a67
    v_accvgpr_read_b32 v36, a68
    v_accvgpr_read_b32 v37, a69
    v_accvgpr_read_b32 v38, a70
    v_accvgpr_read_b32 v39, a71
    v_accvgpr_read_b32 v40, a72
    v_accvgpr_read_b32 v41, a73
    v_accvgpr_read_b32 v42, a74
    v_accvgpr_read_b32 v43, a75
    v_accvgpr_read_b32 v44, a76
    v_accvgpr_read_b32 v45, a77
    v_accvgpr_read_b32 v46, a78
    v_accvgpr_read_b32 v47, a79
    v_cvt_pk_bf16_f32 v56, v32, v33
    v_cvt_pk_bf16_f32 v57, v34, v35
    v_xor_b32 v60, 0, v21
    v_add_u32 v60, v60, v16
    s_waitcnt lgkmcnt(14)
    ds_write_b64 v60, v[56:57] offset:8192
    v_cvt_pk_bf16_f32 v58, v36, v37
    v_cvt_pk_bf16_f32 v59, v38, v39
    v_xor_b32 v61, 16, v21
    v_add_u32 v61, v61, v16
    s_waitcnt lgkmcnt(14)
    ds_write_b64 v61, v[58:59] offset:8192
    v_cvt_pk_bf16_f32 v56, v40, v41
    v_cvt_pk_bf16_f32 v57, v42, v43
    v_xor_b32 v60, 32, v21
    v_add_u32 v60, v60, v16
    s_waitcnt lgkmcnt(14)
    ds_write_b64 v60, v[56:57] offset:8192
    v_cvt_pk_bf16_f32 v58, v44, v45
    v_cvt_pk_bf16_f32 v59, v46, v47
    v_xor_b32 v61, 48, v21
    v_add_u32 v61, v61, v16
    s_waitcnt lgkmcnt(14)
    ds_write_b64 v61, v[58:59] offset:8192
    v_accvgpr_read_b32 v32, a80
    v_accvgpr_read_b32 v33, a81
    v_accvgpr_read_b32 v34, a82
    v_accvgpr_read_b32 v35, a83
    v_accvgpr_read_b32 v36, a84
    v_accvgpr_read_b32 v37, a85
    v_accvgpr_read_b32 v38, a86
    v_accvgpr_read_b32 v39, a87
    v_accvgpr_read_b32 v40, a88
    v_accvgpr_read_b32 v41, a89
    v_accvgpr_read_b32 v42, a90
    v_accvgpr_read_b32 v43, a91
    v_accvgpr_read_b32 v44, a92
    v_accvgpr_read_b32 v45, a93
    v_accvgpr_read_b32 v46, a94
    v_accvgpr_read_b32 v47, a95
    v_cvt_pk_bf16_f32 v56, v32, v33
    v_cvt_pk_bf16_f32 v57, v34, v35
    v_xor_b32 v60, 64, v21
    v_add_u32 v60, v60, v16
    s_waitcnt lgkmcnt(14)
    ds_write_b64 v60, v[56:57] offset:8192
    v_cvt_pk_bf16_f32 v58, v36, v37
    v_cvt_pk_bf16_f32 v59, v38, v39
    v_xor_b32 v61, 80, v21
    v_add_u32 v61, v61, v16
    s_waitcnt lgkmcnt(14)
    ds_write_b64 v61, v[58:59] offset:8192
    v_cvt_pk_bf16_f32 v56, v40, v41
    v_cvt_pk_bf16_f32 v57, v42, v43
    v_xor_b32 v60, 96, v21
    v_add_u32 v60, v60, v16
    s_waitcnt lgkmcnt(14)
    ds_write_b64 v60, v[56:57] offset:8192
    v_cvt_pk_bf16_f32 v58, v44, v45
    v_cvt_pk_bf16_f32 v59, v46, v47
    v_xor_b32 v61, 112, v21
    v_add_u32 v61, v61, v16
    s_waitcnt lgkmcnt(14)
    ds_write_b64 v61, v[58:59] offset:8192
    v_accvgpr_read_b32 v32, a96
    v_accvgpr_read_b32 v33, a97
    v_accvgpr_read_b32 v34, a98
    v_accvgpr_read_b32 v35, a99
    v_accvgpr_read_b32 v36, a100
    v_accvgpr_read_b32 v37, a101
    v_accvgpr_read_b32 v38, a102
    v_accvgpr_read_b32 v39, a103
    v_accvgpr_read_b32 v40, a104
    v_accvgpr_read_b32 v41, a105
    v_accvgpr_read_b32 v42, a106
    v_accvgpr_read_b32 v43, a107
    v_accvgpr_read_b32 v44, a108
    v_accvgpr_read_b32 v45, a109
    v_accvgpr_read_b32 v46, a110
    v_accvgpr_read_b32 v47, a111
    v_cvt_pk_bf16_f32 v56, v32, v33
    v_cvt_pk_bf16_f32 v57, v34, v35
    v_xor_b32 v60, 128, v21
    v_add_u32 v60, v60, v16
    s_waitcnt lgkmcnt(14)
    ds_write_b64 v60, v[56:57] offset:8192
    v_cvt_pk_bf16_f32 v58, v36, v37
    v_cvt_pk_bf16_f32 v59, v38, v39
    v_xor_b32 v61, 144, v21
    v_add_u32 v61, v61, v16
    s_waitcnt lgkmcnt(14)
    ds_write_b64 v61, v[58:59] offset:8192
    v_cvt_pk_bf16_f32 v56, v40, v41
    v_cvt_pk_bf16_f32 v57, v42, v43
    v_xor_b32 v60, 160, v21
    v_add_u32 v60, v60, v16
    s_waitcnt lgkmcnt(14)
    ds_write_b64 v60, v[56:57] offset:8192
    v_cvt_pk_bf16_f32 v58, v44, v45
    v_cvt_pk_bf16_f32 v59, v46, v47
    v_xor_b32 v61, 176, v21
    v_add_u32 v61, v61, v16
    s_waitcnt lgkmcnt(14)
    ds_write_b64 v61, v[58:59] offset:8192
    v_accvgpr_read_b32 v32, a112
    v_accvgpr_read_b32 v33, a113
    v_accvgpr_read_b32 v34, a114
    v_accvgpr_read_b32 v35, a115
    v_accvgpr_read_b32 v36, a116
    v_accvgpr_read_b32 v37, a117
    v_accvgpr_read_b32 v38, a118
    v_accvgpr_read_b32 v39, a119
    v_accvgpr_read_b32 v40, a120
    v_accvgpr_read_b32 v41, a121
    v_accvgpr_read_b32 v42, a122
    v_accvgpr_read_b32 v43, a123
    v_accvgpr_read_b32 v44, a124
    v_accvgpr_read_b32 v45, a125
    v_accvgpr_read_b32 v46, a126
    v_accvgpr_read_b32 v47, a127
    v_cvt_pk_bf16_f32 v56, v32, v33
    v_cvt_pk_bf16_f32 v57, v34, v35
    v_xor_b32 v60, 192, v21
    v_add_u32 v60, v60, v16
    s_waitcnt lgkmcnt(14)
    ds_write_b64 v60, v[56:57] offset:8192
    v_cvt_pk_bf16_f32 v58, v36, v37
    v_cvt_pk_bf16_f32 v59, v38, v39
    v_xor_b32 v61, 208, v21
    v_add_u32 v61, v61, v16
    s_waitcnt lgkmcnt(14)
    ds_write_b64 v61, v[58:59] offset:8192
    v_cvt_pk_bf16_f32 v56, v40, v41
    v_cvt_pk_bf16_f32 v57, v42, v43
    v_xor_b32 v60, 224, v21
    v_add_u32 v60, v60, v16
    s_waitcnt lgkmcnt(14)
    ds_write_b64 v60, v[56:57] offset:8192
    v_cvt_pk_bf16_f32 v58, v44, v45
    v_cvt_pk_bf16_f32 v59, v46, v47
    v_xor_b32 v61, 240, v21
    v_add_u32 v61, v61, v16
    s_waitcnt lgkmcnt(14)
    ds_write_b64 v61, v[58:59] offset:8192
    s_waitcnt lgkmcnt(0)
    v_xor_b32 v62, 0, v17
    ds_read_b128 v[96:99], v62 offset:0
    v_xor_b32 v63, 64, v17
    ds_read_b128 v[100:103], v63 offset:1024
    v_xor_b32 v62, 128, v17
    ds_read_b128 v[104:107], v62 offset:2048
    v_xor_b32 v63, 192, v17
    ds_read_b128 v[108:111], v63 offset:3072
    v_xor_b32 v62, 0, v17
    ds_read_b128 v[112:115], v62 offset:4096
    v_xor_b32 v63, 64, v17
    ds_read_b128 v[116:119], v63 offset:5120
    v_xor_b32 v62, 128, v17
    ds_read_b128 v[120:123], v62 offset:6144
    v_xor_b32 v63, 192, v17
    ds_read_b128 v[124:127], v63 offset:7168
    s_waitcnt lgkmcnt(7)
    buffer_store_dwordx4 v[96:99], v20, s[40:43], s56 offen sc1
    s_add_u32 s56, s56, s57
    s_waitcnt lgkmcnt(6)
    buffer_store_dwordx4 v[100:103], v20, s[40:43], s56 offen sc1
    s_add_u32 s56, s56, s57
    s_waitcnt lgkmcnt(5)
    buffer_store_dwordx4 v[104:107], v20, s[40:43], s56 offen sc1
    s_add_u32 s56, s56, s57
    s_waitcnt lgkmcnt(4)
    buffer_store_dwordx4 v[108:111], v20, s[40:43], s56 offen sc1
    s_add_u32 s56, s56, s57
    s_waitcnt lgkmcnt(3)
    buffer_store_dwordx4 v[112:115], v20, s[40:43], s56 offen sc1
    s_add_u32 s56, s56, s57
    s_waitcnt lgkmcnt(2)
    buffer_store_dwordx4 v[116:119], v20, s[40:43], s56 offen sc1
    s_add_u32 s56, s56, s57
    s_waitcnt lgkmcnt(1)
    buffer_store_dwordx4 v[120:123], v20, s[40:43], s56 offen sc1
    s_add_u32 s56, s56, s57
    s_waitcnt lgkmcnt(0)
    buffer_store_dwordx4 v[124:127], v20, s[40:43], s56 offen sc1
    s_add_u32 s56, s56, s57
    v_xor_b32 v62, 0, v17
    ds_read_b128 v[96:99], v62 offset:8192
    v_xor_b32 v63, 64, v17
    ds_read_b128 v[100:103], v63 offset:9216
    v_xor_b32 v62, 128, v17
    ds_read_b128 v[104:107], v62 offset:10240
    v_xor_b32 v63, 192, v17
    ds_read_b128 v[108:111], v63 offset:11264
    v_xor_b32 v62, 0, v17
    ds_read_b128 v[112:115], v62 offset:12288
    v_xor_b32 v63, 64, v17
    ds_read_b128 v[116:119], v63 offset:13312
    v_xor_b32 v62, 128, v17
    ds_read_b128 v[120:123], v62 offset:14336
    v_xor_b32 v63, 192, v17
    ds_read_b128 v[124:127], v63 offset:15360
    s_waitcnt lgkmcnt(7)
    buffer_store_dwordx4 v[96:99], v20, s[40:43], s56 offen sc1
    s_add_u32 s56, s56, s57
    s_waitcnt lgkmcnt(6)
    buffer_store_dwordx4 v[100:103], v20, s[40:43], s56 offen sc1
    s_add_u32 s56, s56, s57
    s_waitcnt lgkmcnt(5)
    buffer_store_dwordx4 v[104:107], v20, s[40:43], s56 offen sc1
    s_add_u32 s56, s56, s57
    s_waitcnt lgkmcnt(4)
    buffer_store_dwordx4 v[108:111], v20, s[40:43], s56 offen sc1
    s_add_u32 s56, s56, s57
    s_waitcnt lgkmcnt(3)
    buffer_store_dwordx4 v[112:115], v20, s[40:43], s56 offen sc1
    s_add_u32 s56, s56, s57
    s_waitcnt lgkmcnt(2)
    buffer_store_dwordx4 v[116:119], v20, s[40:43], s56 offen sc1
    s_add_u32 s56, s56, s57
    s_waitcnt lgkmcnt(1)
    buffer_store_dwordx4 v[120:123], v20, s[40:43], s56 offen sc1
    s_add_u32 s56, s56, s57
    s_waitcnt lgkmcnt(0)
    buffer_store_dwordx4 v[124:127], v20, s[40:43], s56 offen sc1
    s_add_u32 s56, s56, s57
    s_waitcnt lgkmcnt(0)
    v_accvgpr_read_b32 v32, a128
    v_accvgpr_read_b32 v33, a129
    v_accvgpr_read_b32 v34, a130
    v_accvgpr_read_b32 v35, a131
    v_accvgpr_read_b32 v36, a132
    v_accvgpr_read_b32 v37, a133
    v_accvgpr_read_b32 v38, a134
    v_accvgpr_read_b32 v39, a135
    v_accvgpr_read_b32 v40, a136
    v_accvgpr_read_b32 v41, a137
    v_accvgpr_read_b32 v42, a138
    v_accvgpr_read_b32 v43, a139
    v_accvgpr_read_b32 v44, a140
    v_accvgpr_read_b32 v45, a141
    v_accvgpr_read_b32 v46, a142
    v_accvgpr_read_b32 v47, a143
    v_cvt_pk_bf16_f32 v56, v32, v33
    v_cvt_pk_bf16_f32 v57, v34, v35
    v_xor_b32 v60, 0, v21
    v_add_u32 v60, v60, v16
    ds_write_b64 v60, v[56:57] offset:0
    v_cvt_pk_bf16_f32 v58, v36, v37
    v_cvt_pk_bf16_f32 v59, v38, v39
    v_xor_b32 v61, 16, v21
    v_add_u32 v61, v61, v16
    ds_write_b64 v61, v[58:59] offset:0
    v_cvt_pk_bf16_f32 v56, v40, v41
    v_cvt_pk_bf16_f32 v57, v42, v43
    v_xor_b32 v60, 32, v21
    v_add_u32 v60, v60, v16
    ds_write_b64 v60, v[56:57] offset:0
    v_cvt_pk_bf16_f32 v58, v44, v45
    v_cvt_pk_bf16_f32 v59, v46, v47
    v_xor_b32 v61, 48, v21
    v_add_u32 v61, v61, v16
    ds_write_b64 v61, v[58:59] offset:0
    v_accvgpr_read_b32 v32, a144
    v_accvgpr_read_b32 v33, a145
    v_accvgpr_read_b32 v34, a146
    v_accvgpr_read_b32 v35, a147
    v_accvgpr_read_b32 v36, a148
    v_accvgpr_read_b32 v37, a149
    v_accvgpr_read_b32 v38, a150
    v_accvgpr_read_b32 v39, a151
    v_accvgpr_read_b32 v40, a152
    v_accvgpr_read_b32 v41, a153
    v_accvgpr_read_b32 v42, a154
    v_accvgpr_read_b32 v43, a155
    v_accvgpr_read_b32 v44, a156
    v_accvgpr_read_b32 v45, a157
    v_accvgpr_read_b32 v46, a158
    v_accvgpr_read_b32 v47, a159
    v_cvt_pk_bf16_f32 v56, v32, v33
    v_cvt_pk_bf16_f32 v57, v34, v35
    v_xor_b32 v60, 64, v21
    v_add_u32 v60, v60, v16
    ds_write_b64 v60, v[56:57] offset:0
    v_cvt_pk_bf16_f32 v58, v36, v37
    v_cvt_pk_bf16_f32 v59, v38, v39
    v_xor_b32 v61, 80, v21
    v_add_u32 v61, v61, v16
    ds_write_b64 v61, v[58:59] offset:0
    v_cvt_pk_bf16_f32 v56, v40, v41
    v_cvt_pk_bf16_f32 v57, v42, v43
    v_xor_b32 v60, 96, v21
    v_add_u32 v60, v60, v16
    ds_write_b64 v60, v[56:57] offset:0
    v_cvt_pk_bf16_f32 v58, v44, v45
    v_cvt_pk_bf16_f32 v59, v46, v47
    v_xor_b32 v61, 112, v21
    v_add_u32 v61, v61, v16
    ds_write_b64 v61, v[58:59] offset:0
    v_accvgpr_read_b32 v32, a160
    v_accvgpr_read_b32 v33, a161
    v_accvgpr_read_b32 v34, a162
    v_accvgpr_read_b32 v35, a163
    v_accvgpr_read_b32 v36, a164
    v_accvgpr_read_b32 v37, a165
    v_accvgpr_read_b32 v38, a166
    v_accvgpr_read_b32 v39, a167
    v_accvgpr_read_b32 v40, a168
    v_accvgpr_read_b32 v41, a169
    v_accvgpr_read_b32 v42, a170
    v_accvgpr_read_b32 v43, a171
    v_accvgpr_read_b32 v44, a172
    v_accvgpr_read_b32 v45, a173
    v_accvgpr_read_b32 v46, a174
    v_accvgpr_read_b32 v47, a175
    v_cvt_pk_bf16_f32 v56, v32, v33
    v_cvt_pk_bf16_f32 v57, v34, v35
    v_xor_b32 v60, 128, v21
    v_add_u32 v60, v60, v16
    ds_write_b64 v60, v[56:57] offset:0
    v_cvt_pk_bf16_f32 v58, v36, v37
    v_cvt_pk_bf16_f32 v59, v38, v39
    v_xor_b32 v61, 144, v21
    v_add_u32 v61, v61, v16
    ds_write_b64 v61, v[58:59] offset:0
    v_cvt_pk_bf16_f32 v56, v40, v41
    v_cvt_pk_bf16_f32 v57, v42, v43
    v_xor_b32 v60, 160, v21
    v_add_u32 v60, v60, v16
    ds_write_b64 v60, v[56:57] offset:0
    v_cvt_pk_bf16_f32 v58, v44, v45
    v_cvt_pk_bf16_f32 v59, v46, v47
    v_xor_b32 v61, 176, v21
    v_add_u32 v61, v61, v16
    ds_write_b64 v61, v[58:59] offset:0
    v_accvgpr_read_b32 v32, a176
    v_accvgpr_read_b32 v33, a177
    v_accvgpr_read_b32 v34, a178
    v_accvgpr_read_b32 v35, a179
    v_accvgpr_read_b32 v36, a180
    v_accvgpr_read_b32 v37, a181
    v_accvgpr_read_b32 v38, a182
    v_accvgpr_read_b32 v39, a183
    v_accvgpr_read_b32 v40, a184
    v_accvgpr_read_b32 v41, a185
    v_accvgpr_read_b32 v42, a186
    v_accvgpr_read_b32 v43, a187
    v_accvgpr_read_b32 v44, a188
    v_accvgpr_read_b32 v45, a189
    v_accvgpr_read_b32 v46, a190
    v_accvgpr_read_b32 v47, a191
    v_cvt_pk_bf16_f32 v56, v32, v33
    v_cvt_pk_bf16_f32 v57, v34, v35
    v_xor_b32 v60, 192, v21
    v_add_u32 v60, v60, v16
    ds_write_b64 v60, v[56:57] offset:0
    v_cvt_pk_bf16_f32 v58, v36, v37
    v_cvt_pk_bf16_f32 v59, v38, v39
    v_xor_b32 v61, 208, v21
    v_add_u32 v61, v61, v16
    ds_write_b64 v61, v[58:59] offset:0
    v_cvt_pk_bf16_f32 v56, v40, v41
    v_cvt_pk_bf16_f32 v57, v42, v43
    v_xor_b32 v60, 224, v21
    v_add_u32 v60, v60, v16
    ds_write_b64 v60, v[56:57] offset:0
    v_cvt_pk_bf16_f32 v58, v44, v45
    v_cvt_pk_bf16_f32 v59, v46, v47
    v_xor_b32 v61, 240, v21
    v_add_u32 v61, v61, v16
    s_waitcnt lgkmcnt(14)
    ds_write_b64 v61, v[58:59] offset:0
    v_accvgpr_read_b32 v32, a192
    v_accvgpr_read_b32 v33, a193
    v_accvgpr_read_b32 v34, a194
    v_accvgpr_read_b32 v35, a195
    v_accvgpr_read_b32 v36, a196
    v_accvgpr_read_b32 v37, a197
    v_accvgpr_read_b32 v38, a198
    v_accvgpr_read_b32 v39, a199
    v_accvgpr_read_b32 v40, a200
    v_accvgpr_read_b32 v41, a201
    v_accvgpr_read_b32 v42, a202
    v_accvgpr_read_b32 v43, a203
    v_accvgpr_read_b32 v44, a204
    v_accvgpr_read_b32 v45, a205
    v_accvgpr_read_b32 v46, a206
    v_accvgpr_read_b32 v47, a207
    v_cvt_pk_bf16_f32 v56, v32, v33
    v_cvt_pk_bf16_f32 v57, v34, v35
    v_xor_b32 v60, 0, v21
    v_add_u32 v60, v60, v16
    s_waitcnt lgkmcnt(14)
    ds_write_b64 v60, v[56:57] offset:8192
    v_cvt_pk_bf16_f32 v58, v36, v37
    v_cvt_pk_bf16_f32 v59, v38, v39
    v_xor_b32 v61, 16, v21
    v_add_u32 v61, v61, v16
    s_waitcnt lgkmcnt(14)
    ds_write_b64 v61, v[58:59] offset:8192
    v_cvt_pk_bf16_f32 v56, v40, v41
    v_cvt_pk_bf16_f32 v57, v42, v43
    v_xor_b32 v60, 32, v21
    v_add_u32 v60, v60, v16
    s_waitcnt lgkmcnt(14)
    ds_write_b64 v60, v[56:57] offset:8192
    v_cvt_pk_bf16_f32 v58, v44, v45
    v_cvt_pk_bf16_f32 v59, v46, v47
    v_xor_b32 v61, 48, v21
    v_add_u32 v61, v61, v16
    s_waitcnt lgkmcnt(14)
    ds_write_b64 v61, v[58:59] offset:8192
    v_accvgpr_read_b32 v32, a208
    v_accvgpr_read_b32 v33, a209
    v_accvgpr_read_b32 v34, a210
    v_accvgpr_read_b32 v35, a211
    v_accvgpr_read_b32 v36, a212
    v_accvgpr_read_b32 v37, a213
    v_accvgpr_read_b32 v38, a214
    v_accvgpr_read_b32 v39, a215
    v_accvgpr_read_b32 v40, a216
    v_accvgpr_read_b32 v41, a217
    v_accvgpr_read_b32 v42, a218
    v_accvgpr_read_b32 v43, a219
    v_accvgpr_read_b32 v44, a220
    v_accvgpr_read_b32 v45, a221
    v_accvgpr_read_b32 v46, a222
    v_accvgpr_read_b32 v47, a223
    v_cvt_pk_bf16_f32 v56, v32, v33
    v_cvt_pk_bf16_f32 v57, v34, v35
    v_xor_b32 v60, 64, v21
    v_add_u32 v60, v60, v16
    s_waitcnt lgkmcnt(14)
    ds_write_b64 v60, v[56:57] offset:8192
    v_cvt_pk_bf16_f32 v58, v36, v37
    v_cvt_pk_bf16_f32 v59, v38, v39
    v_xor_b32 v61, 80, v21
    v_add_u32 v61, v61, v16
    s_waitcnt lgkmcnt(14)
    ds_write_b64 v61, v[58:59] offset:8192
    v_cvt_pk_bf16_f32 v56, v40, v41
    v_cvt_pk_bf16_f32 v57, v42, v43
    v_xor_b32 v60, 96, v21
    v_add_u32 v60, v60, v16
    s_waitcnt lgkmcnt(14)
    ds_write_b64 v60, v[56:57] offset:8192
    v_cvt_pk_bf16_f32 v58, v44, v45
    v_cvt_pk_bf16_f32 v59, v46, v47
    v_xor_b32 v61, 112, v21
    v_add_u32 v61, v61, v16
    s_waitcnt lgkmcnt(14)
    ds_write_b64 v61, v[58:59] offset:8192
    v_accvgpr_read_b32 v32, a224
    v_accvgpr_read_b32 v33, a225
    v_accvgpr_read_b32 v34, a226
    v_accvgpr_read_b32 v35, a227
    v_accvgpr_read_b32 v36, a228
    v_accvgpr_read_b32 v37, a229
    v_accvgpr_read_b32 v38, a230
    v_accvgpr_read_b32 v39, a231
    v_accvgpr_read_b32 v40, a232
    v_accvgpr_read_b32 v41, a233
    v_accvgpr_read_b32 v42, a234
    v_accvgpr_read_b32 v43, a235
    v_accvgpr_read_b32 v44, a236
    v_accvgpr_read_b32 v45, a237
    v_accvgpr_read_b32 v46, a238
    v_accvgpr_read_b32 v47, a239
    v_cvt_pk_bf16_f32 v56, v32, v33
    v_cvt_pk_bf16_f32 v57, v34, v35
    v_xor_b32 v60, 128, v21
    v_add_u32 v60, v60, v16
    s_waitcnt lgkmcnt(14)
    ds_write_b64 v60, v[56:57] offset:8192
    v_cvt_pk_bf16_f32 v58, v36, v37
    v_cvt_pk_bf16_f32 v59, v38, v39
    v_xor_b32 v61, 144, v21
    v_add_u32 v61, v61, v16
    s_waitcnt lgkmcnt(14)
    ds_write_b64 v61, v[58:59] offset:8192
    v_cvt_pk_bf16_f32 v56, v40, v41
    v_cvt_pk_bf16_f32 v57, v42, v43
    v_xor_b32 v60, 160, v21
    v_add_u32 v60, v60, v16
    s_waitcnt lgkmcnt(14)
    ds_write_b64 v60, v[56:57] offset:8192
    v_cvt_pk_bf16_f32 v58, v44, v45
    v_cvt_pk_bf16_f32 v59, v46, v47
    v_xor_b32 v61, 176, v21
    v_add_u32 v61, v61, v16
    s_waitcnt lgkmcnt(14)
    ds_write_b64 v61, v[58:59] offset:8192
    v_accvgpr_read_b32 v32, a240
    v_accvgpr_read_b32 v33, a241
    v_accvgpr_read_b32 v34, a242
    v_accvgpr_read_b32 v35, a243
    v_accvgpr_read_b32 v36, a244
    v_accvgpr_read_b32 v37, a245
    v_accvgpr_read_b32 v38, a246
    v_accvgpr_read_b32 v39, a247
    v_accvgpr_read_b32 v40, a248
    v_accvgpr_read_b32 v41, a249
    v_accvgpr_read_b32 v42, a250
    v_accvgpr_read_b32 v43, a251
    v_accvgpr_read_b32 v44, a252
    v_accvgpr_read_b32 v45, a253
    v_accvgpr_read_b32 v46, a254
    v_accvgpr_read_b32 v47, a255
    v_cvt_pk_bf16_f32 v56, v32, v33
    v_cvt_pk_bf16_f32 v57, v34, v35
    v_xor_b32 v60, 192, v21
    v_add_u32 v60, v60, v16
    s_waitcnt lgkmcnt(14)
    ds_write_b64 v60, v[56:57] offset:8192
    v_cvt_pk_bf16_f32 v58, v36, v37
    v_cvt_pk_bf16_f32 v59, v38, v39
    v_xor_b32 v61, 208, v21
    v_add_u32 v61, v61, v16
    s_waitcnt lgkmcnt(14)
    ds_write_b64 v61, v[58:59] offset:8192
    v_cvt_pk_bf16_f32 v56, v40, v41
    v_cvt_pk_bf16_f32 v57, v42, v43
    v_xor_b32 v60, 224, v21
    v_add_u32 v60, v60, v16
    s_waitcnt lgkmcnt(14)
    ds_write_b64 v60, v[56:57] offset:8192
    v_cvt_pk_bf16_f32 v58, v44, v45
    v_cvt_pk_bf16_f32 v59, v46, v47
    v_xor_b32 v61, 240, v21
    v_add_u32 v61, v61, v16
    s_waitcnt lgkmcnt(14)
    ds_write_b64 v61, v[58:59] offset:8192
    s_waitcnt lgkmcnt(0)
    v_xor_b32 v62, 0, v17
    ds_read_b128 v[96:99], v62 offset:0
    v_xor_b32 v63, 64, v17
    ds_read_b128 v[100:103], v63 offset:1024
    v_xor_b32 v62, 128, v17
    ds_read_b128 v[104:107], v62 offset:2048
    v_xor_b32 v63, 192, v17
    ds_read_b128 v[108:111], v63 offset:3072
    v_xor_b32 v62, 0, v17
    ds_read_b128 v[112:115], v62 offset:4096
    v_xor_b32 v63, 64, v17
    ds_read_b128 v[116:119], v63 offset:5120
    v_xor_b32 v62, 128, v17
    ds_read_b128 v[120:123], v62 offset:6144
    v_xor_b32 v63, 192, v17
    ds_read_b128 v[124:127], v63 offset:7168
    s_waitcnt lgkmcnt(7)
    buffer_store_dwordx4 v[96:99], v20, s[40:43], s56 offen sc1
    s_add_u32 s56, s56, s57
    s_waitcnt lgkmcnt(6)
    buffer_store_dwordx4 v[100:103], v20, s[40:43], s56 offen sc1
    s_add_u32 s56, s56, s57
    s_waitcnt lgkmcnt(5)
    buffer_store_dwordx4 v[104:107], v20, s[40:43], s56 offen sc1
    s_add_u32 s56, s56, s57
    s_waitcnt lgkmcnt(4)
    buffer_store_dwordx4 v[108:111], v20, s[40:43], s56 offen sc1
    s_add_u32 s56, s56, s57
    s_waitcnt lgkmcnt(3)
    buffer_store_dwordx4 v[112:115], v20, s[40:43], s56 offen sc1
    s_add_u32 s56, s56, s57
    s_waitcnt lgkmcnt(2)
    buffer_store_dwordx4 v[116:119], v20, s[40:43], s56 offen sc1
    s_add_u32 s56, s56, s57
    s_waitcnt lgkmcnt(1)
    buffer_store_dwordx4 v[120:123], v20, s[40:43], s56 offen sc1
    s_add_u32 s56, s56, s57
    s_waitcnt lgkmcnt(0)
    buffer_store_dwordx4 v[124:127], v20, s[40:43], s56 offen sc1
    s_add_u32 s56, s56, s57
    v_xor_b32 v62, 0, v17
    ds_read_b128 v[96:99], v62 offset:8192
    v_xor_b32 v63, 64, v17
    ds_read_b128 v[100:103], v63 offset:9216
    v_xor_b32 v62, 128, v17
    ds_read_b128 v[104:107], v62 offset:10240
    v_xor_b32 v63, 192, v17
    ds_read_b128 v[108:111], v63 offset:11264
    v_xor_b32 v62, 0, v17
    ds_read_b128 v[112:115], v62 offset:12288
    v_xor_b32 v63, 64, v17
    ds_read_b128 v[116:119], v63 offset:13312
    v_xor_b32 v62, 128, v17
    ds_read_b128 v[120:123], v62 offset:14336
    v_xor_b32 v63, 192, v17
    ds_read_b128 v[124:127], v63 offset:15360
    s_waitcnt lgkmcnt(7)
    buffer_store_dwordx4 v[96:99], v20, s[40:43], s56 offen sc1
    s_add_u32 s56, s56, s57
    s_waitcnt lgkmcnt(6)
    buffer_store_dwordx4 v[100:103], v20, s[40:43], s56 offen sc1
    s_add_u32 s56, s56, s57
    s_waitcnt lgkmcnt(5)
    buffer_store_dwordx4 v[104:107], v20, s[40:43], s56 offen sc1
    s_add_u32 s56, s56, s57
    s_waitcnt lgkmcnt(4)
    buffer_store_dwordx4 v[108:111], v20, s[40:43], s56 offen sc1
    s_add_u32 s56, s56, s57
    s_waitcnt lgkmcnt(3)
    buffer_store_dwordx4 v[112:115], v20, s[40:43], s56 offen sc1
    s_add_u32 s56, s56, s57
    s_waitcnt lgkmcnt(2)
    buffer_store_dwordx4 v[116:119], v20, s[40:43], s56 offen sc1
    s_add_u32 s56, s56, s57
    s_waitcnt lgkmcnt(1)
    buffer_store_dwordx4 v[120:123], v20, s[40:43], s56 offen sc1
    s_add_u32 s56, s56, s57
    s_waitcnt lgkmcnt(0)
    buffer_store_dwordx4 v[124:127], v20, s[40:43], s56 offen sc1
    s_add_u32 s56, s56, s57
    s_waitcnt lgkmcnt(0)
L_eskip_k:
    s_waitcnt vmcnt(0)
    s_barrier
    s_cmp_lg_u32 s27, 0
    s_cbranch_scc1 L_sgk_s
    s_cmp_lg_u32 s93, 0
    s_cbranch_scc1 L_sgk_i
    s_mov_b32 s82, 0
L_sgk_ip:
    buffer_load_dword v31, off, s[12:15], 0 offset:128 sc1
    s_add_u32 s82, s82, 1
    s_cmp_gt_u32 s82, 0x200000
    s_cbranch_scc1 L_wbail
    s_waitcnt vmcnt(0)
    v_cmp_eq_u32 vcc, 0, v31
    s_cbranch_vccnz L_sgk_ip
    s_mov_b32 s93, 1
L_sgk_i:
    v_mov_b32 v31, s90
    s_mov_b64 exec, 1
    buffer_atomic_add v31, off, s[4:7], s85
    s_mov_b64 exec, -1
L_sgk_s:
    s_add_u32 s89, s89, 1
    s_branch L_fetch
L_task_v:
    v_and_b32 v14, 31, v1
    v_bfe_u32 v15, v1, 1, 3
    v_lshrrev_b32 v16, 5, v1
    v_xor_b32 v15, v15, v16
    v_lshlrev_b32 v14, 7, v14
    s_mul_i32 s55, s58, 16384
    v_add_u32 v14, s55, v14
    v_xor_b32 v16, 0, v15
    v_lshl_add_u32 v2, v16, 4, v14
    v_xor_b32 v16, 2, v15
    v_lshl_add_u32 v3, v16, 4, v14
    v_xor_b32 v16, 4, v15
    v_lshl_add_u32 v4, v16, 4, v14
    v_xor_b32 v16, 6, v15
    v_lshl_add_u32 v5, v16, 4, v14
    v_lshrrev_b32 v14, 5, v1
    v_lshlrev_b32 v14, 3, v14
    v_bfe_u32 v15, v1, 2, 2
    v_add_u32 v14, v14, v15
    v_lshlrev_b32 v14, 9, v14
    v_bfe_u32 v16, v1, 4, 1
    v_lshl_or_b32 v14, v16, 5, v14
    v_bfe_u32 v16, v1, 1, 1
    v_lshl_or_b32 v14, v16, 4, v14
    v_and_b32 v16, 1, v1
    v_lshl_or_b32 v14, v16, 3, v14
    s_lshl_b32 s55, s59, 8
    s_add_u32 s55, s55, 32768
    v_add_u32 v14, s55, v14
    v_xor_b32 v16, 0, v15
    v_lshl_add_u32 v6, v16, 6, v14
    v_xor_b32 v16, 1, v15
    v_lshl_add_u32 v7, v16, 6, v14
    v_xor_b32 v16, 2, v15
    v_lshl_add_u32 v8, v16, 6, v14
    v_xor_b32 v16, 3, v15
    v_lshl_add_u32 v9, v16, 6, v14
    v_lshrrev_b32 v14, 3, v1
    v_mul_lo_u32 v14, v14, s44
    v_and_b32 v15, 7, v1
    v_bfe_u32 v16, v1, 4, 2
    v_xor_b32 v15, v15, v16
    v_lshl_add_u32 v10, v15, 4, v14
    v_xor_b32 v15, 4, v15
    v_lshl_add_u32 v11, v15, 4, v14
    v_lshrrev_b32 v16, 5, v1
    v_mul_lo_u32 v14, v16, s45
    v_and_b32 v15, 31, v1
    v_lshlrev_b32 v16, 2, v16
    v_xor_b32 v15, v15, v16
    v_lshl_add_u32 v12, v15, 4, v14
    v_xor_b32 v15, 8, v15
    v_lshl_add_u32 v13, v15, 4, v14
    s_mov_b32 s10, s66
    s_mov_b32 s38, s67
    s_lshl_b32 s57, s44, 3
    s_lshl_b32 s61, s45, 1
    s_mul_i32 s52, s44, s27
    s_mul_i32 s52, s52, 64
    s_add_u32 s52, s52, s47
    s_mul_i32 s53, s45, s27
    s_lshl_b32 s53, s53, 4
    s_add_u32 s53, s53, s48
    s_lshl_b32 s54, s27, 13
    s_mul_i32 s65, s27, 8192
    s_mov_b32 s55, s52
    s_add_u32 m0, s65, 0
    s_nop 0
    buffer_load_dwordx4 v10, s[8:11], s55 offen sc1 lds
    s_add_u32 s55, s55, s57
    s_add_u32 m0, s65, 1024
    s_nop 0
    buffer_load_dwordx4 v11, s[8:11], s55 offen sc1 lds
    s_add_u32 s55, s55, s57
    s_add_u32 m0, s65, 2048
    s_nop 0
    buffer_load_dwordx4 v10, s[8:11], s55 offen sc1 lds
    s_add_u32 s55, s55, s57
    s_add_u32 m0, s65, 3072
    s_nop 0
    buffer_load_dwordx4 v11, s[8:11], s55 offen sc1 lds
    s_add_u32 s55, s55, s57
    s_add_u32 m0, s65, 4096
    s_nop 0
    buffer_load_dwordx4 v10, s[8:11], s55 offen sc1 lds
    s_add_u32 s55, s55, s57
    s_add_u32 m0, s65, 5120
    s_nop 0
    buffer_load_dwordx4 v11, s[8:11], s55 offen sc1 lds
    s_add_u32 s55, s55, s57
    s_add_u32 m0, s65, 6144
    s_nop 0
    buffer_load_dwordx4 v10, s[8:11], s55 offen sc1 lds
    s_add_u32 s55, s55, s57
    s_add_u32 m0, s65, 7168
    s_nop 0
    buffer_load_dwordx4 v11, s[8:11], s55 offen sc1 lds
    s_mov_b32 s56, s53
    s_add_u32 m0, s54, 32768
    s_nop 0
    buffer_load_dwordx4 v12, s[36:39], s56 offen lds
    s_add_u32 s56, s56, s61
    s_add_u32 m0, s54, 33792
    s_nop 0
    buffer_load_dwordx4 v13, s[36:39], s56 offen lds
    s_add_u32 s56, s56, s61
    s_add_u32 m0, s54, 34816
    s_nop 0
    buffer_load_dwordx4 v12, s[36:39], s56 offen lds
    s_add_u32 s56, s56, s61
    s_add_u32 m0, s54, 35840
    s_nop 0
    buffer_load_dwordx4 v13, s[36:39], s56 offen lds
    s_add_u32 s56, s56, s61
    s_add_u32 m0, s54, 36864
    s_nop 0
    buffer_load_dwordx4 v12, s[36:39], s56 offen lds
    s_add_u32 s56, s56, s61
    s_add_u32 m0, s54, 37888
    s_nop 0
    buffer_load_dwordx4 v13, s[36:39], s56 offen lds
    s_add_u32 s56, s56, s61
    s_add_u32 m0, s54, 38912
    s_nop 0
    buffer_load_dwordx4 v12, s[36:39], s56 offen lds
    s_add_u32 s56, s56, s61
    s_add_u32 m0, s54, 39936
    s_nop 0
    buffer_load_dwordx4 v13, s[36:39], s56 offen lds
    s_add_u32 s52, s52, 128
    s_lshl_b32 s62, s45, 6
    s_add_u32 s53, s53, s62
    s_xor_b32 s54, s54, 0x10000
    s_xor_b32 s65, s65, 0x10000
    s_mov_b32 s63, 0
    v_accvgpr_write_b32 a0, 0
    v_accvgpr_write_b32 a1, 0
    v_accvgpr_write_b32 a2, 0
    v_accvgpr_write_b32 a3, 0
    v_accvgpr_write_b32 a4, 0
    v_accvgpr_write_b32 a5, 0
    v_accvgpr_write_b32 a6, 0
    v_accvgpr_write_b32 a7, 0
    v_accvgpr_write_b32 a8, 0
    v_accvgpr_write_b32 a9, 0
    v_accvgpr_write_b32 a10, 0
    v_accvgpr_write_b32 a11, 0
    v_accvgpr_write_b32 a12, 0
    v_accvgpr_write_b32 a13, 0
    v_accvgpr_write_b32 a14, 0
    v_accvgpr_write_b32 a15, 0
    v_accvgpr_write_b32 a16, 0
    v_accvgpr_write_b32 a17, 0
    v_accvgpr_write_b32 a18, 0
    v_accvgpr_write_b32 a19, 0
    v_accvgpr_write_b32 a20, 0
    v_accvgpr_write_b32 a21, 0
    v_accvgpr_write_b32 a22, 0
    v_accvgpr_write_b32 a23, 0
    v_accvgpr_write_b32 a24, 0
    v_accvgpr_write_b32 a25, 0
    v_accvgpr_write_b32 a26, 0
    v_accvgpr_write_b32 a27, 0
    v_accvgpr_write_b32 a28, 0
    v_accvgpr_write_b32 a29, 0
    v_accvgpr_write_b32 a30, 0
    v_accvgpr_write_b32 a31, 0
    v_accvgpr_write_b32 a32, 0
    v_accvgpr_write_b32 a33, 0
    v_accvgpr_write_b32 a34, 0
    v_accvgpr_write_b32 a35, 0
    v_accvgpr_write_b32 a36, 0
    v_accvgpr_write_b32 a37, 0
    v_accvgpr_write_b32 a38, 0
    v_accvgpr_write_b32 a39, 0
    v_accvgpr_write_b32 a40, 0
    v_accvgpr_write_b32 a41, 0
    v_accvgpr_write_b32 a42, 0
    v_accvgpr_write_b32 a43, 0
    v_accvgpr_write_b32 a44, 0
    v_accvgpr_write_b32 a45, 0
    v_accvgpr_write_b32 a46, 0
    v_accvgpr_write_b32 a47, 0
    v_accvgpr_write_b32 a48, 0
    v_accvgpr_write_b32 a49, 0
    v_accvgpr_write_b32 a50, 0
    v_accvgpr_write_b32 a51, 0
    v_accvgpr_write_b32 a52, 0
    v_accvgpr_write_b32 a53, 0
    v_accvgpr_write_b32 a54, 0
    v_accvgpr_write_b32 a55, 0
    v_accvgpr_write_b32 a56, 0
    v_accvgpr_write_b32 a57, 0
    v_accvgpr_write_b32 a58, 0
    v_accvgpr_write_b32 a59, 0
    v_accvgpr_write_b32 a60, 0
    v_accvgpr_write_b32 a61, 0
    v_accvgpr_write_b32 a62, 0
    v_accvgpr_write_b32 a63, 0
    v_accvgpr_write_b32 a64, 0
    v_accvgpr_write_b32 a65, 0
    v_accvgpr_write_b32 a66, 0
    v_accvgpr_write_b32 a67, 0
    v_accvgpr_write_b32 a68, 0
    v_accvgpr_write_b32 a69, 0
    v_accvgpr_write_b32 a70, 0
    v_accvgpr_write_b32 a71, 0
    v_accvgpr_write_b32 a72, 0
    v_accvgpr_write_b32 a73, 0
    v_accvgpr_write_b32 a74, 0
    v_accvgpr_write_b32 a75, 0
    v_accvgpr_write_b32 a76, 0
    v_accvgpr_write_b32 a77, 0
    v_accvgpr_write_b32 a78, 0
    v_accvgpr_write_b32 a79, 0
    v_accvgpr_write_b32 a80, 0
    v_accvgpr_write_b32 a81, 0
    v_accvgpr_write_b32 a82, 0
    v_accvgpr_write_b32 a83, 0
    v_accvgpr_write_b32 a84, 0
    v_accvgpr_write_b32 a85, 0
    v_accvgpr_write_b32 a86, 0
    v_accvgpr_write_b32 a87, 0
    v_accvgpr_write_b32 a88, 0
    v_accvgpr_write_b32 a89, 0
    v_accvgpr_write_b32 a90, 0
    v_accvgpr_write_b32 a91, 0
    v_accvgpr_write_b32 a92, 0
    v_accvgpr_write_b32 a93, 0
    v_accvgpr_write_b32 a94, 0
    v_accvgpr_write_b32 a95, 0
    v_accvgpr_write_b32 a96, 0
    v_accvgpr_write_b32 a97, 0
    v_accvgpr_write_b32 a98, 0
    v_accvgpr_write_b32 a99, 0
    v_accvgpr_write_b32 a100, 0
    v_accvgpr_write_b32 a101, 0
    v_accvgpr_write_b32 a102, 0
    v_accvgpr_write_b32 a103, 0
    v_accvgpr_write_b32 a104, 0
    v_accvgpr_write_b32 a105, 0
    v_accvgpr_write_b32 a106, 0
    v_accvgpr_write_b32 a107, 0
    v_accvgpr_write_b32 a108, 0
    v_accvgpr_write_b32 a109, 0
    v_accvgpr_write_b32 a110, 0
    v_accvgpr_write_b32 a111, 0
    v_accvgpr_write_b32 a112, 0
    v_accvgpr_write_b32 a113, 0
    v_accvgpr_write_b32 a114, 0
    v_accvgpr_write_b32 a115, 0
    v_accvgpr_write_b32 a116, 0
    v_accvgpr_write_b32 a117, 0
    v_accvgpr_write_b32 a118, 0
    v_accvgpr_write_b32 a119, 0
    v_accvgpr_write_b32 a120, 0
    v_accvgpr_write_b32 a121, 0
    v_accvgpr_write_b32 a122, 0
    v_accvgpr_write_b32 a123, 0
    v_accvgpr_write_b32 a124, 0
    v_accvgpr_write_b32 a125, 0
    v_accvgpr_write_b32 a126, 0
    v_accvgpr_write_b32 a127, 0
    v_accvgpr_write_b32 a128, 0
    v_accvgpr_write_b32 a129, 0
    v_accvgpr_write_b32 a130, 0
    v_accvgpr_write_b32 a131, 0
    v_accvgpr_write_b32 a132, 0
    v_accvgpr_write_b32 a133, 0
    v_accvgpr_write_b32 a134, 0
    v_accvgpr_write_b32 a135, 0
    v_accvgpr_write_b32 a136, 0
    v_accvgpr_write_b32 a137, 0
    v_accvgpr_write_b32 a138, 0
    v_accvgpr_write_b32 a139, 0
    v_accvgpr_write_b32 a140, 0
    v_accvgpr_write_b32 a141, 0
    v_accvgpr_write_b32 a142, 0
    v_accvgpr_write_b32 a143, 0
    v_accvgpr_write_b32 a144, 0
    v_accvgpr_write_b32 a145, 0
    v_accvgpr_write_b32 a146, 0
    v_accvgpr_write_b32 a147, 0
    v_accvgpr_write_b32 a148, 0
    v_accvgpr_write_b32 a149, 0
    v_accvgpr_write_b32 a150, 0
    v_accvgpr_write_b32 a151, 0
    v_accvgpr_write_b32 a152, 0
    v_accvgpr_write_b32 a153, 0
    v_accvgpr_write_b32 a154, 0
    v_accvgpr_write_b32 a155, 0
    v_accvgpr_write_b32 a156, 0
    v_accvgpr_write_b32 a157, 0
    v_accvgpr_write_b32 a158, 0
    v_accvgpr_write_b32 a159, 0
    v_accvgpr_write_b32 a160, 0
    v_accvgpr_write_b32 a161, 0
    v_accvgpr_write_b32 a162, 0
    v_accvgpr_write_b32 a163, 0
    v_accvgpr_write_b32 a164, 0
    v_accvgpr_write_b32 a165, 0
    v_accvgpr_write_b32 a166, 0
    v_accvgpr_write_b32 a167, 0
    v_accvgpr_write_b32 a168, 0
    v_accvgpr_write_b32 a169, 0
    v_accvgpr_write_b32 a170, 0
    v_accvgpr_write_b32 a171, 0
    v_accvgpr_write_b32 a172, 0
    v_accvgpr_write_b32 a173, 0
    v_accvgpr_write_b32 a174, 0
    v_accvgpr_write_b32 a175, 0
    v_accvgpr_write_b32 a176, 0
    v_accvgpr_write_b32 a177, 0
    v_accvgpr_write_b32 a178, 0
    v_accvgpr_write_b32 a179, 0
    v_accvgpr_write_b32 a180, 0
    v_accvgpr_write_b32 a181, 0
    v_accvgpr_write_b32 a182, 0
    v_accvgpr_write_b32 a183, 0
    v_accvgpr_write_b32 a184, 0
    v_accvgpr_write_b32 a185, 0
    v_accvgpr_write_b32 a186, 0
    v_accvgpr_write_b32 a187, 0
    v_accvgpr_write_b32 a188, 0
    v_accvgpr_write_b32 a189, 0
    v_accvgpr_write_b32 a190, 0
    v_accvgpr_write_b32 a191, 0
    v_accvgpr_write_b32 a192, 0
    v_accvgpr_write_b32 a193, 0
    v_accvgpr_write_b32 a194, 0
    v_accvgpr_write_b32 a195, 0
    v_accvgpr_write_b32 a196, 0
    v_accvgpr_write_b32 a197, 0
    v_accvgpr_write_b32 a198, 0
    v_accvgpr_write_b32 a199, 0
    v_accvgpr_write_b32 a200, 0
    v_accvgpr_write_b32 a201, 0
    v_accvgpr_write_b32 a202, 0
    v_accvgpr_write_b32 a203, 0
    v_accvgpr_write_b32 a204, 0
    v_accvgpr_write_b32 a205, 0
    v_accvgpr_write_b32 a206, 0
    v_accvgpr_write_b32 a207, 0
    v_accvgpr_write_b32 a208, 0
    v_accvgpr_write_b32 a209, 0
    v_accvgpr_write_b32 a210, 0
    v_accvgpr_write_b32 a211, 0
    v_accvgpr_write_b32 a212, 0
    v_accvgpr_write_b32 a213, 0
    v_accvgpr_write_b32 a214, 0
    v_accvgpr_write_b32 a215, 0
    v_accvgpr_write_b32 a216, 0
    v_accvgpr_write_b32 a217, 0
    v_accvgpr_write_b32 a218, 0
    v_accvgpr_write_b32 a219, 0
    v_accvgpr_write_b32 a220, 0
    v_accvgpr_write_b32 a221, 0
    v_accvgpr_write_b32 a222, 0
    v_accvgpr_write_b32 a223, 0
    v_accvgpr_write_b32 a224, 0
    v_accvgpr_write_b32 a225, 0
    v_accvgpr_write_b32 a226, 0
    v_accvgpr_write_b32 a227, 0
    v_accvgpr_write_b32 a228, 0
    v_accvgpr_write_b32 a229, 0
    v_accvgpr_write_b32 a230, 0
    v_accvgpr_write_b32 a231, 0
    v_accvgpr_write_b32 a232, 0
    v_accvgpr_write_b32 a233, 0
    v_accvgpr_write_b32 a234, 0
    v_accvgpr_write_b32 a235, 0
    v_accvgpr_write_b32 a236, 0
    v_accvgpr_write_b32 a237, 0
    v_accvgpr_write_b32 a238, 0
    v_accvgpr_write_b32 a239, 0
    v_accvgpr_write_b32 a240, 0
    v_accvgpr_write_b32 a241, 0
    v_accvgpr_write_b32 a242, 0
    v_accvgpr_write_b32 a243, 0
    v_accvgpr_write_b32 a244, 0
    v_accvgpr_write_b32 a245, 0
    v_accvgpr_write_b32 a246, 0
    v_accvgpr_write_b32 a247, 0
    v_accvgpr_write_b32 a248, 0
    v_accvgpr_write_b32 a249, 0
    v_accvgpr_write_b32 a250, 0
    v_accvgpr_write_b32 a251, 0
    v_accvgpr_write_b32 a252, 0
    v_accvgpr_write_b32 a253, 0
    v_accvgpr_write_b32 a254, 0
    v_accvgpr_write_b32 a255, 0
    s_mov_b32 s51, 0
    s_nop 0
L_gv:
    s_waitcnt vmcnt(0)
    s_barrier
    ds_read_b128 v[64:67], v2 offset:0
    ds_read_b64_tr_b16 v[96:97], v6 offset:0
    ds_read_b64_tr_b16 v[98:99], v6 offset:2048
    ds_read_b64_tr_b16 v[100:101], v7 offset:0
    ds_read_b64_tr_b16 v[102:103], v7 offset:2048
    ds_read_b128 v[68:71], v2 offset:4096
    ds_read_b64_tr_b16 v[104:105], v8 offset:0
    ds_read_b64_tr_b16 v[106:107], v8 offset:2048
    ds_read_b64_tr_b16 v[108:109], v9 offset:0
    ds_read_b64_tr_b16 v[110:111], v9 offset:2048
    ds_read_b128 v[72:75], v2 offset:8192
    ds_read_b128 v[76:79], v2 offset:12288
    s_add_u32 s55, s51, 1
    s_cmp_ge_u32 s55, s50
    s_cselect_b32 s10, 0, s66
    s_cselect_b32 s38, 0, s67
    s_waitcnt lgkmcnt(9)
    v_mfma_f32_32x32x16_bf16 a[0:15], v[64:67], v[96:99], a[0:15]
    ds_read_b128 v[80:83], v3 offset:0
    s_mov_b32 s55, s52
    s_add_u32 m0, s65, 0
    s_nop 0
    buffer_load_dwordx4 v10, s[8:11], s55 offen sc1 lds
    s_waitcnt lgkmcnt(8)
    v_mfma_f32_32x32x16_bf16 a[16:31], v[64:67], v[100:103], a[16:31]
    ds_read_b64_tr_b16 v[112:113], v6 offset:8192
    s_add_u32 s55, s55, s57
    s_add_u32 m0, s65, 1024
    s_nop 0
    buffer_load_dwordx4 v11, s[8:11], s55 offen sc1 lds
    s_waitcnt lgkmcnt(8)
    v_mfma_f32_32x32x16_bf16 a[64:79], v[68:71], v[96:99], a[64:79]
    ds_read_b64_tr_b16 v[114:115], v6 offset:10240
    s_add_u32 s55, s55, s57
    s_add_u32 m0, s65, 2048
    s_nop 0
    buffer_load_dwordx4 v10, s[8:11], s55 offen sc1 lds
    v_mfma_f32_32x32x16_bf16 a[80:95], v[68:71], v[100:103], a[80:95]
    ds_read_b64_tr_b16 v[116:117], v7 offset:8192
    s_add_u32 s55, s55, s57
    s_add_u32 m0, s65, 3072
    s_nop 0
    buffer_load_dwordx4 v11, s[8:11], s55 offen sc1 lds
    s_waitcnt lgkmcnt(8)
    v_mfma_f32_32x32x16_bf16 a[32:47], v[64:67], v[104:107], a[32:47]
    ds_read_b64_tr_b16 v[118:119], v7 offset:10240
    s_add_u32 s55, s55, s57
    s_add_u32 m0, s65, 4096
    s_nop 0
    buffer_load_dwordx4 v10, s[8:11], s55 offen sc1 lds
    s_waitcnt lgkmcnt(7)
    v_mfma_f32_32x32x16_bf16 a[48:63], v[64:67], v[108:111], a[48:63]
    ds_read_b128 v[84:87], v3 offset:4096
    s_add_u32 s55, s55, s57
    s_add_u32 m0, s65, 5120
    s_nop 0
    buffer_load_dwordx4 v11, s[8:11], s55 offen sc1 lds
    v_mfma_f32_32x32x16_bf16 a[96:111], v[68:71], v[104:107], a[96:111]
    ds_read_b64_tr_b16 v[120:121], v8 offset:8192
    s_add_u32 s55, s55, s57
    s_add_u32 m0, s65, 6144
    s_nop 0
    buffer_load_dwordx4 v10, s[8:11], s55 offen sc1 lds
    v_mfma_f32_32x32x16_bf16 a[112:127], v[68:71], v[108:111], a[112:127]
    ds_read_b64_tr_b16 v[122:123], v8 offset:10240
    s_add_u32 s55, s55, s57
    s_add_u32 m0, s65, 7168
    s_nop 0
    buffer_load_dwordx4 v11, s[8:11], s55 offen sc1 lds
    s_waitcnt lgkmcnt(9)
    v_mfma_f32_32x32x16_bf16 a[128:143], v[72:75], v[96:99], a[128:143]
    ds_read_b64_tr_b16 v[124:125], v9 offset:8192
    s_mov_b32 s56, s53
    s_add_u32 m0, s54, 32768
    s_nop 0
    buffer_load_dwordx4 v12, s[36:39], s56 offen lds
    v_mfma_f32_32x32x16_bf16 a[144:159], v[72:75], v[100:103], a[144:159]
    ds_read_b64_tr_b16 v[126:127], v9 offset:10240
    s_add_u32 s56, s56, s61
    s_add_u32 m0, s54, 33792
    s_nop 0
    buffer_load_dwordx4 v13, s[36:39], s56 offen lds
    v_mfma_f32_32x32x16_bf16 a[160:175], v[72:75], v[104:107], a[160:175]
    ds_read_b128 v[88:91], v3 offset:8192
    s_add_u32 s56, s56, s61
    s_add_u32 m0, s54, 34816
    s_nop 0
    buffer_load_dwordx4 v12, s[36:39], s56 offen lds
    v_mfma_f32_32x32x16_bf16 a[176:191], v[72:75], v[108:111], a[176:191]
    ds_read_b128 v[92:95], v3 offset:12288
    s_add_u32 s56, s56, s61
    s_add_u32 m0, s54, 35840
    s_nop 0
    buffer_load_dwordx4 v13, s[36:39], s56 offen lds
    s_waitcnt lgkmcnt(12)
    v_mfma_f32_32x32x16_bf16 a[192:207], v[76:79], v[96:99], a[192:207]
    s_add_u32 s56, s56, s61
    s_add_u32 m0, s54, 36864
    s_nop 0
    buffer_load_dwordx4 v12, s[36:39], s56 offen lds
    v_mfma_f32_32x32x16_bf16 a[208:223], v[76:79], v[100:103], a[208:223]
    s_add_u32 s56, s56, s61
    s_add_u32 m0, s54, 37888
    s_nop 0
    buffer_load_dwordx4 v13, s[36:39], s56 offen lds
    v_mfma_f32_32x32x16_bf16 a[224:239], v[76:79], v[104:107], a[224:239]
    s_add_u32 s56, s56, s61
    s_add_u32 m0, s54, 38912
    s_nop 0
    buffer_load_dwordx4 v12, s[36:39], s56 offen lds
    v_mfma_f32_32x32x16_bf16 a[240:255], v[76:79], v[108:111], a[240:255]
    s_add_u32 s56, s56, s61
    s_add_u32 m0, s54, 39936
    s_nop 0
    buffer_load_dwordx4 v13, s[36:39], s56 offen lds
    s_waitcnt lgkmcnt(9)
    v_mfma_f32_32x32x16_bf16 a[0:15], v[80:83], v[112:115], a[0:15]
    ds_read_b128 v[64:67], v4 offset:0
    s_waitcnt lgkmcnt(8)
    v_mfma_f32_32x32x16_bf16 a[16:31], v[80:83], v[116:119], a[16:31]
    ds_read_b64_tr_b16 v[96:97], v6 offset:16384
    s_waitcnt lgkmcnt(8)
    v_mfma_f32_32x32x16_bf16 a[64:79], v[84:87], v[112:115], a[64:79]
    ds_read_b64_tr_b16 v[98:99], v6 offset:18432
    v_mfma_f32_32x32x16_bf16 a[80:95], v[84:87], v[116:119], a[80:95]
    ds_read_b64_tr_b16 v[100:101], v7 offset:16384
    s_waitcnt lgkmcnt(8)
    v_mfma_f32_32x32x16_bf16 a[32:47], v[80:83], v[120:123], a[32:47]
    ds_read_b64_tr_b16 v[102:103], v7 offset:18432
    s_waitcnt lgkmcnt(7)
    v_mfma_f32_32x32x16_bf16 a[48:63], v[80:83], v[124:127], a[48:63]
    ds_read_b128 v[68:71], v4 offset:4096
    v_mfma_f32_32x32x16_bf16 a[96:111], v[84:87], v[120:123], a[96:111]
    ds_read_b64_tr_b16 v[104:105], v8 offset:16384
    v_mfma_f32_32x32x16_bf16 a[112:127], v[84:87], v[124:127], a[112:127]
    ds_read_b64_tr_b16 v[106:107], v8 offset:18432
    s_waitcnt lgkmcnt(9)
    v_mfma_f32_32x32x16_bf16 a[128:143], v[88:91], v[112:115], a[128:143]
    ds_read_b64_tr_b16 v[108:109], v9 offset:16384
    v_mfma_f32_32x32x16_bf16 a[144:159], v[88:91], v[116:119], a[144:159]
    ds_read_b64_tr_b16 v[110:111], v9 offset:18432
    v_mfma_f32_32x32x16_bf16 a[160:175], v[88:91], v[120:123], a[160:175]
    ds_read_b128 v[72:75], v4 offset:8192
    v_mfma_f32_32x32x16_bf16 a[176:191], v[88:91], v[124:127], a[176:191]
    ds_read_b128 v[76:79], v4 offset:12288
    s_waitcnt lgkmcnt(12)
    v_mfma_f32_32x32x16_bf16 a[192:207], v[92:95], v[112:115], a[192:207]
    v_mfma_f32_32x32x16_bf16 a[208:223], v[92:95], v[116:119], a[208:223]
    v_mfma_f32_32x32x16_bf16 a[224:239], v[92:95], v[120:123], a[224:239]
    v_mfma_f32_32x32x16_bf16 a[240:255], v[92:95], v[124:127], a[240:255]
    s_waitcnt lgkmcnt(9)
    v_mfma_f32_32x32x16_bf16 a[0:15], v[64:67], v[96:99], a[0:15]
    ds_read_b128 v[80:83], v5 offset:0
    s_waitcnt lgkmcnt(8)
    v_mfma_f32_32x32x16_bf16 a[16:31], v[64:67], v[100:103], a[16:31]
    ds_read_b64_tr_b16 v[112:113], v6 offset:24576
    s_waitcnt lgkmcnt(8)
    v_mfma_f32_32x32x16_bf16 a[64:79], v[68:71], v[96:99], a[64:79]
    ds_read_b64_tr_b16 v[114:115], v6 offset:26624
    v_mfma_f32_32x32x16_bf16 a[80:95], v[68:71], v[100:103], a[80:95]
    ds_read_b64_tr_b16 v[116:117], v7 offset:24576
    s_waitcnt lgkmcnt(8)
    v_mfma_f32_32x32x16_bf16 a[32:47], v[64:67], v[104:107], a[32:47]
    ds_read_b64_tr_b16 v[118:119], v7 offset:26624
    s_waitcnt lgkmcnt(7)
    v_mfma_f32_32x32x16_bf16 a[48:63], v[64:67], v[108:111], a[48:63]
    ds_read_b128 v[84:87], v5 offset:4096
    v_mfma_f32_32x32x16_bf16 a[96:111], v[68:71], v[104:107], a[96:111]
    ds_read_b64_tr_b16 v[120:121], v8 offset:24576
    v_mfma_f32_32x32x16_bf16 a[112:127], v[68:71], v[108:111], a[112:127]
    ds_read_b64_tr_b16 v[122:123], v8 offset:26624
    s_waitcnt lgkmcnt(9)
    v_mfma_f32_32x32x16_bf16 a[128:143], v[72:75], v[96:99], a[128:143]
    ds_read_b64_tr_b16 v[124:125], v9 offset:24576
    v_mfma_f32_32x32x16_bf16 a[144:159], v[72:75], v[100:103], a[144:159]
    ds_read_b64_tr_b16 v[126:127], v9 offset:26624
    v_mfma_f32_32x32x16_bf16 a[160:175], v[72:75], v[104:107], a[160:175]
    ds_read_b128 v[88:91], v5 offset:8192
    v_mfma_f32_32x32x16_bf16 a[176:191], v[72:75], v[108:111], a[176:191]
    ds_read_b128 v[92:95], v5 offset:12288
    s_waitcnt lgkmcnt(12)
    v_mfma_f32_32x32x16_bf16 a[192:207], v[76:79], v[96:99], a[192:207]
    v_mfma_f32_32x32x16_bf16 a[208:223], v[76:79], v[100:103], a[208:223]
    v_mfma_f32_32x32x16_bf16 a[224:239], v[76:79], v[104:107], a[224:239]
    v_mfma_f32_32x32x16_bf16 a[240:255], v[76:79], v[108:111], a[240:255]
    s_waitcnt lgkmcnt(9)
    v_mfma_f32_32x32x16_bf16 a[0:15], v[80:83], v[112:115], a[0:15]
    s_waitcnt lgkmcnt(7)
    v_mfma_f32_32x32x16_bf16 a[16:31], v[80:83], v[116:119], a[16:31]
    s_waitcnt lgkmcnt(6)
    v_mfma_f32_32x32x16_bf16 a[64:79], v[84:87], v[112:115], a[64:79]
    v_mfma_f32_32x32x16_bf16 a[80:95], v[84:87], v[116:119], a[80:95]
    s_waitcnt lgkmcnt(4)
    v_mfma_f32_32x32x16_bf16 a[32:47], v[80:83], v[120:123], a[32:47]
    s_waitcnt lgkmcnt(2)
    v_mfma_f32_32x32x16_bf16 a[48:63], v[80:83], v[124:127], a[48:63]
    v_mfma_f32_32x32x16_bf16 a[96:111], v[84:87], v[120:123], a[96:111]
    v_mfma_f32_32x32x16_bf16 a[112:127], v[84:87], v[124:127], a[112:127]
    s_waitcnt lgkmcnt(1)
    v_mfma_f32_32x32x16_bf16 a[128:143], v[88:91], v[112:115], a[128:143]
    v_mfma_f32_32x32x16_bf16 a[144:159], v[88:91], v[116:119], a[144:159]
    v_mfma_f32_32x32x16_bf16 a[160:175], v[88:91], v[120:123], a[160:175]
    v_mfma_f32_32x32x16_bf16 a[176:191], v[88:91], v[124:127], a[176:191]
    s_waitcnt lgkmcnt(0)
    v_mfma_f32_32x32x16_bf16 a[192:207], v[92:95], v[112:115], a[192:207]
    v_mfma_f32_32x32x16_bf16 a[208:223], v[92:95], v[116:119], a[208:223]
    v_mfma_f32_32x32x16_bf16 a[224:239], v[92:95], v[120:123], a[224:239]
    v_mfma_f32_32x32x16_bf16 a[240:255], v[92:95], v[124:127], a[240:255]
    s_add_u32 s52, s52, 128
    s_lshl_b32 s62, s45, 6
    s_add_u32 s53, s53, s62
    s_xor_b32 s54, s54, 0x10000
    s_xor_b32 s65, s65, 0x10000
    v_xor_b32 v2, 0x10000, v2
    v_xor_b32 v3, 0x10000, v3
    v_xor_b32 v4, 0x10000, v4
    v_xor_b32 v5, 0x10000, v5
    v_xor_b32 v6, 0x10000, v6
    v_xor_b32 v7, 0x10000, v7
    v_xor_b32 v8, 0x10000, v8
    v_xor_b32 v9, 0x10000, v9
    s_add_u32 s51, s51, 1
    s_cmp_lt_u32 s51, s50
    s_waitcnt lgkmcnt(0)
    s_cbranch_scc1 L_gv
    s_waitcnt vmcnt(0)
    s_barrier
    s_mul_i32 s55, s27, 24576
    s_add_u32 s55, s55, 65536
    v_and_b32 v14, 31, v1
    v_lshlrev_b32 v16, 6, v14
    v_add_u32 v16, s55, v16
    v_bfe_u32 v14, v1, 1, 2
    v_lshrrev_b32 v15, 5, v1
    v_xor_b32 v14, v14, v15
    v_lshlrev_b32 v21, 4, v14
    v_add_u32 v22, v21, v16
    v_xor_b32 v21, 32, v21
    v_add_u32 v21, v21, v16
    v_lshlrev_b32 v17, 4, v1
    v_add_u32 v17, s55, v17
    v_lshrrev_b32 v14, 2, v1
    v_lshlrev_b32 v14, 6, v14
    v_and_b32 v15, 3, v1
    v_bfe_u32 v20, v1, 3, 2
    v_xor_b32 v15, v15, v20
    v_lshl_or_b32 v14, v15, 4, v14
    s_mul_i32 s55, s58, 1048576
    s_lshl_b32 s56, s59, 13
    s_add_u32 s55, s55, s56
    v_add_u32 v20, s55, v14
    s_mov_b32 s56, s49
    v_accvgpr_read_b32 v32, a0
    v_accvgpr_read_b32 v33, a1
    v_accvgpr_read_b32 v34, a2
    v_accvgpr_read_b32 v35, a3
    v_accvgpr_read_b32 v36, a4
    v_accvgpr_read_b32 v37, a5
    v_accvgpr_read_b32 v38, a6
    v_accvgpr_read_b32 v39, a7
    v_accvgpr_read_b32 v40, a8
    v_accvgpr_read_b32 v41, a9
    v_accvgpr_read_b32 v42, a10
    v_accvgpr_read_b32 v43, a11
    v_accvgpr_read_b32 v44, a12
    v_accvgpr_read_b32 v45, a13
    v_accvgpr_read_b32 v46, a14
    v_accvgpr_read_b32 v47, a15
    v_cvt_pk_bf16_f32 v48, v32, v33
    v_cvt_pk_bf16_f32 v49, v34, v35
    v_cvt_pk_bf16_f32 v50, v40, v41
    v_cvt_pk_bf16_f32 v51, v42, v43
    ds_write_b128 v22, v[48:51] offset:0
    v_cvt_pk_bf16_f32 v52, v36, v37
    v_cvt_pk_bf16_f32 v53, v38, v39
    v_cvt_pk_bf16_f32 v54, v44, v45
    v_cvt_pk_bf16_f32 v55, v46, v47
    ds_write_b128 v21, v[52:55] offset:0
    v_accvgpr_read_b32 v32, a16
    v_accvgpr_read_b32 v33, a17
    v_accvgpr_read_b32 v34, a18
    v_accvgpr_read_b32 v35, a19
    v_accvgpr_read_b32 v36, a20
    v_accvgpr_read_b32 v37, a21
    v_accvgpr_read_b32 v38, a22
    v_accvgpr_read_b32 v39, a23
    v_accvgpr_read_b32 v40, a24
    v_accvgpr_read_b32 v41, a25
    v_accvgpr_read_b32 v42, a26
    v_accvgpr_read_b32 v43, a27
    v_accvgpr_read_b32 v44, a28
    v_accvgpr_read_b32 v45, a29
    v_accvgpr_read_b32 v46, a30
    v_accvgpr_read_b32 v47, a31
    v_cvt_pk_bf16_f32 v48, v32, v33
    v_cvt_pk_bf16_f32 v49, v34, v35
    v_cvt_pk_bf16_f32 v50, v40, v41
    v_cvt_pk_bf16_f32 v51, v42, v43
    ds_write_b128 v22, v[48:51] offset:2048
    v_cvt_pk_bf16_f32 v52, v36, v37
    v_cvt_pk_bf16_f32 v53, v38, v39
    v_cvt_pk_bf16_f32 v54, v44, v45
    v_cvt_pk_bf16_f32 v55, v46, v47
    ds_write_b128 v21, v[52:55] offset:2048
    v_accvgpr_read_b32 v32, a32
    v_accvgpr_read_b32 v33, a33
    v_accvgpr_read_b32 v34, a34
    v_accvgpr_read_b32 v35, a35
    v_accvgpr_read_b32 v36, a36
    v_accvgpr_read_b32 v37, a37
    v_accvgpr_read_b32 v38, a38
    v_accvgpr_read_b32 v39, a39
    v_accvgpr_read_b32 v40, a40
    v_accvgpr_read_b32 v41, a41
    v_accvgpr_read_b32 v42, a42
    v_accvgpr_read_b32 v43, a43
    v_accvgpr_read_b32 v44, a44
    v_accvgpr_read_b32 v45, a45
    v_accvgpr_read_b32 v46, a46
    v_accvgpr_read_b32 v47, a47
    v_cvt_pk_bf16_f32 v48, v32, v33
    v_cvt_pk_bf16_f32 v49, v34, v35
    v_cvt_pk_bf16_f32 v50, v40, v41
    v_cvt_pk_bf16_f32 v51, v42, v43
    ds_write_b128 v22, v[48:51] offset:4096
    v_cvt_pk_bf16_f32 v52, v36, v37
    v_cvt_pk_bf16_f32 v53, v38, v39
    v_cvt_pk_bf16_f32 v54, v44, v45
    v_cvt_pk_bf16_f32 v55, v46, v47
    ds_write_b128 v21, v[52:55] offset:4096
    v_accvgpr_read_b32 v32, a48
    v_accvgpr_read_b32 v33, a49
    v_accvgpr_read_b32 v34, a50
    v_accvgpr_read_b32 v35, a51
    v_accvgpr_read_b32 v36, a52
    v_accvgpr_read_b32 v37, a53
    v_accvgpr_read_b32 v38, a54
    v_accvgpr_read_b32 v39, a55
    v_accvgpr_read_b32 v40, a56
    v_accvgpr_read_b32 v41, a57
    v_accvgpr_read_b32 v42, a58
    v_accvgpr_read_b32 v43, a59
    v_accvgpr_read_b32 v44, a60
    v_accvgpr_read_b32 v45, a61
    v_accvgpr_read_b32 v46, a62
    v_accvgpr_read_b32 v47, a63
    v_cvt_pk_bf16_f32 v48, v32, v33
    v_cvt_pk_bf16_f32 v49, v34, v35
    v_cvt_pk_bf16_f32 v50, v40, v41
    v_cvt_pk_bf16_f32 v51, v42, v43
    ds_write_b128 v22, v[48:51] offset:6144
    v_cvt_pk_bf16_f32 v52, v36, v37
    v_cvt_pk_bf16_f32 v53, v38, v39
    v_cvt_pk_bf16_f32 v54, v44, v45
    v_cvt_pk_bf16_f32 v55, v46, v47
    ds_write_b128 v21, v[52:55] offset:6144
    v_accvgpr_read_b32 v32, a64
    v_accvgpr_read_b32 v33, a65
    v_accvgpr_read_b32 v34, a66
    v_accvgpr_read_b32 v35, a67
    v_accvgpr_read_b32 v36, a68
    v_accvgpr_read_b32 v37, a69
    v_accvgpr_read_b32 v38, a70
    v_accvgpr_read_b32 v39, a71
    v_accvgpr_read_b32 v40, a72
    v_accvgpr_read_b32 v41, a73
    v_accvgpr_read_b32 v42, a74
    v_accvgpr_read_b32 v43, a75
    v_accvgpr_read_b32 v44, a76
    v_accvgpr_read_b32 v45, a77
    v_accvgpr_read_b32 v46, a78
    v_accvgpr_read_b32 v47, a79
    v_cvt_pk_bf16_f32 v48, v32, v33
    v_cvt_pk_bf16_f32 v49, v34, v35
    v_cvt_pk_bf16_f32 v50, v40, v41
    v_cvt_pk_bf16_f32 v51, v42, v43
    ds_write_b128 v22, v[48:51] offset:8192
    v_cvt_pk_bf16_f32 v52, v36, v37
    v_cvt_pk_bf16_f32 v53, v38, v39
    v_cvt_pk_bf16_f32 v54, v44, v45
    v_cvt_pk_bf16_f32 v55, v46, v47
    ds_write_b128 v21, v[52:55] offset:8192
    v_accvgpr_read_b32 v32, a80
    v_accvgpr_read_b32 v33, a81
    v_accvgpr_read_b32 v34, a82
    v_accvgpr_read_b32 v35, a83
    v_accvgpr_read_b32 v36, a84
    v_accvgpr_read_b32 v37, a85
    v_accvgpr_read_b32 v38, a86
    v_accvgpr_read_b32 v39, a87
    v_accvgpr_read_b32 v40, a88
    v_accvgpr_read_b32 v41, a89
    v_accvgpr_read_b32 v42, a90
    v_accvgpr_read_b32 v43, a91
    v_accvgpr_read_b32 v44, a92
    v_accvgpr_read_b32 v45, a93
    v_accvgpr_read_b32 v46, a94
    v_accvgpr_read_b32 v47, a95
    v_cvt_pk_bf16_f32 v48, v32, v33
    v_cvt_pk_bf16_f32 v49, v34, v35
    v_cvt_pk_bf16_f32 v50, v40, v41
    v_cvt_pk_bf16_f32 v51, v42, v43
    ds_write_b128 v22, v[48:51] offset:10240
    v_cvt_pk_bf16_f32 v52, v36, v37
    v_cvt_pk_bf16_f32 v53, v38, v39
    v_cvt_pk_bf16_f32 v54, v44, v45
    v_cvt_pk_bf16_f32 v55, v46, v47
    ds_write_b128 v21, v[52:55] offset:10240
    v_accvgpr_read_b32 v32, a96
    v_accvgpr_read_b32 v33, a97
    v_accvgpr_read_b32 v34, a98
    v_accvgpr_read_b32 v35, a99
    v_accvgpr_read_b32 v36, a100
    v_accvgpr_read_b32 v37, a101
    v_accvgpr_read_b32 v38, a102
    v_accvgpr_read_b32 v39, a103
    v_accvgpr_read_b32 v40, a104
    v_accvgpr_read_b32 v41, a105
    v_accvgpr_read_b32 v42, a106
    v_accvgpr_read_b32 v43, a107
    v_accvgpr_read_b32 v44, a108
    v_accvgpr_read_b32 v45, a109
    v_accvgpr_read_b32 v46, a110
    v_accvgpr_read_b32 v47, a111
    v_cvt_pk_bf16_f32 v48, v32, v33
    v_cvt_pk_bf16_f32 v49, v34, v35
    v_cvt_pk_bf16_f32 v50, v40, v41
    v_cvt_pk_bf16_f32 v51, v42, v43
    ds_write_b128 v22, v[48:51] offset:12288
    v_cvt_pk_bf16_f32 v52, v36, v37
    v_cvt_pk_bf16_f32 v53, v38, v39
    v_cvt_pk_bf16_f32 v54, v44, v45
    v_cvt_pk_bf16_f32 v55, v46, v47
    ds_write_b128 v21, v[52:55] offset:12288
    v_accvgpr_read_b32 v32, a112
    v_accvgpr_read_b32 v33, a113
    v_accvgpr_read_b32 v34, a114
    v_accvgpr_read_b32 v35, a115
    v_accvgpr_read_b32 v36, a116
    v_accvgpr_read_b32 v37, a117
    v_accvgpr_read_b32 v38, a118
    v_accvgpr_read_b32 v39, a119
    v_accvgpr_read_b32 v40, a120
    v_accvgpr_read_b32 v41, a121
    v_accvgpr_read_b32 v42, a122
    v_accvgpr_read_b32 v43, a123
    v_accvgpr_read_b32 v44, a124
    v_accvgpr_read_b32 v45, a125
    v_accvgpr_read_b32 v46, a126
    v_accvgpr_read_b32 v47, a127
    v_cvt_pk_bf16_f32 v48, v32, v33
    v_cvt_pk_bf16_f32 v49, v34, v35
    v_cvt_pk_bf16_f32 v50, v40, v41
    v_cvt_pk_bf16_f32 v51, v42, v43
    ds_write_b128 v22, v[48:51] offset:14336
    v_cvt_pk_bf16_f32 v52, v36, v37
    v_cvt_pk_bf16_f32 v53, v38, v39
    v_cvt_pk_bf16_f32 v54, v44, v45
    v_cvt_pk_bf16_f32 v55, v46, v47
    s_waitcnt lgkmcnt(14)
    ds_write_b128 v21, v[52:55] offset:14336
    s_waitcnt lgkmcnt(0)
    ds_read_b128 v[96:99], v17 offset:0
    ds_read_b128 v[100:103], v17 offset:1024
    ds_read_b128 v[104:107], v17 offset:2048
    ds_read_b128 v[108:111], v17 offset:3072
    ds_read_b128 v[112:115], v17 offset:4096
    ds_read_b128 v[116:119], v17 offset:5120
    ds_read_b128 v[120:123], v17 offset:6144
    ds_read_b128 v[124:127], v17 offset:7168
    s_add_u32 s55, s56, 0
    s_waitcnt lgkmcnt(7)
    buffer_store_dwordx4 v[96:99], v20, s[40:43], s55 offen offset:0 sc1
    s_waitcnt lgkmcnt(6)
    buffer_store_dwordx4 v[100:103], v20, s[40:43], s55 offen offset:1024 sc1
    s_waitcnt lgkmcnt(5)
    buffer_store_dwordx4 v[104:107], v20, s[40:43], s55 offen offset:2048 sc1
    s_waitcnt lgkmcnt(4)
    buffer_store_dwordx4 v[108:111], v20, s[40:43], s55 offen offset:3072 sc1
    s_add_u32 s55, s56, 4096
    s_waitcnt lgkmcnt(3)
    buffer_store_dwordx4 v[112:115], v20, s[40:43], s55 offen offset:0 sc1
    s_waitcnt lgkmcnt(2)
    buffer_store_dwordx4 v[116:119], v20, s[40:43], s55 offen offset:1024 sc1
    s_waitcnt lgkmcnt(1)
    buffer_store_dwordx4 v[120:123], v20, s[40:43], s55 offen offset:2048 sc1
    s_waitcnt lgkmcnt(0)
    buffer_store_dwordx4 v[124:127], v20, s[40:43], s55 offen offset:3072 sc1
    s_add_u32 s56, s56, 262144
    ds_read_b128 v[96:99], v17 offset:8192
    ds_read_b128 v[100:103], v17 offset:9216
    ds_read_b128 v[104:107], v17 offset:10240
    ds_read_b128 v[108:111], v17 offset:11264
    ds_read_b128 v[112:115], v17 offset:12288
    ds_read_b128 v[116:119], v17 offset:13312
    ds_read_b128 v[120:123], v17 offset:14336
    ds_read_b128 v[124:127], v17 offset:15360
    s_add_u32 s55, s56, 0
    s_waitcnt lgkmcnt(7)
    buffer_store_dwordx4 v[96:99], v20, s[40:43], s55 offen offset:0 sc1
    s_waitcnt lgkmcnt(6)
    buffer_store_dwordx4 v[100:103], v20, s[40:43], s55 offen offset:1024 sc1
    s_waitcnt lgkmcnt(5)
    buffer_store_dwordx4 v[104:107], v20, s[40:43], s55 offen offset:2048 sc1
    s_waitcnt lgkmcnt(4)
    buffer_store_dwordx4 v[108:111], v20, s[40:43], s55 offen offset:3072 sc1
    s_add_u32 s55, s56, 4096
    s_waitcnt lgkmcnt(3)
    buffer_store_dwordx4 v[112:115], v20, s[40:43], s55 offen offset:0 sc1
    s_waitcnt lgkmcnt(2)
    buffer_store_dwordx4 v[116:119], v20, s[40:43], s55 offen offset:1024 sc1
    s_waitcnt lgkmcnt(1)
    buffer_store_dwordx4 v[120:123], v20, s[40:43], s55 offen offset:2048 sc1
    s_waitcnt lgkmcnt(0)
    buffer_store_dwordx4 v[124:127], v20, s[40:43], s55 offen offset:3072 sc1
    s_add_u32 s56, s56, 262144
    s_waitcnt lgkmcnt(0)
    v_accvgpr_read_b32 v32, a128
    v_accvgpr_read_b32 v33, a129
    v_accvgpr_read_b32 v34, a130
    v_accvgpr_read_b32 v35, a131
    v_accvgpr_read_b32 v36, a132
    v_accvgpr_read_b32 v37, a133
    v_accvgpr_read_b32 v38, a134
    v_accvgpr_read_b32 v39, a135
    v_accvgpr_read_b32 v40, a136
    v_accvgpr_read_b32 v41, a137
    v_accvgpr_read_b32 v42, a138
    v_accvgpr_read_b32 v43, a139
    v_accvgpr_read_b32 v44, a140
    v_accvgpr_read_b32 v45, a141
    v_accvgpr_read_b32 v46, a142
    v_accvgpr_read_b32 v47, a143
    v_cvt_pk_bf16_f32 v48, v32, v33
    v_cvt_pk_bf16_f32 v49, v34, v35
    v_cvt_pk_bf16_f32 v50, v40, v41
    v_cvt_pk_bf16_f32 v51, v42, v43
    ds_write_b128 v22, v[48:51] offset:0
    v_cvt_pk_bf16_f32 v52, v36, v37
    v_cvt_pk_bf16_f32 v53, v38, v39
    v_cvt_pk_bf16_f32 v54, v44, v45
    v_cvt_pk_bf16_f32 v55, v46, v47
    ds_write_b128 v21, v[52:55] offset:0
    v_accvgpr_read_b32 v32, a144
    v_accvgpr_read_b32 v33, a145
    v_accvgpr_read_b32 v34, a146
    v_accvgpr_read_b32 v35, a147
    v_accvgpr_read_b32 v36, a148
    v_accvgpr_read_b32 v37, a149
    v_accvgpr_read_b32 v38, a150
    v_accvgpr_read_b32 v39, a151
    v_accvgpr_read_b32 v40, a152
    v_accvgpr_read_b32 v41, a153
    v_accvgpr_read_b32 v42, a154
    v_accvgpr_read_b32 v43, a155
    v_accvgpr_read_b32 v44, a156
    v_accvgpr_read_b32 v45, a157
    v_accvgpr_read_b32 v46, a158
    v_accvgpr_read_b32 v47, a159
    v_cvt_pk_bf16_f32 v48, v32, v33
    v_cvt_pk_bf16_f32 v49, v34, v35
    v_cvt_pk_bf16_f32 v50, v40, v41
    v_cvt_pk_bf16_f32 v51, v42, v43
    ds_write_b128 v22, v[48:51] offset:2048
    v_cvt_pk_bf16_f32 v52, v36, v37
    v_cvt_pk_bf16_f32 v53, v38, v39
    v_cvt_pk_bf16_f32 v54, v44, v45
    v_cvt_pk_bf16_f32 v55, v46, v47
    ds_write_b128 v21, v[52:55] offset:2048
    v_accvgpr_read_b32 v32, a160
    v_accvgpr_read_b32 v33, a161
    v_accvgpr_read_b32 v34, a162
    v_accvgpr_read_b32 v35, a163
    v_accvgpr_read_b32 v36, a164
    v_accvgpr_read_b32 v37, a165
    v_accvgpr_read_b32 v38, a166
    v_accvgpr_read_b32 v39, a167
    v_accvgpr_read_b32 v40, a168
    v_accvgpr_read_b32 v41, a169
    v_accvgpr_read_b32 v42, a170
    v_accvgpr_read_b32 v43, a171
    v_accvgpr_read_b32 v44, a172
    v_accvgpr_read_b32 v45, a173
    v_accvgpr_read_b32 v46, a174
    v_accvgpr_read_b32 v47, a175
    v_cvt_pk_bf16_f32 v48, v32, v33
    v_cvt_pk_bf16_f32 v49, v34, v35
    v_cvt_pk_bf16_f32 v50, v40, v41
    v_cvt_pk_bf16_f32 v51, v42, v43
    ds_write_b128 v22, v[48:51] offset:4096
    v_cvt_pk_bf16_f32 v52, v36, v37
    v_cvt_pk_bf16_f32 v53, v38, v39
    v_cvt_pk_bf16_f32 v54, v44, v45
    v_cvt_pk_bf16_f32 v55, v46, v47
    ds_write_b128 v21, v[52:55] offset:4096
    v_accvgpr_read_b32 v32, a176
    v_accvgpr_read_b32 v33, a177
    v_accvgpr_read_b32 v34, a178
    v_accvgpr_read_b32 v35, a179
    v_accvgpr_read_b32 v36, a180
    v_accvgpr_read_b32 v37, a181
    v_accvgpr_read_b32 v38, a182
    v_accvgpr_read_b32 v39, a183
    v_accvgpr_read_b32 v40, a184
    v_accvgpr_read_b32 v41, a185
    v_accvgpr_read_b32 v42, a186
    v_accvgpr_read_b32 v43, a187
    v_accvgpr_read_b32 v44, a188
    v_accvgpr_read_b32 v45, a189
    v_accvgpr_read_b32 v46, a190
    v_accvgpr_read_b32 v47, a191
    v_cvt_pk_bf16_f32 v48, v32, v33
    v_cvt_pk_bf16_f32 v49, v34, v35
    v_cvt_pk_bf16_f32 v50, v40, v41
    v_cvt_pk_bf16_f32 v51, v42, v43
    ds_write_b128 v22, v[48:51] offset:6144
    v_cvt_pk_bf16_f32 v52, v36, v37
    v_cvt_pk_bf16_f32 v53, v38, v39
    v_cvt_pk_bf16_f32 v54, v44, v45
    v_cvt_pk_bf16_f32 v55, v46, v47
    ds_write_b128 v21, v[52:55] offset:6144
    v_accvgpr_read_b32 v32, a192
    v_accvgpr_read_b32 v33, a193
    v_accvgpr_read_b32 v34, a194
    v_accvgpr_read_b32 v35, a195
    v_accvgpr_read_b32 v36, a196
    v_accvgpr_read_b32 v37, a197
    v_accvgpr_read_b32 v38, a198
    v_accvgpr_read_b32 v39, a199
    v_accvgpr_read_b32 v40, a200
    v_accvgpr_read_b32 v41, a201
    v_accvgpr_read_b32 v42, a202
    v_accvgpr_read_b32 v43, a203
    v_accvgpr_read_b32 v44, a204
    v_accvgpr_read_b32 v45, a205
    v_accvgpr_read_b32 v46, a206
    v_accvgpr_read_b32 v47, a207
    v_cvt_pk_bf16_f32 v48, v32, v33
    v_cvt_pk_bf16_f32 v49, v34, v35
    v_cvt_pk_bf16_f32 v50, v40, v41
    v_cvt_pk_bf16_f32 v51, v42, v43
    ds_write_b128 v22, v[48:51] offset:8192
    v_cvt_pk_bf16_f32 v52, v36, v37
    v_cvt_pk_bf16_f32 v53, v38, v39
    v_cvt_pk_bf16_f32 v54, v44, v45
    v_cvt_pk_bf16_f32 v55, v46, v47
    ds_write_b128 v21, v[52:55] offset:8192
    v_accvgpr_read_b32 v32, a208
    v_accvgpr_read_b32 v33, a209
    v_accvgpr_read_b32 v34, a210
    v_accvgpr_read_b32 v35, a211
    v_accvgpr_read_b32 v36, a212
    v_accvgpr_read_b32 v37, a213
    v_accvgpr_read_b32 v38, a214
    v_accvgpr_read_b32 v39, a215
    v_accvgpr_read_b32 v40, a216
    v_accvgpr_read_b32 v41, a217
    v_accvgpr_read_b32 v42, a218
    v_accvgpr_read_b32 v43, a219
    v_accvgpr_read_b32 v44, a220
    v_accvgpr_read_b32 v45, a221
    v_accvgpr_read_b32 v46, a222
    v_accvgpr_read_b32 v47, a223
    v_cvt_pk_bf16_f32 v48, v32, v33
    v_cvt_pk_bf16_f32 v49, v34, v35
    v_cvt_pk_bf16_f32 v50, v40, v41
    v_cvt_pk_bf16_f32 v51, v42, v43
    ds_write_b128 v22, v[48:51] offset:10240
    v_cvt_pk_bf16_f32 v52, v36, v37
    v_cvt_pk_bf16_f32 v53, v38, v39
    v_cvt_pk_bf16_f32 v54, v44, v45
    v_cvt_pk_bf16_f32 v55, v46, v47
    ds_write_b128 v21, v[52:55] offset:10240
    v_accvgpr_read_b32 v32, a224
    v_accvgpr_read_b32 v33, a225
    v_accvgpr_read_b32 v34, a226
    v_accvgpr_read_b32 v35, a227
    v_accvgpr_read_b32 v36, a228
    v_accvgpr_read_b32 v37, a229
    v_accvgpr_read_b32 v38, a230
    v_accvgpr_read_b32 v39, a231
    v_accvgpr_read_b32 v40, a232
    v_accvgpr_read_b32 v41, a233
    v_accvgpr_read_b32 v42, a234
    v_accvgpr_read_b32 v43, a235
    v_accvgpr_read_b32 v44, a236
    v_accvgpr_read_b32 v45, a237
    v_accvgpr_read_b32 v46, a238
    v_accvgpr_read_b32 v47, a239
    v_cvt_pk_bf16_f32 v48, v32, v33
    v_cvt_pk_bf16_f32 v49, v34, v35
    v_cvt_pk_bf16_f32 v50, v40, v41
    v_cvt_pk_bf16_f32 v51, v42, v43
    ds_write_b128 v22, v[48:51] offset:12288
    v_cvt_pk_bf16_f32 v52, v36, v37
    v_cvt_pk_bf16_f32 v53, v38, v39
    v_cvt_pk_bf16_f32 v54, v44, v45
    v_cvt_pk_bf16_f32 v55, v46, v47
    ds_write_b128 v21, v[52:55] offset:12288
    v_accvgpr_read_b32 v32, a240
    v_accvgpr_read_b32 v33, a241
    v_accvgpr_read_b32 v34, a242
    v_accvgpr_read_b32 v35, a243
    v_accvgpr_read_b32 v36, a244
    v_accvgpr_read_b32 v37, a245
    v_accvgpr_read_b32 v38, a246
    v_accvgpr_read_b32 v39, a247
    v_accvgpr_read_b32 v40, a248
    v_accvgpr_read_b32 v41, a249
    v_accvgpr_read_b32 v42, a250
    v_accvgpr_read_b32 v43, a251
    v_accvgpr_read_b32 v44, a252
    v_accvgpr_read_b32 v45, a253
    v_accvgpr_read_b32 v46, a254
    v_accvgpr_read_b32 v47, a255
    v_cvt_pk_bf16_f32 v48, v32, v33
    v_cvt_pk_bf16_f32 v49, v34, v35
    v_cvt_pk_bf16_f32 v50, v40, v41
    v_cvt_pk_bf16_f32 v51, v42, v43
    ds_write_b128 v22, v[48:51] offset:14336
    v_cvt_pk_bf16_f32 v52, v36, v37
    v_cvt_pk_bf16_f32 v53, v38, v39
    v_cvt_pk_bf16_f32 v54, v44, v45
    v_cvt_pk_bf16_f32 v55, v46, v47
    s_waitcnt lgkmcnt(14)
    ds_write_b128 v21, v[52:55] offset:14336
    s_waitcnt lgkmcnt(0)
    ds_read_b128 v[96:99], v17 offset:0
    ds_read_b128 v[100:103], v17 offset:1024
    ds_read_b128 v[104:107], v17 offset:2048
    ds_read_b128 v[108:111], v17 offset:3072
    ds_read_b128 v[112:115], v17 offset:4096
    ds_read_b128 v[116:119], v17 offset:5120
    ds_read_b128 v[120:123], v17 offset:6144
    ds_read_b128 v[124:127], v17 offset:7168
    s_add_u32 s55, s56, 0
    s_waitcnt lgkmcnt(7)
    buffer_store_dwordx4 v[96:99], v20, s[40:43], s55 offen offset:0 sc1
    s_waitcnt lgkmcnt(6)
    buffer_store_dwordx4 v[100:103], v20, s[40:43], s55 offen offset:1024 sc1
    s_waitcnt lgkmcnt(5)
    buffer_store_dwordx4 v[104:107], v20, s[40:43], s55 offen offset:2048 sc1
    s_waitcnt lgkmcnt(4)
    buffer_store_dwordx4 v[108:111], v20, s[40:43], s55 offen offset:3072 sc1
    s_add_u32 s55, s56, 4096
    s_waitcnt lgkmcnt(3)
    buffer_store_dwordx4 v[112:115], v20, s[40:43], s55 offen offset:0 sc1
    s_waitcnt lgkmcnt(2)
    buffer_store_dwordx4 v[116:119], v20, s[40:43], s55 offen offset:1024 sc1
    s_waitcnt lgkmcnt(1)
    buffer_store_dwordx4 v[120:123], v20, s[40:43], s55 offen offset:2048 sc1
    s_waitcnt lgkmcnt(0)
    buffer_store_dwordx4 v[124:127], v20, s[40:43], s55 offen offset:3072 sc1
    s_add_u32 s56, s56, 262144
    ds_read_b128 v[96:99], v17 offset:8192
    ds_read_b128 v[100:103], v17 offset:9216
    ds_read_b128 v[104:107], v17 offset:10240
    ds_read_b128 v[108:111], v17 offset:11264
    ds_read_b128 v[112:115], v17 offset:12288
    ds_read_b128 v[116:119], v17 offset:13312
    ds_read_b128 v[120:123], v17 offset:14336
    ds_read_b128 v[124:127], v17 offset:15360
    s_add_u32 s55, s56, 0
    s_waitcnt lgkmcnt(7)
    buffer_store_dwordx4 v[96:99], v20, s[40:43], s55 offen offset:0 sc1
    s_waitcnt lgkmcnt(6)
    buffer_store_dwordx4 v[100:103], v20, s[40:43], s55 offen offset:1024 sc1
    s_waitcnt lgkmcnt(5)
    buffer_store_dwordx4 v[104:107], v20, s[40:43], s55 offen offset:2048 sc1
    s_waitcnt lgkmcnt(4)
    buffer_store_dwordx4 v[108:111], v20, s[40:43], s55 offen offset:3072 sc1
    s_add_u32 s55, s56, 4096
    s_waitcnt lgkmcnt(3)
    buffer_store_dwordx4 v[112:115], v20, s[40:43], s55 offen offset:0 sc1
    s_waitcnt lgkmcnt(2)
    buffer_store_dwordx4 v[116:119], v20, s[40:43], s55 offen offset:1024 sc1
    s_waitcnt lgkmcnt(1)
    buffer_store_dwordx4 v[120:123], v20, s[40:43], s55 offen offset:2048 sc1
    s_waitcnt lgkmcnt(0)
    buffer_store_dwordx4 v[124:127], v20, s[40:43], s55 offen offset:3072 sc1
    s_add_u32 s56, s56, 262144
    s_waitcnt lgkmcnt(0)
L_eskip_v:
    s_waitcnt vmcnt(0)
    s_barrier
    s_cmp_lg_u32 s27, 0
    s_cbranch_scc1 L_sgv_s
    s_cmp_lg_u32 s93, 0
    s_cbranch_scc1 L_sgv_i
    s_mov_b32 s82, 0
L_sgv_ip:
    buffer_load_dword v31, off, s[12:15], 0 offset:128 sc1
    s_add_u32 s82, s82, 1
    s_cmp_gt_u32 s82, 0x200000
    s_cbranch_scc1 L_wbail
    s_waitcnt vmcnt(0)
    v_cmp_eq_u32 vcc, 0, v31
    s_cbranch_vccnz L_sgv_ip
    s_mov_b32 s93, 1
L_sgv_i:
    v_mov_b32 v31, s90
    s_mov_b64 exec, 1
    buffer_atomic_add v31, off, s[4:7], s85
    s_mov_b64 exec, -1
L_sgv_s:
    s_add_u32 s89, s89, 1
    s_branch L_fetch
L_task_h:
    v_and_b32 v14, 31, v1
    v_bfe_u32 v15, v1, 1, 3
    v_lshrrev_b32 v16, 5, v1
    v_xor_b32 v15, v15, v16
    v_lshlrev_b32 v14, 7, v14
    s_mul_i32 s55, s58, 16384
    v_add_u32 v14, s55, v14
    v_xor_b32 v16, 0, v15
    v_lshl_add_u32 v2, v16, 4, v14
    v_xor_b32 v16, 2, v15
    v_lshl_add_u32 v3, v16, 4, v14
    v_xor_b32 v16, 4, v15
    v_lshl_add_u32 v4, v16, 4, v14
    v_xor_b32 v16, 6, v15
    v_lshl_add_u32 v5, v16, 4, v14
    v_lshrrev_b32 v14, 5, v1
    v_lshlrev_b32 v14, 3, v14
    v_bfe_u32 v15, v1, 2, 2
    v_add_u32 v14, v14, v15
    v_lshlrev_b32 v14, 9, v14
    v_bfe_u32 v16, v1, 4, 1
    v_lshl_or_b32 v14, v16, 5, v14
    v_bfe_u32 v16, v1, 1, 1
    v_lshl_or_b32 v14, v16, 4, v14
    v_and_b32 v16, 1, v1
    v_lshl_or_b32 v14, v16, 3, v14
    s_lshl_b32 s55, s59, 8
    s_add_u32 s55, s55, 32768
    v_add_u32 v14, s55, v14
    v_xor_b32 v16, 0, v15
    v_lshl_add_u32 v6, v16, 6, v14
    v_xor_b32 v16, 1, v15
    v_lshl_add_u32 v7, v16, 6, v14
    v_xor_b32 v16, 2, v15
    v_lshl_add_u32 v8, v16, 6, v14
    v_xor_b32 v16, 3, v15
    v_lshl_add_u32 v9, v16, 6, v14
    v_lshrrev_b32 v14, 3, v1
    v_mul_lo_u32 v14, v14, s44
    v_and_b32 v15, 7, v1
    v_bfe_u32 v16, v1, 4, 2
    v_xor_b32 v15, v15, v16
    v_lshl_add_u32 v10, v15, 4, v14
    v_xor_b32 v15, 4, v15
    v_lshl_add_u32 v11, v15, 4, v14
    v_lshrrev_b32 v16, 5, v1
    v_mul_lo_u32 v14, v16, s45
    v_and_b32 v15, 31, v1
    v_lshlrev_b32 v16, 2, v16
    v_xor_b32 v15, v15, v16
    v_lshl_add_u32 v12, v15, 4, v14
    v_xor_b32 v15, 8, v15
    v_lshl_add_u32 v13, v15, 4, v14
    s_mov_b32 s10, s66
    s_mov_b32 s38, s67
    s_lshl_b32 s57, s44, 3
    s_lshl_b32 s61, s45, 1
    s_mul_i32 s52, s44, s27
    s_mul_i32 s52, s52, 64
    s_add_u32 s52, s52, s47
    s_mul_i32 s53, s45, s27
    s_lshl_b32 s53, s53, 4
    s_add_u32 s53, s53, s48
    s_lshl_b32 s54, s27, 13
    s_mul_i32 s65, s27, 8192
    s_mov_b32 s55, s52
    s_add_u32 m0, s65, 0
    s_nop 0
    buffer_load_dwordx4 v10, s[8:11], s55 offen sc1 lds
    s_add_u32 s55, s55, s57
    s_add_u32 m0, s65, 1024
    s_nop 0
    buffer_load_dwordx4 v11, s[8:11], s55 offen sc1 lds
    s_add_u32 s55, s55, s57
    s_add_u32 m0, s65, 2048
    s_nop 0
    buffer_load_dwordx4 v10, s[8:11], s55 offen sc1 lds
    s_add_u32 s55, s55, s57
    s_add_u32 m0, s65, 3072
    s_nop 0
    buffer_load_dwordx4 v11, s[8:11], s55 offen sc1 lds
    s_add_u32 s55, s55, s57
    s_add_u32 m0, s65, 4096
    s_nop 0
    buffer_load_dwordx4 v10, s[8:11], s55 offen sc1 lds
    s_add_u32 s55, s55, s57
    s_add_u32 m0, s65, 5120
    s_nop 0
    buffer_load_dwordx4 v11, s[8:11], s55 offen sc1 lds
    s_add_u32 s55, s55, s57
    s_add_u32 m0, s65, 6144
    s_nop 0
    buffer_load_dwordx4 v10, s[8:11], s55 offen sc1 lds
    s_add_u32 s55, s55, s57
    s_add_u32 m0, s65, 7168
    s_nop 0
    buffer_load_dwordx4 v11, s[8:11], s55 offen sc1 lds
    s_mov_b32 s56, s53
    s_add_u32 m0, s54, 32768
    s_nop 0
    buffer_load_dwordx4 v12, s[36:39], s56 offen lds
    s_add_u32 s56, s56, s61
    s_add_u32 m0, s54, 33792
    s_nop 0
    buffer_load_dwordx4 v13, s[36:39], s56 offen lds
    s_add_u32 s56, s56, s61
    s_add_u32 m0, s54, 34816
    s_nop 0
    buffer_load_dwordx4 v12, s[36:39], s56 offen lds
    s_add_u32 s56, s56, s61
    s_add_u32 m0, s54, 35840
    s_nop 0
    buffer_load_dwordx4 v13, s[36:39], s56 offen lds
    s_add_u32 s56, s56, s61
    s_add_u32 m0, s54, 36864
    s_nop 0
    buffer_load_dwordx4 v12, s[36:39], s56 offen lds
    s_add_u32 s56, s56, s61
    s_add_u32 m0, s54, 37888
    s_nop 0
    buffer_load_dwordx4 v13, s[36:39], s56 offen lds
    s_add_u32 s56, s56, s61
    s_add_u32 m0, s54, 38912
    s_nop 0
    buffer_load_dwordx4 v12, s[36:39], s56 offen lds
    s_add_u32 s56, s56, s61
    s_add_u32 m0, s54, 39936
    s_nop 0
    buffer_load_dwordx4 v13, s[36:39], s56 offen lds
    s_add_u32 s52, s52, 128
    s_lshl_b32 s62, s45, 6
    s_add_u32 s53, s53, s62
    s_xor_b32 s54, s54, 0x10000
    s_xor_b32 s65, s65, 0x10000
    s_mov_b32 s63, 0
    v_accvgpr_write_b32 a0, 0
    v_accvgpr_write_b32 a1, 0
    v_accvgpr_write_b32 a2, 0
    v_accvgpr_write_b32 a3, 0
    v_accvgpr_write_b32 a4, 0
    v_accvgpr_write_b32 a5, 0
    v_accvgpr_write_b32 a6, 0
    v_accvgpr_write_b32 a7, 0
    v_accvgpr_write_b32 a8, 0
    v_accvgpr_write_b32 a9, 0
    v_accvgpr_write_b32 a10, 0
    v_accvgpr_write_b32 a11, 0
    v_accvgpr_write_b32 a12, 0
    v_accvgpr_write_b32 a13, 0
    v_accvgpr_write_b32 a14, 0
    v_accvgpr_write_b32 a15, 0
    v_accvgpr_write_b32 a16, 0
    v_accvgpr_write_b32 a17, 0
    v_accvgpr_write_b32 a18, 0
    v_accvgpr_write_b32 a19, 0
    v_accvgpr_write_b32 a20, 0
    v_accvgpr_write_b32 a21, 0
    v_accvgpr_write_b32 a22, 0
    v_accvgpr_write_b32 a23, 0
    v_accvgpr_write_b32 a24, 0
    v_accvgpr_write_b32 a25, 0
    v_accvgpr_write_b32 a26, 0
    v_accvgpr_write_b32 a27, 0
    v_accvgpr_write_b32 a28, 0
    v_accvgpr_write_b32 a29, 0
    v_accvgpr_write_b32 a30, 0
    v_accvgpr_write_b32 a31, 0
    v_accvgpr_write_b32 a32, 0
    v_accvgpr_write_b32 a33, 0
    v_accvgpr_write_b32 a34, 0
    v_accvgpr_write_b32 a35, 0
    v_accvgpr_write_b32 a36, 0
    v_accvgpr_write_b32 a37, 0
    v_accvgpr_write_b32 a38, 0
    v_accvgpr_write_b32 a39, 0
    v_accvgpr_write_b32 a40, 0
    v_accvgpr_write_b32 a41, 0
    v_accvgpr_write_b32 a42, 0
    v_accvgpr_write_b32 a43, 0
    v_accvgpr_write_b32 a44, 0
    v_accvgpr_write_b32 a45, 0
    v_accvgpr_write_b32 a46, 0
    v_accvgpr_write_b32 a47, 0
    v_accvgpr_write_b32 a48, 0
    v_accvgpr_write_b32 a49, 0
    v_accvgpr_write_b32 a50, 0
    v_accvgpr_write_b32 a51, 0
    v_accvgpr_write_b32 a52, 0
    v_accvgpr_write_b32 a53, 0
    v_accvgpr_write_b32 a54, 0
    v_accvgpr_write_b32 a55, 0
    v_accvgpr_write_b32 a56, 0
    v_accvgpr_write_b32 a57, 0
    v_accvgpr_write_b32 a58, 0
    v_accvgpr_write_b32 a59, 0
    v_accvgpr_write_b32 a60, 0
    v_accvgpr_write_b32 a61, 0
    v_accvgpr_write_b32 a62, 0
    v_accvgpr_write_b32 a63, 0
    v_accvgpr_write_b32 a64, 0
    v_accvgpr_write_b32 a65, 0
    v_accvgpr_write_b32 a66, 0
    v_accvgpr_write_b32 a67, 0
    v_accvgpr_write_b32 a68, 0
    v_accvgpr_write_b32 a69, 0
    v_accvgpr_write_b32 a70, 0
    v_accvgpr_write_b32 a71, 0
    v_accvgpr_write_b32 a72, 0
    v_accvgpr_write_b32 a73, 0
    v_accvgpr_write_b32 a74, 0
    v_accvgpr_write_b32 a75, 0
    v_accvgpr_write_b32 a76, 0
    v_accvgpr_write_b32 a77, 0
    v_accvgpr_write_b32 a78, 0
    v_accvgpr_write_b32 a79, 0
    v_accvgpr_write_b32 a80, 0
    v_accvgpr_write_b32 a81, 0
    v_accvgpr_write_b32 a82, 0
    v_accvgpr_write_b32 a83, 0
    v_accvgpr_write_b32 a84, 0
    v_accvgpr_write_b32 a85, 0
    v_accvgpr_write_b32 a86, 0
    v_accvgpr_write_b32 a87, 0
    v_accvgpr_write_b32 a88, 0
    v_accvgpr_write_b32 a89, 0
    v_accvgpr_write_b32 a90, 0
    v_accvgpr_write_b32 a91, 0
    v_accvgpr_write_b32 a92, 0
    v_accvgpr_write_b32 a93, 0
    v_accvgpr_write_b32 a94, 0
    v_accvgpr_write_b32 a95, 0
    v_accvgpr_write_b32 a96, 0
    v_accvgpr_write_b32 a97, 0
    v_accvgpr_write_b32 a98, 0
    v_accvgpr_write_b32 a99, 0
    v_accvgpr_write_b32 a100, 0
    v_accvgpr_write_b32 a101, 0
    v_accvgpr_write_b32 a102, 0
    v_accvgpr_write_b32 a103, 0
    v_accvgpr_write_b32 a104, 0
    v_accvgpr_write_b32 a105, 0
    v_accvgpr_write_b32 a106, 0
    v_accvgpr_write_b32 a107, 0
    v_accvgpr_write_b32 a108, 0
    v_accvgpr_write_b32 a109, 0
    v_accvgpr_write_b32 a110, 0
    v_accvgpr_write_b32 a111, 0
    v_accvgpr_write_b32 a112, 0
    v_accvgpr_write_b32 a113, 0
    v_accvgpr_write_b32 a114, 0
    v_accvgpr_write_b32 a115, 0
    v_accvgpr_write_b32 a116, 0
    v_accvgpr_write_b32 a117, 0
    v_accvgpr_write_b32 a118, 0
    v_accvgpr_write_b32 a119, 0
    v_accvgpr_write_b32 a120, 0
    v_accvgpr_write_b32 a121, 0
    v_accvgpr_write_b32 a122, 0
    v_accvgpr_write_b32 a123, 0
    v_accvgpr_write_b32 a124, 0
    v_accvgpr_write_b32 a125, 0
    v_accvgpr_write_b32 a126, 0
    v_accvgpr_write_b32 a127, 0
    v_accvgpr_write_b32 a128, 0
    v_accvgpr_write_b32 a129, 0
    v_accvgpr_write_b32 a130, 0
    v_accvgpr_write_b32 a131, 0
    v_accvgpr_write_b32 a132, 0
    v_accvgpr_write_b32 a133, 0
    v_accvgpr_write_b32 a134, 0
    v_accvgpr_write_b32 a135, 0
    v_accvgpr_write_b32 a136, 0
    v_accvgpr_write_b32 a137, 0
    v_accvgpr_write_b32 a138, 0
    v_accvgpr_write_b32 a139, 0
    v_accvgpr_write_b32 a140, 0
    v_accvgpr_write_b32 a141, 0
    v_accvgpr_write_b32 a142, 0
    v_accvgpr_write_b32 a143, 0
    v_accvgpr_write_b32 a144, 0
    v_accvgpr_write_b32 a145, 0
    v_accvgpr_write_b32 a146, 0
    v_accvgpr_write_b32 a147, 0
    v_accvgpr_write_b32 a148, 0
    v_accvgpr_write_b32 a149, 0
    v_accvgpr_write_b32 a150, 0
    v_accvgpr_write_b32 a151, 0
    v_accvgpr_write_b32 a152, 0
    v_accvgpr_write_b32 a153, 0
    v_accvgpr_write_b32 a154, 0
    v_accvgpr_write_b32 a155, 0
    v_accvgpr_write_b32 a156, 0
    v_accvgpr_write_b32 a157, 0
    v_accvgpr_write_b32 a158, 0
    v_accvgpr_write_b32 a159, 0
    v_accvgpr_write_b32 a160, 0
    v_accvgpr_write_b32 a161, 0
    v_accvgpr_write_b32 a162, 0
    v_accvgpr_write_b32 a163, 0
    v_accvgpr_write_b32 a164, 0
    v_accvgpr_write_b32 a165, 0
    v_accvgpr_write_b32 a166, 0
    v_accvgpr_write_b32 a167, 0
    v_accvgpr_write_b32 a168, 0
    v_accvgpr_write_b32 a169, 0
    v_accvgpr_write_b32 a170, 0
    v_accvgpr_write_b32 a171, 0
    v_accvgpr_write_b32 a172, 0
    v_accvgpr_write_b32 a173, 0
    v_accvgpr_write_b32 a174, 0
    v_accvgpr_write_b32 a175, 0
    v_accvgpr_write_b32 a176, 0
    v_accvgpr_write_b32 a177, 0
    v_accvgpr_write_b32 a178, 0
    v_accvgpr_write_b32 a179, 0
    v_accvgpr_write_b32 a180, 0
    v_accvgpr_write_b32 a181, 0
    v_accvgpr_write_b32 a182, 0
    v_accvgpr_write_b32 a183, 0
    v_accvgpr_write_b32 a184, 0
    v_accvgpr_write_b32 a185, 0
    v_accvgpr_write_b32 a186, 0
    v_accvgpr_write_b32 a187, 0
    v_accvgpr_write_b32 a188, 0
    v_accvgpr_write_b32 a189, 0
    v_accvgpr_write_b32 a190, 0
    v_accvgpr_write_b32 a191, 0
    v_accvgpr_write_b32 a192, 0
    v_accvgpr_write_b32 a193, 0
    v_accvgpr_write_b32 a194, 0
    v_accvgpr_write_b32 a195, 0
    v_accvgpr_write_b32 a196, 0
    v_accvgpr_write_b32 a197, 0
    v_accvgpr_write_b32 a198, 0
    v_accvgpr_write_b32 a199, 0
    v_accvgpr_write_b32 a200, 0
    v_accvgpr_write_b32 a201, 0
    v_accvgpr_write_b32 a202, 0
    v_accvgpr_write_b32 a203, 0
    v_accvgpr_write_b32 a204, 0
    v_accvgpr_write_b32 a205, 0
    v_accvgpr_write_b32 a206, 0
    v_accvgpr_write_b32 a207, 0
    v_accvgpr_write_b32 a208, 0
    v_accvgpr_write_b32 a209, 0
    v_accvgpr_write_b32 a210, 0
    v_accvgpr_write_b32 a211, 0
    v_accvgpr_write_b32 a212, 0
    v_accvgpr_write_b32 a213, 0
    v_accvgpr_write_b32 a214, 0
    v_accvgpr_write_b32 a215, 0
    v_accvgpr_write_b32 a216, 0
    v_accvgpr_write_b32 a217, 0
    v_accvgpr_write_b32 a218, 0
    v_accvgpr_write_b32 a219, 0
    v_accvgpr_write_b32 a220, 0
    v_accvgpr_write_b32 a221, 0
    v_accvgpr_write_b32 a222, 0
    v_accvgpr_write_b32 a223, 0
    v_accvgpr_write_b32 a224, 0
    v_accvgpr_write_b32 a225, 0
    v_accvgpr_write_b32 a226, 0
    v_accvgpr_write_b32 a227, 0
    v_accvgpr_write_b32 a228, 0
    v_accvgpr_write_b32 a229, 0
    v_accvgpr_write_b32 a230, 0
    v_accvgpr_write_b32 a231, 0
    v_accvgpr_write_b32 a232, 0
    v_accvgpr_write_b32 a233, 0
    v_accvgpr_write_b32 a234, 0
    v_accvgpr_write_b32 a235, 0
    v_accvgpr_write_b32 a236, 0
    v_accvgpr_write_b32 a237, 0
    v_accvgpr_write_b32 a238, 0
    v_accvgpr_write_b32 a239, 0
    v_accvgpr_write_b32 a240, 0
    v_accvgpr_write_b32 a241, 0
    v_accvgpr_write_b32 a242, 0
    v_accvgpr_write_b32 a243, 0
    v_accvgpr_write_b32 a244, 0
    v_accvgpr_write_b32 a245, 0
    v_accvgpr_write_b32 a246, 0
    v_accvgpr_write_b32 a247, 0
    v_accvgpr_write_b32 a248, 0
    v_accvgpr_write_b32 a249, 0
    v_accvgpr_write_b32 a250, 0
    v_accvgpr_write_b32 a251, 0
    v_accvgpr_write_b32 a252, 0
    v_accvgpr_write_b32 a253, 0
    v_accvgpr_write_b32 a254, 0
    v_accvgpr_write_b32 a255, 0
    s_mov_b32 s51, 0
    s_nop 0
L_gh:
    s_waitcnt vmcnt(0)
    s_barrier
    ds_read_b128 v[64:67], v2 offset:0
    ds_read_b64_tr_b16 v[96:97], v6 offset:0
    ds_read_b64_tr_b16 v[98:99], v6 offset:2048
    ds_read_b64_tr_b16 v[100:101], v7 offset:0
    ds_read_b64_tr_b16 v[102:103], v7 offset:2048
    ds_read_b128 v[68:71], v2 offset:4096
    ds_read_b64_tr_b16 v[104:105], v8 offset:0
    ds_read_b64_tr_b16 v[106:107], v8 offset:2048
    ds_read_b64_tr_b16 v[108:109], v9 offset:0
    ds_read_b64_tr_b16 v[110:111], v9 offset:2048
    ds_read_b128 v[72:75], v2 offset:8192
    ds_read_b128 v[76:79], v2 offset:12288
    s_add_u32 s55, s51, 1
    s_cmp_ge_u32 s55, s50
    s_cselect_b32 s10, 0, s66
    s_cselect_b32 s38, 0, s67
    s_waitcnt lgkmcnt(9)
    v_mfma_f32_32x32x16_bf16 a[0:15], v[96:99], v[64:67], a[0:15]
    ds_read_b128 v[80:83], v3 offset:0
    s_mov_b32 s55, s52
    s_add_u32 m0, s65, 0
    s_nop 0
    buffer_load_dwordx4 v10, s[8:11], s55 offen sc1 lds
    s_waitcnt lgkmcnt(8)
    v_mfma_f32_32x32x16_bf16 a[16:31], v[100:103], v[64:67], a[16:31]
    ds_read_b64_tr_b16 v[112:113], v6 offset:8192
    s_add_u32 s55, s55, s57
    s_add_u32 m0, s65, 1024
    s_nop 0
    buffer_load_dwordx4 v11, s[8:11], s55 offen sc1 lds
    s_waitcnt lgkmcnt(8)
    v_mfma_f32_32x32x16_bf16 a[64:79], v[96:99], v[68:71], a[64:79]
    ds_read_b64_tr_b16 v[114:115], v6 offset:10240
    s_add_u32 s55, s55, s57
    s_add_u32 m0, s65, 2048
    s_nop 0
    buffer_load_dwordx4 v10, s[8:11], s55 offen sc1 lds
    v_mfma_f32_32x32x16_bf16 a[80:95], v[100:103], v[68:71], a[80:95]
    ds_read_b64_tr_b16 v[116:117], v7 offset:8192
    s_add_u32 s55, s55, s57
    s_add_u32 m0, s65, 3072
    s_nop 0
    buffer_load_dwordx4 v11, s[8:11], s55 offen sc1 lds
    s_waitcnt lgkmcnt(8)
    v_mfma_f32_32x32x16_bf16 a[32:47], v[104:107], v[64:67], a[32:47]
    ds_read_b64_tr_b16 v[118:119], v7 offset:10240
    s_add_u32 s55, s55, s57
    s_add_u32 m0, s65, 4096
    s_nop 0
    buffer_load_dwordx4 v10, s[8:11], s55 offen sc1 lds
    s_waitcnt lgkmcnt(7)
    v_mfma_f32_32x32x16_bf16 a[48:63], v[108:111], v[64:67], a[48:63]
    ds_read_b128 v[84:87], v3 offset:4096
    s_add_u32 s55, s55, s57
    s_add_u32 m0, s65, 5120
    s_nop 0
    buffer_load_dwordx4 v11, s[8:11], s55 offen sc1 lds
    v_mfma_f32_32x32x16_bf16 a[96:111], v[104:107], v[68:71], a[96:111]
    ds_read_b64_tr_b16 v[120:121], v8 offset:8192
    s_add_u32 s55, s55, s57
    s_add_u32 m0, s65, 6144
    s_nop 0
    buffer_load_dwordx4 v10, s[8:11], s55 offen sc1 lds
    v_mfma_f32_32x32x16_bf16 a[112:127], v[108:111], v[68:71], a[112:127]
    ds_read_b64_tr_b16 v[122:123], v8 offset:10240
    s_add_u32 s55, s55, s57
    s_add_u32 m0, s65, 7168
    s_nop 0
    buffer_load_dwordx4 v11, s[8:11], s55 offen sc1 lds
    s_waitcnt lgkmcnt(9)
    v_mfma_f32_32x32x16_bf16 a[128:143], v[96:99], v[72:75], a[128:143]
    ds_read_b64_tr_b16 v[124:125], v9 offset:8192
    s_mov_b32 s56, s53
    s_add_u32 m0, s54, 32768
    s_nop 0
    buffer_load_dwordx4 v12, s[36:39], s56 offen lds
    v_mfma_f32_32x32x16_bf16 a[144:159], v[100:103], v[72:75], a[144:159]
    ds_read_b64_tr_b16 v[126:127], v9 offset:10240
    s_add_u32 s56, s56, s61
    s_add_u32 m0, s54, 33792
    s_nop 0
    buffer_load_dwordx4 v13, s[36:39], s56 offen lds
    v_mfma_f32_32x32x16_bf16 a[160:175], v[104:107], v[72:75], a[160:175]
    ds_read_b128 v[88:91], v3 offset:8192
    s_add_u32 s56, s56, s61
    s_add_u32 m0, s54, 34816
    s_nop 0
    buffer_load_dwordx4 v12, s[36:39], s56 offen lds
    v_mfma_f32_32x32x16_bf16 a[176:191], v[108:111], v[72:75], a[176:191]
    ds_read_b128 v[92:95], v3 offset:12288
    s_add_u32 s56, s56, s61
    s_add_u32 m0, s54, 35840
    s_nop 0
    buffer_load_dwordx4 v13, s[36:39], s56 offen lds
    s_waitcnt lgkmcnt(12)
    v_mfma_f32_32x32x16_bf16 a[192:207], v[96:99], v[76:79], a[192:207]
    s_add_u32 s56, s56, s61
    s_add_u32 m0, s54, 36864
    s_nop 0
    buffer_load_dwordx4 v12, s[36:39], s56 offen lds
    v_mfma_f32_32x32x16_bf16 a[208:223], v[100:103], v[76:79], a[208:223]
    s_add_u32 s56, s56, s61
    s_add_u32 m0, s54, 37888
    s_nop 0
    buffer_load_dwordx4 v13, s[36:39], s56 offen lds
    v_mfma_f32_32x32x16_bf16 a[224:239], v[104:107], v[76:79], a[224:239]
    s_add_u32 s56, s56, s61
    s_add_u32 m0, s54, 38912
    s_nop 0
    buffer_load_dwordx4 v12, s[36:39], s56 offen lds
    v_mfma_f32_32x32x16_bf16 a[240:255], v[108:111], v[76:79], a[240:255]
    s_add_u32 s56, s56, s61
    s_add_u32 m0, s54, 39936
    s_nop 0
    buffer_load_dwordx4 v13, s[36:39], s56 offen lds
    s_waitcnt lgkmcnt(9)
    v_mfma_f32_32x32x16_bf16 a[0:15], v[112:115], v[80:83], a[0:15]
    ds_read_b128 v[64:67], v4 offset:0
    s_waitcnt lgkmcnt(8)
    v_mfma_f32_32x32x16_bf16 a[16:31], v[116:119], v[80:83], a[16:31]
    ds_read_b64_tr_b16 v[96:97], v6 offset:16384
    s_waitcnt lgkmcnt(8)
    v_mfma_f32_32x32x16_bf16 a[64:79], v[112:115], v[84:87], a[64:79]
    ds_read_b64_tr_b16 v[98:99], v6 offset:18432
    v_mfma_f32_32x32x16_bf16 a[80:95], v[116:119], v[84:87], a[80:95]
    ds_read_b64_tr_b16 v[100:101], v7 offset:16384
    s_waitcnt lgkmcnt(8)
    v_mfma_f32_32x32x16_bf16 a[32:47], v[120:123], v[80:83], a[32:47]
    ds_read_b64_tr_b16 v[102:103], v7 offset:18432
    s_waitcnt lgkmcnt(7)
    v_mfma_f32_32x32x16_bf16 a[48:63], v[124:127], v[80:83], a[48:63]
    ds_read_b128 v[68:71], v4 offset:4096
    v_mfma_f32_32x32x16_bf16 a[96:111], v[120:123], v[84:87], a[96:111]
    ds_read_b64_tr_b16 v[104:105], v8 offset:16384
    v_mfma_f32_32x32x16_bf16 a[112:127], v[124:127], v[84:87], a[112:127]
    ds_read_b64_tr_b16 v[106:107], v8 offset:18432
    s_waitcnt lgkmcnt(9)
    v_mfma_f32_32x32x16_bf16 a[128:143], v[112:115], v[88:91], a[128:143]
    ds_read_b64_tr_b16 v[108:109], v9 offset:16384
    v_mfma_f32_32x32x16_bf16 a[144:159], v[116:119], v[88:91], a[144:159]
    ds_read_b64_tr_b16 v[110:111], v9 offset:18432
    v_mfma_f32_32x32x16_bf16 a[160:175], v[120:123], v[88:91], a[160:175]
    ds_read_b128 v[72:75], v4 offset:8192
    v_mfma_f32_32x32x16_bf16 a[176:191], v[124:127], v[88:91], a[176:191]
    ds_read_b128 v[76:79], v4 offset:12288
    s_waitcnt lgkmcnt(12)
    v_mfma_f32_32x32x16_bf16 a[192:207], v[112:115], v[92:95], a[192:207]
    v_mfma_f32_32x32x16_bf16 a[208:223], v[116:119], v[92:95], a[208:223]
    v_mfma_f32_32x32x16_bf16 a[224:239], v[120:123], v[92:95], a[224:239]
    v_mfma_f32_32x32x16_bf16 a[240:255], v[124:127], v[92:95], a[240:255]
    s_waitcnt lgkmcnt(9)
    v_mfma_f32_32x32x16_bf16 a[0:15], v[96:99], v[64:67], a[0:15]
    ds_read_b128 v[80:83], v5 offset:0
    s_waitcnt lgkmcnt(8)
    v_mfma_f32_32x32x16_bf16 a[16:31], v[100:103], v[64:67], a[16:31]
    ds_read_b64_tr_b16 v[112:113], v6 offset:24576
    s_waitcnt lgkmcnt(8)
    v_mfma_f32_32x32x16_bf16 a[64:79], v[96:99], v[68:71], a[64:79]
    ds_read_b64_tr_b16 v[114:115], v6 offset:26624
    v_mfma_f32_32x32x16_bf16 a[80:95], v[100:103], v[68:71], a[80:95]
    ds_read_b64_tr_b16 v[116:117], v7 offset:24576
    s_waitcnt lgkmcnt(8)
    v_mfma_f32_32x32x16_bf16 a[32:47], v[104:107], v[64:67], a[32:47]
    ds_read_b64_tr_b16 v[118:119], v7 offset:26624
    s_waitcnt lgkmcnt(7)
    v_mfma_f32_32x32x16_bf16 a[48:63], v[108:111], v[64:67], a[48:63]
    ds_read_b128 v[84:87], v5 offset:4096
    v_mfma_f32_32x32x16_bf16 a[96:111], v[104:107], v[68:71], a[96:111]
    ds_read_b64_tr_b16 v[120:121], v8 offset:24576
    v_mfma_f32_32x32x16_bf16 a[112:127], v[108:111], v[68:71], a[112:127]
    ds_read_b64_tr_b16 v[122:123], v8 offset:26624
    s_waitcnt lgkmcnt(9)
    v_mfma_f32_32x32x16_bf16 a[128:143], v[96:99], v[72:75], a[128:143]
    ds_read_b64_tr_b16 v[124:125], v9 offset:24576
    v_mfma_f32_32x32x16_bf16 a[144:159], v[100:103], v[72:75], a[144:159]
    ds_read_b64_tr_b16 v[126:127], v9 offset:26624
    v_mfma_f32_32x32x16_bf16 a[160:175], v[104:107], v[72:75], a[160:175]
    ds_read_b128 v[88:91], v5 offset:8192
    v_mfma_f32_32x32x16_bf16 a[176:191], v[108:111], v[72:75], a[176:191]
    ds_read_b128 v[92:95], v5 offset:12288
    s_waitcnt lgkmcnt(12)
    v_mfma_f32_32x32x16_bf16 a[192:207], v[96:99], v[76:79], a[192:207]
    v_mfma_f32_32x32x16_bf16 a[208:223], v[100:103], v[76:79], a[208:223]
    v_mfma_f32_32x32x16_bf16 a[224:239], v[104:107], v[76:79], a[224:239]
    v_mfma_f32_32x32x16_bf16 a[240:255], v[108:111], v[76:79], a[240:255]
    s_waitcnt lgkmcnt(9)
    v_mfma_f32_32x32x16_bf16 a[0:15], v[112:115], v[80:83], a[0:15]
    s_waitcnt lgkmcnt(7)
    v_mfma_f32_32x32x16_bf16 a[16:31], v[116:119], v[80:83], a[16:31]
    s_waitcnt lgkmcnt(6)
    v_mfma_f32_32x32x16_bf16 a[64:79], v[112:115], v[84:87], a[64:79]
    v_mfma_f32_32x32x16_bf16 a[80:95], v[116:119], v[84:87], a[80:95]
    s_waitcnt lgkmcnt(4)
    v_mfma_f32_32x32x16_bf16 a[32:47], v[120:123], v[80:83], a[32:47]
    s_waitcnt lgkmcnt(2)
    v_mfma_f32_32x32x16_bf16 a[48:63], v[124:127], v[80:83], a[48:63]
    v_mfma_f32_32x32x16_bf16 a[96:111], v[120:123], v[84:87], a[96:111]
    v_mfma_f32_32x32x16_bf16 a[112:127], v[124:127], v[84:87], a[112:127]
    s_waitcnt lgkmcnt(1)
    v_mfma_f32_32x32x16_bf16 a[128:143], v[112:115], v[88:91], a[128:143]
    v_mfma_f32_32x32x16_bf16 a[144:159], v[116:119], v[88:91], a[144:159]
    v_mfma_f32_32x32x16_bf16 a[160:175], v[120:123], v[88:91], a[160:175]
    v_mfma_f32_32x32x16_bf16 a[176:191], v[124:127], v[88:91], a[176:191]
    s_waitcnt lgkmcnt(0)
    v_mfma_f32_32x32x16_bf16 a[192:207], v[112:115], v[92:95], a[192:207]
    v_mfma_f32_32x32x16_bf16 a[208:223], v[116:119], v[92:95], a[208:223]
    v_mfma_f32_32x32x16_bf16 a[224:239], v[120:123], v[92:95], a[224:239]
    v_mfma_f32_32x32x16_bf16 a[240:255], v[124:127], v[92:95], a[240:255]
    s_add_u32 s52, s52, 128
    s_lshl_b32 s62, s45, 6
    s_add_u32 s53, s53, s62
    s_xor_b32 s54, s54, 0x10000
    s_xor_b32 s65, s65, 0x10000
    v_xor_b32 v2, 0x10000, v2
    v_xor_b32 v3, 0x10000, v3
    v_xor_b32 v4, 0x10000, v4
    v_xor_b32 v5, 0x10000, v5
    v_xor_b32 v6, 0x10000, v6
    v_xor_b32 v7, 0x10000, v7
    v_xor_b32 v8, 0x10000, v8
    v_xor_b32 v9, 0x10000, v9
    s_add_u32 s51, s51, 1
    s_cmp_lt_u32 s51, s50
    s_waitcnt lgkmcnt(0)
    s_cbranch_scc1 L_gh
    s_waitcnt vmcnt(0)
    s_barrier
    s_mul_i32 s55, s27, 24576
    s_add_u32 s55, s55, 65536
    v_and_b32 v14, 31, v1
    v_lshlrev_b32 v16, 8, v14
    v_lshrrev_b32 v15, 5, v1
    v_lshl_or_b32 v16, v15, 3, v16
    v_add_u32 v16, s55, v16
    v_and_b32 v14, 15, v1
    v_lshlrev_b32 v21, 4, v14
    v_lshrrev_b32 v15, 4, v1
    v_xor_b32 v14, v14, v15
    v_lshlrev_b32 v14, 4, v14
    v_lshl_or_b32 v17, v15, 8, v14
    v_add_u32 v17, s55, v17
    s_mul_i32 s56, s58, 128
    v_add_u32 v15, s56, v15
    v_mul_lo_u32 v15, v15, s46
    v_and_b32 v14, 15, v1
    v_lshlrev_b32 v14, 4, v14
    s_lshl_b32 s56, s59, 8
    v_add3_u32 v20, v14, v15, s56
    s_lshl_b32 s57, s46, 2
    s_mov_b32 s56, s49
    v_lshrrev_b32 v15, 5, v1
    v_lshlrev_b32 v15, 3, v15
    s_lshl_b32 s55, s59, 8
    s_add_u32 s55, s55, s60
    buffer_load_dwordx2 v[64:65], v15, s[68:71], s55 offen offset:0
    buffer_load_dwordx2 v[66:67], v15, s[68:71], s55 offen offset:16
    buffer_load_dwordx2 v[68:69], v15, s[68:71], s55 offen offset:32
    buffer_load_dwordx2 v[70:71], v15, s[68:71], s55 offen offset:48
    buffer_load_dwordx2 v[72:73], v15, s[68:71], s55 offen offset:64
    buffer_load_dwordx2 v[74:75], v15, s[68:71], s55 offen offset:80
    buffer_load_dwordx2 v[76:77], v15, s[68:71], s55 offen offset:96
    buffer_load_dwordx2 v[78:79], v15, s[68:71], s55 offen offset:112
    buffer_load_dwordx2 v[80:81], v15, s[68:71], s55 offen offset:128
    buffer_load_dwordx2 v[82:83], v15, s[68:71], s55 offen offset:144
    buffer_load_dwordx2 v[84:85], v15, s[68:71], s55 offen offset:160
    buffer_load_dwordx2 v[86:87], v15, s[68:71], s55 offen offset:176
    buffer_load_dwordx2 v[88:89], v15, s[68:71], s55 offen offset:192
    buffer_load_dwordx2 v[90:91], v15, s[68:71], s55 offen offset:208
    buffer_load_dwordx2 v[92:93], v15, s[68:71], s55 offen offset:224
    buffer_load_dwordx2 v[94:95], v15, s[68:71], s55 offen offset:240
    v_mov_b32 v18, 0x40135761
    v_mov_b32 v19, 0x40135761
    s_mov_b32 s64, 0x3dd2d3e8
    s_mov_b32 s65, 0x3dd2d3e8
    v_accvgpr_read_b32 v32, a0
    v_accvgpr_read_b32 v33, a1
    v_accvgpr_read_b32 v34, a2
    v_accvgpr_read_b32 v35, a3
    v_accvgpr_read_b32 v36, a4
    v_accvgpr_read_b32 v37, a5
    v_accvgpr_read_b32 v38, a6
    v_accvgpr_read_b32 v39, a7
    v_accvgpr_read_b32 v40, a8
    v_accvgpr_read_b32 v41, a9
    v_accvgpr_read_b32 v42, a10
    v_accvgpr_read_b32 v43, a11
    v_accvgpr_read_b32 v44, a12
    v_accvgpr_read_b32 v45, a13
    v_accvgpr_read_b32 v46, a14
    v_accvgpr_read_b32 v47, a15
    s_waitcnt vmcnt(15)
    v_lshlrev_b32 v48, 16, v64
    v_and_b32 v49, 0xffff0000, v64
    v_lshlrev_b32 v50, 16, v65
    v_and_b32 v51, 0xffff0000, v65
    v_pk_add_f32 v[32:33], v[32:33], v[48:49]
    v_pk_add_f32 v[34:35], v[34:35], v[50:51]
    v_pk_mul_f32 v[52:53], v[32:33], v[32:33]
    v_pk_mul_f32 v[54:55], v[34:35], v[34:35]
    v_pk_fma_f32 v[52:53], v[52:53], s[64:65], v[18:19]
    v_pk_fma_f32 v[54:55], v[54:55], s[64:65], v[18:19]
    v_pk_mul_f32 v[52:53], v[52:53], v[32:33]
    v_pk_mul_f32 v[54:55], v[54:55], v[34:35]
    v_exp_f32 v52, -v52
    v_exp_f32 v53, -v53
    v_exp_f32 v54, -v54
    v_exp_f32 v55, -v55
    v_pk_add_f32 v[52:53], v[52:53], 1.0 op_sel_hi:[1,0]
    v_pk_add_f32 v[54:55], v[54:55], 1.0 op_sel_hi:[1,0]
    v_rcp_f32 v52, v52
    v_rcp_f32 v53, v53
    v_rcp_f32 v54, v54
    v_rcp_f32 v55, v55
    v_pk_mul_f32 v[32:33], v[32:33], v[52:53]
    v_pk_mul_f32 v[34:35], v[34:35], v[54:55]
    v_cvt_pk_bf16_f32 v56, v32, v33
    v_cvt_pk_bf16_f32 v57, v34, v35
    v_xor_b32 v60, 0, v21
    v_add_u32 v60, v60, v16
    ds_write_b64 v60, v[56:57] offset:0
    s_waitcnt vmcnt(14)
    v_lshlrev_b32 v48, 16, v66
    v_and_b32 v49, 0xffff0000, v66
    v_lshlrev_b32 v50, 16, v67
    v_and_b32 v51, 0xffff0000, v67
    v_pk_add_f32 v[36:37], v[36:37], v[48:49]
    v_pk_add_f32 v[38:39], v[38:39], v[50:51]
    v_pk_mul_f32 v[52:53], v[36:37], v[36:37]
    v_pk_mul_f32 v[54:55], v[38:39], v[38:39]
    v_pk_fma_f32 v[52:53], v[52:53], s[64:65], v[18:19]
    v_pk_fma_f32 v[54:55], v[54:55], s[64:65], v[18:19]
    v_pk_mul_f32 v[52:53], v[52:53], v[36:37]
    v_pk_mul_f32 v[54:55], v[54:55], v[38:39]
    v_exp_f32 v52, -v52
    v_exp_f32 v53, -v53
    v_exp_f32 v54, -v54
    v_exp_f32 v55, -v55
    v_pk_add_f32 v[52:53], v[52:53], 1.0 op_sel_hi:[1,0]
    v_pk_add_f32 v[54:55], v[54:55], 1.0 op_sel_hi:[1,0]
    v_rcp_f32 v52, v52
    v_rcp_f32 v53, v53
    v_rcp_f32 v54, v54
    v_rcp_f32 v55, v55
    v_pk_mul_f32 v[36:37], v[36:37], v[52:53]
    v_pk_mul_f32 v[38:39], v[38:39], v[54:55]
    v_cvt_pk_bf16_f32 v58, v36, v37
    v_cvt_pk_bf16_f32 v59, v38, v39
    v_xor_b32 v61, 16, v21
    v_add_u32 v61, v61, v16
    ds_write_b64 v61, v[58:59] offset:0
    s_waitcnt vmcnt(13)
    v_lshlrev_b32 v48, 16, v68
    v_and_b32 v49, 0xffff0000, v68
    v_lshlrev_b32 v50, 16, v69
    v_and_b32 v51, 0xffff0000, v69
    v_pk_add_f32 v[40:41], v[40:41], v[48:49]
    v_pk_add_f32 v[42:43], v[42:43], v[50:51]
    v_pk_mul_f32 v[52:53], v[40:41], v[40:41]
    v_pk_mul_f32 v[54:55], v[42:43], v[42:43]
    v_pk_fma_f32 v[52:53], v[52:53], s[64:65], v[18:19]
    v_pk_fma_f32 v[54:55], v[54:55], s[64:65], v[18:19]
    v_pk_mul_f32 v[52:53], v[52:53], v[40:41]
    v_pk_mul_f32 v[54:55], v[54:55], v[42:43]
    v_exp_f32 v52, -v52
    v_exp_f32 v53, -v53
    v_exp_f32 v54, -v54
    v_exp_f32 v55, -v55
    v_pk_add_f32 v[52:53], v[52:53], 1.0 op_sel_hi:[1,0]
    v_pk_add_f32 v[54:55], v[54:55], 1.0 op_sel_hi:[1,0]
    v_rcp_f32 v52, v52
    v_rcp_f32 v53, v53
    v_rcp_f32 v54, v54
    v_rcp_f32 v55, v55
    v_pk_mul_f32 v[40:41], v[40:41], v[52:53]
    v_pk_mul_f32 v[42:43], v[42:43], v[54:55]
    v_cvt_pk_bf16_f32 v56, v40, v41
    v_cvt_pk_bf16_f32 v57, v42, v43
    v_xor_b32 v60, 32, v21
    v_add_u32 v60, v60, v16
    ds_write_b64 v60, v[56:57] offset:0
    s_waitcnt vmcnt(12)
    v_lshlrev_b32 v48, 16, v70
    v_and_b32 v49, 0xffff0000, v70
    v_lshlrev_b32 v50, 16, v71
    v_and_b32 v51, 0xffff0000, v71
    v_pk_add_f32 v[44:45], v[44:45], v[48:49]
    v_pk_add_f32 v[46:47], v[46:47], v[50:51]
    v_pk_mul_f32 v[52:53], v[44:45], v[44:45]
    v_pk_mul_f32 v[54:55], v[46:47], v[46:47]
    v_pk_fma_f32 v[52:53], v[52:53], s[64:65], v[18:19]
    v_pk_fma_f32 v[54:55], v[54:55], s[64:65], v[18:19]
    v_pk_mul_f32 v[52:53], v[52:53], v[44:45]
    v_pk_mul_f32 v[54:55], v[54:55], v[46:47]
    v_exp_f32 v52, -v52
    v_exp_f32 v53, -v53
    v_exp_f32 v54, -v54
    v_exp_f32 v55, -v55
    v_pk_add_f32 v[52:53], v[52:53], 1.0 op_sel_hi:[1,0]
    v_pk_add_f32 v[54:55], v[54:55], 1.0 op_sel_hi:[1,0]
    v_rcp_f32 v52, v52
    v_rcp_f32 v53, v53
    v_rcp_f32 v54, v54
    v_rcp_f32 v55, v55
    v_pk_mul_f32 v[44:45], v[44:45], v[52:53]
    v_pk_mul_f32 v[46:47], v[46:47], v[54:55]
    v_cvt_pk_bf16_f32 v58, v44, v45
    v_cvt_pk_bf16_f32 v59, v46, v47
    v_xor_b32 v61, 48, v21
    v_add_u32 v61, v61, v16
    ds_write_b64 v61, v[58:59] offset:0
    v_accvgpr_read_b32 v32, a16
    v_accvgpr_read_b32 v33, a17
    v_accvgpr_read_b32 v34, a18
    v_accvgpr_read_b32 v35, a19
    v_accvgpr_read_b32 v36, a20
    v_accvgpr_read_b32 v37, a21
    v_accvgpr_read_b32 v38, a22
    v_accvgpr_read_b32 v39, a23
    v_accvgpr_read_b32 v40, a24
    v_accvgpr_read_b32 v41, a25
    v_accvgpr_read_b32 v42, a26
    v_accvgpr_read_b32 v43, a27
    v_accvgpr_read_b32 v44, a28
    v_accvgpr_read_b32 v45, a29
    v_accvgpr_read_b32 v46, a30
    v_accvgpr_read_b32 v47, a31
    s_waitcnt vmcnt(11)
    v_lshlrev_b32 v48, 16, v72
    v_and_b32 v49, 0xffff0000, v72
    v_lshlrev_b32 v50, 16, v73
    v_and_b32 v51, 0xffff0000, v73
    v_pk_add_f32 v[32:33], v[32:33], v[48:49]
    v_pk_add_f32 v[34:35], v[34:35], v[50:51]
    v_pk_mul_f32 v[52:53], v[32:33], v[32:33]
    v_pk_mul_f32 v[54:55], v[34:35], v[34:35]
    v_pk_fma_f32 v[52:53], v[52:53], s[64:65], v[18:19]
    v_pk_fma_f32 v[54:55], v[54:55], s[64:65], v[18:19]
    v_pk_mul_f32 v[52:53], v[52:53], v[32:33]
    v_pk_mul_f32 v[54:55], v[54:55], v[34:35]
    v_exp_f32 v52, -v52
    v_exp_f32 v53, -v53
    v_exp_f32 v54, -v54
    v_exp_f32 v55, -v55
    v_pk_add_f32 v[52:53], v[52:53], 1.0 op_sel_hi:[1,0]
    v_pk_add_f32 v[54:55], v[54:55], 1.0 op_sel_hi:[1,0]
    v_rcp_f32 v52, v52
    v_rcp_f32 v53, v53
    v_rcp_f32 v54, v54
    v_rcp_f32 v55, v55
    v_pk_mul_f32 v[32:33], v[32:33], v[52:53]
    v_pk_mul_f32 v[34:35], v[34:35], v[54:55]
    v_cvt_pk_bf16_f32 v56, v32, v33
    v_cvt_pk_bf16_f32 v57, v34, v35
    v_xor_b32 v60, 64, v21
    v_add_u32 v60, v60, v16
    ds_write_b64 v60, v[56:57] offset:0
    s_waitcnt vmcnt(10)
    v_lshlrev_b32 v48, 16, v74
    v_and_b32 v49, 0xffff0000, v74
    v_lshlrev_b32 v50, 16, v75
    v_and_b32 v51, 0xffff0000, v75
    v_pk_add_f32 v[36:37], v[36:37], v[48:49]
    v_pk_add_f32 v[38:39], v[38:39], v[50:51]
    v_pk_mul_f32 v[52:53], v[36:37], v[36:37]
    v_pk_mul_f32 v[54:55], v[38:39], v[38:39]
    v_pk_fma_f32 v[52:53], v[52:53], s[64:65], v[18:19]
    v_pk_fma_f32 v[54:55], v[54:55], s[64:65], v[18:19]
    v_pk_mul_f32 v[52:53], v[52:53], v[36:37]
    v_pk_mul_f32 v[54:55], v[54:55], v[38:39]
    v_exp_f32 v52, -v52
    v_exp_f32 v53, -v53
    v_exp_f32 v54, -v54
    v_exp_f32 v55, -v55
    v_pk_add_f32 v[52:53], v[52:53], 1.0 op_sel_hi:[1,0]
    v_pk_add_f32 v[54:55], v[54:55], 1.0 op_sel_hi:[1,0]
    v_rcp_f32 v52, v52
    v_rcp_f32 v53, v53
    v_rcp_f32 v54, v54
    v_rcp_f32 v55, v55
    v_pk_mul_f32 v[36:37], v[36:37], v[52:53]
    v_pk_mul_f32 v[38:39], v[38:39], v[54:55]
    v_cvt_pk_bf16_f32 v58, v36, v37
    v_cvt_pk_bf16_f32 v59, v38, v39
    v_xor_b32 v61, 80, v21
    v_add_u32 v61, v61, v16
    ds_write_b64 v61, v[58:59] offset:0
    s_waitcnt vmcnt(9)
    v_lshlrev_b32 v48, 16, v76
    v_and_b32 v49, 0xffff0000, v76
    v_lshlrev_b32 v50, 16, v77
    v_and_b32 v51, 0xffff0000, v77
    v_pk_add_f32 v[40:41], v[40:41], v[48:49]
    v_pk_add_f32 v[42:43], v[42:43], v[50:51]
    v_pk_mul_f32 v[52:53], v[40:41], v[40:41]
    v_pk_mul_f32 v[54:55], v[42:43], v[42:43]
    v_pk_fma_f32 v[52:53], v[52:53], s[64:65], v[18:19]
    v_pk_fma_f32 v[54:55], v[54:55], s[64:65], v[18:19]
    v_pk_mul_f32 v[52:53], v[52:53], v[40:41]
    v_pk_mul_f32 v[54:55], v[54:55], v[42:43]
    v_exp_f32 v52, -v52
    v_exp_f32 v53, -v53
    v_exp_f32 v54, -v54
    v_exp_f32 v55, -v55
    v_pk_add_f32 v[52:53], v[52:53], 1.0 op_sel_hi:[1,0]
    v_pk_add_f32 v[54:55], v[54:55], 1.0 op_sel_hi:[1,0]
    v_rcp_f32 v52, v52
    v_rcp_f32 v53, v53
    v_rcp_f32 v54, v54
    v_rcp_f32 v55, v55
    v_pk_mul_f32 v[40:41], v[40:41], v[52:53]
    v_pk_mul_f32 v[42:43], v[42:43], v[54:55]
    v_cvt_pk_bf16_f32 v56, v40, v41
    v_cvt_pk_bf16_f32 v57, v42, v43
    v_xor_b32 v60, 96, v21
    v_add_u32 v60, v60, v16
    ds_write_b64 v60, v[56:57] offset:0
    s_waitcnt vmcnt(8)
    v_lshlrev_b32 v48, 16, v78
    v_and_b32 v49, 0xffff0000, v78
    v_lshlrev_b32 v50, 16, v79
    v_and_b32 v51, 0xffff0000, v79
    v_pk_add_f32 v[44:45], v[44:45], v[48:49]
    v_pk_add_f32 v[46:47], v[46:47], v[50:51]
    v_pk_mul_f32 v[52:53], v[44:45], v[44:45]
    v_pk_mul_f32 v[54:55], v[46:47], v[46:47]
    v_pk_fma_f32 v[52:53], v[52:53], s[64:65], v[18:19]
    v_pk_fma_f32 v[54:55], v[54:55], s[64:65], v[18:19]
    v_pk_mul_f32 v[52:53], v[52:53], v[44:45]
    v_pk_mul_f32 v[54:55], v[54:55], v[46:47]
    v_exp_f32 v52, -v52
    v_exp_f32 v53, -v53
    v_exp_f32 v54, -v54
    v_exp_f32 v55, -v55
    v_pk_add_f32 v[52:53], v[52:53], 1.0 op_sel_hi:[1,0]
    v_pk_add_f32 v[54:55], v[54:55], 1.0 op_sel_hi:[1,0]
    v_rcp_f32 v52, v52
    v_rcp_f32 v53, v53
    v_rcp_f32 v54, v54
    v_rcp_f32 v55, v55
    v_pk_mul_f32 v[44:45], v[44:45], v[52:53]
    v_pk_mul_f32 v[46:47], v[46:47], v[54:55]
    v_cvt_pk_bf16_f32 v58, v44, v45
    v_cvt_pk_bf16_f32 v59, v46, v47
    v_xor_b32 v61, 112, v21
    v_add_u32 v61, v61, v16
    ds_write_b64 v61, v[58:59] offset:0
    v_accvgpr_read_b32 v32, a32
    v_accvgpr_read_b32 v33, a33
    v_accvgpr_read_b32 v34, a34
    v_accvgpr_read_b32 v35, a35
    v_accvgpr_read_b32 v36, a36
    v_accvgpr_read_b32 v37, a37
    v_accvgpr_read_b32 v38, a38
    v_accvgpr_read_b32 v39, a39
    v_accvgpr_read_b32 v40, a40
    v_accvgpr_read_b32 v41, a41
    v_accvgpr_read_b32 v42, a42
    v_accvgpr_read_b32 v43, a43
    v_accvgpr_read_b32 v44, a44
    v_accvgpr_read_b32 v45, a45
    v_accvgpr_read_b32 v46, a46
    v_accvgpr_read_b32 v47, a47
    s_waitcnt vmcnt(7)
    v_lshlrev_b32 v48, 16, v80
    v_and_b32 v49, 0xffff0000, v80
    v_lshlrev_b32 v50, 16, v81
    v_and_b32 v51, 0xffff0000, v81
    v_pk_add_f32 v[32:33], v[32:33], v[48:49]
    v_pk_add_f32 v[34:35], v[34:35], v[50:51]
    v_pk_mul_f32 v[52:53], v[32:33], v[32:33]
    v_pk_mul_f32 v[54:55], v[34:35], v[34:35]
    v_pk_fma_f32 v[52:53], v[52:53], s[64:65], v[18:19]
    v_pk_fma_f32 v[54:55], v[54:55], s[64:65], v[18:19]
    v_pk_mul_f32 v[52:53], v[52:53], v[32:33]
    v_pk_mul_f32 v[54:55], v[54:55], v[34:35]
    v_exp_f32 v52, -v52
    v_exp_f32 v53, -v53
    v_exp_f32 v54, -v54
    v_exp_f32 v55, -v55
    v_pk_add_f32 v[52:53], v[52:53], 1.0 op_sel_hi:[1,0]
    v_pk_add_f32 v[54:55], v[54:55], 1.0 op_sel_hi:[1,0]
    v_rcp_f32 v52, v52
    v_rcp_f32 v53, v53
    v_rcp_f32 v54, v54
    v_rcp_f32 v55, v55
    v_pk_mul_f32 v[32:33], v[32:33], v[52:53]
    v_pk_mul_f32 v[34:35], v[34:35], v[54:55]
    v_cvt_pk_bf16_f32 v56, v32, v33
    v_cvt_pk_bf16_f32 v57, v34, v35
    v_xor_b32 v60, 128, v21
    v_add_u32 v60, v60, v16
    ds_write_b64 v60, v[56:57] offset:0
    s_waitcnt vmcnt(6)
    v_lshlrev_b32 v48, 16, v82
    v_and_b32 v49, 0xffff0000, v82
    v_lshlrev_b32 v50, 16, v83
    v_and_b32 v51, 0xffff0000, v83
    v_pk_add_f32 v[36:37], v[36:37], v[48:49]
    v_pk_add_f32 v[38:39], v[38:39], v[50:51]
    v_pk_mul_f32 v[52:53], v[36:37], v[36:37]
    v_pk_mul_f32 v[54:55], v[38:39], v[38:39]
    v_pk_fma_f32 v[52:53], v[52:53], s[64:65], v[18:19]
    v_pk_fma_f32 v[54:55], v[54:55], s[64:65], v[18:19]
    v_pk_mul_f32 v[52:53], v[52:53], v[36:37]
    v_pk_mul_f32 v[54:55], v[54:55], v[38:39]
    v_exp_f32 v52, -v52
    v_exp_f32 v53, -v53
    v_exp_f32 v54, -v54
    v_exp_f32 v55, -v55
    v_pk_add_f32 v[52:53], v[52:53], 1.0 op_sel_hi:[1,0]
    v_pk_add_f32 v[54:55], v[54:55], 1.0 op_sel_hi:[1,0]
    v_rcp_f32 v52, v52
    v_rcp_f32 v53, v53
    v_rcp_f32 v54, v54
    v_rcp_f32 v55, v55
    v_pk_mul_f32 v[36:37], v[36:37], v[52:53]
    v_pk_mul_f32 v[38:39], v[38:39], v[54:55]
    v_cvt_pk_bf16_f32 v58, v36, v37
    v_cvt_pk_bf16_f32 v59, v38, v39
    v_xor_b32 v61, 144, v21
    v_add_u32 v61, v61, v16
    ds_write_b64 v61, v[58:59] offset:0
    s_waitcnt vmcnt(5)
    v_lshlrev_b32 v48, 16, v84
    v_and_b32 v49, 0xffff0000, v84
    v_lshlrev_b32 v50, 16, v85
    v_and_b32 v51, 0xffff0000, v85
    v_pk_add_f32 v[40:41], v[40:41], v[48:49]
    v_pk_add_f32 v[42:43], v[42:43], v[50:51]
    v_pk_mul_f32 v[52:53], v[40:41], v[40:41]
    v_pk_mul_f32 v[54:55], v[42:43], v[42:43]
    v_pk_fma_f32 v[52:53], v[52:53], s[64:65], v[18:19]
    v_pk_fma_f32 v[54:55], v[54:55], s[64:65], v[18:19]
    v_pk_mul_f32 v[52:53], v[52:53], v[40:41]
    v_pk_mul_f32 v[54:55], v[54:55], v[42:43]
    v_exp_f32 v52, -v52
    v_exp_f32 v53, -v53
    v_exp_f32 v54, -v54
    v_exp_f32 v55, -v55
    v_pk_add_f32 v[52:53], v[52:53], 1.0 op_sel_hi:[1,0]
    v_pk_add_f32 v[54:55], v[54:55], 1.0 op_sel_hi:[1,0]
    v_rcp_f32 v52, v52
    v_rcp_f32 v53, v53
    v_rcp_f32 v54, v54
    v_rcp_f32 v55, v55
    v_pk_mul_f32 v[40:41], v[40:41], v[52:53]
    v_pk_mul_f32 v[42:43], v[42:43], v[54:55]
    v_cvt_pk_bf16_f32 v56, v40, v41
    v_cvt_pk_bf16_f32 v57, v42, v43
    v_xor_b32 v60, 160, v21
    v_add_u32 v60, v60, v16
    ds_write_b64 v60, v[56:57] offset:0
    s_waitcnt vmcnt(4)
    v_lshlrev_b32 v48, 16, v86
    v_and_b32 v49, 0xffff0000, v86
    v_lshlrev_b32 v50, 16, v87
    v_and_b32 v51, 0xffff0000, v87
    v_pk_add_f32 v[44:45], v[44:45], v[48:49]
    v_pk_add_f32 v[46:47], v[46:47], v[50:51]
    v_pk_mul_f32 v[52:53], v[44:45], v[44:45]
    v_pk_mul_f32 v[54:55], v[46:47], v[46:47]
    v_pk_fma_f32 v[52:53], v[52:53], s[64:65], v[18:19]
    v_pk_fma_f32 v[54:55], v[54:55], s[64:65], v[18:19]
    v_pk_mul_f32 v[52:53], v[52:53], v[44:45]
    v_pk_mul_f32 v[54:55], v[54:55], v[46:47]
    v_exp_f32 v52, -v52
    v_exp_f32 v53, -v53
    v_exp_f32 v54, -v54
    v_exp_f32 v55, -v55
    v_pk_add_f32 v[52:53], v[52:53], 1.0 op_sel_hi:[1,0]
    v_pk_add_f32 v[54:55], v[54:55], 1.0 op_sel_hi:[1,0]
    v_rcp_f32 v52, v52
    v_rcp_f32 v53, v53
    v_rcp_f32 v54, v54
    v_rcp_f32 v55, v55
    v_pk_mul_f32 v[44:45], v[44:45], v[52:53]
    v_pk_mul_f32 v[46:47], v[46:47], v[54:55]
    v_cvt_pk_bf16_f32 v58, v44, v45
    v_cvt_pk_bf16_f32 v59, v46, v47
    v_xor_b32 v61, 176, v21
    v_add_u32 v61, v61, v16
    ds_write_b64 v61, v[58:59] offset:0
    v_accvgpr_read_b32 v32, a48
    v_accvgpr_read_b32 v33, a49
    v_accvgpr_read_b32 v34, a50
    v_accvgpr_read_b32 v35, a51
    v_accvgpr_read_b32 v36, a52
    v_accvgpr_read_b32 v37, a53
    v_accvgpr_read_b32 v38, a54
    v_accvgpr_read_b32 v39, a55
    v_accvgpr_read_b32 v40, a56
    v_accvgpr_read_b32 v41, a57
    v_accvgpr_read_b32 v42, a58
    v_accvgpr_read_b32 v43, a59
    v_accvgpr_read_b32 v44, a60
    v_accvgpr_read_b32 v45, a61
    v_accvgpr_read_b32 v46, a62
    v_accvgpr_read_b32 v47, a63
    s_waitcnt vmcnt(3)
    v_lshlrev_b32 v48, 16, v88
    v_and_b32 v49, 0xffff0000, v88
    v_lshlrev_b32 v50, 16, v89
    v_and_b32 v51, 0xffff0000, v89
    v_pk_add_f32 v[32:33], v[32:33], v[48:49]
    v_pk_add_f32 v[34:35], v[34:35], v[50:51]
    v_pk_mul_f32 v[52:53], v[32:33], v[32:33]
    v_pk_mul_f32 v[54:55], v[34:35], v[34:35]
    v_pk_fma_f32 v[52:53], v[52:53], s[64:65], v[18:19]
    v_pk_fma_f32 v[54:55], v[54:55], s[64:65], v[18:19]
    v_pk_mul_f32 v[52:53], v[52:53], v[32:33]
    v_pk_mul_f32 v[54:55], v[54:55], v[34:35]
    v_exp_f32 v52, -v52
    v_exp_f32 v53, -v53
    v_exp_f32 v54, -v54
    v_exp_f32 v55, -v55
    v_pk_add_f32 v[52:53], v[52:53], 1.0 op_sel_hi:[1,0]
    v_pk_add_f32 v[54:55], v[54:55], 1.0 op_sel_hi:[1,0]
    v_rcp_f32 v52, v52
    v_rcp_f32 v53, v53
    v_rcp_f32 v54, v54
    v_rcp_f32 v55, v55
    v_pk_mul_f32 v[32:33], v[32:33], v[52:53]
    v_pk_mul_f32 v[34:35], v[34:35], v[54:55]
    v_cvt_pk_bf16_f32 v56, v32, v33
    v_cvt_pk_bf16_f32 v57, v34, v35
    v_xor_b32 v60, 192, v21
    v_add_u32 v60, v60, v16
    ds_write_b64 v60, v[56:57] offset:0
    s_waitcnt vmcnt(2)
    v_lshlrev_b32 v48, 16, v90
    v_and_b32 v49, 0xffff0000, v90
    v_lshlrev_b32 v50, 16, v91
    v_and_b32 v51, 0xffff0000, v91
    v_pk_add_f32 v[36:37], v[36:37], v[48:49]
    v_pk_add_f32 v[38:39], v[38:39], v[50:51]
    v_pk_mul_f32 v[52:53], v[36:37], v[36:37]
    v_pk_mul_f32 v[54:55], v[38:39], v[38:39]
    v_pk_fma_f32 v[52:53], v[52:53], s[64:65], v[18:19]
    v_pk_fma_f32 v[54:55], v[54:55], s[64:65], v[18:19]
    v_pk_mul_f32 v[52:53], v[52:53], v[36:37]
    v_pk_mul_f32 v[54:55], v[54:55], v[38:39]
    v_exp_f32 v52, -v52
    v_exp_f32 v53, -v53
    v_exp_f32 v54, -v54
    v_exp_f32 v55, -v55
    v_pk_add_f32 v[52:53], v[52:53], 1.0 op_sel_hi:[1,0]
    v_pk_add_f32 v[54:55], v[54:55], 1.0 op_sel_hi:[1,0]
    v_rcp_f32 v52, v52
    v_rcp_f32 v53, v53
    v_rcp_f32 v54, v54
    v_rcp_f32 v55, v55
    v_pk_mul_f32 v[36:37], v[36:37], v[52:53]
    v_pk_mul_f32 v[38:39], v[38:39], v[54:55]
    v_cvt_pk_bf16_f32 v58, v36, v37
    v_cvt_pk_bf16_f32 v59, v38, v39
    v_xor_b32 v61, 208, v21
    v_add_u32 v61, v61, v16
    ds_write_b64 v61, v[58:59] offset:0
    s_waitcnt vmcnt(1)
    v_lshlrev_b32 v48, 16, v92
    v_and_b32 v49, 0xffff0000, v92
    v_lshlrev_b32 v50, 16, v93
    v_and_b32 v51, 0xffff0000, v93
    v_pk_add_f32 v[40:41], v[40:41], v[48:49]
    v_pk_add_f32 v[42:43], v[42:43], v[50:51]
    v_pk_mul_f32 v[52:53], v[40:41], v[40:41]
    v_pk_mul_f32 v[54:55], v[42:43], v[42:43]
    v_pk_fma_f32 v[52:53], v[52:53], s[64:65], v[18:19]
    v_pk_fma_f32 v[54:55], v[54:55], s[64:65], v[18:19]
    v_pk_mul_f32 v[52:53], v[52:53], v[40:41]
    v_pk_mul_f32 v[54:55], v[54:55], v[42:43]
    v_exp_f32 v52, -v52
    v_exp_f32 v53, -v53
    v_exp_f32 v54, -v54
    v_exp_f32 v55, -v55
    v_pk_add_f32 v[52:53], v[52:53], 1.0 op_sel_hi:[1,0]
    v_pk_add_f32 v[54:55], v[54:55], 1.0 op_sel_hi:[1,0]
    v_rcp_f32 v52, v52
    v_rcp_f32 v53, v53
    v_rcp_f32 v54, v54
    v_rcp_f32 v55, v55
    v_pk_mul_f32 v[40:41], v[40:41], v[52:53]
    v_pk_mul_f32 v[42:43], v[42:43], v[54:55]
    v_cvt_pk_bf16_f32 v56, v40, v41
    v_cvt_pk_bf16_f32 v57, v42, v43
    v_xor_b32 v60, 224, v21
    v_add_u32 v60, v60, v16
    ds_write_b64 v60, v[56:57] offset:0
    s_waitcnt vmcnt(0)
    v_lshlrev_b32 v48, 16, v94
    v_and_b32 v49, 0xffff0000, v94
    v_lshlrev_b32 v50, 16, v95
    v_and_b32 v51, 0xffff0000, v95
    v_pk_add_f32 v[44:45], v[44:45], v[48:49]
    v_pk_add_f32 v[46:47], v[46:47], v[50:51]
    v_pk_mul_f32 v[52:53], v[44:45], v[44:45]
    v_pk_mul_f32 v[54:55], v[46:47], v[46:47]
    v_pk_fma_f32 v[52:53], v[52:53], s[64:65], v[18:19]
    v_pk_fma_f32 v[54:55], v[54:55], s[64:65], v[18:19]
    v_pk_mul_f32 v[52:53], v[52:53], v[44:45]
    v_pk_mul_f32 v[54:55], v[54:55], v[46:47]
    v_exp_f32 v52, -v52
    v_exp_f32 v53, -v53
    v_exp_f32 v54, -v54
    v_exp_f32 v55, -v55
    v_pk_add_f32 v[52:53], v[52:53], 1.0 op_sel_hi:[1,0]
    v_pk_add_f32 v[54:55], v[54:55], 1.0 op_sel_hi:[1,0]
    v_rcp_f32 v52, v52
    v_rcp_f32 v53, v53
    v_rcp_f32 v54, v54
    v_rcp_f32 v55, v55
    v_pk_mul_f32 v[44:45], v[44:45], v[52:53]
    v_pk_mul_f32 v[46:47], v[46:47], v[54:55]
    v_cvt_pk_bf16_f32 v58, v44, v45
    v_cvt_pk_bf16_f32 v59, v46, v47
    v_xor_b32 v61, 240, v21
    v_add_u32 v61, v61, v16
    s_waitcnt lgkmcnt(14)
    ds_write_b64 v61, v[58:59] offset:0
    v_accvgpr_read_b32 v32, a64
    v_accvgpr_read_b32 v33, a65
    v_accvgpr_read_b32 v34, a66
    v_accvgpr_read_b32 v35, a67
    v_accvgpr_read_b32 v36, a68
    v_accvgpr_read_b32 v37, a69
    v_accvgpr_read_b32 v38, a70
    v_accvgpr_read_b32 v39, a71
    v_accvgpr_read_b32 v40, a72
    v_accvgpr_read_b32 v41, a73
    v_accvgpr_read_b32 v42, a74
    v_accvgpr_read_b32 v43, a75
    v_accvgpr_read_b32 v44, a76
    v_accvgpr_read_b32 v45, a77
    v_accvgpr_read_b32 v46, a78
    v_accvgpr_read_b32 v47, a79
    v_lshlrev_b32 v48, 16, v64
    v_and_b32 v49, 0xffff0000, v64
    v_lshlrev_b32 v50, 16, v65
    v_and_b32 v51, 0xffff0000, v65
    v_pk_add_f32 v[32:33], v[32:33], v[48:49]
    v_pk_add_f32 v[34:35], v[34:35], v[50:51]
    v_pk_mul_f32 v[52:53], v[32:33], v[32:33]
    v_pk_mul_f32 v[54:55], v[34:35], v[34:35]
    v_pk_fma_f32 v[52:53], v[52:53], s[64:65], v[18:19]
    v_pk_fma_f32 v[54:55], v[54:55], s[64:65], v[18:19]
    v_pk_mul_f32 v[52:53], v[52:53], v[32:33]
    v_pk_mul_f32 v[54:55], v[54:55], v[34:35]
    v_exp_f32 v52, -v52
    v_exp_f32 v53, -v53
    v_exp_f32 v54, -v54
    v_exp_f32 v55, -v55
    v_pk_add_f32 v[52:53], v[52:53], 1.0 op_sel_hi:[1,0]
    v_pk_add_f32 v[54:55], v[54:55], 1.0 op_sel_hi:[1,0]
    v_rcp_f32 v52, v52
    v_rcp_f32 v53, v53
    v_rcp_f32 v54, v54
    v_rcp_f32 v55, v55
    v_pk_mul_f32 v[32:33], v[32:33], v[52:53]
    v_pk_mul_f32 v[34:35], v[34:35], v[54:55]
    v_cvt_pk_bf16_f32 v56, v32, v33
    v_cvt_pk_bf16_f32 v57, v34, v35
    v_xor_b32 v60, 0, v21
    v_add_u32 v60, v60, v16
    s_waitcnt lgkmcnt(14)
    ds_write_b64 v60, v[56:57] offset:8192
    v_lshlrev_b32 v48, 16, v66
    v_and_b32 v49, 0xffff0000, v66
    v_lshlrev_b32 v50, 16, v67
    v_and_b32 v51, 0xffff0000, v67
    v_pk_add_f32 v[36:37], v[36:37], v[48:49]
    v_pk_add_f32 v[38:39], v[38:39], v[50:51]
    v_pk_mul_f32 v[52:53], v[36:37], v[36:37]
    v_pk_mul_f32 v[54:55], v[38:39], v[38:39]
    v_pk_fma_f32 v[52:53], v[52:53], s[64:65], v[18:19]
    v_pk_fma_f32 v[54:55], v[54:55], s[64:65], v[18:19]
    v_pk_mul_f32 v[52:53], v[52:53], v[36:37]
    v_pk_mul_f32 v[54:55], v[54:55], v[38:39]
    v_exp_f32 v52, -v52
    v_exp_f32 v53, -v53
    v_exp_f32 v54, -v54
    v_exp_f32 v55, -v55
    v_pk_add_f32 v[52:53], v[52:53], 1.0 op_sel_hi:[1,0]
    v_pk_add_f32 v[54:55], v[54:55], 1.0 op_sel_hi:[1,0]
    v_rcp_f32 v52, v52
    v_rcp_f32 v53, v53
    v_rcp_f32 v54, v54
    v_rcp_f32 v55, v55
    v_pk_mul_f32 v[36:37], v[36:37], v[52:53]
    v_pk_mul_f32 v[38:39], v[38:39], v[54:55]
    v_cvt_pk_bf16_f32 v58, v36, v37
    v_cvt_pk_bf16_f32 v59, v38, v39
    v_xor_b32 v61, 16, v21
    v_add_u32 v61, v61, v16
    s_waitcnt lgkmcnt(14)
    ds_write_b64 v61, v[58:59] offset:8192
    v_lshlrev_b32 v48, 16, v68
    v_and_b32 v49, 0xffff0000, v68
    v_lshlrev_b32 v50, 16, v69
    v_and_b32 v51, 0xffff0000, v69
    v_pk_add_f32 v[40:41], v[40:41], v[48:49]
    v_pk_add_f32 v[42:43], v[42:43], v[50:51]
    v_pk_mul_f32 v[52:53], v[40:41], v[40:41]
    v_pk_mul_f32 v[54:55], v[42:43], v[42:43]
    v_pk_fma_f32 v[52:53], v[52:53], s[64:65], v[18:19]
    v_pk_fma_f32 v[54:55], v[54:55], s[64:65], v[18:19]
    v_pk_mul_f32 v[52:53], v[52:53], v[40:41]
    v_pk_mul_f32 v[54:55], v[54:55], v[42:43]
    v_exp_f32 v52, -v52
    v_exp_f32 v53, -v53
    v_exp_f32 v54, -v54
    v_exp_f32 v55, -v55
    v_pk_add_f32 v[52:53], v[52:53], 1.0 op_sel_hi:[1,0]
    v_pk_add_f32 v[54:55], v[54:55], 1.0 op_sel_hi:[1,0]
    v_rcp_f32 v52, v52
    v_rcp_f32 v53, v53
    v_rcp_f32 v54, v54
    v_rcp_f32 v55, v55
    v_pk_mul_f32 v[40:41], v[40:41], v[52:53]
    v_pk_mul_f32 v[42:43], v[42:43], v[54:55]
    v_cvt_pk_bf16_f32 v56, v40, v41
    v_cvt_pk_bf16_f32 v57, v42, v43
    v_xor_b32 v60, 32, v21
    v_add_u32 v60, v60, v16
    s_waitcnt lgkmcnt(14)
    ds_write_b64 v60, v[56:57] offset:8192
    v_lshlrev_b32 v48, 16, v70
    v_and_b32 v49, 0xffff0000, v70
    v_lshlrev_b32 v50, 16, v71
    v_and_b32 v51, 0xffff0000, v71
    v_pk_add_f32 v[44:45], v[44:45], v[48:49]
    v_pk_add_f32 v[46:47], v[46:47], v[50:51]
    v_pk_mul_f32 v[52:53], v[44:45], v[44:45]
    v_pk_mul_f32 v[54:55], v[46:47], v[46:47]
    v_pk_fma_f32 v[52:53], v[52:53], s[64:65], v[18:19]
    v_pk_fma_f32 v[54:55], v[54:55], s[64:65], v[18:19]
    v_pk_mul_f32 v[52:53], v[52:53], v[44:45]
    v_pk_mul_f32 v[54:55], v[54:55], v[46:47]
    v_exp_f32 v52, -v52
    v_exp_f32 v53, -v53
    v_exp_f32 v54, -v54
    v_exp_f32 v55, -v55
    v_pk_add_f32 v[52:53], v[52:53], 1.0 op_sel_hi:[1,0]
    v_pk_add_f32 v[54:55], v[54:55], 1.0 op_sel_hi:[1,0]
    v_rcp_f32 v52, v52
    v_rcp_f32 v53, v53
    v_rcp_f32 v54, v54
    v_rcp_f32 v55, v55
    v_pk_mul_f32 v[44:45], v[44:45], v[52:53]
    v_pk_mul_f32 v[46:47], v[46:47], v[54:55]
    v_cvt_pk_bf16_f32 v58, v44, v45
    v_cvt_pk_bf16_f32 v59, v46, v47
    v_xor_b32 v61, 48, v21
    v_add_u32 v61, v61, v16
    s_waitcnt lgkmcnt(14)
    ds_write_b64 v61, v[58:59] offset:8192
    v_accvgpr_read_b32 v32, a80
    v_accvgpr_read_b32 v33, a81
    v_accvgpr_read_b32 v34, a82
    v_accvgpr_read_b32 v35, a83
    v_accvgpr_read_b32 v36, a84
    v_accvgpr_read_b32 v37, a85
    v_accvgpr_read_b32 v38, a86
    v_accvgpr_read_b32 v39, a87
    v_accvgpr_read_b32 v40, a88
    v_accvgpr_read_b32 v41, a89
    v_accvgpr_read_b32 v42, a90
    v_accvgpr_read_b32 v43, a91
    v_accvgpr_read_b32 v44, a92
    v_accvgpr_read_b32 v45, a93
    v_accvgpr_read_b32 v46, a94
    v_accvgpr_read_b32 v47, a95
    v_lshlrev_b32 v48, 16, v72
    v_and_b32 v49, 0xffff0000, v72
    v_lshlrev_b32 v50, 16, v73
    v_and_b32 v51, 0xffff0000, v73
    v_pk_add_f32 v[32:33], v[32:33], v[48:49]
    v_pk_add_f32 v[34:35], v[34:35], v[50:51]
    v_pk_mul_f32 v[52:53], v[32:33], v[32:33]
    v_pk_mul_f32 v[54:55], v[34:35], v[34:35]
    v_pk_fma_f32 v[52:53], v[52:53], s[64:65], v[18:19]
    v_pk_fma_f32 v[54:55], v[54:55], s[64:65], v[18:19]
    v_pk_mul_f32 v[52:53], v[52:53], v[32:33]
    v_pk_mul_f32 v[54:55], v[54:55], v[34:35]
    v_exp_f32 v52, -v52
    v_exp_f32 v53, -v53
    v_exp_f32 v54, -v54
    v_exp_f32 v55, -v55
    v_pk_add_f32 v[52:53], v[52:53], 1.0 op_sel_hi:[1,0]
    v_pk_add_f32 v[54:55], v[54:55], 1.0 op_sel_hi:[1,0]
    v_rcp_f32 v52, v52
    v_rcp_f32 v53, v53
    v_rcp_f32 v54, v54
    v_rcp_f32 v55, v55
    v_pk_mul_f32 v[32:33], v[32:33], v[52:53]
    v_pk_mul_f32 v[34:35], v[34:35], v[54:55]
    v_cvt_pk_bf16_f32 v56, v32, v33
    v_cvt_pk_bf16_f32 v57, v34, v35
    v_xor_b32 v60, 64, v21
    v_add_u32 v60, v60, v16
    s_waitcnt lgkmcnt(14)
    ds_write_b64 v60, v[56:57] offset:8192
    v_lshlrev_b32 v48, 16, v74
    v_and_b32 v49, 0xffff0000, v74
    v_lshlrev_b32 v50, 16, v75
    v_and_b32 v51, 0xffff0000, v75
    v_pk_add_f32 v[36:37], v[36:37], v[48:49]
    v_pk_add_f32 v[38:39], v[38:39], v[50:51]
    v_pk_mul_f32 v[52:53], v[36:37], v[36:37]
    v_pk_mul_f32 v[54:55], v[38:39], v[38:39]
    v_pk_fma_f32 v[52:53], v[52:53], s[64:65], v[18:19]
    v_pk_fma_f32 v[54:55], v[54:55], s[64:65], v[18:19]
    v_pk_mul_f32 v[52:53], v[52:53], v[36:37]
    v_pk_mul_f32 v[54:55], v[54:55], v[38:39]
    v_exp_f32 v52, -v52
    v_exp_f32 v53, -v53
    v_exp_f32 v54, -v54
    v_exp_f32 v55, -v55
    v_pk_add_f32 v[52:53], v[52:53], 1.0 op_sel_hi:[1,0]
    v_pk_add_f32 v[54:55], v[54:55], 1.0 op_sel_hi:[1,0]
    v_rcp_f32 v52, v52
    v_rcp_f32 v53, v53
    v_rcp_f32 v54, v54
    v_rcp_f32 v55, v55
    v_pk_mul_f32 v[36:37], v[36:37], v[52:53]
    v_pk_mul_f32 v[38:39], v[38:39], v[54:55]
    v_cvt_pk_bf16_f32 v58, v36, v37
    v_cvt_pk_bf16_f32 v59, v38, v39
    v_xor_b32 v61, 80, v21
    v_add_u32 v61, v61, v16
    s_waitcnt lgkmcnt(14)
    ds_write_b64 v61, v[58:59] offset:8192
    v_lshlrev_b32 v48, 16, v76
    v_and_b32 v49, 0xffff0000, v76
    v_lshlrev_b32 v50, 16, v77
    v_and_b32 v51, 0xffff0000, v77
    v_pk_add_f32 v[40:41], v[40:41], v[48:49]
    v_pk_add_f32 v[42:43], v[42:43], v[50:51]
    v_pk_mul_f32 v[52:53], v[40:41], v[40:41]
    v_pk_mul_f32 v[54:55], v[42:43], v[42:43]
    v_pk_fma_f32 v[52:53], v[52:53], s[64:65], v[18:19]
    v_pk_fma_f32 v[54:55], v[54:55], s[64:65], v[18:19]
    v_pk_mul_f32 v[52:53], v[52:53], v[40:41]
    v_pk_mul_f32 v[54:55], v[54:55], v[42:43]
    v_exp_f32 v52, -v52
    v_exp_f32 v53, -v53
    v_exp_f32 v54, -v54
    v_exp_f32 v55, -v55
    v_pk_add_f32 v[52:53], v[52:53], 1.0 op_sel_hi:[1,0]
    v_pk_add_f32 v[54:55], v[54:55], 1.0 op_sel_hi:[1,0]
    v_rcp_f32 v52, v52
    v_rcp_f32 v53, v53
    v_rcp_f32 v54, v54
    v_rcp_f32 v55, v55
    v_pk_mul_f32 v[40:41], v[40:41], v[52:53]
    v_pk_mul_f32 v[42:43], v[42:43], v[54:55]
    v_cvt_pk_bf16_f32 v56, v40, v41
    v_cvt_pk_bf16_f32 v57, v42, v43
    v_xor_b32 v60, 96, v21
    v_add_u32 v60, v60, v16
    s_waitcnt lgkmcnt(14)
    ds_write_b64 v60, v[56:57] offset:8192
    v_lshlrev_b32 v48, 16, v78
    v_and_b32 v49, 0xffff0000, v78
    v_lshlrev_b32 v50, 16, v79
    v_and_b32 v51, 0xffff0000, v79
    v_pk_add_f32 v[44:45], v[44:45], v[48:49]
    v_pk_add_f32 v[46:47], v[46:47], v[50:51]
    v_pk_mul_f32 v[52:53], v[44:45], v[44:45]
    v_pk_mul_f32 v[54:55], v[46:47], v[46:47]
    v_pk_fma_f32 v[52:53], v[52:53], s[64:65], v[18:19]
    v_pk_fma_f32 v[54:55], v[54:55], s[64:65], v[18:19]
    v_pk_mul_f32 v[52:53], v[52:53], v[44:45]
    v_pk_mul_f32 v[54:55], v[54:55], v[46:47]
    v_exp_f32 v52, -v52
    v_exp_f32 v53, -v53
    v_exp_f32 v54, -v54
    v_exp_f32 v55, -v55
    v_pk_add_f32 v[52:53], v[52:53], 1.0 op_sel_hi:[1,0]
    v_pk_add_f32 v[54:55], v[54:55], 1.0 op_sel_hi:[1,0]
    v_rcp_f32 v52, v52
    v_rcp_f32 v53, v53
    v_rcp_f32 v54, v54
    v_rcp_f32 v55, v55
    v_pk_mul_f32 v[44:45], v[44:45], v[52:53]
    v_pk_mul_f32 v[46:47], v[46:47], v[54:55]
    v_cvt_pk_bf16_f32 v58, v44, v45
    v_cvt_pk_bf16_f32 v59, v46, v47
    v_xor_b32 v61, 112, v21
    v_add_u32 v61, v61, v16
    s_waitcnt lgkmcnt(14)
    ds_write_b64 v61, v[58:59] offset:8192
    v_accvgpr_read_b32 v32, a96
    v_accvgpr_read_b32 v33, a97
    v_accvgpr_read_b32 v34, a98
    v_accvgpr_read_b32 v35, a99
    v_accvgpr_read_b32 v36, a100
    v_accvgpr_read_b32 v37, a101
    v_accvgpr_read_b32 v38, a102
    v_accvgpr_read_b32 v39, a103
    v_accvgpr_read_b32 v40, a104
    v_accvgpr_read_b32 v41, a105
    v_accvgpr_read_b32 v42, a106
    v_accvgpr_read_b32 v43, a107
    v_accvgpr_read_b32 v44, a108
    v_accvgpr_read_b32 v45, a109
    v_accvgpr_read_b32 v46, a110
    v_accvgpr_read_b32 v47, a111
    v_lshlrev_b32 v48, 16, v80
    v_and_b32 v49, 0xffff0000, v80
    v_lshlrev_b32 v50, 16, v81
    v_and_b32 v51, 0xffff0000, v81
    v_pk_add_f32 v[32:33], v[32:33], v[48:49]
    v_pk_add_f32 v[34:35], v[34:35], v[50:51]
    v_pk_mul_f32 v[52:53], v[32:33], v[32:33]
    v_pk_mul_f32 v[54:55], v[34:35], v[34:35]
    v_pk_fma_f32 v[52:53], v[52:53], s[64:65], v[18:19]
    v_pk_fma_f32 v[54:55], v[54:55], s[64:65], v[18:19]
    v_pk_mul_f32 v[52:53], v[52:53], v[32:33]
    v_pk_mul_f32 v[54:55], v[54:55], v[34:35]
    v_exp_f32 v52, -v52
    v_exp_f32 v53, -v53
    v_exp_f32 v54, -v54
    v_exp_f32 v55, -v55
    v_pk_add_f32 v[52:53], v[52:53], 1.0 op_sel_hi:[1,0]
    v_pk_add_f32 v[54:55], v[54:55], 1.0 op_sel_hi:[1,0]
    v_rcp_f32 v52, v52
    v_rcp_f32 v53, v53
    v_rcp_f32 v54, v54
    v_rcp_f32 v55, v55
    v_pk_mul_f32 v[32:33], v[32:33], v[52:53]
    v_pk_mul_f32 v[34:35], v[34:35], v[54:55]
    v_cvt_pk_bf16_f32 v56, v32, v33
    v_cvt_pk_bf16_f32 v57, v34, v35
    v_xor_b32 v60, 128, v21
    v_add_u32 v60, v60, v16
    s_waitcnt lgkmcnt(14)
    ds_write_b64 v60, v[56:57] offset:8192
    v_lshlrev_b32 v48, 16, v82
    v_and_b32 v49, 0xffff0000, v82
    v_lshlrev_b32 v50, 16, v83
    v_and_b32 v51, 0xffff0000, v83
    v_pk_add_f32 v[36:37], v[36:37], v[48:49]
    v_pk_add_f32 v[38:39], v[38:39], v[50:51]
    v_pk_mul_f32 v[52:53], v[36:37], v[36:37]
    v_pk_mul_f32 v[54:55], v[38:39], v[38:39]
    v_pk_fma_f32 v[52:53], v[52:53], s[64:65], v[18:19]
    v_pk_fma_f32 v[54:55], v[54:55], s[64:65], v[18:19]
    v_pk_mul_f32 v[52:53], v[52:53], v[36:37]
    v_pk_mul_f32 v[54:55], v[54:55], v[38:39]
    v_exp_f32 v52, -v52
    v_exp_f32 v53, -v53
    v_exp_f32 v54, -v54
    v_exp_f32 v55, -v55
    v_pk_add_f32 v[52:53], v[52:53], 1.0 op_sel_hi:[1,0]
    v_pk_add_f32 v[54:55], v[54:55], 1.0 op_sel_hi:[1,0]
    v_rcp_f32 v52, v52
    v_rcp_f32 v53, v53
    v_rcp_f32 v54, v54
    v_rcp_f32 v55, v55
    v_pk_mul_f32 v[36:37], v[36:37], v[52:53]
    v_pk_mul_f32 v[38:39], v[38:39], v[54:55]
    v_cvt_pk_bf16_f32 v58, v36, v37
    v_cvt_pk_bf16_f32 v59, v38, v39
    v_xor_b32 v61, 144, v21
    v_add_u32 v61, v61, v16
    s_waitcnt lgkmcnt(14)
    ds_write_b64 v61, v[58:59] offset:8192
    v_lshlrev_b32 v48, 16, v84
    v_and_b32 v49, 0xffff0000, v84
    v_lshlrev_b32 v50, 16, v85
    v_and_b32 v51, 0xffff0000, v85
    v_pk_add_f32 v[40:41], v[40:41], v[48:49]
    v_pk_add_f32 v[42:43], v[42:43], v[50:51]
    v_pk_mul_f32 v[52:53], v[40:41], v[40:41]
    v_pk_mul_f32 v[54:55], v[42:43], v[42:43]
    v_pk_fma_f32 v[52:53], v[52:53], s[64:65], v[18:19]
    v_pk_fma_f32 v[54:55], v[54:55], s[64:65], v[18:19]
    v_pk_mul_f32 v[52:53], v[52:53], v[40:41]
    v_pk_mul_f32 v[54:55], v[54:55], v[42:43]
    v_exp_f32 v52, -v52
    v_exp_f32 v53, -v53
    v_exp_f32 v54, -v54
    v_exp_f32 v55, -v55
    v_pk_add_f32 v[52:53], v[52:53], 1.0 op_sel_hi:[1,0]
    v_pk_add_f32 v[54:55], v[54:55], 1.0 op_sel_hi:[1,0]
    v_rcp_f32 v52, v52
    v_rcp_f32 v53, v53
    v_rcp_f32 v54, v54
    v_rcp_f32 v55, v55
    v_pk_mul_f32 v[40:41], v[40:41], v[52:53]
    v_pk_mul_f32 v[42:43], v[42:43], v[54:55]
    v_cvt_pk_bf16_f32 v56, v40, v41
    v_cvt_pk_bf16_f32 v57, v42, v43
    v_xor_b32 v60, 160, v21
    v_add_u32 v60, v60, v16
    s_waitcnt lgkmcnt(14)
    ds_write_b64 v60, v[56:57] offset:8192
    v_lshlrev_b32 v48, 16, v86
    v_and_b32 v49, 0xffff0000, v86
    v_lshlrev_b32 v50, 16, v87
    v_and_b32 v51, 0xffff0000, v87
    v_pk_add_f32 v[44:45], v[44:45], v[48:49]
    v_pk_add_f32 v[46:47], v[46:47], v[50:51]
    v_pk_mul_f32 v[52:53], v[44:45], v[44:45]
    v_pk_mul_f32 v[54:55], v[46:47], v[46:47]
    v_pk_fma_f32 v[52:53], v[52:53], s[64:65], v[18:19]
    v_pk_fma_f32 v[54:55], v[54:55], s[64:65], v[18:19]
    v_pk_mul_f32 v[52:53], v[52:53], v[44:45]
    v_pk_mul_f32 v[54:55], v[54:55], v[46:47]
    v_exp_f32 v52, -v52
    v_exp_f32 v53, -v53
    v_exp_f32 v54, -v54
    v_exp_f32 v55, -v55
    v_pk_add_f32 v[52:53], v[52:53], 1.0 op_sel_hi:[1,0]
    v_pk_add_f32 v[54:55], v[54:55], 1.0 op_sel_hi:[1,0]
    v_rcp_f32 v52, v52
    v_rcp_f32 v53, v53
    v_rcp_f32 v54, v54
    v_rcp_f32 v55, v55
    v_pk_mul_f32 v[44:45], v[44:45], v[52:53]
    v_pk_mul_f32 v[46:47], v[46:47], v[54:55]
    v_cvt_pk_bf16_f32 v58, v44, v45
    v_cvt_pk_bf16_f32 v59, v46, v47
    v_xor_b32 v61, 176, v21
    v_add_u32 v61, v61, v16
    s_waitcnt lgkmcnt(14)
    ds_write_b64 v61, v[58:59] offset:8192
    v_accvgpr_read_b32 v32, a112
    v_accvgpr_read_b32 v33, a113
    v_accvgpr_read_b32 v34, a114
    v_accvgpr_read_b32 v35, a115
    v_accvgpr_read_b32 v36, a116
    v_accvgpr_read_b32 v37, a117
    v_accvgpr_read_b32 v38, a118
    v_accvgpr_read_b32 v39, a119
    v_accvgpr_read_b32 v40, a120
    v_accvgpr_read_b32 v41, a121
    v_accvgpr_read_b32 v42, a122
    v_accvgpr_read_b32 v43, a123
    v_accvgpr_read_b32 v44, a124
    v_accvgpr_read_b32 v45, a125
    v_accvgpr_read_b32 v46, a126
    v_accvgpr_read_b32 v47, a127
    v_lshlrev_b32 v48, 16, v88
    v_and_b32 v49, 0xffff0000, v88
    v_lshlrev_b32 v50, 16, v89
    v_and_b32 v51, 0xffff0000, v89
    v_pk_add_f32 v[32:33], v[32:33], v[48:49]
    v_pk_add_f32 v[34:35], v[34:35], v[50:51]
    v_pk_mul_f32 v[52:53], v[32:33], v[32:33]
    v_pk_mul_f32 v[54:55], v[34:35], v[34:35]
    v_pk_fma_f32 v[52:53], v[52:53], s[64:65], v[18:19]
    v_pk_fma_f32 v[54:55], v[54:55], s[64:65], v[18:19]
    v_pk_mul_f32 v[52:53], v[52:53], v[32:33]
    v_pk_mul_f32 v[54:55], v[54:55], v[34:35]
    v_exp_f32 v52, -v52
    v_exp_f32 v53, -v53
    v_exp_f32 v54, -v54
    v_exp_f32 v55, -v55
    v_pk_add_f32 v[52:53], v[52:53], 1.0 op_sel_hi:[1,0]
    v_pk_add_f32 v[54:55], v[54:55], 1.0 op_sel_hi:[1,0]
    v_rcp_f32 v52, v52
    v_rcp_f32 v53, v53
    v_rcp_f32 v54, v54
    v_rcp_f32 v55, v55
    v_pk_mul_f32 v[32:33], v[32:33], v[52:53]
    v_pk_mul_f32 v[34:35], v[34:35], v[54:55]
    v_cvt_pk_bf16_f32 v56, v32, v33
    v_cvt_pk_bf16_f32 v57, v34, v35
    v_xor_b32 v60, 192, v21
    v_add_u32 v60, v60, v16
    s_waitcnt lgkmcnt(14)
    ds_write_b64 v60, v[56:57] offset:8192
    v_lshlrev_b32 v48, 16, v90
    v_and_b32 v49, 0xffff0000, v90
    v_lshlrev_b32 v50, 16, v91
    v_and_b32 v51, 0xffff0000, v91
    v_pk_add_f32 v[36:37], v[36:37], v[48:49]
    v_pk_add_f32 v[38:39], v[38:39], v[50:51]
    v_pk_mul_f32 v[52:53], v[36:37], v[36:37]
    v_pk_mul_f32 v[54:55], v[38:39], v[38:39]
    v_pk_fma_f32 v[52:53], v[52:53], s[64:65], v[18:19]
    v_pk_fma_f32 v[54:55], v[54:55], s[64:65], v[18:19]
    v_pk_mul_f32 v[52:53], v[52:53], v[36:37]
    v_pk_mul_f32 v[54:55], v[54:55], v[38:39]
    v_exp_f32 v52, -v52
    v_exp_f32 v53, -v53
    v_exp_f32 v54, -v54
    v_exp_f32 v55, -v55
    v_pk_add_f32 v[52:53], v[52:53], 1.0 op_sel_hi:[1,0]
    v_pk_add_f32 v[54:55], v[54:55], 1.0 op_sel_hi:[1,0]
    v_rcp_f32 v52, v52
    v_rcp_f32 v53, v53
    v_rcp_f32 v54, v54
    v_rcp_f32 v55, v55
    v_pk_mul_f32 v[36:37], v[36:37], v[52:53]
    v_pk_mul_f32 v[38:39], v[38:39], v[54:55]
    v_cvt_pk_bf16_f32 v58, v36, v37
    v_cvt_pk_bf16_f32 v59, v38, v39
    v_xor_b32 v61, 208, v21
    v_add_u32 v61, v61, v16
    s_waitcnt lgkmcnt(14)
    ds_write_b64 v61, v[58:59] offset:8192
    v_lshlrev_b32 v48, 16, v92
    v_and_b32 v49, 0xffff0000, v92
    v_lshlrev_b32 v50, 16, v93
    v_and_b32 v51, 0xffff0000, v93
    v_pk_add_f32 v[40:41], v[40:41], v[48:49]
    v_pk_add_f32 v[42:43], v[42:43], v[50:51]
    v_pk_mul_f32 v[52:53], v[40:41], v[40:41]
    v_pk_mul_f32 v[54:55], v[42:43], v[42:43]
    v_pk_fma_f32 v[52:53], v[52:53], s[64:65], v[18:19]
    v_pk_fma_f32 v[54:55], v[54:55], s[64:65], v[18:19]
    v_pk_mul_f32 v[52:53], v[52:53], v[40:41]
    v_pk_mul_f32 v[54:55], v[54:55], v[42:43]
    v_exp_f32 v52, -v52
    v_exp_f32 v53, -v53
    v_exp_f32 v54, -v54
    v_exp_f32 v55, -v55
    v_pk_add_f32 v[52:53], v[52:53], 1.0 op_sel_hi:[1,0]
    v_pk_add_f32 v[54:55], v[54:55], 1.0 op_sel_hi:[1,0]
    v_rcp_f32 v52, v52
    v_rcp_f32 v53, v53
    v_rcp_f32 v54, v54
    v_rcp_f32 v55, v55
    v_pk_mul_f32 v[40:41], v[40:41], v[52:53]
    v_pk_mul_f32 v[42:43], v[42:43], v[54:55]
    v_cvt_pk_bf16_f32 v56, v40, v41
    v_cvt_pk_bf16_f32 v57, v42, v43
    v_xor_b32 v60, 224, v21
    v_add_u32 v60, v60, v16
    s_waitcnt lgkmcnt(14)
    ds_write_b64 v60, v[56:57] offset:8192
    v_lshlrev_b32 v48, 16, v94
    v_and_b32 v49, 0xffff0000, v94
    v_lshlrev_b32 v50, 16, v95
    v_and_b32 v51, 0xffff0000, v95
    v_pk_add_f32 v[44:45], v[44:45], v[48:49]
    v_pk_add_f32 v[46:47], v[46:47], v[50:51]
    v_pk_mul_f32 v[52:53], v[44:45], v[44:45]
    v_pk_mul_f32 v[54:55], v[46:47], v[46:47]
    v_pk_fma_f32 v[52:53], v[52:53], s[64:65], v[18:19]
    v_pk_fma_f32 v[54:55], v[54:55], s[64:65], v[18:19]
    v_pk_mul_f32 v[52:53], v[52:53], v[44:45]
    v_pk_mul_f32 v[54:55], v[54:55], v[46:47]
    v_exp_f32 v52, -v52
    v_exp_f32 v53, -v53
    v_exp_f32 v54, -v54
    v_exp_f32 v55, -v55
    v_pk_add_f32 v[52:53], v[52:53], 1.0 op_sel_hi:[1,0]
    v_pk_add_f32 v[54:55], v[54:55], 1.0 op_sel_hi:[1,0]
    v_rcp_f32 v52, v52
    v_rcp_f32 v53, v53
    v_rcp_f32 v54, v54
    v_rcp_f32 v55, v55
    v_pk_mul_f32 v[44:45], v[44:45], v[52:53]
    v_pk_mul_f32 v[46:47], v[46:47], v[54:55]
    v_cvt_pk_bf16_f32 v58, v44, v45
    v_cvt_pk_bf16_f32 v59, v46, v47
    v_xor_b32 v61, 240, v21
    v_add_u32 v61, v61, v16
    s_waitcnt lgkmcnt(14)
    ds_write_b64 v61, v[58:59] offset:8192
    s_waitcnt lgkmcnt(0)
    v_xor_b32 v62, 0, v17
    ds_read_b128 v[96:99], v62 offset:0
    v_xor_b32 v63, 64, v17
    ds_read_b128 v[100:103], v63 offset:1024
    v_xor_b32 v62, 128, v17
    ds_read_b128 v[104:107], v62 offset:2048
    v_xor_b32 v63, 192, v17
    ds_read_b128 v[108:111], v63 offset:3072
    v_xor_b32 v62, 0, v17
    ds_read_b128 v[112:115], v62 offset:4096
    v_xor_b32 v63, 64, v17
    ds_read_b128 v[116:119], v63 offset:5120
    v_xor_b32 v62, 128, v17
    ds_read_b128 v[120:123], v62 offset:6144
    v_xor_b32 v63, 192, v17
    ds_read_b128 v[124:127], v63 offset:7168
    s_waitcnt lgkmcnt(7)
    buffer_store_dwordx4 v[96:99], v20, s[40:43], s56 offen sc1
    s_add_u32 s56, s56, s57
    s_waitcnt lgkmcnt(6)
    buffer_store_dwordx4 v[100:103], v20, s[40:43], s56 offen sc1
    s_add_u32 s56, s56, s57
    s_waitcnt lgkmcnt(5)
    buffer_store_dwordx4 v[104:107], v20, s[40:43], s56 offen sc1
    s_add_u32 s56, s56, s57
    s_waitcnt lgkmcnt(4)
    buffer_store_dwordx4 v[108:111], v20, s[40:43], s56 offen sc1
    s_add_u32 s56, s56, s57
    s_waitcnt lgkmcnt(3)
    buffer_store_dwordx4 v[112:115], v20, s[40:43], s56 offen sc1
    s_add_u32 s56, s56, s57
    s_waitcnt lgkmcnt(2)
    buffer_store_dwordx4 v[116:119], v20, s[40:43], s56 offen sc1
    s_add_u32 s56, s56, s57
    s_waitcnt lgkmcnt(1)
    buffer_store_dwordx4 v[120:123], v20, s[40:43], s56 offen sc1
    s_add_u32 s56, s56, s57
    s_waitcnt lgkmcnt(0)
    buffer_store_dwordx4 v[124:127], v20, s[40:43], s56 offen sc1
    s_add_u32 s56, s56, s57
    v_xor_b32 v62, 0, v17
    ds_read_b128 v[96:99], v62 offset:8192
    v_xor_b32 v63, 64, v17
    ds_read_b128 v[100:103], v63 offset:9216
    v_xor_b32 v62, 128, v17
    ds_read_b128 v[104:107], v62 offset:10240
    v_xor_b32 v63, 192, v17
    ds_read_b128 v[108:111], v63 offset:11264
    v_xor_b32 v62, 0, v17
    ds_read_b128 v[112:115], v62 offset:12288
    v_xor_b32 v63, 64, v17
    ds_read_b128 v[116:119], v63 offset:13312
    v_xor_b32 v62, 128, v17
    ds_read_b128 v[120:123], v62 offset:14336
    v_xor_b32 v63, 192, v17
    ds_read_b128 v[124:127], v63 offset:15360
    s_waitcnt lgkmcnt(7)
    buffer_store_dwordx4 v[96:99], v20, s[40:43], s56 offen sc1
    s_add_u32 s56, s56, s57
    s_waitcnt lgkmcnt(6)
    buffer_store_dwordx4 v[100:103], v20, s[40:43], s56 offen sc1
    s_add_u32 s56, s56, s57
    s_waitcnt lgkmcnt(5)
    buffer_store_dwordx4 v[104:107], v20, s[40:43], s56 offen sc1
    s_add_u32 s56, s56, s57
    s_waitcnt lgkmcnt(4)
    buffer_store_dwordx4 v[108:111], v20, s[40:43], s56 offen sc1
    s_add_u32 s56, s56, s57
    s_waitcnt lgkmcnt(3)
    buffer_store_dwordx4 v[112:115], v20, s[40:43], s56 offen sc1
    s_add_u32 s56, s56, s57
    s_waitcnt lgkmcnt(2)
    buffer_store_dwordx4 v[116:119], v20, s[40:43], s56 offen sc1
    s_add_u32 s56, s56, s57
    s_waitcnt lgkmcnt(1)
    buffer_store_dwordx4 v[120:123], v20, s[40:43], s56 offen sc1
    s_add_u32 s56, s56, s57
    s_waitcnt lgkmcnt(0)
    buffer_store_dwordx4 v[124:127], v20, s[40:43], s56 offen sc1
    s_add_u32 s56, s56, s57
    s_waitcnt lgkmcnt(0)
    v_accvgpr_read_b32 v32, a128
    v_accvgpr_read_b32 v33, a129
    v_accvgpr_read_b32 v34, a130
    v_accvgpr_read_b32 v35, a131
    v_accvgpr_read_b32 v36, a132
    v_accvgpr_read_b32 v37, a133
    v_accvgpr_read_b32 v38, a134
    v_accvgpr_read_b32 v39, a135
    v_accvgpr_read_b32 v40, a136
    v_accvgpr_read_b32 v41, a137
    v_accvgpr_read_b32 v42, a138
    v_accvgpr_read_b32 v43, a139
    v_accvgpr_read_b32 v44, a140
    v_accvgpr_read_b32 v45, a141
    v_accvgpr_read_b32 v46, a142
    v_accvgpr_read_b32 v47, a143
    v_lshlrev_b32 v48, 16, v64
    v_and_b32 v49, 0xffff0000, v64
    v_lshlrev_b32 v50, 16, v65
    v_and_b32 v51, 0xffff0000, v65
    v_pk_add_f32 v[32:33], v[32:33], v[48:49]
    v_pk_add_f32 v[34:35], v[34:35], v[50:51]
    v_pk_mul_f32 v[52:53], v[32:33], v[32:33]
    v_pk_mul_f32 v[54:55], v[34:35], v[34:35]
    v_pk_fma_f32 v[52:53], v[52:53], s[64:65], v[18:19]
    v_pk_fma_f32 v[54:55], v[54:55], s[64:65], v[18:19]
    v_pk_mul_f32 v[52:53], v[52:53], v[32:33]
    v_pk_mul_f32 v[54:55], v[54:55], v[34:35]
    v_exp_f32 v52, -v52
    v_exp_f32 v53, -v53
    v_exp_f32 v54, -v54
    v_exp_f32 v55, -v55
    v_pk_add_f32 v[52:53], v[52:53], 1.0 op_sel_hi:[1,0]
    v_pk_add_f32 v[54:55], v[54:55], 1.0 op_sel_hi:[1,0]
    v_rcp_f32 v52, v52
    v_rcp_f32 v53, v53
    v_rcp_f32 v54, v54
    v_rcp_f32 v55, v55
    v_pk_mul_f32 v[32:33], v[32:33], v[52:53]
    v_pk_mul_f32 v[34:35], v[34:35], v[54:55]
    v_cvt_pk_bf16_f32 v56, v32, v33
    v_cvt_pk_bf16_f32 v57, v34, v35
    v_xor_b32 v60, 0, v21
    v_add_u32 v60, v60, v16
    ds_write_b64 v60, v[56:57] offset:0
    v_lshlrev_b32 v48, 16, v66
    v_and_b32 v49, 0xffff0000, v66
    v_lshlrev_b32 v50, 16, v67
    v_and_b32 v51, 0xffff0000, v67
    v_pk_add_f32 v[36:37], v[36:37], v[48:49]
    v_pk_add_f32 v[38:39], v[38:39], v[50:51]
    v_pk_mul_f32 v[52:53], v[36:37], v[36:37]
    v_pk_mul_f32 v[54:55], v[38:39], v[38:39]
    v_pk_fma_f32 v[52:53], v[52:53], s[64:65], v[18:19]
    v_pk_fma_f32 v[54:55], v[54:55], s[64:65], v[18:19]
    v_pk_mul_f32 v[52:53], v[52:53], v[36:37]
    v_pk_mul_f32 v[54:55], v[54:55], v[38:39]
    v_exp_f32 v52, -v52
    v_exp_f32 v53, -v53
    v_exp_f32 v54, -v54
    v_exp_f32 v55, -v55
    v_pk_add_f32 v[52:53], v[52:53], 1.0 op_sel_hi:[1,0]
    v_pk_add_f32 v[54:55], v[54:55], 1.0 op_sel_hi:[1,0]
    v_rcp_f32 v52, v52
    v_rcp_f32 v53, v53
    v_rcp_f32 v54, v54
    v_rcp_f32 v55, v55
    v_pk_mul_f32 v[36:37], v[36:37], v[52:53]
    v_pk_mul_f32 v[38:39], v[38:39], v[54:55]
    v_cvt_pk_bf16_f32 v58, v36, v37
    v_cvt_pk_bf16_f32 v59, v38, v39
    v_xor_b32 v61, 16, v21
    v_add_u32 v61, v61, v16
    ds_write_b64 v61, v[58:59] offset:0
    v_lshlrev_b32 v48, 16, v68
    v_and_b32 v49, 0xffff0000, v68
    v_lshlrev_b32 v50, 16, v69
    v_and_b32 v51, 0xffff0000, v69
    v_pk_add_f32 v[40:41], v[40:41], v[48:49]
    v_pk_add_f32 v[42:43], v[42:43], v[50:51]
    v_pk_mul_f32 v[52:53], v[40:41], v[40:41]
    v_pk_mul_f32 v[54:55], v[42:43], v[42:43]
    v_pk_fma_f32 v[52:53], v[52:53], s[64:65], v[18:19]
    v_pk_fma_f32 v[54:55], v[54:55], s[64:65], v[18:19]
    v_pk_mul_f32 v[52:53], v[52:53], v[40:41]
    v_pk_mul_f32 v[54:55], v[54:55], v[42:43]
    v_exp_f32 v52, -v52
    v_exp_f32 v53, -v53
    v_exp_f32 v54, -v54
    v_exp_f32 v55, -v55
    v_pk_add_f32 v[52:53], v[52:53], 1.0 op_sel_hi:[1,0]
    v_pk_add_f32 v[54:55], v[54:55], 1.0 op_sel_hi:[1,0]
    v_rcp_f32 v52, v52
    v_rcp_f32 v53, v53
    v_rcp_f32 v54, v54
    v_rcp_f32 v55, v55
    v_pk_mul_f32 v[40:41], v[40:41], v[52:53]
    v_pk_mul_f32 v[42:43], v[42:43], v[54:55]
    v_cvt_pk_bf16_f32 v56, v40, v41
    v_cvt_pk_bf16_f32 v57, v42, v43
    v_xor_b32 v60, 32, v21
    v_add_u32 v60, v60, v16
    ds_write_b64 v60, v[56:57] offset:0
    v_lshlrev_b32 v48, 16, v70
    v_and_b32 v49, 0xffff0000, v70
    v_lshlrev_b32 v50, 16, v71
    v_and_b32 v51, 0xffff0000, v71
    v_pk_add_f32 v[44:45], v[44:45], v[48:49]
    v_pk_add_f32 v[46:47], v[46:47], v[50:51]
    v_pk_mul_f32 v[52:53], v[44:45], v[44:45]
    v_pk_mul_f32 v[54:55], v[46:47], v[46:47]
    v_pk_fma_f32 v[52:53], v[52:53], s[64:65], v[18:19]
    v_pk_fma_f32 v[54:55], v[54:55], s[64:65], v[18:19]
    v_pk_mul_f32 v[52:53], v[52:53], v[44:45]
    v_pk_mul_f32 v[54:55], v[54:55], v[46:47]
    v_exp_f32 v52, -v52
    v_exp_f32 v53, -v53
    v_exp_f32 v54, -v54
    v_exp_f32 v55, -v55
    v_pk_add_f32 v[52:53], v[52:53], 1.0 op_sel_hi:[1,0]
    v_pk_add_f32 v[54:55], v[54:55], 1.0 op_sel_hi:[1,0]
    v_rcp_f32 v52, v52
    v_rcp_f32 v53, v53
    v_rcp_f32 v54, v54
    v_rcp_f32 v55, v55
    v_pk_mul_f32 v[44:45], v[44:45], v[52:53]
    v_pk_mul_f32 v[46:47], v[46:47], v[54:55]
    v_cvt_pk_bf16_f32 v58, v44, v45
    v_cvt_pk_bf16_f32 v59, v46, v47
    v_xor_b32 v61, 48, v21
    v_add_u32 v61, v61, v16
    ds_write_b64 v61, v[58:59] offset:0
    v_accvgpr_read_b32 v32, a144
    v_accvgpr_read_b32 v33, a145
    v_accvgpr_read_b32 v34, a146
    v_accvgpr_read_b32 v35, a147
    v_accvgpr_read_b32 v36, a148
    v_accvgpr_read_b32 v37, a149
    v_accvgpr_read_b32 v38, a150
    v_accvgpr_read_b32 v39, a151
    v_accvgpr_read_b32 v40, a152
    v_accvgpr_read_b32 v41, a153
    v_accvgpr_read_b32 v42, a154
    v_accvgpr_read_b32 v43, a155
    v_accvgpr_read_b32 v44, a156
    v_accvgpr_read_b32 v45, a157
    v_accvgpr_read_b32 v46, a158
    v_accvgpr_read_b32 v47, a159
    v_lshlrev_b32 v48, 16, v72
    v_and_b32 v49, 0xffff0000, v72
    v_lshlrev_b32 v50, 16, v73
    v_and_b32 v51, 0xffff0000, v73
    v_pk_add_f32 v[32:33], v[32:33], v[48:49]
    v_pk_add_f32 v[34:35], v[34:35], v[50:51]
    v_pk_mul_f32 v[52:53], v[32:33], v[32:33]
    v_pk_mul_f32 v[54:55], v[34:35], v[34:35]
    v_pk_fma_f32 v[52:53], v[52:53], s[64:65], v[18:19]
    v_pk_fma_f32 v[54:55], v[54:55], s[64:65], v[18:19]
    v_pk_mul_f32 v[52:53], v[52:53], v[32:33]
    v_pk_mul_f32 v[54:55], v[54:55], v[34:35]
    v_exp_f32 v52, -v52
    v_exp_f32 v53, -v53
    v_exp_f32 v54, -v54
    v_exp_f32 v55, -v55
    v_pk_add_f32 v[52:53], v[52:53], 1.0 op_sel_hi:[1,0]
    v_pk_add_f32 v[54:55], v[54:55], 1.0 op_sel_hi:[1,0]
    v_rcp_f32 v52, v52
    v_rcp_f32 v53, v53
    v_rcp_f32 v54, v54
    v_rcp_f32 v55, v55
    v_pk_mul_f32 v[32:33], v[32:33], v[52:53]
    v_pk_mul_f32 v[34:35], v[34:35], v[54:55]
    v_cvt_pk_bf16_f32 v56, v32, v33
    v_cvt_pk_bf16_f32 v57, v34, v35
    v_xor_b32 v60, 64, v21
    v_add_u32 v60, v60, v16
    ds_write_b64 v60, v[56:57] offset:0
    v_lshlrev_b32 v48, 16, v74
    v_and_b32 v49, 0xffff0000, v74
    v_lshlrev_b32 v50, 16, v75
    v_and_b32 v51, 0xffff0000, v75
    v_pk_add_f32 v[36:37], v[36:37], v[48:49]
    v_pk_add_f32 v[38:39], v[38:39], v[50:51]
    v_pk_mul_f32 v[52:53], v[36:37], v[36:37]
    v_pk_mul_f32 v[54:55], v[38:39], v[38:39]
    v_pk_fma_f32 v[52:53], v[52:53], s[64:65], v[18:19]
    v_pk_fma_f32 v[54:55], v[54:55], s[64:65], v[18:19]
    v_pk_mul_f32 v[52:53], v[52:53], v[36:37]
    v_pk_mul_f32 v[54:55], v[54:55], v[38:39]
    v_exp_f32 v52, -v52
    v_exp_f32 v53, -v53
    v_exp_f32 v54, -v54
    v_exp_f32 v55, -v55
    v_pk_add_f32 v[52:53], v[52:53], 1.0 op_sel_hi:[1,0]
    v_pk_add_f32 v[54:55], v[54:55], 1.0 op_sel_hi:[1,0]
    v_rcp_f32 v52, v52
    v_rcp_f32 v53, v53
    v_rcp_f32 v54, v54
    v_rcp_f32 v55, v55
    v_pk_mul_f32 v[36:37], v[36:37], v[52:53]
    v_pk_mul_f32 v[38:39], v[38:39], v[54:55]
    v_cvt_pk_bf16_f32 v58, v36, v37
    v_cvt_pk_bf16_f32 v59, v38, v39
    v_xor_b32 v61, 80, v21
    v_add_u32 v61, v61, v16
    ds_write_b64 v61, v[58:59] offset:0
    v_lshlrev_b32 v48, 16, v76
    v_and_b32 v49, 0xffff0000, v76
    v_lshlrev_b32 v50, 16, v77
    v_and_b32 v51, 0xffff0000, v77
    v_pk_add_f32 v[40:41], v[40:41], v[48:49]
    v_pk_add_f32 v[42:43], v[42:43], v[50:51]
    v_pk_mul_f32 v[52:53], v[40:41], v[40:41]
    v_pk_mul_f32 v[54:55], v[42:43], v[42:43]
    v_pk_fma_f32 v[52:53], v[52:53], s[64:65], v[18:19]
    v_pk_fma_f32 v[54:55], v[54:55], s[64:65], v[18:19]
    v_pk_mul_f32 v[52:53], v[52:53], v[40:41]
    v_pk_mul_f32 v[54:55], v[54:55], v[42:43]
    v_exp_f32 v52, -v52
    v_exp_f32 v53, -v53
    v_exp_f32 v54, -v54
    v_exp_f32 v55, -v55
    v_pk_add_f32 v[52:53], v[52:53], 1.0 op_sel_hi:[1,0]
    v_pk_add_f32 v[54:55], v[54:55], 1.0 op_sel_hi:[1,0]
    v_rcp_f32 v52, v52
    v_rcp_f32 v53, v53
    v_rcp_f32 v54, v54
    v_rcp_f32 v55, v55
    v_pk_mul_f32 v[40:41], v[40:41], v[52:53]
    v_pk_mul_f32 v[42:43], v[42:43], v[54:55]
    v_cvt_pk_bf16_f32 v56, v40, v41
    v_cvt_pk_bf16_f32 v57, v42, v43
    v_xor_b32 v60, 96, v21
    v_add_u32 v60, v60, v16
    ds_write_b64 v60, v[56:57] offset:0
    v_lshlrev_b32 v48, 16, v78
    v_and_b32 v49, 0xffff0000, v78
    v_lshlrev_b32 v50, 16, v79
    v_and_b32 v51, 0xffff0000, v79
    v_pk_add_f32 v[44:45], v[44:45], v[48:49]
    v_pk_add_f32 v[46:47], v[46:47], v[50:51]
    v_pk_mul_f32 v[52:53], v[44:45], v[44:45]
    v_pk_mul_f32 v[54:55], v[46:47], v[46:47]
    v_pk_fma_f32 v[52:53], v[52:53], s[64:65], v[18:19]
    v_pk_fma_f32 v[54:55], v[54:55], s[64:65], v[18:19]
    v_pk_mul_f32 v[52:53], v[52:53], v[44:45]
    v_pk_mul_f32 v[54:55], v[54:55], v[46:47]
    v_exp_f32 v52, -v52
    v_exp_f32 v53, -v53
    v_exp_f32 v54, -v54
    v_exp_f32 v55, -v55
    v_pk_add_f32 v[52:53], v[52:53], 1.0 op_sel_hi:[1,0]
    v_pk_add_f32 v[54:55], v[54:55], 1.0 op_sel_hi:[1,0]
    v_rcp_f32 v52, v52
    v_rcp_f32 v53, v53
    v_rcp_f32 v54, v54
    v_rcp_f32 v55, v55
    v_pk_mul_f32 v[44:45], v[44:45], v[52:53]
    v_pk_mul_f32 v[46:47], v[46:47], v[54:55]
    v_cvt_pk_bf16_f32 v58, v44, v45
    v_cvt_pk_bf16_f32 v59, v46, v47
    v_xor_b32 v61, 112, v21
    v_add_u32 v61, v61, v16
    ds_write_b64 v61, v[58:59] offset:0
    v_accvgpr_read_b32 v32, a160
    v_accvgpr_read_b32 v33, a161
    v_accvgpr_read_b32 v34, a162
    v_accvgpr_read_b32 v35, a163
    v_accvgpr_read_b32 v36, a164
    v_accvgpr_read_b32 v37, a165
    v_accvgpr_read_b32 v38, a166
    v_accvgpr_read_b32 v39, a167
    v_accvgpr_read_b32 v40, a168
    v_accvgpr_read_b32 v41, a169
    v_accvgpr_read_b32 v42, a170
    v_accvgpr_read_b32 v43, a171
    v_accvgpr_read_b32 v44, a172
    v_accvgpr_read_b32 v45, a173
    v_accvgpr_read_b32 v46, a174
    v_accvgpr_read_b32 v47, a175
    v_lshlrev_b32 v48, 16, v80
    v_and_b32 v49, 0xffff0000, v80
    v_lshlrev_b32 v50, 16, v81
    v_and_b32 v51, 0xffff0000, v81
    v_pk_add_f32 v[32:33], v[32:33], v[48:49]
    v_pk_add_f32 v[34:35], v[34:35], v[50:51]
    v_pk_mul_f32 v[52:53], v[32:33], v[32:33]
    v_pk_mul_f32 v[54:55], v[34:35], v[34:35]
    v_pk_fma_f32 v[52:53], v[52:53], s[64:65], v[18:19]
    v_pk_fma_f32 v[54:55], v[54:55], s[64:65], v[18:19]
    v_pk_mul_f32 v[52:53], v[52:53], v[32:33]
    v_pk_mul_f32 v[54:55], v[54:55], v[34:35]
    v_exp_f32 v52, -v52
    v_exp_f32 v53, -v53
    v_exp_f32 v54, -v54
    v_exp_f32 v55, -v55
    v_pk_add_f32 v[52:53], v[52:53], 1.0 op_sel_hi:[1,0]
    v_pk_add_f32 v[54:55], v[54:55], 1.0 op_sel_hi:[1,0]
    v_rcp_f32 v52, v52
    v_rcp_f32 v53, v53
    v_rcp_f32 v54, v54
    v_rcp_f32 v55, v55
    v_pk_mul_f32 v[32:33], v[32:33], v[52:53]
    v_pk_mul_f32 v[34:35], v[34:35], v[54:55]
    v_cvt_pk_bf16_f32 v56, v32, v33
    v_cvt_pk_bf16_f32 v57, v34, v35
    v_xor_b32 v60, 128, v21
    v_add_u32 v60, v60, v16
    ds_write_b64 v60, v[56:57] offset:0
    v_lshlrev_b32 v48, 16, v82
    v_and_b32 v49, 0xffff0000, v82
    v_lshlrev_b32 v50, 16, v83
    v_and_b32 v51, 0xffff0000, v83
    v_pk_add_f32 v[36:37], v[36:37], v[48:49]
    v_pk_add_f32 v[38:39], v[38:39], v[50:51]
    v_pk_mul_f32 v[52:53], v[36:37], v[36:37]
    v_pk_mul_f32 v[54:55], v[38:39], v[38:39]
    v_pk_fma_f32 v[52:53], v[52:53], s[64:65], v[18:19]
    v_pk_fma_f32 v[54:55], v[54:55], s[64:65], v[18:19]
    v_pk_mul_f32 v[52:53], v[52:53], v[36:37]
    v_pk_mul_f32 v[54:55], v[54:55], v[38:39]
    v_exp_f32 v52, -v52
    v_exp_f32 v53, -v53
    v_exp_f32 v54, -v54
    v_exp_f32 v55, -v55
    v_pk_add_f32 v[52:53], v[52:53], 1.0 op_sel_hi:[1,0]
    v_pk_add_f32 v[54:55], v[54:55], 1.0 op_sel_hi:[1,0]
    v_rcp_f32 v52, v52
    v_rcp_f32 v53, v53
    v_rcp_f32 v54, v54
    v_rcp_f32 v55, v55
    v_pk_mul_f32 v[36:37], v[36:37], v[52:53]
    v_pk_mul_f32 v[38:39], v[38:39], v[54:55]
    v_cvt_pk_bf16_f32 v58, v36, v37
    v_cvt_pk_bf16_f32 v59, v38, v39
    v_xor_b32 v61, 144, v21
    v_add_u32 v61, v61, v16
    ds_write_b64 v61, v[58:59] offset:0
    v_lshlrev_b32 v48, 16, v84
    v_and_b32 v49, 0xffff0000, v84
    v_lshlrev_b32 v50, 16, v85
    v_and_b32 v51, 0xffff0000, v85
    v_pk_add_f32 v[40:41], v[40:41], v[48:49]
    v_pk_add_f32 v[42:43], v[42:43], v[50:51]
    v_pk_mul_f32 v[52:53], v[40:41], v[40:41]
    v_pk_mul_f32 v[54:55], v[42:43], v[42:43]
    v_pk_fma_f32 v[52:53], v[52:53], s[64:65], v[18:19]
    v_pk_fma_f32 v[54:55], v[54:55], s[64:65], v[18:19]
    v_pk_mul_f32 v[52:53], v[52:53], v[40:41]
    v_pk_mul_f32 v[54:55], v[54:55], v[42:43]
    v_exp_f32 v52, -v52
    v_exp_f32 v53, -v53
    v_exp_f32 v54, -v54
    v_exp_f32 v55, -v55
    v_pk_add_f32 v[52:53], v[52:53], 1.0 op_sel_hi:[1,0]
    v_pk_add_f32 v[54:55], v[54:55], 1.0 op_sel_hi:[1,0]
    v_rcp_f32 v52, v52
    v_rcp_f32 v53, v53
    v_rcp_f32 v54, v54
    v_rcp_f32 v55, v55
    v_pk_mul_f32 v[40:41], v[40:41], v[52:53]
    v_pk_mul_f32 v[42:43], v[42:43], v[54:55]
    v_cvt_pk_bf16_f32 v56, v40, v41
    v_cvt_pk_bf16_f32 v57, v42, v43
    v_xor_b32 v60, 160, v21
    v_add_u32 v60, v60, v16
    ds_write_b64 v60, v[56:57] offset:0
    v_lshlrev_b32 v48, 16, v86
    v_and_b32 v49, 0xffff0000, v86
    v_lshlrev_b32 v50, 16, v87
    v_and_b32 v51, 0xffff0000, v87
    v_pk_add_f32 v[44:45], v[44:45], v[48:49]
    v_pk_add_f32 v[46:47], v[46:47], v[50:51]
    v_pk_mul_f32 v[52:53], v[44:45], v[44:45]
    v_pk_mul_f32 v[54:55], v[46:47], v[46:47]
    v_pk_fma_f32 v[52:53], v[52:53], s[64:65], v[18:19]
    v_pk_fma_f32 v[54:55], v[54:55], s[64:65], v[18:19]
    v_pk_mul_f32 v[52:53], v[52:53], v[44:45]
    v_pk_mul_f32 v[54:55], v[54:55], v[46:47]
    v_exp_f32 v52, -v52
    v_exp_f32 v53, -v53
    v_exp_f32 v54, -v54
    v_exp_f32 v55, -v55
    v_pk_add_f32 v[52:53], v[52:53], 1.0 op_sel_hi:[1,0]
    v_pk_add_f32 v[54:55], v[54:55], 1.0 op_sel_hi:[1,0]
    v_rcp_f32 v52, v52
    v_rcp_f32 v53, v53
    v_rcp_f32 v54, v54
    v_rcp_f32 v55, v55
    v_pk_mul_f32 v[44:45], v[44:45], v[52:53]
    v_pk_mul_f32 v[46:47], v[46:47], v[54:55]
    v_cvt_pk_bf16_f32 v58, v44, v45
    v_cvt_pk_bf16_f32 v59, v46, v47
    v_xor_b32 v61, 176, v21
    v_add_u32 v61, v61, v16
    ds_write_b64 v61, v[58:59] offset:0
    v_accvgpr_read_b32 v32, a176
    v_accvgpr_read_b32 v33, a177
    v_accvgpr_read_b32 v34, a178
    v_accvgpr_read_b32 v35, a179
    v_accvgpr_read_b32 v36, a180
    v_accvgpr_read_b32 v37, a181
    v_accvgpr_read_b32 v38, a182
    v_accvgpr_read_b32 v39, a183
    v_accvgpr_read_b32 v40, a184
    v_accvgpr_read_b32 v41, a185
    v_accvgpr_read_b32 v42, a186
    v_accvgpr_read_b32 v43, a187
    v_accvgpr_read_b32 v44, a188
    v_accvgpr_read_b32 v45, a189
    v_accvgpr_read_b32 v46, a190
    v_accvgpr_read_b32 v47, a191
    v_lshlrev_b32 v48, 16, v88
    v_and_b32 v49, 0xffff0000, v88
    v_lshlrev_b32 v50, 16, v89
    v_and_b32 v51, 0xffff0000, v89
    v_pk_add_f32 v[32:33], v[32:33], v[48:49]
    v_pk_add_f32 v[34:35], v[34:35], v[50:51]
    v_pk_mul_f32 v[52:53], v[32:33], v[32:33]
    v_pk_mul_f32 v[54:55], v[34:35], v[34:35]
    v_pk_fma_f32 v[52:53], v[52:53], s[64:65], v[18:19]
    v_pk_fma_f32 v[54:55], v[54:55], s[64:65], v[18:19]
    v_pk_mul_f32 v[52:53], v[52:53], v[32:33]
    v_pk_mul_f32 v[54:55], v[54:55], v[34:35]
    v_exp_f32 v52, -v52
    v_exp_f32 v53, -v53
    v_exp_f32 v54, -v54
    v_exp_f32 v55, -v55
    v_pk_add_f32 v[52:53], v[52:53], 1.0 op_sel_hi:[1,0]
    v_pk_add_f32 v[54:55], v[54:55], 1.0 op_sel_hi:[1,0]
    v_rcp_f32 v52, v52
    v_rcp_f32 v53, v53
    v_rcp_f32 v54, v54
    v_rcp_f32 v55, v55
    v_pk_mul_f32 v[32:33], v[32:33], v[52:53]
    v_pk_mul_f32 v[34:35], v[34:35], v[54:55]
    v_cvt_pk_bf16_f32 v56, v32, v33
    v_cvt_pk_bf16_f32 v57, v34, v35
    v_xor_b32 v60, 192, v21
    v_add_u32 v60, v60, v16
    ds_write_b64 v60, v[56:57] offset:0
    v_lshlrev_b32 v48, 16, v90
    v_and_b32 v49, 0xffff0000, v90
    v_lshlrev_b32 v50, 16, v91
    v_and_b32 v51, 0xffff0000, v91
    v_pk_add_f32 v[36:37], v[36:37], v[48:49]
    v_pk_add_f32 v[38:39], v[38:39], v[50:51]
    v_pk_mul_f32 v[52:53], v[36:37], v[36:37]
    v_pk_mul_f32 v[54:55], v[38:39], v[38:39]
    v_pk_fma_f32 v[52:53], v[52:53], s[64:65], v[18:19]
    v_pk_fma_f32 v[54:55], v[54:55], s[64:65], v[18:19]
    v_pk_mul_f32 v[52:53], v[52:53], v[36:37]
    v_pk_mul_f32 v[54:55], v[54:55], v[38:39]
    v_exp_f32 v52, -v52
    v_exp_f32 v53, -v53
    v_exp_f32 v54, -v54
    v_exp_f32 v55, -v55
    v_pk_add_f32 v[52:53], v[52:53], 1.0 op_sel_hi:[1,0]
    v_pk_add_f32 v[54:55], v[54:55], 1.0 op_sel_hi:[1,0]
    v_rcp_f32 v52, v52
    v_rcp_f32 v53, v53
    v_rcp_f32 v54, v54
    v_rcp_f32 v55, v55
    v_pk_mul_f32 v[36:37], v[36:37], v[52:53]
    v_pk_mul_f32 v[38:39], v[38:39], v[54:55]
    v_cvt_pk_bf16_f32 v58, v36, v37
    v_cvt_pk_bf16_f32 v59, v38, v39
    v_xor_b32 v61, 208, v21
    v_add_u32 v61, v61, v16
    ds_write_b64 v61, v[58:59] offset:0
    v_lshlrev_b32 v48, 16, v92
    v_and_b32 v49, 0xffff0000, v92
    v_lshlrev_b32 v50, 16, v93
    v_and_b32 v51, 0xffff0000, v93
    v_pk_add_f32 v[40:41], v[40:41], v[48:49]
    v_pk_add_f32 v[42:43], v[42:43], v[50:51]
    v_pk_mul_f32 v[52:53], v[40:41], v[40:41]
    v_pk_mul_f32 v[54:55], v[42:43], v[42:43]
    v_pk_fma_f32 v[52:53], v[52:53], s[64:65], v[18:19]
    v_pk_fma_f32 v[54:55], v[54:55], s[64:65], v[18:19]
    v_pk_mul_f32 v[52:53], v[52:53], v[40:41]
    v_pk_mul_f32 v[54:55], v[54:55], v[42:43]
    v_exp_f32 v52, -v52
    v_exp_f32 v53, -v53
    v_exp_f32 v54, -v54
    v_exp_f32 v55, -v55
    v_pk_add_f32 v[52:53], v[52:53], 1.0 op_sel_hi:[1,0]
    v_pk_add_f32 v[54:55], v[54:55], 1.0 op_sel_hi:[1,0]
    v_rcp_f32 v52, v52
    v_rcp_f32 v53, v53
    v_rcp_f32 v54, v54
    v_rcp_f32 v55, v55
    v_pk_mul_f32 v[40:41], v[40:41], v[52:53]
    v_pk_mul_f32 v[42:43], v[42:43], v[54:55]
    v_cvt_pk_bf16_f32 v56, v40, v41
    v_cvt_pk_bf16_f32 v57, v42, v43
    v_xor_b32 v60, 224, v21
    v_add_u32 v60, v60, v16
    ds_write_b64 v60, v[56:57] offset:0
    v_lshlrev_b32 v48, 16, v94
    v_and_b32 v49, 0xffff0000, v94
    v_lshlrev_b32 v50, 16, v95
    v_and_b32 v51, 0xffff0000, v95
    v_pk_add_f32 v[44:45], v[44:45], v[48:49]
    v_pk_add_f32 v[46:47], v[46:47], v[50:51]
    v_pk_mul_f32 v[52:53], v[44:45], v[44:45]
    v_pk_mul_f32 v[54:55], v[46:47], v[46:47]
    v_pk_fma_f32 v[52:53], v[52:53], s[64:65], v[18:19]
    v_pk_fma_f32 v[54:55], v[54:55], s[64:65], v[18:19]
    v_pk_mul_f32 v[52:53], v[52:53], v[44:45]
    v_pk_mul_f32 v[54:55], v[54:55], v[46:47]
    v_exp_f32 v52, -v52
    v_exp_f32 v53, -v53
    v_exp_f32 v54, -v54
    v_exp_f32 v55, -v55
    v_pk_add_f32 v[52:53], v[52:53], 1.0 op_sel_hi:[1,0]
    v_pk_add_f32 v[54:55], v[54:55], 1.0 op_sel_hi:[1,0]
    v_rcp_f32 v52, v52
    v_rcp_f32 v53, v53
    v_rcp_f32 v54, v54
    v_rcp_f32 v55, v55
    v_pk_mul_f32 v[44:45], v[44:45], v[52:53]
    v_pk_mul_f32 v[46:47], v[46:47], v[54:55]
    v_cvt_pk_bf16_f32 v58, v44, v45
    v_cvt_pk_bf16_f32 v59, v46, v47
    v_xor_b32 v61, 240, v21
    v_add_u32 v61, v61, v16
    s_waitcnt lgkmcnt(14)
    ds_write_b64 v61, v[58:59] offset:0
    v_accvgpr_read_b32 v32, a192
    v_accvgpr_read_b32 v33, a193
    v_accvgpr_read_b32 v34, a194
    v_accvgpr_read_b32 v35, a195
    v_accvgpr_read_b32 v36, a196
    v_accvgpr_read_b32 v37, a197
    v_accvgpr_read_b32 v38, a198
    v_accvgpr_read_b32 v39, a199
    v_accvgpr_read_b32 v40, a200
    v_accvgpr_read_b32 v41, a201
    v_accvgpr_read_b32 v42, a202
    v_accvgpr_read_b32 v43, a203
    v_accvgpr_read_b32 v44, a204
    v_accvgpr_read_b32 v45, a205
    v_accvgpr_read_b32 v46, a206
    v_accvgpr_read_b32 v47, a207
    v_lshlrev_b32 v48, 16, v64
    v_and_b32 v49, 0xffff0000, v64
    v_lshlrev_b32 v50, 16, v65
    v_and_b32 v51, 0xffff0000, v65
    v_pk_add_f32 v[32:33], v[32:33], v[48:49]
    v_pk_add_f32 v[34:35], v[34:35], v[50:51]
    v_pk_mul_f32 v[52:53], v[32:33], v[32:33]
    v_pk_mul_f32 v[54:55], v[34:35], v[34:35]
    v_pk_fma_f32 v[52:53], v[52:53], s[64:65], v[18:19]
    v_pk_fma_f32 v[54:55], v[54:55], s[64:65], v[18:19]
    v_pk_mul_f32 v[52:53], v[52:53], v[32:33]
    v_pk_mul_f32 v[54:55], v[54:55], v[34:35]
    v_exp_f32 v52, -v52
    v_exp_f32 v53, -v53
    v_exp_f32 v54, -v54
    v_exp_f32 v55, -v55
    v_pk_add_f32 v[52:53], v[52:53], 1.0 op_sel_hi:[1,0]
    v_pk_add_f32 v[54:55], v[54:55], 1.0 op_sel_hi:[1,0]
    v_rcp_f32 v52, v52
    v_rcp_f32 v53, v53
    v_rcp_f32 v54, v54
    v_rcp_f32 v55, v55
    v_pk_mul_f32 v[32:33], v[32:33], v[52:53]
    v_pk_mul_f32 v[34:35], v[34:35], v[54:55]
    v_cvt_pk_bf16_f32 v56, v32, v33
    v_cvt_pk_bf16_f32 v57, v34, v35
    v_xor_b32 v60, 0, v21
    v_add_u32 v60, v60, v16
    s_waitcnt lgkmcnt(14)
    ds_write_b64 v60, v[56:57] offset:8192
    v_lshlrev_b32 v48, 16, v66
    v_and_b32 v49, 0xffff0000, v66
    v_lshlrev_b32 v50, 16, v67
    v_and_b32 v51, 0xffff0000, v67
    v_pk_add_f32 v[36:37], v[36:37], v[48:49]
    v_pk_add_f32 v[38:39], v[38:39], v[50:51]
    v_pk_mul_f32 v[52:53], v[36:37], v[36:37]
    v_pk_mul_f32 v[54:55], v[38:39], v[38:39]
    v_pk_fma_f32 v[52:53], v[52:53], s[64:65], v[18:19]
    v_pk_fma_f32 v[54:55], v[54:55], s[64:65], v[18:19]
    v_pk_mul_f32 v[52:53], v[52:53], v[36:37]
    v_pk_mul_f32 v[54:55], v[54:55], v[38:39]
    v_exp_f32 v52, -v52
    v_exp_f32 v53, -v53
    v_exp_f32 v54, -v54
    v_exp_f32 v55, -v55
    v_pk_add_f32 v[52:53], v[52:53], 1.0 op_sel_hi:[1,0]
    v_pk_add_f32 v[54:55], v[54:55], 1.0 op_sel_hi:[1,0]
    v_rcp_f32 v52, v52
    v_rcp_f32 v53, v53
    v_rcp_f32 v54, v54
    v_rcp_f32 v55, v55
    v_pk_mul_f32 v[36:37], v[36:37], v[52:53]
    v_pk_mul_f32 v[38:39], v[38:39], v[54:55]
    v_cvt_pk_bf16_f32 v58, v36, v37
    v_cvt_pk_bf16_f32 v59, v38, v39
    v_xor_b32 v61, 16, v21
    v_add_u32 v61, v61, v16
    s_waitcnt lgkmcnt(14)
    ds_write_b64 v61, v[58:59] offset:8192
    v_lshlrev_b32 v48, 16, v68
    v_and_b32 v49, 0xffff0000, v68
    v_lshlrev_b32 v50, 16, v69
    v_and_b32 v51, 0xffff0000, v69
    v_pk_add_f32 v[40:41], v[40:41], v[48:49]
    v_pk_add_f32 v[42:43], v[42:43], v[50:51]
    v_pk_mul_f32 v[52:53], v[40:41], v[40:41]
    v_pk_mul_f32 v[54:55], v[42:43], v[42:43]
    v_pk_fma_f32 v[52:53], v[52:53], s[64:65], v[18:19]
    v_pk_fma_f32 v[54:55], v[54:55], s[64:65], v[18:19]
    v_pk_mul_f32 v[52:53], v[52:53], v[40:41]
    v_pk_mul_f32 v[54:55], v[54:55], v[42:43]
    v_exp_f32 v52, -v52
    v_exp_f32 v53, -v53
    v_exp_f32 v54, -v54
    v_exp_f32 v55, -v55
    v_pk_add_f32 v[52:53], v[52:53], 1.0 op_sel_hi:[1,0]
    v_pk_add_f32 v[54:55], v[54:55], 1.0 op_sel_hi:[1,0]
    v_rcp_f32 v52, v52
    v_rcp_f32 v53, v53
    v_rcp_f32 v54, v54
    v_rcp_f32 v55, v55
    v_pk_mul_f32 v[40:41], v[40:41], v[52:53]
    v_pk_mul_f32 v[42:43], v[42:43], v[54:55]
    v_cvt_pk_bf16_f32 v56, v40, v41
    v_cvt_pk_bf16_f32 v57, v42, v43
    v_xor_b32 v60, 32, v21
    v_add_u32 v60, v60, v16
    s_waitcnt lgkmcnt(14)
    ds_write_b64 v60, v[56:57] offset:8192
    v_lshlrev_b32 v48, 16, v70
    v_and_b32 v49, 0xffff0000, v70
    v_lshlrev_b32 v50, 16, v71
    v_and_b32 v51, 0xffff0000, v71
    v_pk_add_f32 v[44:45], v[44:45], v[48:49]
    v_pk_add_f32 v[46:47], v[46:47], v[50:51]
    v_pk_mul_f32 v[52:53], v[44:45], v[44:45]
    v_pk_mul_f32 v[54:55], v[46:47], v[46:47]
    v_pk_fma_f32 v[52:53], v[52:53], s[64:65], v[18:19]
    v_pk_fma_f32 v[54:55], v[54:55], s[64:65], v[18:19]
    v_pk_mul_f32 v[52:53], v[52:53], v[44:45]
    v_pk_mul_f32 v[54:55], v[54:55], v[46:47]
    v_exp_f32 v52, -v52
    v_exp_f32 v53, -v53
    v_exp_f32 v54, -v54
    v_exp_f32 v55, -v55
    v_pk_add_f32 v[52:53], v[52:53], 1.0 op_sel_hi:[1,0]
    v_pk_add_f32 v[54:55], v[54:55], 1.0 op_sel_hi:[1,0]
    v_rcp_f32 v52, v52
    v_rcp_f32 v53, v53
    v_rcp_f32 v54, v54
    v_rcp_f32 v55, v55
    v_pk_mul_f32 v[44:45], v[44:45], v[52:53]
    v_pk_mul_f32 v[46:47], v[46:47], v[54:55]
    v_cvt_pk_bf16_f32 v58, v44, v45
    v_cvt_pk_bf16_f32 v59, v46, v47
    v_xor_b32 v61, 48, v21
    v_add_u32 v61, v61, v16
    s_waitcnt lgkmcnt(14)
    ds_write_b64 v61, v[58:59] offset:8192
    v_accvgpr_read_b32 v32, a208
    v_accvgpr_read_b32 v33, a209
    v_accvgpr_read_b32 v34, a210
    v_accvgpr_read_b32 v35, a211
    v_accvgpr_read_b32 v36, a212
    v_accvgpr_read_b32 v37, a213
    v_accvgpr_read_b32 v38, a214
    v_accvgpr_read_b32 v39, a215
    v_accvgpr_read_b32 v40, a216
    v_accvgpr_read_b32 v41, a217
    v_accvgpr_read_b32 v42, a218
    v_accvgpr_read_b32 v43, a219
    v_accvgpr_read_b32 v44, a220
    v_accvgpr_read_b32 v45, a221
    v_accvgpr_read_b32 v46, a222
    v_accvgpr_read_b32 v47, a223
    v_lshlrev_b32 v48, 16, v72
    v_and_b32 v49, 0xffff0000, v72
    v_lshlrev_b32 v50, 16, v73
    v_and_b32 v51, 0xffff0000, v73
    v_pk_add_f32 v[32:33], v[32:33], v[48:49]
    v_pk_add_f32 v[34:35], v[34:35], v[50:51]
    v_pk_mul_f32 v[52:53], v[32:33], v[32:33]
    v_pk_mul_f32 v[54:55], v[34:35], v[34:35]
    v_pk_fma_f32 v[52:53], v[52:53], s[64:65], v[18:19]
    v_pk_fma_f32 v[54:55], v[54:55], s[64:65], v[18:19]
    v_pk_mul_f32 v[52:53], v[52:53], v[32:33]
    v_pk_mul_f32 v[54:55], v[54:55], v[34:35]
    v_exp_f32 v52, -v52
    v_exp_f32 v53, -v53
    v_exp_f32 v54, -v54
    v_exp_f32 v55, -v55
    v_pk_add_f32 v[52:53], v[52:53], 1.0 op_sel_hi:[1,0]
    v_pk_add_f32 v[54:55], v[54:55], 1.0 op_sel_hi:[1,0]
    v_rcp_f32 v52, v52
    v_rcp_f32 v53, v53
    v_rcp_f32 v54, v54
    v_rcp_f32 v55, v55
    v_pk_mul_f32 v[32:33], v[32:33], v[52:53]
    v_pk_mul_f32 v[34:35], v[34:35], v[54:55]
    v_cvt_pk_bf16_f32 v56, v32, v33
    v_cvt_pk_bf16_f32 v57, v34, v35
    v_xor_b32 v60, 64, v21
    v_add_u32 v60, v60, v16
    s_waitcnt lgkmcnt(14)
    ds_write_b64 v60, v[56:57] offset:8192
    v_lshlrev_b32 v48, 16, v74
    v_and_b32 v49, 0xffff0000, v74
    v_lshlrev_b32 v50, 16, v75
    v_and_b32 v51, 0xffff0000, v75
    v_pk_add_f32 v[36:37], v[36:37], v[48:49]
    v_pk_add_f32 v[38:39], v[38:39], v[50:51]
    v_pk_mul_f32 v[52:53], v[36:37], v[36:37]
    v_pk_mul_f32 v[54:55], v[38:39], v[38:39]
    v_pk_fma_f32 v[52:53], v[52:53], s[64:65], v[18:19]
    v_pk_fma_f32 v[54:55], v[54:55], s[64:65], v[18:19]
    v_pk_mul_f32 v[52:53], v[52:53], v[36:37]
    v_pk_mul_f32 v[54:55], v[54:55], v[38:39]
    v_exp_f32 v52, -v52
    v_exp_f32 v53, -v53
    v_exp_f32 v54, -v54
    v_exp_f32 v55, -v55
    v_pk_add_f32 v[52:53], v[52:53], 1.0 op_sel_hi:[1,0]
    v_pk_add_f32 v[54:55], v[54:55], 1.0 op_sel_hi:[1,0]
    v_rcp_f32 v52, v52
    v_rcp_f32 v53, v53
    v_rcp_f32 v54, v54
    v_rcp_f32 v55, v55
    v_pk_mul_f32 v[36:37], v[36:37], v[52:53]
    v_pk_mul_f32 v[38:39], v[38:39], v[54:55]
    v_cvt_pk_bf16_f32 v58, v36, v37
    v_cvt_pk_bf16_f32 v59, v38, v39
    v_xor_b32 v61, 80, v21
    v_add_u32 v61, v61, v16
    s_waitcnt lgkmcnt(14)
    ds_write_b64 v61, v[58:59] offset:8192
    v_lshlrev_b32 v48, 16, v76
    v_and_b32 v49, 0xffff0000, v76
    v_lshlrev_b32 v50, 16, v77
    v_and_b32 v51, 0xffff0000, v77
    v_pk_add_f32 v[40:41], v[40:41], v[48:49]
    v_pk_add_f32 v[42:43], v[42:43], v[50:51]
    v_pk_mul_f32 v[52:53], v[40:41], v[40:41]
    v_pk_mul_f32 v[54:55], v[42:43], v[42:43]
    v_pk_fma_f32 v[52:53], v[52:53], s[64:65], v[18:19]
    v_pk_fma_f32 v[54:55], v[54:55], s[64:65], v[18:19]
    v_pk_mul_f32 v[52:53], v[52:53], v[40:41]
    v_pk_mul_f32 v[54:55], v[54:55], v[42:43]
    v_exp_f32 v52, -v52
    v_exp_f32 v53, -v53
    v_exp_f32 v54, -v54
    v_exp_f32 v55, -v55
    v_pk_add_f32 v[52:53], v[52:53], 1.0 op_sel_hi:[1,0]
    v_pk_add_f32 v[54:55], v[54:55], 1.0 op_sel_hi:[1,0]
    v_rcp_f32 v52, v52
    v_rcp_f32 v53, v53
    v_rcp_f32 v54, v54
    v_rcp_f32 v55, v55
    v_pk_mul_f32 v[40:41], v[40:41], v[52:53]
    v_pk_mul_f32 v[42:43], v[42:43], v[54:55]
    v_cvt_pk_bf16_f32 v56, v40, v41
    v_cvt_pk_bf16_f32 v57, v42, v43
    v_xor_b32 v60, 96, v21
    v_add_u32 v60, v60, v16
    s_waitcnt lgkmcnt(14)
    ds_write_b64 v60, v[56:57] offset:8192
    v_lshlrev_b32 v48, 16, v78
    v_and_b32 v49, 0xffff0000, v78
    v_lshlrev_b32 v50, 16, v79
    v_and_b32 v51, 0xffff0000, v79
    v_pk_add_f32 v[44:45], v[44:45], v[48:49]
    v_pk_add_f32 v[46:47], v[46:47], v[50:51]
    v_pk_mul_f32 v[52:53], v[44:45], v[44:45]
    v_pk_mul_f32 v[54:55], v[46:47], v[46:47]
    v_pk_fma_f32 v[52:53], v[52:53], s[64:65], v[18:19]
    v_pk_fma_f32 v[54:55], v[54:55], s[64:65], v[18:19]
    v_pk_mul_f32 v[52:53], v[52:53], v[44:45]
    v_pk_mul_f32 v[54:55], v[54:55], v[46:47]
    v_exp_f32 v52, -v52
    v_exp_f32 v53, -v53
    v_exp_f32 v54, -v54
    v_exp_f32 v55, -v55
    v_pk_add_f32 v[52:53], v[52:53], 1.0 op_sel_hi:[1,0]
    v_pk_add_f32 v[54:55], v[54:55], 1.0 op_sel_hi:[1,0]
    v_rcp_f32 v52, v52
    v_rcp_f32 v53, v53
    v_rcp_f32 v54, v54
    v_rcp_f32 v55, v55
    v_pk_mul_f32 v[44:45], v[44:45], v[52:53]
    v_pk_mul_f32 v[46:47], v[46:47], v[54:55]
    v_cvt_pk_bf16_f32 v58, v44, v45
    v_cvt_pk_bf16_f32 v59, v46, v47
    v_xor_b32 v61, 112, v21
    v_add_u32 v61, v61, v16
    s_waitcnt lgkmcnt(14)
    ds_write_b64 v61, v[58:59] offset:8192
    v_accvgpr_read_b32 v32, a224
    v_accvgpr_read_b32 v33, a225
    v_accvgpr_read_b32 v34, a226
    v_accvgpr_read_b32 v35, a227
    v_accvgpr_read_b32 v36, a228
    v_accvgpr_read_b32 v37, a229
    v_accvgpr_read_b32 v38, a230
    v_accvgpr_read_b32 v39, a231
    v_accvgpr_read_b32 v40, a232
    v_accvgpr_read_b32 v41, a233
    v_accvgpr_read_b32 v42, a234
    v_accvgpr_read_b32 v43, a235
    v_accvgpr_read_b32 v44, a236
    v_accvgpr_read_b32 v45, a237
    v_accvgpr_read_b32 v46, a238
    v_accvgpr_read_b32 v47, a239
    v_lshlrev_b32 v48, 16, v80
    v_and_b32 v49, 0xffff0000, v80
    v_lshlrev_b32 v50, 16, v81
    v_and_b32 v51, 0xffff0000, v81
    v_pk_add_f32 v[32:33], v[32:33], v[48:49]
    v_pk_add_f32 v[34:35], v[34:35], v[50:51]
    v_pk_mul_f32 v[52:53], v[32:33], v[32:33]
    v_pk_mul_f32 v[54:55], v[34:35], v[34:35]
    v_pk_fma_f32 v[52:53], v[52:53], s[64:65], v[18:19]
    v_pk_fma_f32 v[54:55], v[54:55], s[64:65], v[18:19]
    v_pk_mul_f32 v[52:53], v[52:53], v[32:33]
    v_pk_mul_f32 v[54:55], v[54:55], v[34:35]
    v_exp_f32 v52, -v52
    v_exp_f32 v53, -v53
    v_exp_f32 v54, -v54
    v_exp_f32 v55, -v55
    v_pk_add_f32 v[52:53], v[52:53], 1.0 op_sel_hi:[1,0]
    v_pk_add_f32 v[54:55], v[54:55], 1.0 op_sel_hi:[1,0]
    v_rcp_f32 v52, v52
    v_rcp_f32 v53, v53
    v_rcp_f32 v54, v54
    v_rcp_f32 v55, v55
    v_pk_mul_f32 v[32:33], v[32:33], v[52:53]
    v_pk_mul_f32 v[34:35], v[34:35], v[54:55]
    v_cvt_pk_bf16_f32 v56, v32, v33
    v_cvt_pk_bf16_f32 v57, v34, v35
    v_xor_b32 v60, 128, v21
    v_add_u32 v60, v60, v16
    s_waitcnt lgkmcnt(14)
    ds_write_b64 v60, v[56:57] offset:8192
    v_lshlrev_b32 v48, 16, v82
    v_and_b32 v49, 0xffff0000, v82
    v_lshlrev_b32 v50, 16, v83
    v_and_b32 v51, 0xffff0000, v83
    v_pk_add_f32 v[36:37], v[36:37], v[48:49]
    v_pk_add_f32 v[38:39], v[38:39], v[50:51]
    v_pk_mul_f32 v[52:53], v[36:37], v[36:37]
    v_pk_mul_f32 v[54:55], v[38:39], v[38:39]
    v_pk_fma_f32 v[52:53], v[52:53], s[64:65], v[18:19]
    v_pk_fma_f32 v[54:55], v[54:55], s[64:65], v[18:19]
    v_pk_mul_f32 v[52:53], v[52:53], v[36:37]
    v_pk_mul_f32 v[54:55], v[54:55], v[38:39]
    v_exp_f32 v52, -v52
    v_exp_f32 v53, -v53
    v_exp_f32 v54, -v54
    v_exp_f32 v55, -v55
    v_pk_add_f32 v[52:53], v[52:53], 1.0 op_sel_hi:[1,0]
    v_pk_add_f32 v[54:55], v[54:55], 1.0 op_sel_hi:[1,0]
    v_rcp_f32 v52, v52
    v_rcp_f32 v53, v53
    v_rcp_f32 v54, v54
    v_rcp_f32 v55, v55
    v_pk_mul_f32 v[36:37], v[36:37], v[52:53]
    v_pk_mul_f32 v[38:39], v[38:39], v[54:55]
    v_cvt_pk_bf16_f32 v58, v36, v37
    v_cvt_pk_bf16_f32 v59, v38, v39
    v_xor_b32 v61, 144, v21
    v_add_u32 v61, v61, v16
    s_waitcnt lgkmcnt(14)
    ds_write_b64 v61, v[58:59] offset:8192
    v_lshlrev_b32 v48, 16, v84
    v_and_b32 v49, 0xffff0000, v84
    v_lshlrev_b32 v50, 16, v85
    v_and_b32 v51, 0xffff0000, v85
    v_pk_add_f32 v[40:41], v[40:41], v[48:49]
    v_pk_add_f32 v[42:43], v[42:43], v[50:51]
    v_pk_mul_f32 v[52:53], v[40:41], v[40:41]
    v_pk_mul_f32 v[54:55], v[42:43], v[42:43]
    v_pk_fma_f32 v[52:53], v[52:53], s[64:65], v[18:19]
    v_pk_fma_f32 v[54:55], v[54:55], s[64:65], v[18:19]
    v_pk_mul_f32 v[52:53], v[52:53], v[40:41]
    v_pk_mul_f32 v[54:55], v[54:55], v[42:43]
    v_exp_f32 v52, -v52
    v_exp_f32 v53, -v53
    v_exp_f32 v54, -v54
    v_exp_f32 v55, -v55
    v_pk_add_f32 v[52:53], v[52:53], 1.0 op_sel_hi:[1,0]
    v_pk_add_f32 v[54:55], v[54:55], 1.0 op_sel_hi:[1,0]
    v_rcp_f32 v52, v52
    v_rcp_f32 v53, v53
    v_rcp_f32 v54, v54
    v_rcp_f32 v55, v55
    v_pk_mul_f32 v[40:41], v[40:41], v[52:53]
    v_pk_mul_f32 v[42:43], v[42:43], v[54:55]
    v_cvt_pk_bf16_f32 v56, v40, v41
    v_cvt_pk_bf16_f32 v57, v42, v43
    v_xor_b32 v60, 160, v21
    v_add_u32 v60, v60, v16
    s_waitcnt lgkmcnt(14)
    ds_write_b64 v60, v[56:57] offset:8192
    v_lshlrev_b32 v48, 16, v86
    v_and_b32 v49, 0xffff0000, v86
    v_lshlrev_b32 v50, 16, v87
    v_and_b32 v51, 0xffff0000, v87
    v_pk_add_f32 v[44:45], v[44:45], v[48:49]
    v_pk_add_f32 v[46:47], v[46:47], v[50:51]
    v_pk_mul_f32 v[52:53], v[44:45], v[44:45]
    v_pk_mul_f32 v[54:55], v[46:47], v[46:47]
    v_pk_fma_f32 v[52:53], v[52:53], s[64:65], v[18:19]
    v_pk_fma_f32 v[54:55], v[54:55], s[64:65], v[18:19]
    v_pk_mul_f32 v[52:53], v[52:53], v[44:45]
    v_pk_mul_f32 v[54:55], v[54:55], v[46:47]
    v_exp_f32 v52, -v52
    v_exp_f32 v53, -v53
    v_exp_f32 v54, -v54
    v_exp_f32 v55, -v55
    v_pk_add_f32 v[52:53], v[52:53], 1.0 op_sel_hi:[1,0]
    v_pk_add_f32 v[54:55], v[54:55], 1.0 op_sel_hi:[1,0]
    v_rcp_f32 v52, v52
    v_rcp_f32 v53, v53
    v_rcp_f32 v54, v54
    v_rcp_f32 v55, v55
    v_pk_mul_f32 v[44:45], v[44:45], v[52:53]
    v_pk_mul_f32 v[46:47], v[46:47], v[54:55]
    v_cvt_pk_bf16_f32 v58, v44, v45
    v_cvt_pk_bf16_f32 v59, v46, v47
    v_xor_b32 v61, 176, v21
    v_add_u32 v61, v61, v16
    s_waitcnt lgkmcnt(14)
    ds_write_b64 v61, v[58:59] offset:8192
    v_accvgpr_read_b32 v32, a240
    v_accvgpr_read_b32 v33, a241
    v_accvgpr_read_b32 v34, a242
    v_accvgpr_read_b32 v35, a243
    v_accvgpr_read_b32 v36, a244
    v_accvgpr_read_b32 v37, a245
    v_accvgpr_read_b32 v38, a246
    v_accvgpr_read_b32 v39, a247
    v_accvgpr_read_b32 v40, a248
    v_accvgpr_read_b32 v41, a249
    v_accvgpr_read_b32 v42, a250
    v_accvgpr_read_b32 v43, a251
    v_accvgpr_read_b32 v44, a252
    v_accvgpr_read_b32 v45, a253
    v_accvgpr_read_b32 v46, a254
    v_accvgpr_read_b32 v47, a255
    v_lshlrev_b32 v48, 16, v88
    v_and_b32 v49, 0xffff0000, v88
    v_lshlrev_b32 v50, 16, v89
    v_and_b32 v51, 0xffff0000, v89
    v_pk_add_f32 v[32:33], v[32:33], v[48:49]
    v_pk_add_f32 v[34:35], v[34:35], v[50:51]
    v_pk_mul_f32 v[52:53], v[32:33], v[32:33]
    v_pk_mul_f32 v[54:55], v[34:35], v[34:35]
    v_pk_fma_f32 v[52:53], v[52:53], s[64:65], v[18:19]
    v_pk_fma_f32 v[54:55], v[54:55], s[64:65], v[18:19]
    v_pk_mul_f32 v[52:53], v[52:53], v[32:33]
    v_pk_mul_f32 v[54:55], v[54:55], v[34:35]
    v_exp_f32 v52, -v52
    v_exp_f32 v53, -v53
    v_exp_f32 v54, -v54
    v_exp_f32 v55, -v55
    v_pk_add_f32 v[52:53], v[52:53], 1.0 op_sel_hi:[1,0]
    v_pk_add_f32 v[54:55], v[54:55], 1.0 op_sel_hi:[1,0]
    v_rcp_f32 v52, v52
    v_rcp_f32 v53, v53
    v_rcp_f32 v54, v54
    v_rcp_f32 v55, v55
    v_pk_mul_f32 v[32:33], v[32:33], v[52:53]
    v_pk_mul_f32 v[34:35], v[34:35], v[54:55]
    v_cvt_pk_bf16_f32 v56, v32, v33
    v_cvt_pk_bf16_f32 v57, v34, v35
    v_xor_b32 v60, 192, v21
    v_add_u32 v60, v60, v16
    s_waitcnt lgkmcnt(14)
    ds_write_b64 v60, v[56:57] offset:8192
    v_lshlrev_b32 v48, 16, v90
    v_and_b32 v49, 0xffff0000, v90
    v_lshlrev_b32 v50, 16, v91
    v_and_b32 v51, 0xffff0000, v91
    v_pk_add_f32 v[36:37], v[36:37], v[48:49]
    v_pk_add_f32 v[38:39], v[38:39], v[50:51]
    v_pk_mul_f32 v[52:53], v[36:37], v[36:37]
    v_pk_mul_f32 v[54:55], v[38:39], v[38:39]
    v_pk_fma_f32 v[52:53], v[52:53], s[64:65], v[18:19]
    v_pk_fma_f32 v[54:55], v[54:55], s[64:65], v[18:19]
    v_pk_mul_f32 v[52:53], v[52:53], v[36:37]
    v_pk_mul_f32 v[54:55], v[54:55], v[38:39]
    v_exp_f32 v52, -v52
    v_exp_f32 v53, -v53
    v_exp_f32 v54, -v54
    v_exp_f32 v55, -v55
    v_pk_add_f32 v[52:53], v[52:53], 1.0 op_sel_hi:[1,0]
    v_pk_add_f32 v[54:55], v[54:55], 1.0 op_sel_hi:[1,0]
    v_rcp_f32 v52, v52
    v_rcp_f32 v53, v53
    v_rcp_f32 v54, v54
    v_rcp_f32 v55, v55
    v_pk_mul_f32 v[36:37], v[36:37], v[52:53]
    v_pk_mul_f32 v[38:39], v[38:39], v[54:55]
    v_cvt_pk_bf16_f32 v58, v36, v37
    v_cvt_pk_bf16_f32 v59, v38, v39
    v_xor_b32 v61, 208, v21
    v_add_u32 v61, v61, v16
    s_waitcnt lgkmcnt(14)
    ds_write_b64 v61, v[58:59] offset:8192
    v_lshlrev_b32 v48, 16, v92
    v_and_b32 v49, 0xffff0000, v92
    v_lshlrev_b32 v50, 16, v93
    v_and_b32 v51, 0xffff0000, v93
    v_pk_add_f32 v[40:41], v[40:41], v[48:49]
    v_pk_add_f32 v[42:43], v[42:43], v[50:51]
    v_pk_mul_f32 v[52:53], v[40:41], v[40:41]
    v_pk_mul_f32 v[54:55], v[42:43], v[42:43]
    v_pk_fma_f32 v[52:53], v[52:53], s[64:65], v[18:19]
    v_pk_fma_f32 v[54:55], v[54:55], s[64:65], v[18:19]
    v_pk_mul_f32 v[52:53], v[52:53], v[40:41]
    v_pk_mul_f32 v[54:55], v[54:55], v[42:43]
    v_exp_f32 v52, -v52
    v_exp_f32 v53, -v53
    v_exp_f32 v54, -v54
    v_exp_f32 v55, -v55
    v_pk_add_f32 v[52:53], v[52:53], 1.0 op_sel_hi:[1,0]
    v_pk_add_f32 v[54:55], v[54:55], 1.0 op_sel_hi:[1,0]
    v_rcp_f32 v52, v52
    v_rcp_f32 v53, v53
    v_rcp_f32 v54, v54
    v_rcp_f32 v55, v55
    v_pk_mul_f32 v[40:41], v[40:41], v[52:53]
    v_pk_mul_f32 v[42:43], v[42:43], v[54:55]
    v_cvt_pk_bf16_f32 v56, v40, v41
    v_cvt_pk_bf16_f32 v57, v42, v43
    v_xor_b32 v60, 224, v21
    v_add_u32 v60, v60, v16
    s_waitcnt lgkmcnt(14)
    ds_write_b64 v60, v[56:57] offset:8192
    v_lshlrev_b32 v48, 16, v94
    v_and_b32 v49, 0xffff0000, v94
    v_lshlrev_b32 v50, 16, v95
    v_and_b32 v51, 0xffff0000, v95
    v_pk_add_f32 v[44:45], v[44:45], v[48:49]
    v_pk_add_f32 v[46:47], v[46:47], v[50:51]
    v_pk_mul_f32 v[52:53], v[44:45], v[44:45]
    v_pk_mul_f32 v[54:55], v[46:47], v[46:47]
    v_pk_fma_f32 v[52:53], v[52:53], s[64:65], v[18:19]
    v_pk_fma_f32 v[54:55], v[54:55], s[64:65], v[18:19]
    v_pk_mul_f32 v[52:53], v[52:53], v[44:45]
    v_pk_mul_f32 v[54:55], v[54:55], v[46:47]
    v_exp_f32 v52, -v52
    v_exp_f32 v53, -v53
    v_exp_f32 v54, -v54
    v_exp_f32 v55, -v55
    v_pk_add_f32 v[52:53], v[52:53], 1.0 op_sel_hi:[1,0]
    v_pk_add_f32 v[54:55], v[54:55], 1.0 op_sel_hi:[1,0]
    v_rcp_f32 v52, v52
    v_rcp_f32 v53, v53
    v_rcp_f32 v54, v54
    v_rcp_f32 v55, v55
    v_pk_mul_f32 v[44:45], v[44:45], v[52:53]
    v_pk_mul_f32 v[46:47], v[46:47], v[54:55]
    v_cvt_pk_bf16_f32 v58, v44, v45
    v_cvt_pk_bf16_f32 v59, v46, v47
    v_xor_b32 v61, 240, v21
    v_add_u32 v61, v61, v16
    s_waitcnt lgkmcnt(14)
    ds_write_b64 v61, v[58:59] offset:8192
    s_waitcnt lgkmcnt(0)
    v_xor_b32 v62, 0, v17
    ds_read_b128 v[96:99], v62 offset:0
    v_xor_b32 v63, 64, v17
    ds_read_b128 v[100:103], v63 offset:1024
    v_xor_b32 v62, 128, v17
    ds_read_b128 v[104:107], v62 offset:2048
    v_xor_b32 v63, 192, v17
    ds_read_b128 v[108:111], v63 offset:3072
    v_xor_b32 v62, 0, v17
    ds_read_b128 v[112:115], v62 offset:4096
    v_xor_b32 v63, 64, v17
    ds_read_b128 v[116:119], v63 offset:5120
    v_xor_b32 v62, 128, v17
    ds_read_b128 v[120:123], v62 offset:6144
    v_xor_b32 v63, 192, v17
    ds_read_b128 v[124:127], v63 offset:7168
    s_waitcnt lgkmcnt(7)
    buffer_store_dwordx4 v[96:99], v20, s[40:43], s56 offen sc1
    s_add_u32 s56, s56, s57
    s_waitcnt lgkmcnt(6)
    buffer_store_dwordx4 v[100:103], v20, s[40:43], s56 offen sc1
    s_add_u32 s56, s56, s57
    s_waitcnt lgkmcnt(5)
    buffer_store_dwordx4 v[104:107], v20, s[40:43], s56 offen sc1
    s_add_u32 s56, s56, s57
    s_waitcnt lgkmcnt(4)
    buffer_store_dwordx4 v[108:111], v20, s[40:43], s56 offen sc1
    s_add_u32 s56, s56, s57
    s_waitcnt lgkmcnt(3)
    buffer_store_dwordx4 v[112:115], v20, s[40:43], s56 offen sc1
    s_add_u32 s56, s56, s57
    s_waitcnt lgkmcnt(2)
    buffer_store_dwordx4 v[116:119], v20, s[40:43], s56 offen sc1
    s_add_u32 s56, s56, s57
    s_waitcnt lgkmcnt(1)
    buffer_store_dwordx4 v[120:123], v20, s[40:43], s56 offen sc1
    s_add_u32 s56, s56, s57
    s_waitcnt lgkmcnt(0)
    buffer_store_dwordx4 v[124:127], v20, s[40:43], s56 offen sc1
    s_add_u32 s56, s56, s57
    v_xor_b32 v62, 0, v17
    ds_read_b128 v[96:99], v62 offset:8192
    v_xor_b32 v63, 64, v17
    ds_read_b128 v[100:103], v63 offset:9216
    v_xor_b32 v62, 128, v17
    ds_read_b128 v[104:107], v62 offset:10240
    v_xor_b32 v63, 192, v17
    ds_read_b128 v[108:111], v63 offset:11264
    v_xor_b32 v62, 0, v17
    ds_read_b128 v[112:115], v62 offset:12288
    v_xor_b32 v63, 64, v17
    ds_read_b128 v[116:119], v63 offset:13312
    v_xor_b32 v62, 128, v17
    ds_read_b128 v[120:123], v62 offset:14336
    v_xor_b32 v63, 192, v17
    ds_read_b128 v[124:127], v63 offset:15360
    s_waitcnt lgkmcnt(7)
    buffer_store_dwordx4 v[96:99], v20, s[40:43], s56 offen sc1
    s_add_u32 s56, s56, s57
    s_waitcnt lgkmcnt(6)
    buffer_store_dwordx4 v[100:103], v20, s[40:43], s56 offen sc1
    s_add_u32 s56, s56, s57
    s_waitcnt lgkmcnt(5)
    buffer_store_dwordx4 v[104:107], v20, s[40:43], s56 offen sc1
    s_add_u32 s56, s56, s57
    s_waitcnt lgkmcnt(4)
    buffer_store_dwordx4 v[108:111], v20, s[40:43], s56 offen sc1
    s_add_u32 s56, s56, s57
    s_waitcnt lgkmcnt(3)
    buffer_store_dwordx4 v[112:115], v20, s[40:43], s56 offen sc1
    s_add_u32 s56, s56, s57
    s_waitcnt lgkmcnt(2)
    buffer_store_dwordx4 v[116:119], v20, s[40:43], s56 offen sc1
    s_add_u32 s56, s56, s57
    s_waitcnt lgkmcnt(1)
    buffer_store_dwordx4 v[120:123], v20, s[40:43], s56 offen sc1
    s_add_u32 s56, s56, s57
    s_waitcnt lgkmcnt(0)
    buffer_store_dwordx4 v[124:127], v20, s[40:43], s56 offen sc1
    s_add_u32 s56, s56, s57
    s_waitcnt lgkmcnt(0)
L_eskip_h:
    s_waitcnt vmcnt(0)
    s_barrier
    s_cmp_lg_u32 s27, 0
    s_cbranch_scc1 L_sgh_s
    s_cmp_lg_u32 s93, 0
    s_cbranch_scc1 L_sgh_i
    s_mov_b32 s82, 0
L_sgh_ip:
    buffer_load_dword v31, off, s[12:15], 0 offset:128 sc1
    s_add_u32 s82, s82, 1
    s_cmp_gt_u32 s82, 0x200000
    s_cbranch_scc1 L_wbail
    s_waitcnt vmcnt(0)
    v_cmp_eq_u32 vcc, 0, v31
    s_cbranch_vccnz L_sgh_ip
    s_mov_b32 s93, 1
L_sgh_i:
    v_mov_b32 v31, s90
    s_mov_b64 exec, 1
    buffer_atomic_add v31, off, s[4:7], s85
    s_mov_b64 exec, -1
L_sgh_s:
    s_add_u32 s89, s89, 1
    s_branch L_fetch
L_m2:
    s_sub_u32 s83, s28, 536
    s_lshr_b32 s84, s83, 3
    s_lshl_b32 s84, s84, 7
    s_add_u32 s85, s84, 91229184
    s_add_u32 s84, s84, 91228160
    s_cmp_lg_u32 s27, 0
    s_cbranch_scc1 L_hw_j
    s_mov_b32 s82, 0
L_hw_p:
    buffer_load_dword v31, off, s[4:7], s84 sc1
    s_add_u32 s82, s82, 1
    s_cmp_gt_u32 s82, 2097152
    s_cbranch_scc1 L_wbail
    s_waitcnt vmcnt(0)
    v_cmp_gt_u32 vcc, 7, v31
    s_cbranch_vccz L_hw_j
    s_sleep 2
    s_branch L_hw_p
L_hw_j:
    s_barrier
    s_mov_b32 s90, 1
    s_mov_b32 s44, 3584
    s_mov_b32 s50, 7
    s_mov_b32 s66, 268435456
    s_mov_b32 s8, s4
    s_mov_b32 s9, s5
    s_mov_b32 s11, 0x20000
    s_mov_b32 s40, s4
    s_mov_b32 s41, s5
    s_mov_b32 s42, 268435456
    s_mov_b32 s43, 0x20000
    s_mov_b32 s36, s78
    s_and_b32 s37, s79, 0xffff
    s_mov_b32 s39, 0x20000
    s_mov_b32 s45, 1024
    s_mov_b32 s67, 1835008
    s_mov_b32 s46, 2048
    s_and_b32 s55, s83, 3
    s_bfe_u32 s56, s83, 0x10002
    s_lshr_b32 s57, s83, 3
    s_mul_i32 s47, s57, 917504
    s_mul_i32 s60, s55, 896
    s_add_u32 s47, s47, s60
    s_add_u32 s47, s47, 69206016
    s_mul_i32 s48, s55, 458752
    s_lshl_b32 s60, s56, 9
    s_add_u32 s48, s48, s60
    s_lshl_b32 s49, s55, 22
    s_lshl_b32 s60, s57, 19
    s_add_u32 s49, s49, s60
    s_lshl_b32 s60, s56, 10
    s_add_u32 s49, s49, s60
    s_add_u32 s49, s49, 134217728
L_task_m2:
    v_and_b32 v14, 31, v1
    v_bfe_u32 v15, v1, 1, 3
    v_lshrrev_b32 v16, 5, v1
    v_xor_b32 v15, v15, v16
    v_lshlrev_b32 v14, 7, v14
    s_mul_i32 s55, s58, 16384
    v_add_u32 v14, s55, v14
    v_xor_b32 v16, 0, v15
    v_lshl_add_u32 v2, v16, 4, v14
    v_xor_b32 v16, 2, v15
    v_lshl_add_u32 v3, v16, 4, v14
    v_xor_b32 v16, 4, v15
    v_lshl_add_u32 v4, v16, 4, v14
    v_xor_b32 v16, 6, v15
    v_lshl_add_u32 v5, v16, 4, v14
    v_lshrrev_b32 v14, 5, v1
    v_lshlrev_b32 v14, 3, v14
    v_bfe_u32 v15, v1, 2, 2
    v_add_u32 v14, v14, v15
    v_lshlrev_b32 v14, 9, v14
    v_bfe_u32 v16, v1, 4, 1
    v_lshl_or_b32 v14, v16, 5, v14
    v_bfe_u32 v16, v1, 1, 1
    v_lshl_or_b32 v14, v16, 4, v14
    v_and_b32 v16, 1, v1
    v_lshl_or_b32 v14, v16, 3, v14
    s_lshl_b32 s55, s59, 8
    s_add_u32 s55, s55, 32768
    v_add_u32 v14, s55, v14
    v_xor_b32 v16, 0, v15
    v_lshl_add_u32 v6, v16, 6, v14
    v_xor_b32 v16, 1, v15
    v_lshl_add_u32 v7, v16, 6, v14
    v_xor_b32 v16, 2, v15
    v_lshl_add_u32 v8, v16, 6, v14
    v_xor_b32 v16, 3, v15
    v_lshl_add_u32 v9, v16, 6, v14
    v_lshrrev_b32 v14, 3, v1
    v_mul_lo_u32 v14, v14, s44
    v_and_b32 v15, 7, v1
    v_bfe_u32 v16, v1, 4, 2
    v_xor_b32 v15, v15, v16
    v_lshl_add_u32 v10, v15, 4, v14
    v_xor_b32 v15, 4, v15
    v_lshl_add_u32 v11, v15, 4, v14
    v_lshrrev_b32 v16, 5, v1
    v_mul_lo_u32 v14, v16, s45
    v_and_b32 v15, 31, v1
    v_lshlrev_b32 v16, 2, v16
    v_xor_b32 v15, v15, v16
    v_lshl_add_u32 v12, v15, 4, v14
    v_xor_b32 v15, 8, v15
    v_lshl_add_u32 v13, v15, 4, v14
    s_mov_b32 s10, s66
    s_mov_b32 s38, s67
    s_lshl_b32 s57, s44, 3
    s_lshl_b32 s61, s45, 1
    s_mul_i32 s52, s44, s27
    s_mul_i32 s52, s52, 64
    s_add_u32 s52, s52, s47
    s_mul_i32 s53, s45, s27
    s_lshl_b32 s53, s53, 4
    s_add_u32 s53, s53, s48
    s_lshl_b32 s54, s27, 13
    s_mul_i32 s65, s27, 8192
    s_mov_b32 s55, s52
    s_add_u32 m0, s65, 0
    s_nop 0
    buffer_load_dwordx4 v10, s[8:11], s55 offen sc1 lds
    s_add_u32 s55, s55, s57
    s_add_u32 m0, s65, 1024
    s_nop 0
    buffer_load_dwordx4 v11, s[8:11], s55 offen sc1 lds
    s_add_u32 s55, s55, s57
    s_add_u32 m0, s65, 2048
    s_nop 0
    buffer_load_dwordx4 v10, s[8:11], s55 offen sc1 lds
    s_add_u32 s55, s55, s57
    s_add_u32 m0, s65, 3072
    s_nop 0
    buffer_load_dwordx4 v11, s[8:11], s55 offen sc1 lds
    s_add_u32 s55, s55, s57
    s_add_u32 m0, s65, 4096
    s_nop 0
    buffer_load_dwordx4 v10, s[8:11], s55 offen sc1 lds
    s_add_u32 s55, s55, s57
    s_add_u32 m0, s65, 5120
    s_nop 0
    buffer_load_dwordx4 v11, s[8:11], s55 offen sc1 lds
    s_add_u32 s55, s55, s57
    s_add_u32 m0, s65, 6144
    s_nop 0
    buffer_load_dwordx4 v10, s[8:11], s55 offen sc1 lds
    s_add_u32 s55, s55, s57
    s_add_u32 m0, s65, 7168
    s_nop 0
    buffer_load_dwordx4 v11, s[8:11], s55 offen sc1 lds
    s_mov_b32 s56, s53
    s_add_u32 m0, s54, 32768
    s_nop 0
    buffer_load_dwordx4 v12, s[36:39], s56 offen lds
    s_add_u32 s56, s56, s61
    s_add_u32 m0, s54, 33792
    s_nop 0
    buffer_load_dwordx4 v13, s[36:39], s56 offen lds
    s_add_u32 s56, s56, s61
    s_add_u32 m0, s54, 34816
    s_nop 0
    buffer_load_dwordx4 v12, s[36:39], s56 offen lds
    s_add_u32 s56, s56, s61
    s_add_u32 m0, s54, 35840
    s_nop 0
    buffer_load_dwordx4 v13, s[36:39], s56 offen lds
    s_add_u32 s56, s56, s61
    s_add_u32 m0, s54, 36864
    s_nop 0
    buffer_load_dwordx4 v12, s[36:39], s56 offen lds
    s_add_u32 s56, s56, s61
    s_add_u32 m0, s54, 37888
    s_nop 0
    buffer_load_dwordx4 v13, s[36:39], s56 offen lds
    s_add_u32 s56, s56, s61
    s_add_u32 m0, s54, 38912
    s_nop 0
    buffer_load_dwordx4 v12, s[36:39], s56 offen lds
    s_add_u32 s56, s56, s61
    s_add_u32 m0, s54, 39936
    s_nop 0
    buffer_load_dwordx4 v13, s[36:39], s56 offen lds
    s_add_u32 s52, s52, 128
    s_lshl_b32 s62, s45, 6
    s_add_u32 s53, s53, s62
    s_xor_b32 s54, s54, 0x10000
    s_xor_b32 s65, s65, 0x10000
    s_mov_b32 s63, 0
    v_accvgpr_write_b32 a0, 0
    v_accvgpr_write_b32 a1, 0
    v_accvgpr_write_b32 a2, 0
    v_accvgpr_write_b32 a3, 0
    v_accvgpr_write_b32 a4, 0
    v_accvgpr_write_b32 a5, 0
    v_accvgpr_write_b32 a6, 0
    v_accvgpr_write_b32 a7, 0
    v_accvgpr_write_b32 a8, 0
    v_accvgpr_write_b32 a9, 0
    v_accvgpr_write_b32 a10, 0
    v_accvgpr_write_b32 a11, 0
    v_accvgpr_write_b32 a12, 0
    v_accvgpr_write_b32 a13, 0
    v_accvgpr_write_b32 a14, 0
    v_accvgpr_write_b32 a15, 0
    v_accvgpr_write_b32 a16, 0
    v_accvgpr_write_b32 a17, 0
    v_accvgpr_write_b32 a18, 0
    v_accvgpr_write_b32 a19, 0
    v_accvgpr_write_b32 a20, 0
    v_accvgpr_write_b32 a21, 0
    v_accvgpr_write_b32 a22, 0
    v_accvgpr_write_b32 a23, 0
    v_accvgpr_write_b32 a24, 0
    v_accvgpr_write_b32 a25, 0
    v_accvgpr_write_b32 a26, 0
    v_accvgpr_write_b32 a27, 0
    v_accvgpr_write_b32 a28, 0
    v_accvgpr_write_b32 a29, 0
    v_accvgpr_write_b32 a30, 0
    v_accvgpr_write_b32 a31, 0
    v_accvgpr_write_b32 a32, 0
    v_accvgpr_write_b32 a33, 0
    v_accvgpr_write_b32 a34, 0
    v_accvgpr_write_b32 a35, 0
    v_accvgpr_write_b32 a36, 0
    v_accvgpr_write_b32 a37, 0
    v_accvgpr_write_b32 a38, 0
    v_accvgpr_write_b32 a39, 0
    v_accvgpr_write_b32 a40, 0
    v_accvgpr_write_b32 a41, 0
    v_accvgpr_write_b32 a42, 0
    v_accvgpr_write_b32 a43, 0
    v_accvgpr_write_b32 a44, 0
    v_accvgpr_write_b32 a45, 0
    v_accvgpr_write_b32 a46, 0
    v_accvgpr_write_b32 a47, 0
    v_accvgpr_write_b32 a48, 0
    v_accvgpr_write_b32 a49, 0
    v_accvgpr_write_b32 a50, 0
    v_accvgpr_write_b32 a51, 0
    v_accvgpr_write_b32 a52, 0
    v_accvgpr_write_b32 a53, 0
    v_accvgpr_write_b32 a54, 0
    v_accvgpr_write_b32 a55, 0
    v_accvgpr_write_b32 a56, 0
    v_accvgpr_write_b32 a57, 0
    v_accvgpr_write_b32 a58, 0
    v_accvgpr_write_b32 a59, 0
    v_accvgpr_write_b32 a60, 0
    v_accvgpr_write_b32 a61, 0
    v_accvgpr_write_b32 a62, 0
    v_accvgpr_write_b32 a63, 0
    v_accvgpr_write_b32 a64, 0
    v_accvgpr_write_b32 a65, 0
    v_accvgpr_write_b32 a66, 0
    v_accvgpr_write_b32 a67, 0
    v_accvgpr_write_b32 a68, 0
    v_accvgpr_write_b32 a69, 0
    v_accvgpr_write_b32 a70, 0
    v_accvgpr_write_b32 a71, 0
    v_accvgpr_write_b32 a72, 0
    v_accvgpr_write_b32 a73, 0
    v_accvgpr_write_b32 a74, 0
    v_accvgpr_write_b32 a75, 0
    v_accvgpr_write_b32 a76, 0
    v_accvgpr_write_b32 a77, 0
    v_accvgpr_write_b32 a78, 0
    v_accvgpr_write_b32 a79, 0
    v_accvgpr_write_b32 a80, 0
    v_accvgpr_write_b32 a81, 0
    v_accvgpr_write_b32 a82, 0
    v_accvgpr_write_b32 a83, 0
    v_accvgpr_write_b32 a84, 0
    v_accvgpr_write_b32 a85, 0
    v_accvgpr_write_b32 a86, 0
    v_accvgpr_write_b32 a87, 0
    v_accvgpr_write_b32 a88, 0
    v_accvgpr_write_b32 a89, 0
    v_accvgpr_write_b32 a90, 0
    v_accvgpr_write_b32 a91, 0
    v_accvgpr_write_b32 a92, 0
    v_accvgpr_write_b32 a93, 0
    v_accvgpr_write_b32 a94, 0
    v_accvgpr_write_b32 a95, 0
    v_accvgpr_write_b32 a96, 0
    v_accvgpr_write_b32 a97, 0
    v_accvgpr_write_b32 a98, 0
    v_accvgpr_write_b32 a99, 0
    v_accvgpr_write_b32 a100, 0
    v_accvgpr_write_b32 a101, 0
    v_accvgpr_write_b32 a102, 0
    v_accvgpr_write_b32 a103, 0
    v_accvgpr_write_b32 a104, 0
    v_accvgpr_write_b32 a105, 0
    v_accvgpr_write_b32 a106, 0
    v_accvgpr_write_b32 a107, 0
    v_accvgpr_write_b32 a108, 0
    v_accvgpr_write_b32 a109, 0
    v_accvgpr_write_b32 a110, 0
    v_accvgpr_write_b32 a111, 0
    v_accvgpr_write_b32 a112, 0
    v_accvgpr_write_b32 a113, 0
    v_accvgpr_write_b32 a114, 0
    v_accvgpr_write_b32 a115, 0
    v_accvgpr_write_b32 a116, 0
    v_accvgpr_write_b32 a117, 0
    v_accvgpr_write_b32 a118, 0
    v_accvgpr_write_b32 a119, 0
    v_accvgpr_write_b32 a120, 0
    v_accvgpr_write_b32 a121, 0
    v_accvgpr_write_b32 a122, 0
    v_accvgpr_write_b32 a123, 0
    v_accvgpr_write_b32 a124, 0
    v_accvgpr_write_b32 a125, 0
    v_accvgpr_write_b32 a126, 0
    v_accvgpr_write_b32 a127, 0
    v_accvgpr_write_b32 a128, 0
    v_accvgpr_write_b32 a129, 0
    v_accvgpr_write_b32 a130, 0
    v_accvgpr_write_b32 a131, 0
    v_accvgpr_write_b32 a132, 0
    v_accvgpr_write_b32 a133, 0
    v_accvgpr_write_b32 a134, 0
    v_accvgpr_write_b32 a135, 0
    v_accvgpr_write_b32 a136, 0
    v_accvgpr_write_b32 a137, 0
    v_accvgpr_write_b32 a138, 0
    v_accvgpr_write_b32 a139, 0
    v_accvgpr_write_b32 a140, 0
    v_accvgpr_write_b32 a141, 0
    v_accvgpr_write_b32 a142, 0
    v_accvgpr_write_b32 a143, 0
    v_accvgpr_write_b32 a144, 0
    v_accvgpr_write_b32 a145, 0
    v_accvgpr_write_b32 a146, 0
    v_accvgpr_write_b32 a147, 0
    v_accvgpr_write_b32 a148, 0
    v_accvgpr_write_b32 a149, 0
    v_accvgpr_write_b32 a150, 0
    v_accvgpr_write_b32 a151, 0
    v_accvgpr_write_b32 a152, 0
    v_accvgpr_write_b32 a153, 0
    v_accvgpr_write_b32 a154, 0
    v_accvgpr_write_b32 a155, 0
    v_accvgpr_write_b32 a156, 0
    v_accvgpr_write_b32 a157, 0
    v_accvgpr_write_b32 a158, 0
    v_accvgpr_write_b32 a159, 0
    v_accvgpr_write_b32 a160, 0
    v_accvgpr_write_b32 a161, 0
    v_accvgpr_write_b32 a162, 0
    v_accvgpr_write_b32 a163, 0
    v_accvgpr_write_b32 a164, 0
    v_accvgpr_write_b32 a165, 0
    v_accvgpr_write_b32 a166, 0
    v_accvgpr_write_b32 a167, 0
    v_accvgpr_write_b32 a168, 0
    v_accvgpr_write_b32 a169, 0
    v_accvgpr_write_b32 a170, 0
    v_accvgpr_write_b32 a171, 0
    v_accvgpr_write_b32 a172, 0
    v_accvgpr_write_b32 a173, 0
    v_accvgpr_write_b32 a174, 0
    v_accvgpr_write_b32 a175, 0
    v_accvgpr_write_b32 a176, 0
    v_accvgpr_write_b32 a177, 0
    v_accvgpr_write_b32 a178, 0
    v_accvgpr_write_b32 a179, 0
    v_accvgpr_write_b32 a180, 0
    v_accvgpr_write_b32 a181, 0
    v_accvgpr_write_b32 a182, 0
    v_accvgpr_write_b32 a183, 0
    v_accvgpr_write_b32 a184, 0
    v_accvgpr_write_b32 a185, 0
    v_accvgpr_write_b32 a186, 0
    v_accvgpr_write_b32 a187, 0
    v_accvgpr_write_b32 a188, 0
    v_accvgpr_write_b32 a189, 0
    v_accvgpr_write_b32 a190, 0
    v_accvgpr_write_b32 a191, 0
    v_accvgpr_write_b32 a192, 0
    v_accvgpr_write_b32 a193, 0
    v_accvgpr_write_b32 a194, 0
    v_accvgpr_write_b32 a195, 0
    v_accvgpr_write_b32 a196, 0
    v_accvgpr_write_b32 a197, 0
    v_accvgpr_write_b32 a198, 0
    v_accvgpr_write_b32 a199, 0
    v_accvgpr_write_b32 a200, 0
    v_accvgpr_write_b32 a201, 0
    v_accvgpr_write_b32 a202, 0
    v_accvgpr_write_b32 a203, 0
    v_accvgpr_write_b32 a204, 0
    v_accvgpr_write_b32 a205, 0
    v_accvgpr_write_b32 a206, 0
    v_accvgpr_write_b32 a207, 0
    v_accvgpr_write_b32 a208, 0
    v_accvgpr_write_b32 a209, 0
    v_accvgpr_write_b32 a210, 0
    v_accvgpr_write_b32 a211, 0
    v_accvgpr_write_b32 a212, 0
    v_accvgpr_write_b32 a213, 0
    v_accvgpr_write_b32 a214, 0
    v_accvgpr_write_b32 a215, 0
    v_accvgpr_write_b32 a216, 0
    v_accvgpr_write_b32 a217, 0
    v_accvgpr_write_b32 a218, 0
    v_accvgpr_write_b32 a219, 0
    v_accvgpr_write_b32 a220, 0
    v_accvgpr_write_b32 a221, 0
    v_accvgpr_write_b32 a222, 0
    v_accvgpr_write_b32 a223, 0
    v_accvgpr_write_b32 a224, 0
    v_accvgpr_write_b32 a225, 0
    v_accvgpr_write_b32 a226, 0
    v_accvgpr_write_b32 a227, 0
    v_accvgpr_write_b32 a228, 0
    v_accvgpr_write_b32 a229, 0
    v_accvgpr_write_b32 a230, 0
    v_accvgpr_write_b32 a231, 0
    v_accvgpr_write_b32 a232, 0
    v_accvgpr_write_b32 a233, 0
    v_accvgpr_write_b32 a234, 0
    v_accvgpr_write_b32 a235, 0
    v_accvgpr_write_b32 a236, 0
    v_accvgpr_write_b32 a237, 0
    v_accvgpr_write_b32 a238, 0
    v_accvgpr_write_b32 a239, 0
    v_accvgpr_write_b32 a240, 0
    v_accvgpr_write_b32 a241, 0
    v_accvgpr_write_b32 a242, 0
    v_accvgpr_write_b32 a243, 0
    v_accvgpr_write_b32 a244, 0
    v_accvgpr_write_b32 a245, 0
    v_accvgpr_write_b32 a246, 0
    v_accvgpr_write_b32 a247, 0
    v_accvgpr_write_b32 a248, 0
    v_accvgpr_write_b32 a249, 0
    v_accvgpr_write_b32 a250, 0
    v_accvgpr_write_b32 a251, 0
    v_accvgpr_write_b32 a252, 0
    v_accvgpr_write_b32 a253, 0
    v_accvgpr_write_b32 a254, 0
    v_accvgpr_write_b32 a255, 0
    s_mov_b32 s51, 0
    s_nop 0
L_gm2:
    s_waitcnt vmcnt(0)
    s_barrier
    ds_read_b128 v[64:67], v2 offset:0
    ds_read_b64_tr_b16 v[96:97], v6 offset:0
    ds_read_b64_tr_b16 v[98:99], v6 offset:2048
    ds_read_b64_tr_b16 v[100:101], v7 offset:0
    ds_read_b64_tr_b16 v[102:103], v7 offset:2048
    ds_read_b128 v[68:71], v2 offset:4096
    ds_read_b64_tr_b16 v[104:105], v8 offset:0
    ds_read_b64_tr_b16 v[106:107], v8 offset:2048
    ds_read_b64_tr_b16 v[108:109], v9 offset:0
    ds_read_b64_tr_b16 v[110:111], v9 offset:2048
    ds_read_b128 v[72:75], v2 offset:8192
    ds_read_b128 v[76:79], v2 offset:12288
    s_add_u32 s55, s51, 1
    s_cmp_ge_u32 s55, s50
    s_cselect_b32 s10, 0, s66
    s_cselect_b32 s38, 0, s67
    s_waitcnt lgkmcnt(9)
    v_mfma_f32_32x32x16_bf16 a[0:15], v[96:99], v[64:67], a[0:15]
    ds_read_b128 v[80:83], v3 offset:0
    s_mov_b32 s55, s52
    s_add_u32 m0, s65, 0
    s_nop 0
    buffer_load_dwordx4 v10, s[8:11], s55 offen sc1 lds
    s_waitcnt lgkmcnt(8)
    v_mfma_f32_32x32x16_bf16 a[16:31], v[100:103], v[64:67], a[16:31]
    ds_read_b64_tr_b16 v[112:113], v6 offset:8192
    s_add_u32 s55, s55, s57
    s_add_u32 m0, s65, 1024
    s_nop 0
    buffer_load_dwordx4 v11, s[8:11], s55 offen sc1 lds
    s_waitcnt lgkmcnt(8)
    v_mfma_f32_32x32x16_bf16 a[64:79], v[96:99], v[68:71], a[64:79]
    ds_read_b64_tr_b16 v[114:115], v6 offset:10240
    s_add_u32 s55, s55, s57
    s_add_u32 m0, s65, 2048
    s_nop 0
    buffer_load_dwordx4 v10, s[8:11], s55 offen sc1 lds
    v_mfma_f32_32x32x16_bf16 a[80:95], v[100:103], v[68:71], a[80:95]
    ds_read_b64_tr_b16 v[116:117], v7 offset:8192
    s_add_u32 s55, s55, s57
    s_add_u32 m0, s65, 3072
    s_nop 0
    buffer_load_dwordx4 v11, s[8:11], s55 offen sc1 lds
    s_waitcnt lgkmcnt(8)
    v_mfma_f32_32x32x16_bf16 a[32:47], v[104:107], v[64:67], a[32:47]
    ds_read_b64_tr_b16 v[118:119], v7 offset:10240
    s_add_u32 s55, s55, s57
    s_add_u32 m0, s65, 4096
    s_nop 0
    buffer_load_dwordx4 v10, s[8:11], s55 offen sc1 lds
    s_waitcnt lgkmcnt(7)
    v_mfma_f32_32x32x16_bf16 a[48:63], v[108:111], v[64:67], a[48:63]
    ds_read_b128 v[84:87], v3 offset:4096
    s_add_u32 s55, s55, s57
    s_add_u32 m0, s65, 5120
    s_nop 0
    buffer_load_dwordx4 v11, s[8:11], s55 offen sc1 lds
    v_mfma_f32_32x32x16_bf16 a[96:111], v[104:107], v[68:71], a[96:111]
    ds_read_b64_tr_b16 v[120:121], v8 offset:8192
    s_add_u32 s55, s55, s57
    s_add_u32 m0, s65, 6144
    s_nop 0
    buffer_load_dwordx4 v10, s[8:11], s55 offen sc1 lds
    v_mfma_f32_32x32x16_bf16 a[112:127], v[108:111], v[68:71], a[112:127]
    ds_read_b64_tr_b16 v[122:123], v8 offset:10240
    s_add_u32 s55, s55, s57
    s_add_u32 m0, s65, 7168
    s_nop 0
    buffer_load_dwordx4 v11, s[8:11], s55 offen sc1 lds
    s_waitcnt lgkmcnt(9)
    v_mfma_f32_32x32x16_bf16 a[128:143], v[96:99], v[72:75], a[128:143]
    ds_read_b64_tr_b16 v[124:125], v9 offset:8192
    s_mov_b32 s56, s53
    s_add_u32 m0, s54, 32768
    s_nop 0
    buffer_load_dwordx4 v12, s[36:39], s56 offen lds
    v_mfma_f32_32x32x16_bf16 a[144:159], v[100:103], v[72:75], a[144:159]
    ds_read_b64_tr_b16 v[126:127], v9 offset:10240
    s_add_u32 s56, s56, s61
    s_add_u32 m0, s54, 33792
    s_nop 0
    buffer_load_dwordx4 v13, s[36:39], s56 offen lds
    v_mfma_f32_32x32x16_bf16 a[160:175], v[104:107], v[72:75], a[160:175]
    ds_read_b128 v[88:91], v3 offset:8192
    s_add_u32 s56, s56, s61
    s_add_u32 m0, s54, 34816
    s_nop 0
    buffer_load_dwordx4 v12, s[36:39], s56 offen lds
    v_mfma_f32_32x32x16_bf16 a[176:191], v[108:111], v[72:75], a[176:191]
    ds_read_b128 v[92:95], v3 offset:12288
    s_add_u32 s56, s56, s61
    s_add_u32 m0, s54, 35840
    s_nop 0
    buffer_load_dwordx4 v13, s[36:39], s56 offen lds
    s_waitcnt lgkmcnt(12)
    v_mfma_f32_32x32x16_bf16 a[192:207], v[96:99], v[76:79], a[192:207]
    s_add_u32 s56, s56, s61
    s_add_u32 m0, s54, 36864
    s_nop 0
    buffer_load_dwordx4 v12, s[36:39], s56 offen lds
    v_mfma_f32_32x32x16_bf16 a[208:223], v[100:103], v[76:79], a[208:223]
    s_add_u32 s56, s56, s61
    s_add_u32 m0, s54, 37888
    s_nop 0
    buffer_load_dwordx4 v13, s[36:39], s56 offen lds
    v_mfma_f32_32x32x16_bf16 a[224:239], v[104:107], v[76:79], a[224:239]
    s_add_u32 s56, s56, s61
    s_add_u32 m0, s54, 38912
    s_nop 0
    buffer_load_dwordx4 v12, s[36:39], s56 offen lds
    v_mfma_f32_32x32x16_bf16 a[240:255], v[108:111], v[76:79], a[240:255]
    s_add_u32 s56, s56, s61
    s_add_u32 m0, s54, 39936
    s_nop 0
    buffer_load_dwordx4 v13, s[36:39], s56 offen lds
    s_waitcnt lgkmcnt(9)
    v_mfma_f32_32x32x16_bf16 a[0:15], v[112:115], v[80:83], a[0:15]
    ds_read_b128 v[64:67], v4 offset:0
    s_waitcnt lgkmcnt(8)
    v_mfma_f32_32x32x16_bf16 a[16:31], v[116:119], v[80:83], a[16:31]
    ds_read_b64_tr_b16 v[96:97], v6 offset:16384
    s_waitcnt lgkmcnt(8)
    v_mfma_f32_32x32x16_bf16 a[64:79], v[112:115], v[84:87], a[64:79]
    ds_read_b64_tr_b16 v[98:99], v6 offset:18432
    v_mfma_f32_32x32x16_bf16 a[80:95], v[116:119], v[84:87], a[80:95]
    ds_read_b64_tr_b16 v[100:101], v7 offset:16384
    s_waitcnt lgkmcnt(8)
    v_mfma_f32_32x32x16_bf16 a[32:47], v[120:123], v[80:83], a[32:47]
    ds_read_b64_tr_b16 v[102:103], v7 offset:18432
    s_waitcnt lgkmcnt(7)
    v_mfma_f32_32x32x16_bf16 a[48:63], v[124:127], v[80:83], a[48:63]
    ds_read_b128 v[68:71], v4 offset:4096
    v_mfma_f32_32x32x16_bf16 a[96:111], v[120:123], v[84:87], a[96:111]
    ds_read_b64_tr_b16 v[104:105], v8 offset:16384
    v_mfma_f32_32x32x16_bf16 a[112:127], v[124:127], v[84:87], a[112:127]
    ds_read_b64_tr_b16 v[106:107], v8 offset:18432
    s_waitcnt lgkmcnt(9)
    v_mfma_f32_32x32x16_bf16 a[128:143], v[112:115], v[88:91], a[128:143]
    ds_read_b64_tr_b16 v[108:109], v9 offset:16384
    v_mfma_f32_32x32x16_bf16 a[144:159], v[116:119], v[88:91], a[144:159]
    ds_read_b64_tr_b16 v[110:111], v9 offset:18432
    v_mfma_f32_32x32x16_bf16 a[160:175], v[120:123], v[88:91], a[160:175]
    ds_read_b128 v[72:75], v4 offset:8192
    v_mfma_f32_32x32x16_bf16 a[176:191], v[124:127], v[88:91], a[176:191]
    ds_read_b128 v[76:79], v4 offset:12288
    s_waitcnt lgkmcnt(12)
    v_mfma_f32_32x32x16_bf16 a[192:207], v[112:115], v[92:95], a[192:207]
    v_mfma_f32_32x32x16_bf16 a[208:223], v[116:119], v[92:95], a[208:223]
    v_mfma_f32_32x32x16_bf16 a[224:239], v[120:123], v[92:95], a[224:239]
    v_mfma_f32_32x32x16_bf16 a[240:255], v[124:127], v[92:95], a[240:255]
    s_waitcnt lgkmcnt(9)
    v_mfma_f32_32x32x16_bf16 a[0:15], v[96:99], v[64:67], a[0:15]
    ds_read_b128 v[80:83], v5 offset:0
    s_waitcnt lgkmcnt(8)
    v_mfma_f32_32x32x16_bf16 a[16:31], v[100:103], v[64:67], a[16:31]
    ds_read_b64_tr_b16 v[112:113], v6 offset:24576
    s_waitcnt lgkmcnt(8)
    v_mfma_f32_32x32x16_bf16 a[64:79], v[96:99], v[68:71], a[64:79]
    ds_read_b64_tr_b16 v[114:115], v6 offset:26624
    v_mfma_f32_32x32x16_bf16 a[80:95], v[100:103], v[68:71], a[80:95]
    ds_read_b64_tr_b16 v[116:117], v7 offset:24576
    s_waitcnt lgkmcnt(8)
    v_mfma_f32_32x32x16_bf16 a[32:47], v[104:107], v[64:67], a[32:47]
    ds_read_b64_tr_b16 v[118:119], v7 offset:26624
    s_waitcnt lgkmcnt(7)
    v_mfma_f32_32x32x16_bf16 a[48:63], v[108:111], v[64:67], a[48:63]
    ds_read_b128 v[84:87], v5 offset:4096
    v_mfma_f32_32x32x16_bf16 a[96:111], v[104:107], v[68:71], a[96:111]
    ds_read_b64_tr_b16 v[120:121], v8 offset:24576
    v_mfma_f32_32x32x16_bf16 a[112:127], v[108:111], v[68:71], a[112:127]
    ds_read_b64_tr_b16 v[122:123], v8 offset:26624
    s_waitcnt lgkmcnt(9)
    v_mfma_f32_32x32x16_bf16 a[128:143], v[96:99], v[72:75], a[128:143]
    ds_read_b64_tr_b16 v[124:125], v9 offset:24576
    v_mfma_f32_32x32x16_bf16 a[144:159], v[100:103], v[72:75], a[144:159]
    ds_read_b64_tr_b16 v[126:127], v9 offset:26624
    v_mfma_f32_32x32x16_bf16 a[160:175], v[104:107], v[72:75], a[160:175]
    ds_read_b128 v[88:91], v5 offset:8192
    v_mfma_f32_32x32x16_bf16 a[176:191], v[108:111], v[72:75], a[176:191]
    ds_read_b128 v[92:95], v5 offset:12288
    s_waitcnt lgkmcnt(12)
    v_mfma_f32_32x32x16_bf16 a[192:207], v[96:99], v[76:79], a[192:207]
    v_mfma_f32_32x32x16_bf16 a[208:223], v[100:103], v[76:79], a[208:223]
    v_mfma_f32_32x32x16_bf16 a[224:239], v[104:107], v[76:79], a[224:239]
    v_mfma_f32_32x32x16_bf16 a[240:255], v[108:111], v[76:79], a[240:255]
    s_waitcnt lgkmcnt(9)
    v_mfma_f32_32x32x16_bf16 a[0:15], v[112:115], v[80:83], a[0:15]
    s_waitcnt lgkmcnt(7)
    v_mfma_f32_32x32x16_bf16 a[16:31], v[116:119], v[80:83], a[16:31]
    s_waitcnt lgkmcnt(6)
    v_mfma_f32_32x32x16_bf16 a[64:79], v[112:115], v[84:87], a[64:79]
    v_mfma_f32_32x32x16_bf16 a[80:95], v[116:119], v[84:87], a[80:95]
    s_waitcnt lgkmcnt(4)
    v_mfma_f32_32x32x16_bf16 a[32:47], v[120:123], v[80:83], a[32:47]
    s_waitcnt lgkmcnt(2)
    v_mfma_f32_32x32x16_bf16 a[48:63], v[124:127], v[80:83], a[48:63]
    v_mfma_f32_32x32x16_bf16 a[96:111], v[120:123], v[84:87], a[96:111]
    v_mfma_f32_32x32x16_bf16 a[112:127], v[124:127], v[84:87], a[112:127]
    s_waitcnt lgkmcnt(1)
    v_mfma_f32_32x32x16_bf16 a[128:143], v[112:115], v[88:91], a[128:143]
    v_mfma_f32_32x32x16_bf16 a[144:159], v[116:119], v[88:91], a[144:159]
    v_mfma_f32_32x32x16_bf16 a[160:175], v[120:123], v[88:91], a[160:175]
    v_mfma_f32_32x32x16_bf16 a[176:191], v[124:127], v[88:91], a[176:191]
    s_waitcnt lgkmcnt(0)
    v_mfma_f32_32x32x16_bf16 a[192:207], v[112:115], v[92:95], a[192:207]
    v_mfma_f32_32x32x16_bf16 a[208:223], v[116:119], v[92:95], a[208:223]
    v_mfma_f32_32x32x16_bf16 a[224:239], v[120:123], v[92:95], a[224:239]
    v_mfma_f32_32x32x16_bf16 a[240:255], v[124:127], v[92:95], a[240:255]
    s_add_u32 s52, s52, 128
    s_lshl_b32 s62, s45, 6
    s_add_u32 s53, s53, s62
    s_xor_b32 s54, s54, 0x10000
    s_xor_b32 s65, s65, 0x10000
    v_xor_b32 v2, 0x10000, v2
    v_xor_b32 v3, 0x10000, v3
    v_xor_b32 v4, 0x10000, v4
    v_xor_b32 v5, 0x10000, v5
    v_xor_b32 v6, 0x10000, v6
    v_xor_b32 v7, 0x10000, v7
    v_xor_b32 v8, 0x10000, v8
    v_xor_b32 v9, 0x10000, v9
    s_add_u32 s51, s51, 1
    s_cmp_lt_u32 s51, s50
    s_waitcnt lgkmcnt(0)
    s_cbranch_scc1 L_gm2
    s_waitcnt vmcnt(0)
    s_barrier
    s_mul_i32 s55, s27, 24576
    s_add_u32 s55, s55, 65536
    v_and_b32 v14, 31, v1
    v_lshlrev_b32 v16, 9, v14
    v_add_u32 v16, s55, v16
    v_and_b32 v14, 7, v1
    v_lshrrev_b32 v15, 5, v1
    v_xor_b32 v14, v14, v15
    v_lshlrev_b32 v21, 4, v14
    v_lshrrev_b32 v15, 5, v1
    v_and_b32 v14, 31, v1
    v_xor_b32 v14, v14, v15
    v_lshlrev_b32 v14, 4, v14
    v_lshl_or_b32 v17, v15, 9, v14
    v_add_u32 v17, s55, v17
    s_lshl_b32 s56, s58, 7
    v_add_u32 v15, s56, v15
    v_mul_lo_u32 v15, v15, s46
    v_and_b32 v14, 31, v1
    v_lshlrev_b32 v14, 4, v14
    s_lshl_b32 s56, s59, 9
    v_add3_u32 v20, v14, v15, s56
    s_lshl_b32 s57, s46, 1
    s_mov_b32 s56, s49
    v_accvgpr_read_b32 v32, a0
    v_accvgpr_read_b32 v33, a1
    v_accvgpr_read_b32 v34, a2
    v_accvgpr_read_b32 v35, a3
    v_accvgpr_read_b32 v36, a4
    v_accvgpr_read_b32 v37, a5
    v_accvgpr_read_b32 v38, a6
    v_accvgpr_read_b32 v39, a7
    v_accvgpr_read_b32 v40, a8
    v_accvgpr_read_b32 v41, a9
    v_accvgpr_read_b32 v42, a10
    v_accvgpr_read_b32 v43, a11
    v_accvgpr_read_b32 v44, a12
    v_accvgpr_read_b32 v45, a13
    v_accvgpr_read_b32 v46, a14
    v_accvgpr_read_b32 v47, a15
    v_xor_b32 v22, 0, v21
    v_add_u32 v22, v22, v16
    ds_write_b128 v22, v[32:35]
    v_xor_b32 v23, 32, v21
    v_add_u32 v23, v23, v16
    ds_write_b128 v23, v[36:39]
    v_xor_b32 v22, 64, v21
    v_add_u32 v22, v22, v16
    ds_write_b128 v22, v[40:43]
    v_xor_b32 v23, 96, v21
    v_add_u32 v23, v23, v16
    ds_write_b128 v23, v[44:47]
    v_accvgpr_read_b32 v48, a16
    v_accvgpr_read_b32 v49, a17
    v_accvgpr_read_b32 v50, a18
    v_accvgpr_read_b32 v51, a19
    v_accvgpr_read_b32 v52, a20
    v_accvgpr_read_b32 v53, a21
    v_accvgpr_read_b32 v54, a22
    v_accvgpr_read_b32 v55, a23
    v_accvgpr_read_b32 v56, a24
    v_accvgpr_read_b32 v57, a25
    v_accvgpr_read_b32 v58, a26
    v_accvgpr_read_b32 v59, a27
    v_accvgpr_read_b32 v60, a28
    v_accvgpr_read_b32 v61, a29
    v_accvgpr_read_b32 v62, a30
    v_accvgpr_read_b32 v63, a31
    v_xor_b32 v22, 128, v21
    v_add_u32 v22, v22, v16
    ds_write_b128 v22, v[48:51]
    v_xor_b32 v23, 160, v21
    v_add_u32 v23, v23, v16
    ds_write_b128 v23, v[52:55]
    v_xor_b32 v22, 192, v21
    v_add_u32 v22, v22, v16
    ds_write_b128 v22, v[56:59]
    v_xor_b32 v23, 224, v21
    v_add_u32 v23, v23, v16
    ds_write_b128 v23, v[60:63]
    v_accvgpr_read_b32 v32, a32
    v_accvgpr_read_b32 v33, a33
    v_accvgpr_read_b32 v34, a34
    v_accvgpr_read_b32 v35, a35
    v_accvgpr_read_b32 v36, a36
    v_accvgpr_read_b32 v37, a37
    v_accvgpr_read_b32 v38, a38
    v_accvgpr_read_b32 v39, a39
    v_accvgpr_read_b32 v40, a40
    v_accvgpr_read_b32 v41, a41
    v_accvgpr_read_b32 v42, a42
    v_accvgpr_read_b32 v43, a43
    v_accvgpr_read_b32 v44, a44
    v_accvgpr_read_b32 v45, a45
    v_accvgpr_read_b32 v46, a46
    v_accvgpr_read_b32 v47, a47
    v_xor_b32 v22, 256, v21
    v_add_u32 v22, v22, v16
    ds_write_b128 v22, v[32:35]
    v_xor_b32 v23, 288, v21
    v_add_u32 v23, v23, v16
    ds_write_b128 v23, v[36:39]
    v_xor_b32 v22, 320, v21
    v_add_u32 v22, v22, v16
    ds_write_b128 v22, v[40:43]
    v_xor_b32 v23, 352, v21
    v_add_u32 v23, v23, v16
    ds_write_b128 v23, v[44:47]
    v_accvgpr_read_b32 v48, a48
    v_accvgpr_read_b32 v49, a49
    v_accvgpr_read_b32 v50, a50
    v_accvgpr_read_b32 v51, a51
    v_accvgpr_read_b32 v52, a52
    v_accvgpr_read_b32 v53, a53
    v_accvgpr_read_b32 v54, a54
    v_accvgpr_read_b32 v55, a55
    v_accvgpr_read_b32 v56, a56
    v_accvgpr_read_b32 v57, a57
    v_accvgpr_read_b32 v58, a58
    v_accvgpr_read_b32 v59, a59
    v_accvgpr_read_b32 v60, a60
    v_accvgpr_read_b32 v61, a61
    v_accvgpr_read_b32 v62, a62
    v_accvgpr_read_b32 v63, a63
    v_xor_b32 v22, 384, v21
    v_add_u32 v22, v22, v16
    ds_write_b128 v22, v[48:51]
    v_xor_b32 v23, 416, v21
    v_add_u32 v23, v23, v16
    ds_write_b128 v23, v[52:55]
    v_xor_b32 v22, 448, v21
    v_add_u32 v22, v22, v16
    ds_write_b128 v22, v[56:59]
    v_xor_b32 v23, 480, v21
    v_add_u32 v23, v23, v16
    s_waitcnt lgkmcnt(14)
    ds_write_b128 v23, v[60:63]
    s_waitcnt lgkmcnt(0)
    v_xor_b32 v22, 0, v17
    ds_read_b128 v[96:99], v22 offset:0
    v_xor_b32 v23, 32, v17
    ds_read_b128 v[100:103], v23 offset:1024
    v_xor_b32 v22, 64, v17
    ds_read_b128 v[104:107], v22 offset:2048
    v_xor_b32 v23, 96, v17
    ds_read_b128 v[108:111], v23 offset:3072
    v_xor_b32 v22, 0, v17
    ds_read_b128 v[112:115], v22 offset:4096
    v_xor_b32 v23, 32, v17
    ds_read_b128 v[116:119], v23 offset:5120
    v_xor_b32 v22, 64, v17
    ds_read_b128 v[120:123], v22 offset:6144
    v_xor_b32 v23, 96, v17
    ds_read_b128 v[124:127], v23 offset:7168
    s_waitcnt lgkmcnt(7)
    buffer_store_dwordx4 v[96:99], v20, s[40:43], s56 offen sc1
    s_add_u32 s56, s56, s57
    s_waitcnt lgkmcnt(6)
    buffer_store_dwordx4 v[100:103], v20, s[40:43], s56 offen sc1
    s_add_u32 s56, s56, s57
    s_waitcnt lgkmcnt(5)
    buffer_store_dwordx4 v[104:107], v20, s[40:43], s56 offen sc1
    s_add_u32 s56, s56, s57
    s_waitcnt lgkmcnt(4)
    buffer_store_dwordx4 v[108:111], v20, s[40:43], s56 offen sc1
    s_add_u32 s56, s56, s57
    s_waitcnt lgkmcnt(3)
    buffer_store_dwordx4 v[112:115], v20, s[40:43], s56 offen sc1
    s_add_u32 s56, s56, s57
    s_waitcnt lgkmcnt(2)
    buffer_store_dwordx4 v[116:119], v20, s[40:43], s56 offen sc1
    s_add_u32 s56, s56, s57
    s_waitcnt lgkmcnt(1)
    buffer_store_dwordx4 v[120:123], v20, s[40:43], s56 offen sc1
    s_add_u32 s56, s56, s57
    s_waitcnt lgkmcnt(0)
    buffer_store_dwordx4 v[124:127], v20, s[40:43], s56 offen sc1
    s_add_u32 s56, s56, s57
    v_xor_b32 v22, 0, v17
    ds_read_b128 v[96:99], v22 offset:8192
    v_xor_b32 v23, 32, v17
    ds_read_b128 v[100:103], v23 offset:9216
    v_xor_b32 v22, 64, v17
    ds_read_b128 v[104:107], v22 offset:10240
    v_xor_b32 v23, 96, v17
    ds_read_b128 v[108:111], v23 offset:11264
    v_xor_b32 v22, 0, v17
    ds_read_b128 v[112:115], v22 offset:12288
    v_xor_b32 v23, 32, v17
    ds_read_b128 v[116:119], v23 offset:13312
    v_xor_b32 v22, 64, v17
    ds_read_b128 v[120:123], v22 offset:14336
    v_xor_b32 v23, 96, v17
    ds_read_b128 v[124:127], v23 offset:15360
    s_waitcnt lgkmcnt(7)
    buffer_store_dwordx4 v[96:99], v20, s[40:43], s56 offen sc1
    s_add_u32 s56, s56, s57
    s_waitcnt lgkmcnt(6)
    buffer_store_dwordx4 v[100:103], v20, s[40:43], s56 offen sc1
    s_add_u32 s56, s56, s57
    s_waitcnt lgkmcnt(5)
    buffer_store_dwordx4 v[104:107], v20, s[40:43], s56 offen sc1
    s_add_u32 s56, s56, s57
    s_waitcnt lgkmcnt(4)
    buffer_store_dwordx4 v[108:111], v20, s[40:43], s56 offen sc1
    s_add_u32 s56, s56, s57
    s_waitcnt lgkmcnt(3)
    buffer_store_dwordx4 v[112:115], v20, s[40:43], s56 offen sc1
    s_add_u32 s56, s56, s57
    s_waitcnt lgkmcnt(2)
    buffer_store_dwordx4 v[116:119], v20, s[40:43], s56 offen sc1
    s_add_u32 s56, s56, s57
    s_waitcnt lgkmcnt(1)
    buffer_store_dwordx4 v[120:123], v20, s[40:43], s56 offen sc1
    s_add_u32 s56, s56, s57
    s_waitcnt lgkmcnt(0)
    buffer_store_dwordx4 v[124:127], v20, s[40:43], s56 offen sc1
    s_add_u32 s56, s56, s57
    s_waitcnt lgkmcnt(0)
    v_accvgpr_read_b32 v32, a64
    v_accvgpr_read_b32 v33, a65
    v_accvgpr_read_b32 v34, a66
    v_accvgpr_read_b32 v35, a67
    v_accvgpr_read_b32 v36, a68
    v_accvgpr_read_b32 v37, a69
    v_accvgpr_read_b32 v38, a70
    v_accvgpr_read_b32 v39, a71
    v_accvgpr_read_b32 v40, a72
    v_accvgpr_read_b32 v41, a73
    v_accvgpr_read_b32 v42, a74
    v_accvgpr_read_b32 v43, a75
    v_accvgpr_read_b32 v44, a76
    v_accvgpr_read_b32 v45, a77
    v_accvgpr_read_b32 v46, a78
    v_accvgpr_read_b32 v47, a79
    v_xor_b32 v22, 0, v21
    v_add_u32 v22, v22, v16
    ds_write_b128 v22, v[32:35]
    v_xor_b32 v23, 32, v21
    v_add_u32 v23, v23, v16
    ds_write_b128 v23, v[36:39]
    v_xor_b32 v22, 64, v21
    v_add_u32 v22, v22, v16
    ds_write_b128 v22, v[40:43]
    v_xor_b32 v23, 96, v21
    v_add_u32 v23, v23, v16
    ds_write_b128 v23, v[44:47]
    v_accvgpr_read_b32 v48, a80
    v_accvgpr_read_b32 v49, a81
    v_accvgpr_read_b32 v50, a82
    v_accvgpr_read_b32 v51, a83
    v_accvgpr_read_b32 v52, a84
    v_accvgpr_read_b32 v53, a85
    v_accvgpr_read_b32 v54, a86
    v_accvgpr_read_b32 v55, a87
    v_accvgpr_read_b32 v56, a88
    v_accvgpr_read_b32 v57, a89
    v_accvgpr_read_b32 v58, a90
    v_accvgpr_read_b32 v59, a91
    v_accvgpr_read_b32 v60, a92
    v_accvgpr_read_b32 v61, a93
    v_accvgpr_read_b32 v62, a94
    v_accvgpr_read_b32 v63, a95
    v_xor_b32 v22, 128, v21
    v_add_u32 v22, v22, v16
    ds_write_b128 v22, v[48:51]
    v_xor_b32 v23, 160, v21
    v_add_u32 v23, v23, v16
    ds_write_b128 v23, v[52:55]
    v_xor_b32 v22, 192, v21
    v_add_u32 v22, v22, v16
    ds_write_b128 v22, v[56:59]
    v_xor_b32 v23, 224, v21
    v_add_u32 v23, v23, v16
    ds_write_b128 v23, v[60:63]
    v_accvgpr_read_b32 v32, a96
    v_accvgpr_read_b32 v33, a97
    v_accvgpr_read_b32 v34, a98
    v_accvgpr_read_b32 v35, a99
    v_accvgpr_read_b32 v36, a100
    v_accvgpr_read_b32 v37, a101
    v_accvgpr_read_b32 v38, a102
    v_accvgpr_read_b32 v39, a103
    v_accvgpr_read_b32 v40, a104
    v_accvgpr_read_b32 v41, a105
    v_accvgpr_read_b32 v42, a106
    v_accvgpr_read_b32 v43, a107
    v_accvgpr_read_b32 v44, a108
    v_accvgpr_read_b32 v45, a109
    v_accvgpr_read_b32 v46, a110
    v_accvgpr_read_b32 v47, a111
    v_xor_b32 v22, 256, v21
    v_add_u32 v22, v22, v16
    ds_write_b128 v22, v[32:35]
    v_xor_b32 v23, 288, v21
    v_add_u32 v23, v23, v16
    ds_write_b128 v23, v[36:39]
    v_xor_b32 v22, 320, v21
    v_add_u32 v22, v22, v16
    ds_write_b128 v22, v[40:43]
    v_xor_b32 v23, 352, v21
    v_add_u32 v23, v23, v16
    ds_write_b128 v23, v[44:47]
    v_accvgpr_read_b32 v48, a112
    v_accvgpr_read_b32 v49, a113
    v_accvgpr_read_b32 v50, a114
    v_accvgpr_read_b32 v51, a115
    v_accvgpr_read_b32 v52, a116
    v_accvgpr_read_b32 v53, a117
    v_accvgpr_read_b32 v54, a118
    v_accvgpr_read_b32 v55, a119
    v_accvgpr_read_b32 v56, a120
    v_accvgpr_read_b32 v57, a121
    v_accvgpr_read_b32 v58, a122
    v_accvgpr_read_b32 v59, a123
    v_accvgpr_read_b32 v60, a124
    v_accvgpr_read_b32 v61, a125
    v_accvgpr_read_b32 v62, a126
    v_accvgpr_read_b32 v63, a127
    v_xor_b32 v22, 384, v21
    v_add_u32 v22, v22, v16
    ds_write_b128 v22, v[48:51]
    v_xor_b32 v23, 416, v21
    v_add_u32 v23, v23, v16
    ds_write_b128 v23, v[52:55]
    v_xor_b32 v22, 448, v21
    v_add_u32 v22, v22, v16
    ds_write_b128 v22, v[56:59]
    v_xor_b32 v23, 480, v21
    v_add_u32 v23, v23, v16
    s_waitcnt lgkmcnt(14)
    ds_write_b128 v23, v[60:63]
    s_waitcnt lgkmcnt(0)
    v_xor_b32 v22, 0, v17
    ds_read_b128 v[96:99], v22 offset:0
    v_xor_b32 v23, 32, v17
    ds_read_b128 v[100:103], v23 offset:1024
    v_xor_b32 v22, 64, v17
    ds_read_b128 v[104:107], v22 offset:2048
    v_xor_b32 v23, 96, v17
    ds_read_b128 v[108:111], v23 offset:3072
    v_xor_b32 v22, 0, v17
    ds_read_b128 v[112:115], v22 offset:4096
    v_xor_b32 v23, 32, v17
    ds_read_b128 v[116:119], v23 offset:5120
    v_xor_b32 v22, 64, v17
    ds_read_b128 v[120:123], v22 offset:6144
    v_xor_b32 v23, 96, v17
    ds_read_b128 v[124:127], v23 offset:7168
    s_waitcnt lgkmcnt(7)
    buffer_store_dwordx4 v[96:99], v20, s[40:43], s56 offen sc1
    s_add_u32 s56, s56, s57
    s_waitcnt lgkmcnt(6)
    buffer_store_dwordx4 v[100:103], v20, s[40:43], s56 offen sc1
    s_add_u32 s56, s56, s57
    s_waitcnt lgkmcnt(5)
    buffer_store_dwordx4 v[104:107], v20, s[40:43], s56 offen sc1
    s_add_u32 s56, s56, s57
    s_waitcnt lgkmcnt(4)
    buffer_store_dwordx4 v[108:111], v20, s[40:43], s56 offen sc1
    s_add_u32 s56, s56, s57
    s_waitcnt lgkmcnt(3)
    buffer_store_dwordx4 v[112:115], v20, s[40:43], s56 offen sc1
    s_add_u32 s56, s56, s57
    s_waitcnt lgkmcnt(2)
    buffer_store_dwordx4 v[116:119], v20, s[40:43], s56 offen sc1
    s_add_u32 s56, s56, s57
    s_waitcnt lgkmcnt(1)
    buffer_store_dwordx4 v[120:123], v20, s[40:43], s56 offen sc1
    s_add_u32 s56, s56, s57
    s_waitcnt lgkmcnt(0)
    buffer_store_dwordx4 v[124:127], v20, s[40:43], s56 offen sc1
    s_add_u32 s56, s56, s57
    v_xor_b32 v22, 0, v17
    ds_read_b128 v[96:99], v22 offset:8192
    v_xor_b32 v23, 32, v17
    ds_read_b128 v[100:103], v23 offset:9216
    v_xor_b32 v22, 64, v17
    ds_read_b128 v[104:107], v22 offset:10240
    v_xor_b32 v23, 96, v17
    ds_read_b128 v[108:111], v23 offset:11264
    v_xor_b32 v22, 0, v17
    ds_read_b128 v[112:115], v22 offset:12288
    v_xor_b32 v23, 32, v17
    ds_read_b128 v[116:119], v23 offset:13312
    v_xor_b32 v22, 64, v17
    ds_read_b128 v[120:123], v22 offset:14336
    v_xor_b32 v23, 96, v17
    ds_read_b128 v[124:127], v23 offset:15360
    s_waitcnt lgkmcnt(7)
    buffer_store_dwordx4 v[96:99], v20, s[40:43], s56 offen sc1
    s_add_u32 s56, s56, s57
    s_waitcnt lgkmcnt(6)
    buffer_store_dwordx4 v[100:103], v20, s[40:43], s56 offen sc1
    s_add_u32 s56, s56, s57
    s_waitcnt lgkmcnt(5)
    buffer_store_dwordx4 v[104:107], v20, s[40:43], s56 offen sc1
    s_add_u32 s56, s56, s57
    s_waitcnt lgkmcnt(4)
    buffer_store_dwordx4 v[108:111], v20, s[40:43], s56 offen sc1
    s_add_u32 s56, s56, s57
    s_waitcnt lgkmcnt(3)
    buffer_store_dwordx4 v[112:115], v20, s[40:43], s56 offen sc1
    s_add_u32 s56, s56, s57
    s_waitcnt lgkmcnt(2)
    buffer_store_dwordx4 v[116:119], v20, s[40:43], s56 offen sc1
    s_add_u32 s56, s56, s57
    s_waitcnt lgkmcnt(1)
    buffer_store_dwordx4 v[120:123], v20, s[40:43], s56 offen sc1
    s_add_u32 s56, s56, s57
    s_waitcnt lgkmcnt(0)
    buffer_store_dwordx4 v[124:127], v20, s[40:43], s56 offen sc1
    s_add_u32 s56, s56, s57
    s_waitcnt lgkmcnt(0)
    v_accvgpr_read_b32 v32, a128
    v_accvgpr_read_b32 v33, a129
    v_accvgpr_read_b32 v34, a130
    v_accvgpr_read_b32 v35, a131
    v_accvgpr_read_b32 v36, a132
    v_accvgpr_read_b32 v37, a133
    v_accvgpr_read_b32 v38, a134
    v_accvgpr_read_b32 v39, a135
    v_accvgpr_read_b32 v40, a136
    v_accvgpr_read_b32 v41, a137
    v_accvgpr_read_b32 v42, a138
    v_accvgpr_read_b32 v43, a139
    v_accvgpr_read_b32 v44, a140
    v_accvgpr_read_b32 v45, a141
    v_accvgpr_read_b32 v46, a142
    v_accvgpr_read_b32 v47, a143
    v_xor_b32 v22, 0, v21
    v_add_u32 v22, v22, v16
    ds_write_b128 v22, v[32:35]
    v_xor_b32 v23, 32, v21
    v_add_u32 v23, v23, v16
    ds_write_b128 v23, v[36:39]
    v_xor_b32 v22, 64, v21
    v_add_u32 v22, v22, v16
    ds_write_b128 v22, v[40:43]
    v_xor_b32 v23, 96, v21
    v_add_u32 v23, v23, v16
    ds_write_b128 v23, v[44:47]
    v_accvgpr_read_b32 v48, a144
    v_accvgpr_read_b32 v49, a145
    v_accvgpr_read_b32 v50, a146
    v_accvgpr_read_b32 v51, a147
    v_accvgpr_read_b32 v52, a148
    v_accvgpr_read_b32 v53, a149
    v_accvgpr_read_b32 v54, a150
    v_accvgpr_read_b32 v55, a151
    v_accvgpr_read_b32 v56, a152
    v_accvgpr_read_b32 v57, a153
    v_accvgpr_read_b32 v58, a154
    v_accvgpr_read_b32 v59, a155
    v_accvgpr_read_b32 v60, a156
    v_accvgpr_read_b32 v61, a157
    v_accvgpr_read_b32 v62, a158
    v_accvgpr_read_b32 v63, a159
    v_xor_b32 v22, 128, v21
    v_add_u32 v22, v22, v16
    ds_write_b128 v22, v[48:51]
    v_xor_b32 v23, 160, v21
    v_add_u32 v23, v23, v16
    ds_write_b128 v23, v[52:55]
    v_xor_b32 v22, 192, v21
    v_add_u32 v22, v22, v16
    ds_write_b128 v22, v[56:59]
    v_xor_b32 v23, 224, v21
    v_add_u32 v23, v23, v16
    ds_write_b128 v23, v[60:63]
    v_accvgpr_read_b32 v32, a160
    v_accvgpr_read_b32 v33, a161
    v_accvgpr_read_b32 v34, a162
    v_accvgpr_read_b32 v35, a163
    v_accvgpr_read_b32 v36, a164
    v_accvgpr_read_b32 v37, a165
    v_accvgpr_read_b32 v38, a166
    v_accvgpr_read_b32 v39, a167
    v_accvgpr_read_b32 v40, a168
    v_accvgpr_read_b32 v41, a169
    v_accvgpr_read_b32 v42, a170
    v_accvgpr_read_b32 v43, a171
    v_accvgpr_read_b32 v44, a172
    v_accvgpr_read_b32 v45, a173
    v_accvgpr_read_b32 v46, a174
    v_accvgpr_read_b32 v47, a175
    v_xor_b32 v22, 256, v21
    v_add_u32 v22, v22, v16
    ds_write_b128 v22, v[32:35]
    v_xor_b32 v23, 288, v21
    v_add_u32 v23, v23, v16
    ds_write_b128 v23, v[36:39]
    v_xor_b32 v22, 320, v21
    v_add_u32 v22, v22, v16
    ds_write_b128 v22, v[40:43]
    v_xor_b32 v23, 352, v21
    v_add_u32 v23, v23, v16
    ds_write_b128 v23, v[44:47]
    v_accvgpr_read_b32 v48, a176
    v_accvgpr_read_b32 v49, a177
    v_accvgpr_read_b32 v50, a178
    v_accvgpr_read_b32 v51, a179
    v_accvgpr_read_b32 v52, a180
    v_accvgpr_read_b32 v53, a181
    v_accvgpr_read_b32 v54, a182
    v_accvgpr_read_b32 v55, a183
    v_accvgpr_read_b32 v56, a184
    v_accvgpr_read_b32 v57, a185
    v_accvgpr_read_b32 v58, a186
    v_accvgpr_read_b32 v59, a187
    v_accvgpr_read_b32 v60, a188
    v_accvgpr_read_b32 v61, a189
    v_accvgpr_read_b32 v62, a190
    v_accvgpr_read_b32 v63, a191
    v_xor_b32 v22, 384, v21
    v_add_u32 v22, v22, v16
    ds_write_b128 v22, v[48:51]
    v_xor_b32 v23, 416, v21
    v_add_u32 v23, v23, v16
    ds_write_b128 v23, v[52:55]
    v_xor_b32 v22, 448, v21
    v_add_u32 v22, v22, v16
    ds_write_b128 v22, v[56:59]
    v_xor_b32 v23, 480, v21
    v_add_u32 v23, v23, v16
    s_waitcnt lgkmcnt(14)
    ds_write_b128 v23, v[60:63]
    s_waitcnt lgkmcnt(0)
    v_xor_b32 v22, 0, v17
    ds_read_b128 v[96:99], v22 offset:0
    v_xor_b32 v23, 32, v17
    ds_read_b128 v[100:103], v23 offset:1024
    v_xor_b32 v22, 64, v17
    ds_read_b128 v[104:107], v22 offset:2048
    v_xor_b32 v23, 96, v17
    ds_read_b128 v[108:111], v23 offset:3072
    v_xor_b32 v22, 0, v17
    ds_read_b128 v[112:115], v22 offset:4096
    v_xor_b32 v23, 32, v17
    ds_read_b128 v[116:119], v23 offset:5120
    v_xor_b32 v22, 64, v17
    ds_read_b128 v[120:123], v22 offset:6144
    v_xor_b32 v23, 96, v17
    ds_read_b128 v[124:127], v23 offset:7168
    s_waitcnt lgkmcnt(7)
    buffer_store_dwordx4 v[96:99], v20, s[40:43], s56 offen sc1
    s_add_u32 s56, s56, s57
    s_waitcnt lgkmcnt(6)
    buffer_store_dwordx4 v[100:103], v20, s[40:43], s56 offen sc1
    s_add_u32 s56, s56, s57
    s_waitcnt lgkmcnt(5)
    buffer_store_dwordx4 v[104:107], v20, s[40:43], s56 offen sc1
    s_add_u32 s56, s56, s57
    s_waitcnt lgkmcnt(4)
    buffer_store_dwordx4 v[108:111], v20, s[40:43], s56 offen sc1
    s_add_u32 s56, s56, s57
    s_waitcnt lgkmcnt(3)
    buffer_store_dwordx4 v[112:115], v20, s[40:43], s56 offen sc1
    s_add_u32 s56, s56, s57
    s_waitcnt lgkmcnt(2)
    buffer_store_dwordx4 v[116:119], v20, s[40:43], s56 offen sc1
    s_add_u32 s56, s56, s57
    s_waitcnt lgkmcnt(1)
    buffer_store_dwordx4 v[120:123], v20, s[40:43], s56 offen sc1
    s_add_u32 s56, s56, s57
    s_waitcnt lgkmcnt(0)
    buffer_store_dwordx4 v[124:127], v20, s[40:43], s56 offen sc1
    s_add_u32 s56, s56, s57
    v_xor_b32 v22, 0, v17
    ds_read_b128 v[96:99], v22 offset:8192
    v_xor_b32 v23, 32, v17
    ds_read_b128 v[100:103], v23 offset:9216
    v_xor_b32 v22, 64, v17
    ds_read_b128 v[104:107], v22 offset:10240
    v_xor_b32 v23, 96, v17
    ds_read_b128 v[108:111], v23 offset:11264
    v_xor_b32 v22, 0, v17
    ds_read_b128 v[112:115], v22 offset:12288
    v_xor_b32 v23, 32, v17
    ds_read_b128 v[116:119], v23 offset:13312
    v_xor_b32 v22, 64, v17
    ds_read_b128 v[120:123], v22 offset:14336
    v_xor_b32 v23, 96, v17
    ds_read_b128 v[124:127], v23 offset:15360
    s_waitcnt lgkmcnt(7)
    buffer_store_dwordx4 v[96:99], v20, s[40:43], s56 offen sc1
    s_add_u32 s56, s56, s57
    s_waitcnt lgkmcnt(6)
    buffer_store_dwordx4 v[100:103], v20, s[40:43], s56 offen sc1
    s_add_u32 s56, s56, s57
    s_waitcnt lgkmcnt(5)
    buffer_store_dwordx4 v[104:107], v20, s[40:43], s56 offen sc1
    s_add_u32 s56, s56, s57
    s_waitcnt lgkmcnt(4)
    buffer_store_dwordx4 v[108:111], v20, s[40:43], s56 offen sc1
    s_add_u32 s56, s56, s57
    s_waitcnt lgkmcnt(3)
    buffer_store_dwordx4 v[112:115], v20, s[40:43], s56 offen sc1
    s_add_u32 s56, s56, s57
    s_waitcnt lgkmcnt(2)
    buffer_store_dwordx4 v[116:119], v20, s[40:43], s56 offen sc1
    s_add_u32 s56, s56, s57
    s_waitcnt lgkmcnt(1)
    buffer_store_dwordx4 v[120:123], v20, s[40:43], s56 offen sc1
    s_add_u32 s56, s56, s57
    s_waitcnt lgkmcnt(0)
    buffer_store_dwordx4 v[124:127], v20, s[40:43], s56 offen sc1
    s_add_u32 s56, s56, s57
    s_waitcnt lgkmcnt(0)
    v_accvgpr_read_b32 v32, a192
    v_accvgpr_read_b32 v33, a193
    v_accvgpr_read_b32 v34, a194
    v_accvgpr_read_b32 v35, a195
    v_accvgpr_read_b32 v36, a196
    v_accvgpr_read_b32 v37, a197
    v_accvgpr_read_b32 v38, a198
    v_accvgpr_read_b32 v39, a199
    v_accvgpr_read_b32 v40, a200
    v_accvgpr_read_b32 v41, a201
    v_accvgpr_read_b32 v42, a202
    v_accvgpr_read_b32 v43, a203
    v_accvgpr_read_b32 v44, a204
    v_accvgpr_read_b32 v45, a205
    v_accvgpr_read_b32 v46, a206
    v_accvgpr_read_b32 v47, a207
    v_xor_b32 v22, 0, v21
    v_add_u32 v22, v22, v16
    ds_write_b128 v22, v[32:35]
    v_xor_b32 v23, 32, v21
    v_add_u32 v23, v23, v16
    ds_write_b128 v23, v[36:39]
    v_xor_b32 v22, 64, v21
    v_add_u32 v22, v22, v16
    ds_write_b128 v22, v[40:43]
    v_xor_b32 v23, 96, v21
    v_add_u32 v23, v23, v16
    ds_write_b128 v23, v[44:47]
    v_accvgpr_read_b32 v48, a208
    v_accvgpr_read_b32 v49, a209
    v_accvgpr_read_b32 v50, a210
    v_accvgpr_read_b32 v51, a211
    v_accvgpr_read_b32 v52, a212
    v_accvgpr_read_b32 v53, a213
    v_accvgpr_read_b32 v54, a214
    v_accvgpr_read_b32 v55, a215
    v_accvgpr_read_b32 v56, a216
    v_accvgpr_read_b32 v57, a217
    v_accvgpr_read_b32 v58, a218
    v_accvgpr_read_b32 v59, a219
    v_accvgpr_read_b32 v60, a220
    v_accvgpr_read_b32 v61, a221
    v_accvgpr_read_b32 v62, a222
    v_accvgpr_read_b32 v63, a223
    v_xor_b32 v22, 128, v21
    v_add_u32 v22, v22, v16
    ds_write_b128 v22, v[48:51]
    v_xor_b32 v23, 160, v21
    v_add_u32 v23, v23, v16
    ds_write_b128 v23, v[52:55]
    v_xor_b32 v22, 192, v21
    v_add_u32 v22, v22, v16
    ds_write_b128 v22, v[56:59]
    v_xor_b32 v23, 224, v21
    v_add_u32 v23, v23, v16
    ds_write_b128 v23, v[60:63]
    v_accvgpr_read_b32 v32, a224
    v_accvgpr_read_b32 v33, a225
    v_accvgpr_read_b32 v34, a226
    v_accvgpr_read_b32 v35, a227
    v_accvgpr_read_b32 v36, a228
    v_accvgpr_read_b32 v37, a229
    v_accvgpr_read_b32 v38, a230
    v_accvgpr_read_b32 v39, a231
    v_accvgpr_read_b32 v40, a232
    v_accvgpr_read_b32 v41, a233
    v_accvgpr_read_b32 v42, a234
    v_accvgpr_read_b32 v43, a235
    v_accvgpr_read_b32 v44, a236
    v_accvgpr_read_b32 v45, a237
    v_accvgpr_read_b32 v46, a238
    v_accvgpr_read_b32 v47, a239
    v_xor_b32 v22, 256, v21
    v_add_u32 v22, v22, v16
    ds_write_b128 v22, v[32:35]
    v_xor_b32 v23, 288, v21
    v_add_u32 v23, v23, v16
    ds_write_b128 v23, v[36:39]
    v_xor_b32 v22, 320, v21
    v_add_u32 v22, v22, v16
    ds_write_b128 v22, v[40:43]
    v_xor_b32 v23, 352, v21
    v_add_u32 v23, v23, v16
    ds_write_b128 v23, v[44:47]
    v_accvgpr_read_b32 v48, a240
    v_accvgpr_read_b32 v49, a241
    v_accvgpr_read_b32 v50, a242
    v_accvgpr_read_b32 v51, a243
    v_accvgpr_read_b32 v52, a244
    v_accvgpr_read_b32 v53, a245
    v_accvgpr_read_b32 v54, a246
    v_accvgpr_read_b32 v55, a247
    v_accvgpr_read_b32 v56, a248
    v_accvgpr_read_b32 v57, a249
    v_accvgpr_read_b32 v58, a250
    v_accvgpr_read_b32 v59, a251
    v_accvgpr_read_b32 v60, a252
    v_accvgpr_read_b32 v61, a253
    v_accvgpr_read_b32 v62, a254
    v_accvgpr_read_b32 v63, a255
    v_xor_b32 v22, 384, v21
    v_add_u32 v22, v22, v16
    ds_write_b128 v22, v[48:51]
    v_xor_b32 v23, 416, v21
    v_add_u32 v23, v23, v16
    ds_write_b128 v23, v[52:55]
    v_xor_b32 v22, 448, v21
    v_add_u32 v22, v22, v16
    ds_write_b128 v22, v[56:59]
    v_xor_b32 v23, 480, v21
    v_add_u32 v23, v23, v16
    s_waitcnt lgkmcnt(14)
    ds_write_b128 v23, v[60:63]
    s_waitcnt lgkmcnt(0)
    v_xor_b32 v22, 0, v17
    ds_read_b128 v[96:99], v22 offset:0
    v_xor_b32 v23, 32, v17
    ds_read_b128 v[100:103], v23 offset:1024
    v_xor_b32 v22, 64, v17
    ds_read_b128 v[104:107], v22 offset:2048
    v_xor_b32 v23, 96, v17
    ds_read_b128 v[108:111], v23 offset:3072
    v_xor_b32 v22, 0, v17
    ds_read_b128 v[112:115], v22 offset:4096
    v_xor_b32 v23, 32, v17
    ds_read_b128 v[116:119], v23 offset:5120
    v_xor_b32 v22, 64, v17
    ds_read_b128 v[120:123], v22 offset:6144
    v_xor_b32 v23, 96, v17
    ds_read_b128 v[124:127], v23 offset:7168
    s_waitcnt lgkmcnt(7)
    buffer_store_dwordx4 v[96:99], v20, s[40:43], s56 offen sc1
    s_add_u32 s56, s56, s57
    s_waitcnt lgkmcnt(6)
    buffer_store_dwordx4 v[100:103], v20, s[40:43], s56 offen sc1
    s_add_u32 s56, s56, s57
    s_waitcnt lgkmcnt(5)
    buffer_store_dwordx4 v[104:107], v20, s[40:43], s56 offen sc1
    s_add_u32 s56, s56, s57
    s_waitcnt lgkmcnt(4)
    buffer_store_dwordx4 v[108:111], v20, s[40:43], s56 offen sc1
    s_add_u32 s56, s56, s57
    s_waitcnt lgkmcnt(3)
    buffer_store_dwordx4 v[112:115], v20, s[40:43], s56 offen sc1
    s_add_u32 s56, s56, s57
    s_waitcnt lgkmcnt(2)
    buffer_store_dwordx4 v[116:119], v20, s[40:43], s56 offen sc1
    s_add_u32 s56, s56, s57
    s_waitcnt lgkmcnt(1)
    buffer_store_dwordx4 v[120:123], v20, s[40:43], s56 offen sc1
    s_add_u32 s56, s56, s57
    s_waitcnt lgkmcnt(0)
    buffer_store_dwordx4 v[124:127], v20, s[40:43], s56 offen sc1
    s_add_u32 s56, s56, s57
    v_xor_b32 v22, 0, v17
    ds_read_b128 v[96:99], v22 offset:8192
    v_xor_b32 v23, 32, v17
    ds_read_b128 v[100:103], v23 offset:9216
    v_xor_b32 v22, 64, v17
    ds_read_b128 v[104:107], v22 offset:10240
    v_xor_b32 v23, 96, v17
    ds_read_b128 v[108:111], v23 offset:11264
    v_xor_b32 v22, 0, v17
    ds_read_b128 v[112:115], v22 offset:12288
    v_xor_b32 v23, 32, v17
    ds_read_b128 v[116:119], v23 offset:13312
    v_xor_b32 v22, 64, v17
    ds_read_b128 v[120:123], v22 offset:14336
    v_xor_b32 v23, 96, v17
    ds_read_b128 v[124:127], v23 offset:15360
    s_waitcnt lgkmcnt(7)
    buffer_store_dwordx4 v[96:99], v20, s[40:43], s56 offen sc1
    s_add_u32 s56, s56, s57
    s_waitcnt lgkmcnt(6)
    buffer_store_dwordx4 v[100:103], v20, s[40:43], s56 offen sc1
    s_add_u32 s56, s56, s57
    s_waitcnt lgkmcnt(5)
    buffer_store_dwordx4 v[104:107], v20, s[40:43], s56 offen sc1
    s_add_u32 s56, s56, s57
    s_waitcnt lgkmcnt(4)
    buffer_store_dwordx4 v[108:111], v20, s[40:43], s56 offen sc1
    s_add_u32 s56, s56, s57
    s_waitcnt lgkmcnt(3)
    buffer_store_dwordx4 v[112:115], v20, s[40:43], s56 offen sc1
    s_add_u32 s56, s56, s57
    s_waitcnt lgkmcnt(2)
    buffer_store_dwordx4 v[116:119], v20, s[40:43], s56 offen sc1
    s_add_u32 s56, s56, s57
    s_waitcnt lgkmcnt(1)
    buffer_store_dwordx4 v[120:123], v20, s[40:43], s56 offen sc1
    s_add_u32 s56, s56, s57
    s_waitcnt lgkmcnt(0)
    s_waitcnt vmcnt(62)
    buffer_store_dwordx4 v[124:127], v20, s[40:43], s56 offen sc1
    s_add_u32 s56, s56, s57
    s_waitcnt lgkmcnt(0)
L_eskip_m2:
    s_waitcnt vmcnt(0)
    s_barrier
    s_cmp_lg_u32 s27, 0
    s_cbranch_scc1 L_sgm2_s
    s_cmp_lg_u32 s93, 0
    s_cbranch_scc1 L_sgm2_i
    s_mov_b32 s82, 0
L_sgm2_ip:
    buffer_load_dword v31, off, s[12:15], 0 offset:128 sc1
    s_add_u32 s82, s82, 1
    s_cmp_gt_u32 s82, 0x200000
    s_cbranch_scc1 L_wbail
    s_waitcnt vmcnt(0)
    v_cmp_eq_u32 vcc, 0, v31
    s_cbranch_vccnz L_sgm2_ip
    s_mov_b32 s93, 1
L_sgm2_i:
    v_mov_b32 v31, s90
    s_mov_b64 exec, 1
    buffer_atomic_add v31, off, s[4:7], s85
    s_mov_b64 exec, -1
L_sgm2_s:
    s_add_u32 s89, s89, 1
    s_branch L_fetch
L_fetch:
    s_cmp_lg_u32 s27, 0
    s_cbranch_scc1 L_nxt_t
    v_mov_b32 v31, 1
    s_mov_b64 exec, 1
    buffer_atomic_add v31, off, s[12:15], 0 offset:64 sc0
    s_waitcnt vmcnt(0)
    v_mov_b32 v30, 163824
    ds_write_b32 v30, v31
    s_waitcnt lgkmcnt(0)
    s_mov_b64 exec, -1
L_nxt_t:
    s_barrier
    v_mov_b32 v30, 163824
    ds_read_b32 v31, v30
    s_waitcnt lgkmcnt(0)
    v_readfirstlane_b32 s28, v31
    s_barrier
    s_branch L_g1_next
L_ao_role:
    s_cmp_lg_u32 s27, 0
    s_cbranch_scc1 L_ini_j
    s_mov_b32 s82, 0
L_ini_p:
    buffer_load_dword v31, off, s[12:15], 0 offset:128 sc1
    s_add_u32 s82, s82, 1
    s_cmp_gt_u32 s82, 2097152
    s_cbranch_scc1 L_wbail
    s_waitcnt vmcnt(0)
    v_cmp_eq_u32 vcc, 0, v31
    s_cbranch_vccz L_ini_j
    s_sleep 2
    s_branch L_ini_p
L_ini_j:
    s_barrier
    s_cmp_lg_u32 s27, 0
    s_cbranch_scc1 L_aot_t
    v_mov_b32 v31, 1
    s_mov_b64 exec, 1
    buffer_atomic_add v31, off, s[12:15], 0 offset:160 sc0
    s_waitcnt vmcnt(0)
    v_mov_b32 v30, 163824
    ds_write_b32 v30, v31
    s_waitcnt lgkmcnt(0)
    s_mov_b64 exec, -1
L_aot_t:
    s_barrier
    v_mov_b32 v30, 163824
    ds_read_b32 v31, v30
    s_waitcnt lgkmcnt(0)
    v_readfirstlane_b32 s28, v31
    s_barrier
    s_nop 0
    s_cmp_ge_u32 s28, 192
    s_cbranch_scc1 L_end
    s_and_b32 s36, s28, 7
    s_bfe_u32 s37, s28, 0x20003
    s_lshr_b32 s38, s28, 5
    s_mov_b32 s56, s72
    s_and_b32 s57, s73, 0xffff
    s_mov_b32 s58, 2097152
    s_mov_b32 s59, 0x20000
    s_mov_b32 s60, s74
    s_and_b32 s61, s75, 0xffff
    s_mov_b32 s62, 1024
    s_mov_b32 s63, 0x20000
    s_mov_b32 s64, s76
    s_and_b32 s65, s77, 0xffff
    s_mov_b32 s66, 2097152
    s_mov_b32 s67, 0x20000
    v_and_b32 v1, 63, v0
    s_mov_b32 s8, s80
    s_and_b32 s9, s81, 0xffff
    s_mov_b32 s10, 4194304
    s_mov_b32 s11, 0x20000
    v_lshrrev_b32 v10, 4, v1
    v_bfe_u32 v11, v1, 1, 3
    v_xor_b32 v11, v11, v10
    v_and_b32 v12, 1, v1
    v_lshl_or_b32 v11, v11, 1, v12
    v_lshlrev_b32 v11, 4, v11
    v_lshl_or_b32 v14, v10, 10, v11
    v_xor_b32 v15, 128, v14
    s_lshl_b32 s40, s36, 19
    s_lshl_b32 s41, s27, 17
    s_add_u32 s40, s40, s41
    s_lshl_b32 s41, s37, 8
    s_add_u32 s40, s40, s41
    s_lshl_b32 s41, s27, 15
    s_mov_b32 m0, s41
    s_nop 0
    buffer_load_dwordx4 v14, s[8:11], s40 offen lds
    s_add_u32 s40, s40, 4096
    s_add_u32 s41, s41, 1024
    s_mov_b32 m0, s41
    s_nop 0
    buffer_load_dwordx4 v14, s[8:11], s40 offen lds
    s_add_u32 s40, s40, 4096
    s_add_u32 s41, s41, 1024
    s_mov_b32 m0, s41
    s_nop 0
    buffer_load_dwordx4 v15, s[8:11], s40 offen lds
    s_add_u32 s40, s40, 4096
    s_add_u32 s41, s41, 1024
    s_mov_b32 m0, s41
    s_nop 0
    buffer_load_dwordx4 v15, s[8:11], s40 offen lds
    s_add_u32 s40, s40, 4096
    s_add_u32 s41, s41, 1024
    s_mov_b32 m0, s41
    s_nop 0
    buffer_load_dwordx4 v14, s[8:11], s40 offen lds
    s_add_u32 s40, s40, 4096
    s_add_u32 s41, s41, 1024
    s_mov_b32 m0, s41
    s_nop 0
    buffer_load_dwordx4 v14, s[8:11], s40 offen lds
    s_add_u32 s40, s40, 4096
    s_add_u32 s41, s41, 1024
    s_mov_b32 m0, s41
    s_nop 0
    buffer_load_dwordx4 v15, s[8:11], s40 offen lds
    s_add_u32 s40, s40, 4096
    s_add_u32 s41, s41, 1024
    s_mov_b32 m0, s41
    s_nop 0
    buffer_load_dwordx4 v15, s[8:11], s40 offen lds
    s_add_u32 s40, s40, 4096
    s_add_u32 s41, s41, 1024
    s_mov_b32 m0, s41
    s_nop 0
    buffer_load_dwordx4 v14, s[8:11], s40 offen lds
    s_add_u32 s40, s40, 4096
    s_add_u32 s41, s41, 1024
    s_mov_b32 m0, s41
    s_nop 0
    buffer_load_dwordx4 v14, s[8:11], s40 offen lds
    s_add_u32 s40, s40, 4096
    s_add_u32 s41, s41, 1024
    s_mov_b32 m0, s41
    s_nop 0
    buffer_load_dwordx4 v15, s[8:11], s40 offen lds
    s_add_u32 s40, s40, 4096
    s_add_u32 s41, s41, 1024
    s_mov_b32 m0, s41
    s_nop 0
    buffer_load_dwordx4 v15, s[8:11], s40 offen lds
    s_add_u32 s40, s40, 4096
    s_add_u32 s41, s41, 1024
    s_mov_b32 m0, s41
    s_nop 0
    buffer_load_dwordx4 v14, s[8:11], s40 offen lds
    s_add_u32 s40, s40, 4096
    s_add_u32 s41, s41, 1024
    s_mov_b32 m0, s41
    s_nop 0
    buffer_load_dwordx4 v14, s[8:11], s40 offen lds
    s_add_u32 s40, s40, 4096
    s_add_u32 s41, s41, 1024
    s_mov_b32 m0, s41
    s_nop 0
    buffer_load_dwordx4 v15, s[8:11], s40 offen lds
    s_add_u32 s40, s40, 4096
    s_add_u32 s41, s41, 1024
    s_mov_b32 m0, s41
    s_nop 0
    buffer_load_dwordx4 v15, s[8:11], s40 offen lds
    s_add_u32 s40, s40, 4096
    s_add_u32 s41, s41, 1024
    s_mov_b32 m0, s41
    s_nop 0
    buffer_load_dwordx4 v14, s[8:11], s40 offen lds
    s_add_u32 s40, s40, 4096
    s_add_u32 s41, s41, 1024
    s_mov_b32 m0, s41
    s_nop 0
    buffer_load_dwordx4 v14, s[8:11], s40 offen lds
    s_add_u32 s40, s40, 4096
    s_add_u32 s41, s41, 1024
    s_mov_b32 m0, s41
    s_nop 0
    buffer_load_dwordx4 v15, s[8:11], s40 offen lds
    s_add_u32 s40, s40, 4096
    s_add_u32 s41, s41, 1024
    s_mov_b32 m0, s41
    s_nop 0
    buffer_load_dwordx4 v15, s[8:11], s40 offen lds
    s_add_u32 s40, s40, 4096
    s_add_u32 s41, s41, 1024
    s_mov_b32 m0, s41
    s_nop 0
    buffer_load_dwordx4 v14, s[8:11], s40 offen lds
    s_add_u32 s40, s40, 4096
    s_add_u32 s41, s41, 1024
    s_mov_b32 m0, s41
    s_nop 0
    buffer_load_dwordx4 v14, s[8:11], s40 offen lds
    s_add_u32 s40, s40, 4096
    s_add_u32 s41, s41, 1024
    s_mov_b32 m0, s41
    s_nop 0
    buffer_load_dwordx4 v15, s[8:11], s40 offen lds
    s_add_u32 s40, s40, 4096
    s_add_u32 s41, s41, 1024
    s_mov_b32 m0, s41
    s_nop 0
    buffer_load_dwordx4 v15, s[8:11], s40 offen lds
    s_add_u32 s40, s40, 4096
    s_add_u32 s41, s41, 1024
    s_mov_b32 m0, s41
    s_nop 0
    buffer_load_dwordx4 v14, s[8:11], s40 offen lds
    s_add_u32 s40, s40, 4096
    s_add_u32 s41, s41, 1024
    s_mov_b32 m0, s41
    s_nop 0
    buffer_load_dwordx4 v14, s[8:11], s40 offen lds
    s_add_u32 s40, s40, 4096
    s_add_u32 s41, s41, 1024
    s_mov_b32 m0, s41
    s_nop 0
    buffer_load_dwordx4 v15, s[8:11], s40 offen lds
    s_add_u32 s40, s40, 4096
    s_add_u32 s41, s41, 1024
    s_mov_b32 m0, s41
    s_nop 0
    buffer_load_dwordx4 v15, s[8:11], s40 offen lds
    s_add_u32 s40, s40, 4096
    s_add_u32 s41, s41, 1024
    s_mov_b32 m0, s41
    s_nop 0
    buffer_load_dwordx4 v14, s[8:11], s40 offen lds
    s_add_u32 s40, s40, 4096
    s_add_u32 s41, s41, 1024
    s_mov_b32 m0, s41
    s_nop 0
    buffer_load_dwordx4 v14, s[8:11], s40 offen lds
    s_add_u32 s40, s40, 4096
    s_add_u32 s41, s41, 1024
    s_mov_b32 m0, s41
    s_nop 0
    buffer_load_dwordx4 v15, s[8:11], s40 offen lds
    s_add_u32 s40, s40, 4096
    s_add_u32 s41, s41, 1024
    s_mov_b32 m0, s41
    s_nop 0
    buffer_load_dwordx4 v15, s[8:11], s40 offen lds
    s_add_u32 s40, s40, 4096
    s_add_u32 s41, s41, 1024
    v_lshrrev_b32 v10, 4, v1
    v_lshlrev_b32 v10, 3, v10
    v_bfe_u32 v11, v1, 2, 2
    v_add_u32 v10, v10, v11
    v_lshlrev_b32 v10, 8, v10
    v_bfe_u32 v12, v1, 4, 1
    v_lshl_or_b32 v11, v12, 2, v11
    s_lshl_b32 s40, s27, 1
    v_xor_b32 v11, s40, v11
    v_lshl_or_b32 v10, v11, 5, v10
    v_and_b32 v12, 3, v1
    v_lshl_or_b32 v10, v12, 3, v10
    v_xor_b32 v13, 32, v10
    v_mov_b32 v16, v10
    v_mov_b32 v17, v13
    v_add_u32 v18, 0x10000, v10
    v_add_u32 v19, 0x10000, v13
    s_waitcnt vmcnt(0)
    s_barrier
    ds_read_b64_tr_b16 a[0:1], v16 offset:0
    ds_read_b64_tr_b16 a[2:3], v16 offset:1024
    ds_read_b64_tr_b16 a[4:5], v16 offset:8192
    ds_read_b64_tr_b16 a[6:7], v16 offset:9216
    ds_read_b64_tr_b16 a[8:9], v16 offset:16384
    ds_read_b64_tr_b16 a[10:11], v16 offset:17408
    ds_read_b64_tr_b16 a[12:13], v16 offset:24576
    ds_read_b64_tr_b16 a[14:15], v16 offset:25600
    ds_read_b64_tr_b16 a[16:17], v16 offset:32768
    ds_read_b64_tr_b16 a[18:19], v16 offset:33792
    ds_read_b64_tr_b16 a[20:21], v16 offset:40960
    ds_read_b64_tr_b16 a[22:23], v16 offset:41984
    ds_read_b64_tr_b16 a[24:25], v16 offset:49152
    ds_read_b64_tr_b16 a[26:27], v16 offset:50176
    ds_read_b64_tr_b16 a[28:29], v16 offset:57344
    s_waitcnt lgkmcnt(14)
    ds_read_b64_tr_b16 a[30:31], v16 offset:58368
    s_waitcnt lgkmcnt(14)
    ds_read_b64_tr_b16 a[32:33], v18 offset:0
    s_waitcnt lgkmcnt(14)
    ds_read_b64_tr_b16 a[34:35], v18 offset:1024
    s_waitcnt lgkmcnt(14)
    ds_read_b64_tr_b16 a[36:37], v18 offset:8192
    s_waitcnt lgkmcnt(14)
    ds_read_b64_tr_b16 a[38:39], v18 offset:9216
    s_waitcnt lgkmcnt(14)
    ds_read_b64_tr_b16 a[40:41], v18 offset:16384
    s_waitcnt lgkmcnt(14)
    ds_read_b64_tr_b16 a[42:43], v18 offset:17408
    s_waitcnt lgkmcnt(14)
    ds_read_b64_tr_b16 a[44:45], v18 offset:24576
    s_waitcnt lgkmcnt(14)
    ds_read_b64_tr_b16 a[46:47], v18 offset:25600
    s_waitcnt lgkmcnt(14)
    ds_read_b64_tr_b16 a[48:49], v18 offset:32768
    s_waitcnt lgkmcnt(14)
    ds_read_b64_tr_b16 a[50:51], v18 offset:33792
    s_waitcnt lgkmcnt(14)
    ds_read_b64_tr_b16 a[52:53], v18 offset:40960
    s_waitcnt lgkmcnt(14)
    ds_read_b64_tr_b16 a[54:55], v18 offset:41984
    s_waitcnt lgkmcnt(14)
    ds_read_b64_tr_b16 a[56:57], v18 offset:49152
    s_waitcnt lgkmcnt(14)
    ds_read_b64_tr_b16 a[58:59], v18 offset:50176
    s_waitcnt lgkmcnt(14)
    ds_read_b64_tr_b16 a[60:61], v18 offset:57344
    s_waitcnt lgkmcnt(14)
    ds_read_b64_tr_b16 a[62:63], v18 offset:58368
    s_waitcnt lgkmcnt(14)
    ds_read_b64_tr_b16 a[64:65], v17 offset:0
    s_waitcnt lgkmcnt(14)
    ds_read_b64_tr_b16 a[66:67], v17 offset:1024
    s_waitcnt lgkmcnt(14)
    ds_read_b64_tr_b16 a[68:69], v17 offset:8192
    s_waitcnt lgkmcnt(14)
    ds_read_b64_tr_b16 a[70:71], v17 offset:9216
    s_waitcnt lgkmcnt(14)
    ds_read_b64_tr_b16 a[72:73], v17 offset:16384
    s_waitcnt lgkmcnt(14)
    ds_read_b64_tr_b16 a[74:75], v17 offset:17408
    s_waitcnt lgkmcnt(14)
    ds_read_b64_tr_b16 a[76:77], v17 offset:24576
    s_waitcnt lgkmcnt(14)
    ds_read_b64_tr_b16 a[78:79], v17 offset:25600
    s_waitcnt lgkmcnt(14)
    ds_read_b64_tr_b16 a[80:81], v17 offset:32768
    s_waitcnt lgkmcnt(14)
    ds_read_b64_tr_b16 a[82:83], v17 offset:33792
    s_waitcnt lgkmcnt(14)
    ds_read_b64_tr_b16 a[84:85], v17 offset:40960
    s_waitcnt lgkmcnt(14)
    ds_read_b64_tr_b16 a[86:87], v17 offset:41984
    s_waitcnt lgkmcnt(14)
    ds_read_b64_tr_b16 a[88:89], v17 offset:49152
    s_waitcnt lgkmcnt(14)
    ds_read_b64_tr_b16 a[90:91], v17 offset:50176
    s_waitcnt lgkmcnt(14)
    ds_read_b64_tr_b16 a[92:93], v17 offset:57344
    s_waitcnt lgkmcnt(14)
    ds_read_b64_tr_b16 a[94:95], v17 offset:58368
    s_waitcnt lgkmcnt(14)
    ds_read_b64_tr_b16 a[96:97], v19 offset:0
    s_waitcnt lgkmcnt(14)
    ds_read_b64_tr_b16 a[98:99], v19 offset:1024
    s_waitcnt lgkmcnt(14)
    ds_read_b64_tr_b16 a[100:101], v19 offset:8192
    s_waitcnt lgkmcnt(14)
    ds_read_b64_tr_b16 a[102:103], v19 offset:9216
    s_waitcnt lgkmcnt(14)
    ds_read_b64_tr_b16 a[104:105], v19 offset:16384
    s_waitcnt lgkmcnt(14)
    ds_read_b64_tr_b16 a[106:107], v19 offset:17408
    s_waitcnt lgkmcnt(14)
    ds_read_b64_tr_b16 a[108:109], v19 offset:24576
    s_waitcnt lgkmcnt(14)
    ds_read_b64_tr_b16 a[110:111], v19 offset:25600
    s_waitcnt lgkmcnt(14)
    ds_read_b64_tr_b16 a[112:113], v19 offset:32768
    s_waitcnt lgkmcnt(14)
    ds_read_b64_tr_b16 a[114:115], v19 offset:33792
    s_waitcnt lgkmcnt(14)
    ds_read_b64_tr_b16 a[116:117], v19 offset:40960
    s_waitcnt lgkmcnt(14)
    ds_read_b64_tr_b16 a[118:119], v19 offset:41984
    s_waitcnt lgkmcnt(14)
    ds_read_b64_tr_b16 a[120:121], v19 offset:49152
    s_waitcnt lgkmcnt(14)
    ds_read_b64_tr_b16 a[122:123], v19 offset:50176
    s_waitcnt lgkmcnt(14)
    ds_read_b64_tr_b16 a[124:125], v19 offset:57344
    s_waitcnt lgkmcnt(14)
    ds_read_b64_tr_b16 a[126:127], v19 offset:58368
    s_waitcnt lgkmcnt(0)
    s_barrier
    s_lshl_b32 s54, s36, 2
    s_add_u32 s54, s54, s27
    v_and_b32 v10, 15, v1
    v_lshlrev_b32 v10, 13, v10
    v_lshrrev_b32 v11, 4, v1
    v_lshl_or_b32 v10, v11, 4, v10
    s_lshl_b32 s40, s54, 8
    v_add_u32 v2, s40, v10
    v_and_b32 v10, 15, v1
    v_lshlrev_b32 v10, 6, v10
    v_lshl_or_b32 v10, v11, 4, v10
    s_lshl_b32 s40, s54, 13
    v_add_u32 v3, s40, v10
    v_lshlrev_b32 v10, 4, v1
    s_lshl_b32 s40, s54, 12
    v_add_u32 v4, s40, v10
    v_and_b32 v10, 15, v1
    v_lshlrev_b32 v10, 5, v10
    v_lshl_or_b32 v10, v11, 3, v10
    s_lshl_b32 s40, s27, 12
    s_add_u32 s40, s40, 32768
    v_add_u32 v5, s40, v10
    v_lshlrev_b32 v10, 3, v11
    v_bfe_u32 v12, v1, 2, 2
    v_add_u32 v10, v10, v12
    v_lshlrev_b32 v10, 5, v10
    v_and_b32 v12, 3, v1
    v_lshl_or_b32 v10, v12, 3, v10
    v_add_u32 v6, s40, v10
    v_mov_b32 v212, 0
    v_mov_b32 v213, 0
    v_mov_b32 v214, 0
    v_mov_b32 v215, 0
    v_lshlrev_b32 v10, 4, v1
    v_add_u32 v10, s40, v10
    ds_write_b128 v10, v[212:215] offset:0
    ds_write_b128 v10, v[212:215] offset:1024
    ds_write_b128 v10, v[212:215] offset:2048
    ds_write_b128 v10, v[212:215] offset:3072
    v_and_b32 v10, 15, v1
    v_lshlrev_b32 v7, 10, v10
    v_bfe_u32 v12, v1, 4, 1
    v_lshl_or_b32 v7, v12, 3, v7
    s_lshl_b32 s40, s27, 8
    v_add_u32 v7, s40, v7
    v_bfe_u32 v12, v1, 5, 1
    v_xor_b32 v10, v10, v12
    v_lshlrev_b32 v20, 4, v10
    v_and_b32 v10, 15, v1
    v_lshlrev_b32 v8, 10, v10
    v_xor_b32 v10, v10, v11
    v_lshlrev_b32 v21, 4, v10
    v_and_b32 v10, 15, v1
    v_lshlrev_b32 v10, 9, v10
    v_lshl_or_b32 v10, v11, 4, v10
    s_lshl_b32 s40, s27, 7
    v_add_u32 v9, s40, v10
    v_and_b32 v10, 15, v1
    v_lshlrev_b32 v12, 2, v11
    v_add_u32 v13, 0, v12
    v_cmp_gt_u32 s[46:47], v13, v10
    v_add_u32 v13, 1, v12
    v_cmp_gt_u32 s[48:49], v13, v10
    v_add_u32 v13, 2, v12
    v_cmp_gt_u32 s[50:51], v13, v10
    v_add_u32 v13, 3, v12
    v_cmp_gt_u32 s[52:53], v13, v10
    v_mov_b32 v200, 0x3f803f80
    v_mov_b32 v201, 0x3f803f80
    v_mov_b32 v202, 0x3f803f80
    v_mov_b32 v203, 0x3f803f80
    s_mov_b32 s44, 0x3e0293ee
    s_mov_b32 s45, 0x3e0293ee
    s_waitcnt lgkmcnt(0)
    s_sub_u32 s83, 63, s38
    s_mul_i32 s84, s83, 10923
    s_lshr_b32 s84, s84, 16
    s_mul_i32 s84, s84, 6
    s_add_u32 s96, s84, s38
    s_lshl_b32 s83, s96, 2
    s_add_u32 s83, s83, s37
    s_lshl_b32 s83, s83, 3
    s_add_u32 s83, s83, s36
    s_lshl_b32 s83, s83, 14
    s_add_u32 s83, s83, 92274688
    v_mov_b32 v32, -1
    v_mov_b32 v33, -1
    v_mov_b32 v34, -1
    v_mov_b32 v35, -1
    v_lshlrev_b32 v36, 4, v0
    s_add_u32 s84, s83, 0
    buffer_store_dwordx4 v[32:35], v36, s[4:7], s84 offen sc1
    s_add_u32 s84, s83, 4096
    buffer_store_dwordx4 v[32:35], v36, s[4:7], s84 offen sc1
    s_add_u32 s84, s83, 8192
    buffer_store_dwordx4 v[32:35], v36, s[4:7], s84 offen sc1
    s_add_u32 s84, s83, 12288
    buffer_store_dwordx4 v[32:35], v36, s[4:7], s84 offen sc1
    s_waitcnt vmcnt(0)
    s_mov_b32 s87, s38
    s_mov_b32 s88, -1
L_ao_loop:
    s_lshr_b32 s83, s38, 3
    s_cmp_eq_u32 s83, s88
    s_cbranch_scc1 L_ao_rbok
    s_mov_b32 s88, s83
    s_lshl_b32 s83, s83, 7
    s_add_u32 s84, s83, 91227136
    s_cmp_lg_u32 s27, 0
    s_cbranch_scc1 L_aq_j
    s_mov_b32 s82, 0
L_aq_p:
    buffer_load_dword v31, off, s[4:7], s84 sc1
    s_add_u32 s82, s82, 1
    s_cmp_gt_u32 s82, 2097152
    s_cbranch_scc1 L_wbail
    s_waitcnt vmcnt(0)
    v_cmp_gt_u32 vcc, 16, v31
    s_cbranch_vccz L_aq_j
    s_sleep 2
    s_branch L_aq_p
L_aq_j:
    s_barrier
    s_add_u32 s84, s83, 91226112
    s_cmp_lg_u32 s27, 0
    s_cbranch_scc1 L_ak_j
    s_mov_b32 s82, 0
L_ak_p:
    buffer_load_dword v31, off, s[4:7], s84 sc1
    s_add_u32 s82, s82, 1
    s_cmp_gt_u32 s82, 2097152
    s_cbranch_scc1 L_wbail
    s_waitcnt vmcnt(0)
    v_cmp_gt_u32 vcc, 128, v31
    s_cbranch_vccz L_ak_j
    s_sleep 2
    s_branch L_ak_p
L_ak_j:
    s_barrier
L_ao_rbok:
    s_lshl_b32 s40, s38, 18
    s_add_u32 s41, s40, 2097152
    s_add_u32 s42, s40, 35651584
    buffer_load_dwordx4 v[64:67], v2, s[4:7], s41 offen offset:0 sc1
    buffer_load_dwordx4 v[68:71], v2, s[4:7], s41 offen offset:64 sc1
    buffer_load_dwordx4 v[72:75], v2, s[4:7], s41 offen offset:128 sc1
    buffer_load_dwordx4 v[76:79], v2, s[4:7], s41 offen offset:192 sc1
    s_add_u32 s41, s41, 131072
    buffer_load_dwordx4 v[80:83], v2, s[4:7], s41 offen offset:0 sc1
    buffer_load_dwordx4 v[84:87], v2, s[4:7], s41 offen offset:64 sc1
    buffer_load_dwordx4 v[88:91], v2, s[4:7], s41 offen offset:128 sc1
    buffer_load_dwordx4 v[92:95], v2, s[4:7], s41 offen offset:192 sc1
    buffer_load_dwordx4 v[32:35], v2, s[4:7], s42 offen offset:0 sc1
    buffer_load_dwordx4 v[36:39], v2, s[4:7], s42 offen offset:64 sc1
    buffer_load_dwordx4 v[40:43], v2, s[4:7], s42 offen offset:128 sc1
    buffer_load_dwordx4 v[44:47], v2, s[4:7], s42 offen offset:192 sc1
    s_add_u32 s42, s42, 131072
    buffer_load_dwordx4 v[48:51], v2, s[4:7], s42 offen offset:0 sc1
    buffer_load_dwordx4 v[52:55], v2, s[4:7], s42 offen offset:64 sc1
    buffer_load_dwordx4 v[56:59], v2, s[4:7], s42 offen offset:128 sc1
    buffer_load_dwordx4 v[60:63], v2, s[4:7], s42 offen offset:192 sc1
    s_add_u32 s40, s40, 18874368
    buffer_load_dwordx4 v[96:99], v3, s[4:7], s40 offen offset:0 sc1
    buffer_load_dwordx4 v[100:103], v3, s[4:7], s40 offen offset:1024 sc1
    buffer_load_dwordx4 v[104:107], v3, s[4:7], s40 offen offset:2048 sc1
    buffer_load_dwordx4 v[108:111], v3, s[4:7], s40 offen offset:3072 sc1
    s_add_u32 s40, s40, 4096
    buffer_load_dwordx4 v[112:115], v3, s[4:7], s40 offen offset:0 sc1
    buffer_load_dwordx4 v[116:119], v3, s[4:7], s40 offen offset:1024 sc1
    buffer_load_dwordx4 v[120:123], v3, s[4:7], s40 offen offset:2048 sc1
    buffer_load_dwordx4 v[124:127], v3, s[4:7], s40 offen offset:3072 sc1
    s_lshl_b32 s39, s38, 17
    s_add_u32 s39, s39, 77594624
    s_cmp_ge_u32 s38, 58
    s_cbranch_scc1 L_ao_tail
    s_cmp_lg_u32 s27, 0
    s_cbranch_scc1 L_ap_j
    s_lshl_b32 s84, s36, 9
    s_add_u32 s84, s84, 91230208
    v_and_b32 v30, 3, v1
    v_lshlrev_b32 v30, 7, v30
    s_mov_b32 s82, 0
L_ap_p:
    buffer_load_dword v31, v30, s[4:7], s84 offen sc1
    s_add_u32 s82, s82, 1
    s_cmp_gt_u32 s82, 0x400000
    s_cbranch_scc1 L_wbail
    s_waitcnt vmcnt(0)
    v_cmp_ge_u32 vcc, s38, v31
    s_cbranch_vccz L_ap_j
    s_sleep 2
    s_branch L_ap_p
L_ap_j:
    s_barrier
    buffer_load_dwordx4 v[128:131], v4, s[4:7], s39 offen offset:0 sc1
    buffer_load_dwordx4 v[132:135], v4, s[4:7], s39 offen offset:1024 sc1
    buffer_load_dwordx4 v[136:139], v4, s[4:7], s39 offen offset:2048 sc1
    buffer_load_dwordx4 v[140:143], v4, s[4:7], s39 offen offset:3072 sc1
    s_branch L_ao_kv
L_ao_tail:
    s_mov_b32 s41, 0
L_ao_tailp:
    buffer_load_dwordx4 v[128:131], v4, s[4:7], s39 offen offset:0 sc1
    buffer_load_dwordx4 v[132:135], v4, s[4:7], s39 offen offset:1024 sc1
    buffer_load_dwordx4 v[136:139], v4, s[4:7], s39 offen offset:2048 sc1
    buffer_load_dwordx4 v[140:143], v4, s[4:7], s39 offen offset:3072 sc1
    s_add_u32 s41, s41, 1
    s_cmp_gt_u32 s41, 0x400000
    s_cbranch_scc1 L_wbail
    s_waitcnt vmcnt(0)
    v_max3_u32 v10, v128, v129, v130
    v_max3_u32 v10, v10, v131, v132
    v_max3_u32 v10, v10, v133, v134
    v_max3_u32 v10, v10, v135, v136
    v_max3_u32 v10, v10, v137, v138
    v_max3_u32 v10, v10, v139, v140
    v_max3_u32 v10, v10, v141, v142
    v_max_u32 v10, v10, v143
    v_cmp_eq_u32 vcc, -1, v10
    s_cbranch_vccnz L_ao_tailp
L_ao_kv:
    s_waitcnt vmcnt(3)
    ds_write2_b32 v5, v128, v129 offset0:1 offset1:129
    v_add_u32 v10, 1024, v5
    s_waitcnt vmcnt(2)
    ds_write2_b32 v10, v132, v133 offset0:1 offset1:129
    v_add_u32 v10, 2048, v5
    s_waitcnt vmcnt(1)
    ds_write2_b32 v10, v136, v137 offset0:1 offset1:129
    v_add_u32 v10, 3072, v5
    s_waitcnt vmcnt(0)
    ds_write2_b32 v10, v140, v141 offset0:1 offset1:129
    s_waitcnt lgkmcnt(0)
    ds_read_b64_tr_b16 v[144:145], v6 offset:0
    ds_read_b64_tr_b16 v[146:147], v6 offset:128
    ds_read_b64_tr_b16 v[148:149], v6 offset:1024
    ds_read_b64_tr_b16 v[150:151], v6 offset:1152
    ds_read_b64_tr_b16 v[152:153], v6 offset:2048
    ds_read_b64_tr_b16 v[154:155], v6 offset:2176
    ds_read_b64_tr_b16 v[156:157], v6 offset:3072
    ds_read_b64_tr_b16 v[158:159], v6 offset:3200
    v_mfma_f32_16x16x32_bf16 v[164:167], v[64:67], v[32:35], 0
    v_mfma_f32_16x16x32_bf16 v[164:167], v[68:71], v[36:39], v[164:167]
    v_mfma_f32_16x16x32_bf16 v[164:167], v[72:75], v[40:43], v[164:167]
    v_mfma_f32_16x16x32_bf16 v[164:167], v[76:79], v[44:47], v[164:167]
    v_mfma_f32_16x16x32_bf16 v[176:179], v[64:67], v[48:51], 0
    v_mfma_f32_16x16x32_bf16 v[176:179], v[68:71], v[52:55], v[176:179]
    v_mfma_f32_16x16x32_bf16 v[176:179], v[72:75], v[56:59], v[176:179]
    v_mfma_f32_16x16x32_bf16 v[176:179], v[76:79], v[60:63], v[176:179]
    v_mfma_f32_16x16x32_bf16 v[180:183], v[80:83], v[48:51], 0
    v_mfma_f32_16x16x32_bf16 v[180:183], v[84:87], v[52:55], v[180:183]
    v_mfma_f32_16x16x32_bf16 v[180:183], v[88:91], v[56:59], v[180:183]
    v_mfma_f32_16x16x32_bf16 v[180:183], v[92:95], v[60:63], v[180:183]
    s_waitcnt lgkmcnt(6)
    v_mfma_f32_16x16x32_bf16 v[160:163], v[144:147], v[32:35], 0
    s_waitcnt lgkmcnt(4)
    v_mfma_f32_16x16x32_bf16 v[160:163], v[148:151], v[36:39], v[160:163]
    s_waitcnt lgkmcnt(2)
    v_mfma_f32_16x16x32_bf16 v[160:163], v[152:155], v[40:43], v[160:163]
    s_waitcnt lgkmcnt(0)
    v_mfma_f32_16x16x32_bf16 v[160:163], v[156:159], v[44:47], v[160:163]
    v_mfma_f32_16x16x32_bf16 v[172:175], v[144:147], v[48:51], 0
    v_mfma_f32_16x16x32_bf16 v[172:175], v[148:151], v[52:55], v[172:175]
    v_mfma_f32_16x16x32_bf16 v[172:175], v[152:155], v[56:59], v[172:175]
    v_mfma_f32_16x16x32_bf16 v[172:175], v[156:159], v[60:63], v[172:175]
    v_mov_b32 v12, 0xff800000
    v_cndmask_b32 v164, v164, v12, s[46:47]
    v_cndmask_b32 v165, v165, v12, s[48:49]
    v_cndmask_b32 v166, v166, v12, s[50:51]
    v_cndmask_b32 v167, v167, v12, s[52:53]
    v_cndmask_b32 v180, v180, v12, s[46:47]
    v_cndmask_b32 v181, v181, v12, s[48:49]
    v_cndmask_b32 v182, v182, v12, s[50:51]
    v_cndmask_b32 v183, v183, v12, s[52:53]
    v_max3_f32 v14, v162, v163, v164
    v_max3_f32 v14, v14, v165, v166
    v_max_f32 v14, v14, v167
    v_mov_b32 v15, v14
    s_nop 1
    v_permlane16_swap_b32 v14, v15
    v_max_f32 v14, v14, v15
    v_mov_b32 v15, v14
    s_nop 1
    v_permlane32_swap_b32 v14, v15
    v_max_f32 v14, v14, v15
    v_mul_f32 v14, s44, v14
    v_fma_f32 v162, v162, s44, -v14
    v_fma_f32 v163, v163, s44, -v14
    v_fma_f32 v164, v164, s44, -v14
    v_fma_f32 v165, v165, s44, -v14
    v_fma_f32 v166, v166, s44, -v14
    v_fma_f32 v167, v167, s44, -v14
    v_exp_f32 v162, v162
    v_exp_f32 v163, v163
    v_exp_f32 v164, v164
    v_exp_f32 v165, v165
    v_exp_f32 v166, v166
    v_exp_f32 v167, v167
    v_cvt_pk_bf16_f32 v184, v164, v165
    v_cvt_pk_bf16_f32 v185, v166, v167
    v_mov_b32 v186, 0
    v_mov_b32 v187, 0
    v_cvt_pk_bf16_f32 v192, v162, v163
    v_mov_b32 v193, 0
    v_mov_b32 v194, 0
    v_mov_b32 v195, v192
    v_max3_f32 v14, v174, v175, v176
    v_max3_f32 v14, v14, v177, v178
    v_max3_f32 v14, v14, v179, v180
    v_max3_f32 v14, v14, v181, v182
    v_max_f32 v14, v14, v183
    v_mov_b32 v15, v14
    s_nop 1
    v_permlane16_swap_b32 v14, v15
    v_max_f32 v14, v14, v15
    v_mov_b32 v15, v14
    s_nop 1
    v_permlane32_swap_b32 v14, v15
    v_max_f32 v14, v14, v15
    v_mul_f32 v14, s44, v14
    v_fma_f32 v174, v174, s44, -v14
    v_fma_f32 v175, v175, s44, -v14
    v_fma_f32 v176, v176, s44, -v14
    v_fma_f32 v177, v177, s44, -v14
    v_fma_f32 v178, v178, s44, -v14
    v_fma_f32 v179, v179, s44, -v14
    v_fma_f32 v180, v180, s44, -v14
    v_fma_f32 v181, v181, s44, -v14
    v_fma_f32 v182, v182, s44, -v14
    v_fma_f32 v183, v183, s44, -v14
    v_exp_f32 v174, v174
    v_exp_f32 v175, v175
    v_exp_f32 v176, v176
    v_exp_f32 v177, v177
    v_exp_f32 v178, v178
    v_exp_f32 v179, v179
    v_exp_f32 v180, v180
    v_exp_f32 v181, v181
    v_exp_f32 v182, v182
    v_exp_f32 v183, v183
    v_cvt_pk_bf16_f32 v188, v176, v177
    v_cvt_pk_bf16_f32 v189, v178, v179
    v_cvt_pk_bf16_f32 v190, v180, v181
    v_cvt_pk_bf16_f32 v191, v182, v183
    v_cvt_pk_bf16_f32 v196, v174, v175
    v_mov_b32 v197, 0
    v_mov_b32 v198, 0
    v_mov_b32 v199, v196
    v_mfma_f32_16x16x32_bf16 v[204:207], v[200:203], v[184:187], 0
    v_mfma_f32_16x16x32_bf16 a[128:131], v[96:99], v[184:187], 0
    v_mfma_f32_16x16x32_bf16 a[132:135], v[100:103], v[184:187], 0
    v_mfma_f32_16x16x32_bf16 a[136:139], v[104:107], v[184:187], 0
    v_mfma_f32_16x16x32_bf16 a[140:143], v[108:111], v[184:187], 0
    v_mfma_f32_16x16x32_bf16 a[144:147], v[112:115], v[184:187], 0
    v_mfma_f32_16x16x32_bf16 a[148:151], v[116:119], v[184:187], 0
    v_mfma_f32_16x16x32_bf16 a[152:155], v[120:123], v[184:187], 0
    v_mfma_f32_16x16x32_bf16 a[156:159], v[124:127], v[184:187], 0
    v_mfma_f32_16x16x16_bf16 v[204:207], v[200:201], v[192:193], v[204:207]
    v_mfma_f32_16x16x16_bf16 a[128:131], v[130:131], v[192:193], a[128:131]
    v_mfma_f32_16x16x16_bf16 a[132:135], v[130:131], v[194:195], a[132:135]
    v_mfma_f32_16x16x16_bf16 a[136:139], v[134:135], v[192:193], a[136:139]
    v_mfma_f32_16x16x16_bf16 a[140:143], v[134:135], v[194:195], a[140:143]
    v_mfma_f32_16x16x16_bf16 a[144:147], v[138:139], v[192:193], a[144:147]
    v_mfma_f32_16x16x16_bf16 a[148:151], v[138:139], v[194:195], a[148:151]
    v_mfma_f32_16x16x16_bf16 a[152:155], v[142:143], v[192:193], a[152:155]
    v_mfma_f32_16x16x16_bf16 a[156:159], v[142:143], v[194:195], a[156:159]
    v_mfma_f32_16x16x32_bf16 v[208:211], v[200:203], v[188:191], 0
    v_mfma_f32_16x16x32_bf16 a[160:163], v[96:99], v[188:191], 0
    v_mfma_f32_16x16x32_bf16 a[164:167], v[100:103], v[188:191], 0
    v_mfma_f32_16x16x32_bf16 a[168:171], v[104:107], v[188:191], 0
    v_mfma_f32_16x16x32_bf16 a[172:175], v[108:111], v[188:191], 0
    v_mfma_f32_16x16x32_bf16 a[176:179], v[112:115], v[188:191], 0
    v_mfma_f32_16x16x32_bf16 a[180:183], v[116:119], v[188:191], 0
    v_mfma_f32_16x16x32_bf16 a[184:187], v[120:123], v[188:191], 0
    v_mfma_f32_16x16x32_bf16 a[188:191], v[124:127], v[188:191], 0
    v_mfma_f32_16x16x16_bf16 v[208:211], v[200:201], v[196:197], v[208:211]
    v_mfma_f32_16x16x16_bf16 a[160:163], v[130:131], v[196:197], a[160:163]
    v_mfma_f32_16x16x16_bf16 a[164:167], v[130:131], v[198:199], a[164:167]
    v_mfma_f32_16x16x16_bf16 a[168:171], v[134:135], v[196:197], a[168:171]
    v_mfma_f32_16x16x16_bf16 a[172:175], v[134:135], v[198:199], a[172:175]
    v_mfma_f32_16x16x16_bf16 a[176:179], v[138:139], v[196:197], a[176:179]
    v_mfma_f32_16x16x16_bf16 a[180:183], v[138:139], v[198:199], a[180:183]
    v_mfma_f32_16x16x16_bf16 a[184:187], v[142:143], v[196:197], a[184:187]
    v_mfma_f32_16x16x16_bf16 a[188:191], v[142:143], v[198:199], a[188:191]
    s_barrier
    v_rcp_f32 v14, v204
    v_accvgpr_read_b32 v22, a128
    v_accvgpr_read_b32 v23, a129
    v_accvgpr_read_b32 v24, a130
    v_accvgpr_read_b32 v25, a131
    v_mul_f32 v22, v22, v14
    v_mul_f32 v23, v23, v14
    v_mul_f32 v24, v24, v14
    v_mul_f32 v25, v25, v14
    v_cvt_pk_bf16_f32 v26, v22, v23
    v_cvt_pk_bf16_f32 v27, v24, v25
    v_xor_b32 v10, 0, v20
    v_add_u32 v10, v10, v7
    ds_write_b64 v10, v[26:27] offset:0
    v_accvgpr_read_b32 v22, a132
    v_accvgpr_read_b32 v23, a133
    v_accvgpr_read_b32 v24, a134
    v_accvgpr_read_b32 v25, a135
    v_mul_f32 v22, v22, v14
    v_mul_f32 v23, v23, v14
    v_mul_f32 v24, v24, v14
    v_mul_f32 v25, v25, v14
    v_cvt_pk_bf16_f32 v26, v22, v23
    v_cvt_pk_bf16_f32 v27, v24, v25
    v_xor_b32 v10, 32, v20
    v_add_u32 v10, v10, v7
    ds_write_b64 v10, v[26:27] offset:0
    v_accvgpr_read_b32 v22, a136
    v_accvgpr_read_b32 v23, a137
    v_accvgpr_read_b32 v24, a138
    v_accvgpr_read_b32 v25, a139
    v_mul_f32 v22, v22, v14
    v_mul_f32 v23, v23, v14
    v_mul_f32 v24, v24, v14
    v_mul_f32 v25, v25, v14
    v_cvt_pk_bf16_f32 v26, v22, v23
    v_cvt_pk_bf16_f32 v27, v24, v25
    v_xor_b32 v10, 64, v20
    v_add_u32 v10, v10, v7
    ds_write_b64 v10, v[26:27] offset:0
    v_accvgpr_read_b32 v22, a140
    v_accvgpr_read_b32 v23, a141
    v_accvgpr_read_b32 v24, a142
    v_accvgpr_read_b32 v25, a143
    v_mul_f32 v22, v22, v14
    v_mul_f32 v23, v23, v14
    v_mul_f32 v24, v24, v14
    v_mul_f32 v25, v25, v14
    v_cvt_pk_bf16_f32 v26, v22, v23
    v_cvt_pk_bf16_f32 v27, v24, v25
    v_xor_b32 v10, 96, v20
    v_add_u32 v10, v10, v7
    ds_write_b64 v10, v[26:27] offset:0
    v_accvgpr_read_b32 v22, a144
    v_accvgpr_read_b32 v23, a145
    v_accvgpr_read_b32 v24, a146
    v_accvgpr_read_b32 v25, a147
    v_mul_f32 v22, v22, v14
    v_mul_f32 v23, v23, v14
    v_mul_f32 v24, v24, v14
    v_mul_f32 v25, v25, v14
    v_cvt_pk_bf16_f32 v26, v22, v23
    v_cvt_pk_bf16_f32 v27, v24, v25
    v_xor_b32 v10, 128, v20
    v_add_u32 v10, v10, v7
    ds_write_b64 v10, v[26:27] offset:0
    v_accvgpr_read_b32 v22, a148
    v_accvgpr_read_b32 v23, a149
    v_accvgpr_read_b32 v24, a150
    v_accvgpr_read_b32 v25, a151
    v_mul_f32 v22, v22, v14
    v_mul_f32 v23, v23, v14
    v_mul_f32 v24, v24, v14
    v_mul_f32 v25, v25, v14
    v_cvt_pk_bf16_f32 v26, v22, v23
    v_cvt_pk_bf16_f32 v27, v24, v25
    v_xor_b32 v10, 160, v20
    v_add_u32 v10, v10, v7
    ds_write_b64 v10, v[26:27] offset:0
    v_accvgpr_read_b32 v22, a152
    v_accvgpr_read_b32 v23, a153
    v_accvgpr_read_b32 v24, a154
    v_accvgpr_read_b32 v25, a155
    v_mul_f32 v22, v22, v14
    v_mul_f32 v23, v23, v14
    v_mul_f32 v24, v24, v14
    v_mul_f32 v25, v25, v14
    v_cvt_pk_bf16_f32 v26, v22, v23
    v_cvt_pk_bf16_f32 v27, v24, v25
    v_xor_b32 v10, 192, v20
    v_add_u32 v10, v10, v7
    ds_write_b64 v10, v[26:27] offset:0
    v_accvgpr_read_b32 v22, a156
    v_accvgpr_read_b32 v23, a157
    v_accvgpr_read_b32 v24, a158
    v_accvgpr_read_b32 v25, a159
    v_mul_f32 v22, v22, v14
    v_mul_f32 v23, v23, v14
    v_mul_f32 v24, v24, v14
    v_mul_f32 v25, v25, v14
    v_cvt_pk_bf16_f32 v26, v22, v23
    v_cvt_pk_bf16_f32 v27, v24, v25
    v_xor_b32 v10, 224, v20
    v_add_u32 v10, v10, v7
    ds_write_b64 v10, v[26:27] offset:0
    v_rcp_f32 v14, v208
    v_accvgpr_read_b32 v22, a160
    v_accvgpr_read_b32 v23, a161
    v_accvgpr_read_b32 v24, a162
    v_accvgpr_read_b32 v25, a163
    v_mul_f32 v22, v22, v14
    v_mul_f32 v23, v23, v14
    v_mul_f32 v24, v24, v14
    v_mul_f32 v25, v25, v14
    v_cvt_pk_bf16_f32 v26, v22, v23
    v_cvt_pk_bf16_f32 v27, v24, v25
    v_xor_b32 v10, 0, v20
    v_add_u32 v10, v10, v7
    ds_write_b64 v10, v[26:27] offset:16384
    v_accvgpr_read_b32 v22, a164
    v_accvgpr_read_b32 v23, a165
    v_accvgpr_read_b32 v24, a166
    v_accvgpr_read_b32 v25, a167
    v_mul_f32 v22, v22, v14
    v_mul_f32 v23, v23, v14
    v_mul_f32 v24, v24, v14
    v_mul_f32 v25, v25, v14
    v_cvt_pk_bf16_f32 v26, v22, v23
    v_cvt_pk_bf16_f32 v27, v24, v25
    v_xor_b32 v10, 32, v20
    v_add_u32 v10, v10, v7
    ds_write_b64 v10, v[26:27] offset:16384
    v_accvgpr_read_b32 v22, a168
    v_accvgpr_read_b32 v23, a169
    v_accvgpr_read_b32 v24, a170
    v_accvgpr_read_b32 v25, a171
    v_mul_f32 v22, v22, v14
    v_mul_f32 v23, v23, v14
    v_mul_f32 v24, v24, v14
    v_mul_f32 v25, v25, v14
    v_cvt_pk_bf16_f32 v26, v22, v23
    v_cvt_pk_bf16_f32 v27, v24, v25
    v_xor_b32 v10, 64, v20
    v_add_u32 v10, v10, v7
    ds_write_b64 v10, v[26:27] offset:16384
    v_accvgpr_read_b32 v22, a172
    v_accvgpr_read_b32 v23, a173
    v_accvgpr_read_b32 v24, a174
    v_accvgpr_read_b32 v25, a175
    v_mul_f32 v22, v22, v14
    v_mul_f32 v23, v23, v14
    v_mul_f32 v24, v24, v14
    v_mul_f32 v25, v25, v14
    v_cvt_pk_bf16_f32 v26, v22, v23
    v_cvt_pk_bf16_f32 v27, v24, v25
    v_xor_b32 v10, 96, v20
    v_add_u32 v10, v10, v7
    ds_write_b64 v10, v[26:27] offset:16384
    v_accvgpr_read_b32 v22, a176
    v_accvgpr_read_b32 v23, a177
    v_accvgpr_read_b32 v24, a178
    v_accvgpr_read_b32 v25, a179
    v_mul_f32 v22, v22, v14
    v_mul_f32 v23, v23, v14
    v_mul_f32 v24, v24, v14
    v_mul_f32 v25, v25, v14
    v_cvt_pk_bf16_f32 v26, v22, v23
    v_cvt_pk_bf16_f32 v27, v24, v25
    v_xor_b32 v10, 128, v20
    v_add_u32 v10, v10, v7
    ds_write_b64 v10, v[26:27] offset:16384
    v_accvgpr_read_b32 v22, a180
    v_accvgpr_read_b32 v23, a181
    v_accvgpr_read_b32 v24, a182
    v_accvgpr_read_b32 v25, a183
    v_mul_f32 v22, v22, v14
    v_mul_f32 v23, v23, v14
    v_mul_f32 v24, v24, v14
    v_mul_f32 v25, v25, v14
    v_cvt_pk_bf16_f32 v26, v22, v23
    v_cvt_pk_bf16_f32 v27, v24, v25
    v_xor_b32 v10, 160, v20
    v_add_u32 v10, v10, v7
    ds_write_b64 v10, v[26:27] offset:16384
    v_accvgpr_read_b32 v22, a184
    v_accvgpr_read_b32 v23, a185
    v_accvgpr_read_b32 v24, a186
    v_accvgpr_read_b32 v25, a187
    v_mul_f32 v22, v22, v14
    v_mul_f32 v23, v23, v14
    v_mul_f32 v24, v24, v14
    v_mul_f32 v25, v25, v14
    v_cvt_pk_bf16_f32 v26, v22, v23
    v_cvt_pk_bf16_f32 v27, v24, v25
    v_xor_b32 v10, 192, v20
    v_add_u32 v10, v10, v7
    ds_write_b64 v10, v[26:27] offset:16384
    v_accvgpr_read_b32 v22, a188
    v_accvgpr_read_b32 v23, a189
    v_accvgpr_read_b32 v24, a190
    v_accvgpr_read_b32 v25, a191
    v_mul_f32 v22, v22, v14
    v_mul_f32 v23, v23, v14
    v_mul_f32 v24, v24, v14
    v_mul_f32 v25, v25, v14
    v_cvt_pk_bf16_f32 v26, v22, v23
    v_cvt_pk_bf16_f32 v27, v24, v25
    v_xor_b32 v10, 224, v20
    v_add_u32 v10, v10, v7
    s_waitcnt lgkmcnt(14)
    ds_write_b64 v10, v[26:27] offset:16384
    s_waitcnt lgkmcnt(0)
    s_barrier
    v_accvgpr_write_b32 a192, 0
    v_accvgpr_write_b32 a193, 0
    v_accvgpr_write_b32 a194, 0
    v_accvgpr_write_b32 a195, 0
    v_accvgpr_write_b32 a196, 0
    v_accvgpr_write_b32 a197, 0
    v_accvgpr_write_b32 a198, 0
    v_accvgpr_write_b32 a199, 0
    v_accvgpr_write_b32 a200, 0
    v_accvgpr_write_b32 a201, 0
    v_accvgpr_write_b32 a202, 0
    v_accvgpr_write_b32 a203, 0
    v_accvgpr_write_b32 a204, 0
    v_accvgpr_write_b32 a205, 0
    v_accvgpr_write_b32 a206, 0
    v_accvgpr_write_b32 a207, 0
    v_xor_b32 v28, 0, v21
    v_add_u32 v28, v28, v8
    v_xor_b32 v29, 64, v21
    v_add_u32 v29, v29, v8
    v_xor_b32 v30, 128, v21
    v_add_u32 v30, v30, v8
    v_xor_b32 v31, 192, v21
    v_add_u32 v31, v31, v8
    ds_read_b128 v[212:215], v28 offset:0
    ds_read_b128 v[216:219], v28 offset:16384
    ds_read_b128 v[220:223], v29 offset:0
    ds_read_b128 v[224:227], v29 offset:16384
    ds_read_b128 v[228:231], v30 offset:0
    ds_read_b128 v[232:235], v30 offset:16384
    s_waitcnt lgkmcnt(5)
    v_mfma_f32_16x16x32_bf16 a[192:195], a[0:3], v[212:215], a[192:195]
    v_mfma_f32_16x16x32_bf16 a[196:199], a[64:67], v[212:215], a[196:199]
    ds_read_b128 v[236:239], v31 offset:0
    s_waitcnt lgkmcnt(5)
    v_mfma_f32_16x16x32_bf16 a[200:203], a[0:3], v[216:219], a[200:203]
    v_mfma_f32_16x16x32_bf16 a[204:207], a[64:67], v[216:219], a[204:207]
    ds_read_b128 v[240:243], v31 offset:16384
    s_waitcnt lgkmcnt(5)
    v_mfma_f32_16x16x32_bf16 a[192:195], a[4:7], v[220:223], a[192:195]
    v_mfma_f32_16x16x32_bf16 a[196:199], a[68:71], v[220:223], a[196:199]
    ds_read_b128 v[212:215], v28 offset:256
    s_waitcnt lgkmcnt(5)
    v_mfma_f32_16x16x32_bf16 a[200:203], a[4:7], v[224:227], a[200:203]
    v_mfma_f32_16x16x32_bf16 a[204:207], a[68:71], v[224:227], a[204:207]
    ds_read_b128 v[216:219], v28 offset:16640
    s_waitcnt lgkmcnt(5)
    v_mfma_f32_16x16x32_bf16 a[192:195], a[8:11], v[228:231], a[192:195]
    v_mfma_f32_16x16x32_bf16 a[196:199], a[72:75], v[228:231], a[196:199]
    ds_read_b128 v[220:223], v29 offset:256
    s_waitcnt lgkmcnt(5)
    v_mfma_f32_16x16x32_bf16 a[200:203], a[8:11], v[232:235], a[200:203]
    v_mfma_f32_16x16x32_bf16 a[204:207], a[72:75], v[232:235], a[204:207]
    ds_read_b128 v[224:227], v29 offset:16640
    s_waitcnt lgkmcnt(5)
    v_mfma_f32_16x16x32_bf16 a[192:195], a[12:15], v[236:239], a[192:195]
    v_mfma_f32_16x16x32_bf16 a[196:199], a[76:79], v[236:239], a[196:199]
    ds_read_b128 v[228:231], v30 offset:256
    s_waitcnt lgkmcnt(5)
    v_mfma_f32_16x16x32_bf16 a[200:203], a[12:15], v[240:243], a[200:203]
    v_mfma_f32_16x16x32_bf16 a[204:207], a[76:79], v[240:243], a[204:207]
    ds_read_b128 v[232:235], v30 offset:16640
    s_waitcnt lgkmcnt(5)
    v_mfma_f32_16x16x32_bf16 a[192:195], a[16:19], v[212:215], a[192:195]
    v_mfma_f32_16x16x32_bf16 a[196:199], a[80:83], v[212:215], a[196:199]
    ds_read_b128 v[236:239], v31 offset:256
    s_waitcnt lgkmcnt(5)
    v_mfma_f32_16x16x32_bf16 a[200:203], a[16:19], v[216:219], a[200:203]
    v_mfma_f32_16x16x32_bf16 a[204:207], a[80:83], v[216:219], a[204:207]
    ds_read_b128 v[240:243], v31 offset:16640
    s_waitcnt lgkmcnt(5)
    v_mfma_f32_16x16x32_bf16 a[192:195], a[20:23], v[220:223], a[192:195]
    v_mfma_f32_16x16x32_bf16 a[196:199], a[84:87], v[220:223], a[196:199]
    ds_read_b128 v[212:215], v28 offset:512
    s_waitcnt lgkmcnt(5)
    v_mfma_f32_16x16x32_bf16 a[200:203], a[20:23], v[224:227], a[200:203]
    v_mfma_f32_16x16x32_bf16 a[204:207], a[84:87], v[224:227], a[204:207]
    ds_read_b128 v[216:219], v28 offset:16896
    s_waitcnt lgkmcnt(5)
    v_mfma_f32_16x16x32_bf16 a[192:195], a[24:27], v[228:231], a[192:195]
    v_mfma_f32_16x16x32_bf16 a[196:199], a[88:91], v[228:231], a[196:199]
    ds_read_b128 v[220:223], v29 offset:512
    s_waitcnt lgkmcnt(5)
    v_mfma_f32_16x16x32_bf16 a[200:203], a[24:27], v[232:235], a[200:203]
    v_mfma_f32_16x16x32_bf16 a[204:207], a[88:91], v[232:235], a[204:207]
    ds_read_b128 v[224:227], v29 offset:16896
    s_waitcnt lgkmcnt(5)
    v_mfma_f32_16x16x32_bf16 a[192:195], a[28:31], v[236:239], a[192:195]
    v_mfma_f32_16x16x32_bf16 a[196:199], a[92:95], v[236:239], a[196:199]
    ds_read_b128 v[228:231], v30 offset:512
    s_waitcnt lgkmcnt(5)
    v_mfma_f32_16x16x32_bf16 a[200:203], a[28:31], v[240:243], a[200:203]
    v_mfma_f32_16x16x32_bf16 a[204:207], a[92:95], v[240:243], a[204:207]
    ds_read_b128 v[232:235], v30 offset:16896
    s_waitcnt lgkmcnt(5)
    v_mfma_f32_16x16x32_bf16 a[192:195], a[32:35], v[212:215], a[192:195]
    v_mfma_f32_16x16x32_bf16 a[196:199], a[96:99], v[212:215], a[196:199]
    ds_read_b128 v[236:239], v31 offset:512
    s_waitcnt lgkmcnt(5)
    v_mfma_f32_16x16x32_bf16 a[200:203], a[32:35], v[216:219], a[200:203]
    v_mfma_f32_16x16x32_bf16 a[204:207], a[96:99], v[216:219], a[204:207]
    ds_read_b128 v[240:243], v31 offset:16896
    s_waitcnt lgkmcnt(5)
    v_mfma_f32_16x16x32_bf16 a[192:195], a[36:39], v[220:223], a[192:195]
    v_mfma_f32_16x16x32_bf16 a[196:199], a[100:103], v[220:223], a[196:199]
    ds_read_b128 v[212:215], v28 offset:768
    s_waitcnt lgkmcnt(5)
    v_mfma_f32_16x16x32_bf16 a[200:203], a[36:39], v[224:227], a[200:203]
    v_mfma_f32_16x16x32_bf16 a[204:207], a[100:103], v[224:227], a[204:207]
    ds_read_b128 v[216:219], v28 offset:17152
    s_waitcnt lgkmcnt(5)
    v_mfma_f32_16x16x32_bf16 a[192:195], a[40:43], v[228:231], a[192:195]
    v_mfma_f32_16x16x32_bf16 a[196:199], a[104:107], v[228:231], a[196:199]
    ds_read_b128 v[220:223], v29 offset:768
    s_waitcnt lgkmcnt(5)
    v_mfma_f32_16x16x32_bf16 a[200:203], a[40:43], v[232:235], a[200:203]
    v_mfma_f32_16x16x32_bf16 a[204:207], a[104:107], v[232:235], a[204:207]
    ds_read_b128 v[224:227], v29 offset:17152
    s_waitcnt lgkmcnt(5)
    v_mfma_f32_16x16x32_bf16 a[192:195], a[44:47], v[236:239], a[192:195]
    v_mfma_f32_16x16x32_bf16 a[196:199], a[108:111], v[236:239], a[196:199]
    ds_read_b128 v[228:231], v30 offset:768
    s_waitcnt lgkmcnt(5)
    v_mfma_f32_16x16x32_bf16 a[200:203], a[44:47], v[240:243], a[200:203]
    v_mfma_f32_16x16x32_bf16 a[204:207], a[108:111], v[240:243], a[204:207]
    ds_read_b128 v[232:235], v30 offset:17152
    s_waitcnt lgkmcnt(5)
    v_mfma_f32_16x16x32_bf16 a[192:195], a[48:51], v[212:215], a[192:195]
    v_mfma_f32_16x16x32_bf16 a[196:199], a[112:115], v[212:215], a[196:199]
    ds_read_b128 v[236:239], v31 offset:768
    s_waitcnt lgkmcnt(5)
    v_mfma_f32_16x16x32_bf16 a[200:203], a[48:51], v[216:219], a[200:203]
    v_mfma_f32_16x16x32_bf16 a[204:207], a[112:115], v[216:219], a[204:207]
    ds_read_b128 v[240:243], v31 offset:17152
    s_waitcnt lgkmcnt(5)
    v_mfma_f32_16x16x32_bf16 a[192:195], a[52:55], v[220:223], a[192:195]
    v_mfma_f32_16x16x32_bf16 a[196:199], a[116:119], v[220:223], a[196:199]
    s_waitcnt lgkmcnt(4)
    v_mfma_f32_16x16x32_bf16 a[200:203], a[52:55], v[224:227], a[200:203]
    v_mfma_f32_16x16x32_bf16 a[204:207], a[116:119], v[224:227], a[204:207]
    s_waitcnt lgkmcnt(3)
    v_mfma_f32_16x16x32_bf16 a[192:195], a[56:59], v[228:231], a[192:195]
    v_mfma_f32_16x16x32_bf16 a[196:199], a[120:123], v[228:231], a[196:199]
    s_waitcnt lgkmcnt(2)
    v_mfma_f32_16x16x32_bf16 a[200:203], a[56:59], v[232:235], a[200:203]
    v_mfma_f32_16x16x32_bf16 a[204:207], a[120:123], v[232:235], a[204:207]
    s_waitcnt lgkmcnt(1)
    v_mfma_f32_16x16x32_bf16 a[192:195], a[60:63], v[236:239], a[192:195]
    v_mfma_f32_16x16x32_bf16 a[196:199], a[124:127], v[236:239], a[196:199]
    s_waitcnt lgkmcnt(0)
    v_mfma_f32_16x16x32_bf16 a[200:203], a[60:63], v[240:243], a[200:203]
    v_mfma_f32_16x16x32_bf16 a[204:207], a[124:127], v[240:243], a[204:207]
    s_lshl_b32 s40, s38, 2
    s_add_u32 s40, s40, s37
    s_lshl_b32 s40, s40, 3
    s_add_u32 s40, s40, s36
    s_lshl_b32 s40, s40, 14
    s_add_u32 s40, s40, 92274688
    s_add_u32 s41, s40, 8192
    v_accvgpr_read_b32 v22, a192
    v_accvgpr_read_b32 v23, a193
    v_accvgpr_read_b32 v24, a194
    v_accvgpr_read_b32 v25, a195
    buffer_store_dwordx4 v[22:25], v9, s[4:7], s40 offen offset:0 sc1
    v_accvgpr_read_b32 v26, a196
    v_accvgpr_read_b32 v27, a197
    v_accvgpr_read_b32 v28, a198
    v_accvgpr_read_b32 v29, a199
    buffer_store_dwordx4 v[26:29], v9, s[4:7], s40 offen offset:64 sc1
    v_accvgpr_read_b32 v22, a200
    v_accvgpr_read_b32 v23, a201
    v_accvgpr_read_b32 v24, a202
    v_accvgpr_read_b32 v25, a203
    buffer_store_dwordx4 v[22:25], v9, s[4:7], s41 offen offset:0 sc1
    v_accvgpr_read_b32 v26, a204
    v_accvgpr_read_b32 v27, a205
    v_accvgpr_read_b32 v28, a206
    v_accvgpr_read_b32 v29, a207
    buffer_store_dwordx4 v[26:29], v9, s[4:7], s41 offen offset:64 sc1
    s_cmp_eq_u32 s38, s96
    s_cbranch_scc1 L_ao_nosig
    s_lshl_b32 s83, s38, 2
    s_add_u32 s83, s83, s37
    s_lshl_b32 s83, s83, 7
    s_add_u32 s85, s83, 91234304
    s_waitcnt vmcnt(0)
    s_barrier
    s_cmp_lg_u32 s27, 0
    s_cbranch_scc1 L_sgr_s
    s_cmp_lg_u32 s93, 0
    s_cbranch_scc1 L_sgr_i
    s_mov_b32 s82, 0
L_sgr_ip:
    buffer_load_dword v31, off, s[12:15], 0 offset:128 sc1
    s_add_u32 s82, s82, 1
    s_cmp_gt_u32 s82, 0x200000
    s_cbranch_scc1 L_wbail
    s_waitcnt vmcnt(0)
    v_cmp_eq_u32 vcc, 0, v31
    s_cbranch_vccnz L_sgr_ip
    s_mov_b32 s93, 1
L_sgr_i:
    v_mov_b32 v31, 1
    s_mov_b64 exec, 1
    buffer_atomic_add v31, off, s[4:7], s85
    s_mov_b64 exec, -1
L_sgr_s:
L_ao_nosig:
    s_add_u32 s38, s38, 6
L_ao_red:
    s_add_u32 s83, s87, 6
    s_cmp_ge_u32 s83, s38
    s_cbranch_scc1 L_ao_rdone
    s_lshl_b32 s83, s87, 2
    s_add_u32 s83, s83, s37
    s_lshl_b32 s83, s83, 7
    s_add_u32 s83, s83, 91234304
    s_lshr_b32 s84, s87, 3
    s_lshl_b32 s84, s84, 7
    s_add_u32 s84, s84, 91229184
    v_and_b32 v28, 1, v1
    v_cmp_eq_u32 vcc, 0, v28
    v_mov_b32 v30, s84
    v_mov_b32 v29, s83
    v_cndmask_b32 v30, v30, v29, vcc
    v_mov_b32 v29, 8
    v_mov_b32 v28, 8
    v_cndmask_b32 v29, v29, v28, vcc
    buffer_load_dword v31, v30, s[4:7], 0 offen sc1
    s_waitcnt vmcnt(0)
    v_cmp_gt_u32 vcc, v29, v31
    s_cbranch_vccnz L_ao_rdone
    s_lshl_b32 s83, s87, 2
    s_add_u32 s83, s83, s37
    s_lshl_b32 s83, s83, 17
    s_add_u32 s83, s83, 92274688
    s_lshl_b32 s40, s36, 2
    s_add_u32 s40, s40, s27
    s_lshl_b32 s41, s40, 9
    s_add_u32 s83, s83, s41
    v_lshlrev_b32 v10, 3, v1
    s_add_u32 s41, s83, 0
    buffer_load_dwordx2 v[32:33], v10, s[4:7], s41 offen sc1
    s_add_u32 s41, s83, 16384
    buffer_load_dwordx2 v[34:35], v10, s[4:7], s41 offen sc1
    s_add_u32 s41, s83, 32768
    buffer_load_dwordx2 v[36:37], v10, s[4:7], s41 offen sc1
    s_add_u32 s41, s83, 49152
    buffer_load_dwordx2 v[38:39], v10, s[4:7], s41 offen sc1
    s_add_u32 s41, s83, 65536
    buffer_load_dwordx2 v[40:41], v10, s[4:7], s41 offen sc1
    s_add_u32 s41, s83, 81920
    buffer_load_dwordx2 v[42:43], v10, s[4:7], s41 offen sc1
    s_add_u32 s41, s83, 98304
    buffer_load_dwordx2 v[44:45], v10, s[4:7], s41 offen sc1
    s_add_u32 s41, s83, 114688
    buffer_load_dwordx2 v[46:47], v10, s[4:7], s41 offen sc1
    s_lshl_b32 s41, s87, 5
    s_add_u32 s40, s40, s41
    s_lshl_b32 s41, s40, 11
    s_lshl_b32 s42, s37, 9
    s_add_u32 s41, s41, s42
    s_add_u32 s41, s41, 134217728
    buffer_load_dwordx2 v[48:49], v10, s[4:7], s41 offen sc1
    s_add_u32 s41, s41, 4194304
    buffer_load_dwordx2 v[50:51], v10, s[4:7], s41 offen sc1
    s_add_u32 s41, s41, 4194304
    buffer_load_dwordx2 v[52:53], v10, s[4:7], s41 offen sc1
    s_add_u32 s41, s41, 4194304
    buffer_load_dwordx2 v[54:55], v10, s[4:7], s41 offen sc1
    v_lshlrev_b32 v11, 2, v1
    s_lshl_b32 s41, s40, 10
    s_lshl_b32 s42, s37, 8
    s_add_u32 s41, s41, s42
    buffer_load_dword v56, v11, s[56:59], s41 offen
    buffer_load_dword v57, v11, s[60:63], s42 offen
    s_waitcnt vmcnt(12)
    v_pk_add_f32 v[32:33], v[32:33], v[34:35]
    s_waitcnt vmcnt(11)
    v_pk_add_f32 v[32:33], v[32:33], v[36:37]
    s_waitcnt vmcnt(10)
    v_pk_add_f32 v[32:33], v[32:33], v[38:39]
    s_waitcnt vmcnt(9)
    v_pk_add_f32 v[32:33], v[32:33], v[40:41]
    s_waitcnt vmcnt(8)
    v_pk_add_f32 v[32:33], v[32:33], v[42:43]
    s_waitcnt vmcnt(7)
    v_pk_add_f32 v[32:33], v[32:33], v[44:45]
    s_waitcnt vmcnt(6)
    v_pk_add_f32 v[32:33], v[32:33], v[46:47]
    s_waitcnt vmcnt(5)
    v_pk_add_f32 v[32:33], v[32:33], v[48:49]
    s_waitcnt vmcnt(4)
    v_pk_add_f32 v[32:33], v[32:33], v[50:51]
    s_waitcnt vmcnt(3)
    v_pk_add_f32 v[32:33], v[32:33], v[52:53]
    s_waitcnt vmcnt(2)
    v_pk_add_f32 v[32:33], v[32:33], v[54:55]
    s_waitcnt vmcnt(1)
    v_lshlrev_b32 v58, 16, v56
    v_and_b32 v59, 0xffff0000, v56
    v_pk_add_f32 v[32:33], v[32:33], v[58:59]
    s_waitcnt vmcnt(0)
    v_lshlrev_b32 v58, 16, v57
    v_and_b32 v59, 0xffff0000, v57
    v_pk_add_f32 v[32:33], v[32:33], v[58:59]
    v_cvt_pk_bf16_f32 v32, v32, v33
    buffer_store_dword v32, v11, s[64:67], s41 offen
    s_add_u32 s87, s87, 6
    s_branch L_ao_red
L_ao_rdone:
    s_cmp_lt_u32 s38, 64
    s_cbranch_scc1 L_ao_loop
L_ao_fin:
    s_cmp_ge_u32 s87, s96
    s_cbranch_scc1 L_ao_lastred
    s_lshl_b32 s83, s87, 2
    s_add_u32 s83, s83, s37
    s_lshl_b32 s83, s83, 7
    s_add_u32 s83, s83, 91234304
    s_lshr_b32 s84, s87, 3
    s_lshl_b32 s84, s84, 7
    s_add_u32 s84, s84, 91229184
    v_and_b32 v28, 1, v1
    v_cmp_eq_u32 vcc, 0, v28
    v_mov_b32 v30, s84
    v_mov_b32 v29, s83
    v_cndmask_b32 v30, v30, v29, vcc
    v_mov_b32 v29, 8
    v_mov_b32 v28, 8
    v_cndmask_b32 v29, v29, v28, vcc
    s_mov_b32 s82, 0
L_rwb:
    buffer_load_dword v31, v30, s[4:7], 0 offen sc1
    s_add_u32 s82, s82, 1
    s_cmp_gt_u32 s82, 0x400000
    s_cbranch_scc1 L_wbail
    s_waitcnt vmcnt(0)
    v_cmp_gt_u32 vcc, v29, v31
    s_cbranch_vccnz L_rwb
    s_lshl_b32 s83, s87, 2
    s_add_u32 s83, s83, s37
    s_lshl_b32 s83, s83, 17
    s_add_u32 s83, s83, 92274688
    s_lshl_b32 s40, s36, 2
    s_add_u32 s40, s40, s27
    s_lshl_b32 s41, s40, 9
    s_add_u32 s83, s83, s41
    v_lshlrev_b32 v10, 3, v1
    s_add_u32 s41, s83, 0
    buffer_load_dwordx2 v[32:33], v10, s[4:7], s41 offen sc1
    s_add_u32 s41, s83, 16384
    buffer_load_dwordx2 v[34:35], v10, s[4:7], s41 offen sc1
    s_add_u32 s41, s83, 32768
    buffer_load_dwordx2 v[36:37], v10, s[4:7], s41 offen sc1
    s_add_u32 s41, s83, 49152
    buffer_load_dwordx2 v[38:39], v10, s[4:7], s41 offen sc1
    s_add_u32 s41, s83, 65536
    buffer_load_dwordx2 v[40:41], v10, s[4:7], s41 offen sc1
    s_add_u32 s41, s83, 81920
    buffer_load_dwordx2 v[42:43], v10, s[4:7], s41 offen sc1
    s_add_u32 s41, s83, 98304
    buffer_load_dwordx2 v[44:45], v10, s[4:7], s41 offen sc1
    s_add_u32 s41, s83, 114688
    buffer_load_dwordx2 v[46:47], v10, s[4:7], s41 offen sc1
    s_lshl_b32 s41, s87, 5
    s_add_u32 s40, s40, s41
    s_lshl_b32 s41, s40, 11
    s_lshl_b32 s42, s37, 9
    s_add_u32 s41, s41, s42
    s_add_u32 s41, s41, 134217728
    buffer_load_dwordx2 v[48:49], v10, s[4:7], s41 offen sc1
    s_add_u32 s41, s41, 4194304
    buffer_load_dwordx2 v[50:51], v10, s[4:7], s41 offen sc1
    s_add_u32 s41, s41, 4194304
    buffer_load_dwordx2 v[52:53], v10, s[4:7], s41 offen sc1
    s_add_u32 s41, s41, 4194304
    buffer_load_dwordx2 v[54:55], v10, s[4:7], s41 offen sc1
    v_lshlrev_b32 v11, 2, v1
    s_lshl_b32 s41, s40, 10
    s_lshl_b32 s42, s37, 8
    s_add_u32 s41, s41, s42
    buffer_load_dword v56, v11, s[56:59], s41 offen
    buffer_load_dword v57, v11, s[60:63], s42 offen
    s_waitcnt vmcnt(12)
    v_pk_add_f32 v[32:33], v[32:33], v[34:35]
    s_waitcnt vmcnt(11)
    v_pk_add_f32 v[32:33], v[32:33], v[36:37]
    s_waitcnt vmcnt(10)
    v_pk_add_f32 v[32:33], v[32:33], v[38:39]
    s_waitcnt vmcnt(9)
    v_pk_add_f32 v[32:33], v[32:33], v[40:41]
    s_waitcnt vmcnt(8)
    v_pk_add_f32 v[32:33], v[32:33], v[42:43]
    s_waitcnt vmcnt(7)
    v_pk_add_f32 v[32:33], v[32:33], v[44:45]
    s_waitcnt vmcnt(6)
    v_pk_add_f32 v[32:33], v[32:33], v[46:47]
    s_waitcnt vmcnt(5)
    v_pk_add_f32 v[32:33], v[32:33], v[48:49]
    s_waitcnt vmcnt(4)
    v_pk_add_f32 v[32:33], v[32:33], v[50:51]
    s_waitcnt vmcnt(3)
    v_pk_add_f32 v[32:33], v[32:33], v[52:53]
    s_waitcnt vmcnt(2)
    v_pk_add_f32 v[32:33], v[32:33], v[54:55]
    s_waitcnt vmcnt(1)
    v_lshlrev_b32 v58, 16, v56
    v_and_b32 v59, 0xffff0000, v56
    v_pk_add_f32 v[32:33], v[32:33], v[58:59]
    s_waitcnt vmcnt(0)
    v_lshlrev_b32 v58, 16, v57
    v_and_b32 v59, 0xffff0000, v57
    v_pk_add_f32 v[32:33], v[32:33], v[58:59]
    v_cvt_pk_bf16_f32 v32, v32, v33
    buffer_store_dword v32, v11, s[64:67], s41 offen
    s_add_u32 s87, s87, 6
    s_branch L_ao_fin
L_ao_lastred:
    s_lshl_b32 s83, s87, 2
    s_add_u32 s83, s83, s37
    s_lshl_b32 s83, s83, 7
    s_add_u32 s83, s83, 91234304
    s_lshr_b32 s84, s87, 3
    s_lshl_b32 s84, s84, 7
    s_add_u32 s84, s84, 91229184
    v_and_b32 v28, 1, v1
    v_cmp_eq_u32 vcc, 0, v28
    v_mov_b32 v30, s84
    v_mov_b32 v29, s83
    v_cndmask_b32 v30, v30, v29, vcc
    v_mov_b32 v29, 8
    v_mov_b32 v28, 8
    v_cndmask_b32 v29, v29, v28, vcc
    v_mov_b32 v28, 0
    v_and_b32 v27, 1, v1
    v_cmp_eq_u32 vcc, 0, v27
    s_nop 1
    v_cndmask_b32 v29, v29, v28, vcc
    s_mov_b32 s82, 0
L_rwc:
    buffer_load_dword v31, v30, s[4:7], 0 offen sc1
    s_add_u32 s82, s82, 1
    s_cmp_gt_u32 s82, 0x400000
    s_cbranch_scc1 L_wbail
    s_waitcnt vmcnt(0)
    v_cmp_gt_u32 vcc, v29, v31
    s_cbranch_vccnz L_rwc
    s_lshl_b32 s83, s87, 2
    s_add_u32 s83, s83, s37
    s_lshl_b32 s83, s83, 17
    s_add_u32 s83, s83, 92274688
    s_lshl_b32 s40, s36, 2
    s_add_u32 s40, s40, s27
    s_lshl_b32 s41, s40, 9
    s_add_u32 s83, s83, s41
    v_lshlrev_b32 v10, 3, v1
    s_mov_b32 s82, 0
L_rdc:
    s_add_u32 s41, s83, 0
    buffer_load_dwordx2 v[32:33], v10, s[4:7], s41 offen sc1
    s_add_u32 s41, s83, 16384
    buffer_load_dwordx2 v[34:35], v10, s[4:7], s41 offen sc1
    s_add_u32 s41, s83, 32768
    buffer_load_dwordx2 v[36:37], v10, s[4:7], s41 offen sc1
    s_add_u32 s41, s83, 49152
    buffer_load_dwordx2 v[38:39], v10, s[4:7], s41 offen sc1
    s_add_u32 s41, s83, 65536
    buffer_load_dwordx2 v[40:41], v10, s[4:7], s41 offen sc1
    s_add_u32 s41, s83, 81920
    buffer_load_dwordx2 v[42:43], v10, s[4:7], s41 offen sc1
    s_add_u32 s41, s83, 98304
    buffer_load_dwordx2 v[44:45], v10, s[4:7], s41 offen sc1
    s_add_u32 s41, s83, 114688
    buffer_load_dwordx2 v[46:47], v10, s[4:7], s41 offen sc1
    s_add_u32 s82, s82, 1
    s_cmp_gt_u32 s82, 0x400000
    s_cbranch_scc1 L_wbail
    s_waitcnt vmcnt(0)
    v_max3_u32 v11, v32, v33, v34
    v_max3_u32 v11, v11, v35, v36
    v_max3_u32 v11, v11, v37, v38
    v_max3_u32 v11, v11, v39, v40
    v_max3_u32 v11, v11, v41, v42
    v_max3_u32 v11, v11, v43, v44
    v_max3_u32 v11, v11, v45, v46
    v_max_u32 v11, v11, v47
    v_cmp_eq_u32 vcc, -1, v11
    s_cbranch_vccnz L_rdc
    s_lshl_b32 s41, s87, 5
    s_add_u32 s40, s40, s41
    s_lshl_b32 s41, s40, 11
    s_lshl_b32 s42, s37, 9
    s_add_u32 s41, s41, s42
    s_add_u32 s41, s41, 134217728
    buffer_load_dwordx2 v[48:49], v10, s[4:7], s41 offen sc1
    s_add_u32 s41, s41, 4194304
    buffer_load_dwordx2 v[50:51], v10, s[4:7], s41 offen sc1
    s_add_u32 s41, s41, 4194304
    buffer_load_dwordx2 v[52:53], v10, s[4:7], s41 offen sc1
    s_add_u32 s41, s41, 4194304
    buffer_load_dwordx2 v[54:55], v10, s[4:7], s41 offen sc1
    v_lshlrev_b32 v11, 2, v1
    s_lshl_b32 s41, s40, 10
    s_lshl_b32 s42, s37, 8
    s_add_u32 s41, s41, s42
    buffer_load_dword v56, v11, s[56:59], s41 offen
    buffer_load_dword v57, v11, s[60:63], s42 offen
    v_pk_add_f32 v[32:33], v[32:33], v[34:35]
    v_pk_add_f32 v[32:33], v[32:33], v[36:37]
    v_pk_add_f32 v[32:33], v[32:33], v[38:39]
    v_pk_add_f32 v[32:33], v[32:33], v[40:41]
    v_pk_add_f32 v[32:33], v[32:33], v[42:43]
    v_pk_add_f32 v[32:33], v[32:33], v[44:45]
    v_pk_add_f32 v[32:33], v[32:33], v[46:47]
    s_waitcnt vmcnt(5)
    v_pk_add_f32 v[32:33], v[32:33], v[48:49]
    s_waitcnt vmcnt(4)
    v_pk_add_f32 v[32:33], v[32:33], v[50:51]
    s_waitcnt vmcnt(3)
    v_pk_add_f32 v[32:33], v[32:33], v[52:53]
    s_waitcnt vmcnt(2)
    v_pk_add_f32 v[32:33], v[32:33], v[54:55]
    s_waitcnt vmcnt(1)
    v_lshlrev_b32 v58, 16, v56
    v_and_b32 v59, 0xffff0000, v56
    v_pk_add_f32 v[32:33], v[32:33], v[58:59]
    s_waitcnt vmcnt(0)
    v_lshlrev_b32 v58, 16, v57
    v_and_b32 v59, 0xffff0000, v57
    v_pk_add_f32 v[32:33], v[32:33], v[58:59]
    v_cvt_pk_bf16_f32 v32, v32, v33
    buffer_store_dword v32, v11, s[64:67], s41 offen
L_ao_end:
    s_waitcnt vmcnt(0)
    s_endpgm
L_wbail:
    s_mov_b64 exec, 1
    v_mov_b32 v31, 0xbeef
    buffer_store_dword v31, off, s[12:15], 0 offset:56
    s_waitcnt vmcnt(0)
    s_endpgm
.section .rodata,"a"
.p2align 6
.amdhsa_kernel parallel_sum__memory_aug_recurrent_mem_tr__mixer_channel_mlp__prompt_kernel
  .amdhsa_next_free_vgpr 512
  .amdhsa_next_free_sgpr 102
  .amdhsa_accum_offset 256
  .amdhsa_group_segment_fixed_size 0
  .amdhsa_kernarg_size 120
  .amdhsa_user_sgpr_count 2
  .amdhsa_user_sgpr_kernarg_segment_ptr 1
  .amdhsa_system_sgpr_workgroup_id_x 1
.end_amdhsa_kernel
```
